```python
import torch

def _softmax(x, axis=-1):
    return torch.softmax(x, dim=axis)

def _gelu(x):
    return torch.nn.functional.gelu(x, approximate='tanh')

def _silu(x):
    return torch.nn.functional.silu(x)

def _sigmoid(x):
    return torch.sigmoid(x)

def _layernorm(x, axis=-1, eps=1e-05):
    m = x.mean(dim=axis, keepdim=True)
    v = x.var(dim=axis, keepdim=True, unbiased=False)
    return (x - m) / torch.sqrt(v + eps)

def _scatter_add(tgt, idx, src, axis=0):
    return tgt.clone().index_add_(axis, idx, src)

def _segment_sum(src, seg, n):
    out = torch.zeros((n,) + src.shape[1:], dtype=src.dtype)
    return out.index_add_(0, seg, src)

def _pad(x, pw):
    flat = tuple((v for pair in reversed(pw) for v in pair))
    return torch.nn.functional.pad(x, flat)
kernel_name = 'adaLN_cond__sliding_block_cached__mixer_gmlp__prompt'

def setup_inputs():

    _w = lambda a: (lambda t: t.to(torch.bfloat16) if t.is_floating_point() else t)(torch.as_tensor(a))

    def _A_setup():
        B, Sq, D = (1, 2048, 576)
        Hq, Hkv, Sk, Dh = (32, 16, 2048, 128)
        assert Hq % Hkv == 0, (Hq, Hkv)
        return {'x': _w((lambda *s: torch.randn(*s, dtype=torch.bfloat16) * 0.1)(B, Sq, D)), 'k_cache': _w((lambda *s: torch.randn(*s, dtype=torch.bfloat16) * 0.8)(B, Hkv, Sk, Dh)), 'v_cache': _w((lambda *s: torch.randn(*s, dtype=torch.bfloat16) * 1.6)(B, Hkv, Sk, Dh)), 'wq': _w((lambda *s: torch.randn(*s, dtype=torch.bfloat16) * 0.8)(D, Hq * Dh) * D ** (-0.5)), 'wo': _w((lambda *s: torch.randn(*s, dtype=torch.bfloat16) * 1.6)(Hq * Dh, D) * (Hq * Dh) ** (-0.5))}
    _A_in = _A_setup()

    def _B_setup():
        B, S, D, F = (1, 2048, 576, 4608)
        Fh = F // 2
        return {'x': _w((lambda *s: torch.randn(*s, dtype=torch.bfloat16) * 0.1)(B, S, D)), 'w_in': _w((lambda *s: torch.randn(*s, dtype=torch.bfloat16) * 1.6)(D, 2 * Fh)), 'w_sp': _w(0.01 * (lambda *s: torch.randn(*s, dtype=torch.bfloat16) * 1.6)(S, S)), 'b_sp': _w(1.0 + 0.01 * (lambda *s: torch.randn(*s, dtype=torch.bfloat16) * 0.2)(S)), 'w_out': _w((lambda *s: torch.randn(*s, dtype=torch.bfloat16) * 0.2)(Fh, D))}
    _B_in = _B_setup()
    return {'A_x': _A_in['x'], 'A_k_cache': _A_in['k_cache'], 'A_v_cache': _A_in['v_cache'], 'A_wq': _A_in['wq'], 'A_wo': _A_in['wo'], 'B_x': _B_in['x'], 'B_w_in': _B_in['w_in'], 'B_w_sp': _B_in['w_sp'], 'B_b_sp': _B_in['b_sp'], 'B_w_out': _B_in['w_out'], 'c': _w((lambda *s: torch.randn(*s, dtype=torch.bfloat16) * 0.8)(1, 576) * 8.0), 'w_mod': _w((lambda *s: torch.randn(*s, dtype=torch.bfloat16) * 0.8)(576, 6 * 576) * 576 ** (-0.5) * 8.0)}

def reference(A_x, A_k_cache, A_v_cache, A_wq, A_wo, B_x, B_w_in, B_w_sp, B_b_sp, B_w_out, c, w_mod):

    def _A_ref(x, k_cache, v_cache, wq, wo):
        B, Sq, D = x.shape
        Hq, Dh = (32, 128)
        Hkv, Sk = (k_cache.shape[1], k_cache.shape[2])
        W = min(4096, max(256, Sk // 4))
        rep = Hq // Hkv
        q = (lambda x, *d: x.permute(*d))((x @ wq).reshape(B, Sq, Hq, Dh), 0, 2, 1, 3)
        k = (lambda x, n, axis: torch.repeat_interleave(x, n, dim=axis))(k_cache[:, :, Sk - W:, :], rep, axis=1)
        v = (lambda x, n, axis: torch.repeat_interleave(x, n, dim=axis))(v_cache[:, :, Sk - W:, :], rep, axis=1)
        scores = torch.einsum('bhqd,bhkd->bhqk', q, k) * Dh ** (-0.5)
        p = _softmax(scores, axis=-1)
        o = torch.einsum('bhqk,bhkd->bhqd', p, v)
        return (lambda x, *d: x.permute(*d))(o, 0, 2, 1, 3).reshape(B, Sq, Hq * Dh) @ wo

    def _B_ref(x, w_in, w_sp, b_sp, w_out):
        B, S, D = x.shape
        F = w_in.shape[-1]
        Fh = F // 2
        z = _gelu(torch.einsum('bsd,df->bsf', x, w_in))
        z1 = z[..., :Fh].clone()
        z2 = _layernorm(z[..., Fh:], axis=-1)
        g = torch.einsum('ts,bsf->btf', w_sp, z2) + b_sp[None, :, None]
        return torch.einsum('bsf,fd->bsd', z1 * g, w_out)
    x = A_x
    mod = (_silu(c) @ w_mod).reshape(c.shape[0], 6, 1, -1)
    sa, ca, ga, sb, cb, gb = (mod[:, 0].clone(), mod[:, 1].clone(), mod[:, 2].clone(), mod[:, 3].clone(), mod[:, 4].clone(), mod[:, 5].clone())
    h = _layernorm(x, axis=-1) * (1 + ca) + sa
    x = x + ga * _A_ref(h, A_k_cache, A_v_cache, A_wq, A_wo)
    h = _layernorm(x, axis=-1) * (1 + cb) + sb
    x = x + gb * _B_ref(h, B_w_in, B_w_sp, B_b_sp, B_w_out)
    return x
```

```asm
; @launch kernel=k1_kernel grid=(256,1,1) block=(512,1,1) lds=147456
; @launch kernel=k3_kernel grid=(512,1,1) block=(256,1,1) lds=75776
.amdgcn_target "amdgcn-amd-amdhsa--gfx950"
.text
  .p2align 8
  .globl k1_kernel
  .type k1_kernel,@function
k1_kernel:
  s_cmp_ge_u32 s2, 256
  s_cbranch_scc1 k1_end
  v_lshrrev_b32 v1, 6, v0
  s_nop 0
  v_readfirstlane_b32 s3, v1
  s_nop 3
  s_cmp_lt_u32 s3, 4
  s_cbranch_scc1 k0_a
  s_cmp_ge_u32 s2, 8
  s_cbranch_scc1 k0_done
  s_getpc_b64 s[96:97]
pc_10_v80:
  v_lshlrev_b32 v14, 7, v0
  v_add_u32 v14, k1_kernel-32768-pc_10_v80, v14
  v_min_u32 v14, k5_end-pc_10_v80, v14
  v_mov_b32 v15, 0
  v_lshl_add_u64 v[14:15], v[14:15], 0, s[96:97]
  global_load_dword v80, v[14:15], off
k0_a:
  s_cmp_ge_u32 s3, 4
  s_cbranch_scc1 k0_done
  s_cmp_ge_u32 s2, 236
  s_cbranch_scc1 k0_b3
  s_load_dwordx2 s[4:5], s[0:1], 0
  s_load_dwordx2 s[6:7], s[0:1], 80
  s_load_dwordx2 s[8:9], s[0:1], 88
  s_load_dwordx2 s[10:11], s[0:1], 112
  s_load_dwordx2 s[24:25], s[0:1], 104
  s_load_dwordx2 s[26:27], s[0:1], 24
  s_load_dwordx2 s[28:29], s[0:1], 8
  s_load_dwordx2 s[36:37], s[0:1], 16
  s_cmp_ge_u32 s2, 108
  s_cbranch_scc1 k0_ln
  s_lshl_b32 s30, s2, 6
  s_sub_u32 s31, 3981312, s30
  s_lshl_b32 s32, s2, 7
  s_waitcnt lgkmcnt(0)
  s_add_u32 s12, s8, 0
  s_addc_u32 s13, s9, 0
  s_add_u32 s12, s12, s30
  s_addc_u32 s13, s13, 0
  s_mov_b32 s14, s31
  s_mov_b32 s15, 0x20000
  s_add_u32 s16, s6, 0
  s_addc_u32 s17, s7, 0
  s_mov_b32 s18, 1152
  s_mov_b32 s19, 0x20000
  s_add_u32 s20, s10, 0
  s_addc_u32 s21, s11, 0
  s_add_u32 s20, s20, s32
  s_addc_u32 s21, s21, 0
  s_mov_b32 s22, 128
  s_mov_b32 s23, 0x20000
  v_lshrrev_b32 v3, 2, v0
  v_lshlrev_b32 v3, 1, v3
  buffer_load_ushort v60, v3, s[16:19], 0 offen offset:0
  buffer_load_ushort v61, v3, s[16:19], 0 offen offset:128
  buffer_load_ushort v62, v3, s[16:19], 0 offen offset:256
  buffer_load_ushort v63, v3, s[16:19], 0 offen offset:384
  buffer_load_ushort v64, v3, s[16:19], 0 offen offset:512
  buffer_load_ushort v65, v3, s[16:19], 0 offen offset:640
  buffer_load_ushort v66, v3, s[16:19], 0 offen offset:768
  buffer_load_ushort v67, v3, s[16:19], 0 offen offset:896
  buffer_load_ushort v68, v3, s[16:19], 0 offen offset:1024
  s_cmp_lt_u32 s2, 36
  s_cbranch_scc1 k0_nw
  s_waitcnt vmcnt(0)
  s_add_u32 s44, s24, 252
  s_addc_u32 s45, s25, 0
  s_mov_b32 s46, 4
  s_mov_b32 s47, 0x20000
  v_mov_b32 v5, 0
k0_gp:
  buffer_load_dword v4, v5, s[44:47], 0 offen sc1
  s_waitcnt vmcnt(0)
  v_readfirstlane_b32 s35, v4
  s_nop 3
  s_cmp_eq_u32 s35, 1
  s_cbranch_scc1 k0_nw
  s_sleep 8
  s_branch k0_gp
k0_nw:
  v_lshrrev_b32 v3, 2, v0
  v_mul_u32_u24 v4, 6912, v3
  v_and_b32 v5, 3, v0
  v_lshl_add_u32 v4, v5, 4, v4
  s_mov_b32 s40, 0
  buffer_load_dwordx4 v[20:23], v4, s[12:15], s40 offen
  s_mov_b32 s40, 442368
  buffer_load_dwordx4 v[24:27], v4, s[12:15], s40 offen
  s_mov_b32 s40, 884736
  buffer_load_dwordx4 v[28:31], v4, s[12:15], s40 offen
  s_mov_b32 s40, 1327104
  buffer_load_dwordx4 v[32:35], v4, s[12:15], s40 offen
  s_mov_b32 s40, 1769472
  buffer_load_dwordx4 v[36:39], v4, s[12:15], s40 offen
  s_mov_b32 s40, 2211840
  buffer_load_dwordx4 v[40:43], v4, s[12:15], s40 offen
  s_mov_b32 s40, 2654208
  buffer_load_dwordx4 v[44:47], v4, s[12:15], s40 offen
  s_mov_b32 s40, 3096576
  buffer_load_dwordx4 v[48:51], v4, s[12:15], s40 offen
  s_mov_b32 s40, 3538944
  buffer_load_dwordx4 v[52:55], v4, s[12:15], s40 offen
  s_waitcnt vmcnt(9)
  v_lshlrev_b32 v60, 16, v60
  v_mul_f32 v4, 0xbfb8aa3b, v60
  v_exp_f32 v4, v4
  s_nop 0
  v_add_f32 v4, 1.0, v4
  v_rcp_f32 v4, v4
  s_nop 0
  v_mul_f32 v60, v60, v4
  v_cvt_pk_bf16_f32 v60, v60, v60
  v_lshlrev_b32 v60, 16, v60
  v_lshlrev_b32 v61, 16, v61
  v_mul_f32 v4, 0xbfb8aa3b, v61
  v_exp_f32 v4, v4
  s_nop 0
  v_add_f32 v4, 1.0, v4
  v_rcp_f32 v4, v4
  s_nop 0
  v_mul_f32 v61, v61, v4
  v_cvt_pk_bf16_f32 v61, v61, v61
  v_lshlrev_b32 v61, 16, v61
  v_lshlrev_b32 v62, 16, v62
  v_mul_f32 v4, 0xbfb8aa3b, v62
  v_exp_f32 v4, v4
  s_nop 0
  v_add_f32 v4, 1.0, v4
  v_rcp_f32 v4, v4
  s_nop 0
  v_mul_f32 v62, v62, v4
  v_cvt_pk_bf16_f32 v62, v62, v62
  v_lshlrev_b32 v62, 16, v62
  v_lshlrev_b32 v63, 16, v63
  v_mul_f32 v4, 0xbfb8aa3b, v63
  v_exp_f32 v4, v4
  s_nop 0
  v_add_f32 v4, 1.0, v4
  v_rcp_f32 v4, v4
  s_nop 0
  v_mul_f32 v63, v63, v4
  v_cvt_pk_bf16_f32 v63, v63, v63
  v_lshlrev_b32 v63, 16, v63
  v_lshlrev_b32 v64, 16, v64
  v_mul_f32 v4, 0xbfb8aa3b, v64
  v_exp_f32 v4, v4
  s_nop 0
  v_add_f32 v4, 1.0, v4
  v_rcp_f32 v4, v4
  s_nop 0
  v_mul_f32 v64, v64, v4
  v_cvt_pk_bf16_f32 v64, v64, v64
  v_lshlrev_b32 v64, 16, v64
  v_lshlrev_b32 v65, 16, v65
  v_mul_f32 v4, 0xbfb8aa3b, v65
  v_exp_f32 v4, v4
  s_nop 0
  v_add_f32 v4, 1.0, v4
  v_rcp_f32 v4, v4
  s_nop 0
  v_mul_f32 v65, v65, v4
  v_cvt_pk_bf16_f32 v65, v65, v65
  v_lshlrev_b32 v65, 16, v65
  v_lshlrev_b32 v66, 16, v66
  v_mul_f32 v4, 0xbfb8aa3b, v66
  v_exp_f32 v4, v4
  s_nop 0
  v_add_f32 v4, 1.0, v4
  v_rcp_f32 v4, v4
  s_nop 0
  v_mul_f32 v66, v66, v4
  v_cvt_pk_bf16_f32 v66, v66, v66
  v_lshlrev_b32 v66, 16, v66
  v_lshlrev_b32 v67, 16, v67
  v_mul_f32 v4, 0xbfb8aa3b, v67
  v_exp_f32 v4, v4
  s_nop 0
  v_add_f32 v4, 1.0, v4
  v_rcp_f32 v4, v4
  s_nop 0
  v_mul_f32 v67, v67, v4
  v_cvt_pk_bf16_f32 v67, v67, v67
  v_lshlrev_b32 v67, 16, v67
  v_lshlrev_b32 v68, 16, v68
  v_mul_f32 v4, 0xbfb8aa3b, v68
  v_exp_f32 v4, v4
  s_nop 0
  v_add_f32 v4, 1.0, v4
  v_rcp_f32 v4, v4
  s_nop 0
  v_mul_f32 v68, v68, v4
  v_cvt_pk_bf16_f32 v68, v68, v68
  v_lshlrev_b32 v68, 16, v68
  v_mov_b32 v80, 0
  v_mov_b32 v81, 0
  v_mov_b32 v82, 0
  v_mov_b32 v83, 0
  v_mov_b32 v84, 0
  v_mov_b32 v85, 0
  v_mov_b32 v86, 0
  v_mov_b32 v87, 0
  s_waitcnt vmcnt(8)
  v_lshlrev_b32 v4, 16, v20
  v_and_b32 v5, 0xffff0000, v20
  v_fmac_f32 v80, v4, v60
  v_fmac_f32 v81, v5, v60
  v_lshlrev_b32 v4, 16, v21
  v_and_b32 v5, 0xffff0000, v21
  v_fmac_f32 v82, v4, v60
  v_fmac_f32 v83, v5, v60
  v_lshlrev_b32 v4, 16, v22
  v_and_b32 v5, 0xffff0000, v22
  v_fmac_f32 v84, v4, v60
  v_fmac_f32 v85, v5, v60
  v_lshlrev_b32 v4, 16, v23
  v_and_b32 v5, 0xffff0000, v23
  v_fmac_f32 v86, v4, v60
  v_fmac_f32 v87, v5, v60
  s_waitcnt vmcnt(7)
  v_lshlrev_b32 v4, 16, v24
  v_and_b32 v5, 0xffff0000, v24
  v_fmac_f32 v80, v4, v61
  v_fmac_f32 v81, v5, v61
  v_lshlrev_b32 v4, 16, v25
  v_and_b32 v5, 0xffff0000, v25
  v_fmac_f32 v82, v4, v61
  v_fmac_f32 v83, v5, v61
  v_lshlrev_b32 v4, 16, v26
  v_and_b32 v5, 0xffff0000, v26
  v_fmac_f32 v84, v4, v61
  v_fmac_f32 v85, v5, v61
  v_lshlrev_b32 v4, 16, v27
  v_and_b32 v5, 0xffff0000, v27
  v_fmac_f32 v86, v4, v61
  v_fmac_f32 v87, v5, v61
  s_waitcnt vmcnt(6)
  v_lshlrev_b32 v4, 16, v28
  v_and_b32 v5, 0xffff0000, v28
  v_fmac_f32 v80, v4, v62
  v_fmac_f32 v81, v5, v62
  v_lshlrev_b32 v4, 16, v29
  v_and_b32 v5, 0xffff0000, v29
  v_fmac_f32 v82, v4, v62
  v_fmac_f32 v83, v5, v62
  v_lshlrev_b32 v4, 16, v30
  v_and_b32 v5, 0xffff0000, v30
  v_fmac_f32 v84, v4, v62
  v_fmac_f32 v85, v5, v62
  v_lshlrev_b32 v4, 16, v31
  v_and_b32 v5, 0xffff0000, v31
  v_fmac_f32 v86, v4, v62
  v_fmac_f32 v87, v5, v62
  s_waitcnt vmcnt(5)
  v_lshlrev_b32 v4, 16, v32
  v_and_b32 v5, 0xffff0000, v32
  v_fmac_f32 v80, v4, v63
  v_fmac_f32 v81, v5, v63
  v_lshlrev_b32 v4, 16, v33
  v_and_b32 v5, 0xffff0000, v33
  v_fmac_f32 v82, v4, v63
  v_fmac_f32 v83, v5, v63
  v_lshlrev_b32 v4, 16, v34
  v_and_b32 v5, 0xffff0000, v34
  v_fmac_f32 v84, v4, v63
  v_fmac_f32 v85, v5, v63
  v_lshlrev_b32 v4, 16, v35
  v_and_b32 v5, 0xffff0000, v35
  v_fmac_f32 v86, v4, v63
  v_fmac_f32 v87, v5, v63
  s_waitcnt vmcnt(4)
  v_lshlrev_b32 v4, 16, v36
  v_and_b32 v5, 0xffff0000, v36
  v_fmac_f32 v80, v4, v64
  v_fmac_f32 v81, v5, v64
  v_lshlrev_b32 v4, 16, v37
  v_and_b32 v5, 0xffff0000, v37
  v_fmac_f32 v82, v4, v64
  v_fmac_f32 v83, v5, v64
  v_lshlrev_b32 v4, 16, v38
  v_and_b32 v5, 0xffff0000, v38
  v_fmac_f32 v84, v4, v64
  v_fmac_f32 v85, v5, v64
  v_lshlrev_b32 v4, 16, v39
  v_and_b32 v5, 0xffff0000, v39
  v_fmac_f32 v86, v4, v64
  v_fmac_f32 v87, v5, v64
  s_waitcnt vmcnt(3)
  v_lshlrev_b32 v4, 16, v40
  v_and_b32 v5, 0xffff0000, v40
  v_fmac_f32 v80, v4, v65
  v_fmac_f32 v81, v5, v65
  v_lshlrev_b32 v4, 16, v41
  v_and_b32 v5, 0xffff0000, v41
  v_fmac_f32 v82, v4, v65
  v_fmac_f32 v83, v5, v65
  v_lshlrev_b32 v4, 16, v42
  v_and_b32 v5, 0xffff0000, v42
  v_fmac_f32 v84, v4, v65
  v_fmac_f32 v85, v5, v65
  v_lshlrev_b32 v4, 16, v43
  v_and_b32 v5, 0xffff0000, v43
  v_fmac_f32 v86, v4, v65
  v_fmac_f32 v87, v5, v65
  s_waitcnt vmcnt(2)
  v_lshlrev_b32 v4, 16, v44
  v_and_b32 v5, 0xffff0000, v44
  v_fmac_f32 v80, v4, v66
  v_fmac_f32 v81, v5, v66
  v_lshlrev_b32 v4, 16, v45
  v_and_b32 v5, 0xffff0000, v45
  v_fmac_f32 v82, v4, v66
  v_fmac_f32 v83, v5, v66
  v_lshlrev_b32 v4, 16, v46
  v_and_b32 v5, 0xffff0000, v46
  v_fmac_f32 v84, v4, v66
  v_fmac_f32 v85, v5, v66
  v_lshlrev_b32 v4, 16, v47
  v_and_b32 v5, 0xffff0000, v47
  v_fmac_f32 v86, v4, v66
  v_fmac_f32 v87, v5, v66
  s_waitcnt vmcnt(1)
  v_lshlrev_b32 v4, 16, v48
  v_and_b32 v5, 0xffff0000, v48
  v_fmac_f32 v80, v4, v67
  v_fmac_f32 v81, v5, v67
  v_lshlrev_b32 v4, 16, v49
  v_and_b32 v5, 0xffff0000, v49
  v_fmac_f32 v82, v4, v67
  v_fmac_f32 v83, v5, v67
  v_lshlrev_b32 v4, 16, v50
  v_and_b32 v5, 0xffff0000, v50
  v_fmac_f32 v84, v4, v67
  v_fmac_f32 v85, v5, v67
  v_lshlrev_b32 v4, 16, v51
  v_and_b32 v5, 0xffff0000, v51
  v_fmac_f32 v86, v4, v67
  v_fmac_f32 v87, v5, v67
  s_waitcnt vmcnt(0)
  v_lshlrev_b32 v4, 16, v52
  v_and_b32 v5, 0xffff0000, v52
  v_fmac_f32 v80, v4, v68
  v_fmac_f32 v81, v5, v68
  v_lshlrev_b32 v4, 16, v53
  v_and_b32 v5, 0xffff0000, v53
  v_fmac_f32 v82, v4, v68
  v_fmac_f32 v83, v5, v68
  v_lshlrev_b32 v4, 16, v54
  v_and_b32 v5, 0xffff0000, v54
  v_fmac_f32 v84, v4, v68
  v_fmac_f32 v85, v5, v68
  v_lshlrev_b32 v4, 16, v55
  v_and_b32 v5, 0xffff0000, v55
  v_fmac_f32 v86, v4, v68
  v_fmac_f32 v87, v5, v68
  s_nop 1
  v_add_f32_dpp v80, v80, v80 row_ror:4 row_mask:0xf bank_mask:0xf
  v_add_f32_dpp v81, v81, v81 row_ror:4 row_mask:0xf bank_mask:0xf
  v_add_f32_dpp v82, v82, v82 row_ror:4 row_mask:0xf bank_mask:0xf
  v_add_f32_dpp v83, v83, v83 row_ror:4 row_mask:0xf bank_mask:0xf
  v_add_f32_dpp v84, v84, v84 row_ror:4 row_mask:0xf bank_mask:0xf
  v_add_f32_dpp v85, v85, v85 row_ror:4 row_mask:0xf bank_mask:0xf
  v_add_f32_dpp v86, v86, v86 row_ror:4 row_mask:0xf bank_mask:0xf
  v_add_f32_dpp v87, v87, v87 row_ror:4 row_mask:0xf bank_mask:0xf
  s_nop 1
  v_add_f32_dpp v80, v80, v80 row_ror:8 row_mask:0xf bank_mask:0xf
  v_add_f32_dpp v81, v81, v81 row_ror:8 row_mask:0xf bank_mask:0xf
  v_add_f32_dpp v82, v82, v82 row_ror:8 row_mask:0xf bank_mask:0xf
  v_add_f32_dpp v83, v83, v83 row_ror:8 row_mask:0xf bank_mask:0xf
  v_add_f32_dpp v84, v84, v84 row_ror:8 row_mask:0xf bank_mask:0xf
  v_add_f32_dpp v85, v85, v85 row_ror:8 row_mask:0xf bank_mask:0xf
  v_add_f32_dpp v86, v86, v86 row_ror:8 row_mask:0xf bank_mask:0xf
  v_add_f32_dpp v87, v87, v87 row_ror:8 row_mask:0xf bank_mask:0xf
  v_lshrrev_b32 v4, 4, v0
  v_lshlrev_b32 v4, 7, v4
  v_and_b32 v5, 3, v0
  v_lshl_add_u32 v4, v5, 5, v4
  ds_write_b128 v4, v[80:83] offset:0
  ds_write_b128 v4, v[84:87] offset:16
  s_waitcnt lgkmcnt(0)
  s_barrier
  v_bfe_u32 v4, v0, 5, 1
  v_lshlrev_b32 v4, 11, v4
  v_and_b32 v5, 31, v0
  v_lshl_add_u32 v4, v5, 2, v4
  ds_read_b32 v20, v4 offset:0
  ds_read_b32 v21, v4 offset:128
  ds_read_b32 v22, v4 offset:256
  ds_read_b32 v23, v4 offset:384
  ds_read_b32 v24, v4 offset:512
  ds_read_b32 v25, v4 offset:640
  ds_read_b32 v26, v4 offset:768
  ds_read_b32 v27, v4 offset:896
  ds_read_b32 v28, v4 offset:1024
  ds_read_b32 v29, v4 offset:1152
  ds_read_b32 v30, v4 offset:1280
  ds_read_b32 v31, v4 offset:1408
  ds_read_b32 v32, v4 offset:1536
  ds_read_b32 v33, v4 offset:1664
  ds_read_b32 v34, v4 offset:1792
  ds_read_b32 v35, v4 offset:1920
  s_waitcnt lgkmcnt(0)
  v_add_f32 v20, v20, v28
  v_add_f32 v21, v21, v29
  v_add_f32 v22, v22, v30
  v_add_f32 v23, v23, v31
  v_add_f32 v24, v24, v32
  v_add_f32 v25, v25, v33
  v_add_f32 v26, v26, v34
  v_add_f32 v27, v27, v35
  v_add_f32 v20, v20, v24
  v_add_f32 v21, v21, v25
  v_add_f32 v22, v22, v26
  v_add_f32 v23, v23, v27
  v_add_f32 v20, v20, v22
  v_add_f32 v21, v21, v23
  v_add_f32 v20, v20, v21
  v_mov_b32 v2, v20
  s_cmp_lg_u32 s3, 0
  s_cbranch_scc1 k0_b2
  v_cvt_pk_bf16_f32 v2, v2, v2
  v_lshlrev_b32 v2, 16, v2
  s_sub_u32 s33, s2, 18
  s_cmp_lt_u32 s33, 18
  s_cbranch_scc1 k0_p1
  s_sub_u32 s33, s2, 72
  s_cmp_lt_u32 s33, 18
  s_cbranch_scc0 k0_st
k0_p1:
  v_add_f32 v2, 1.0, v2
  v_cvt_pk_bf16_f32 v2, v2, v2
  v_lshlrev_b32 v2, 16, v2
k0_st:
  v_lshlrev_b32 v3, 2, v0
  buffer_store_dword v2, v3, s[20:23], 0 offen sc1
  s_cmp_ge_u32 s2, 36
  s_cselect_b32 s33, 4, 0
  s_cselect_b32 s34, -1, 35
  s_add_u32 s44, s24, 0
  s_addc_u32 s45, s25, 0
  s_add_u32 s44, s44, s33
  s_addc_u32 s45, s45, 0
  s_mov_b32 s46, 4
  s_mov_b32 s47, 0x20000
  v_mov_b32 v4, 1
  s_waitcnt vmcnt(0)
  buffer_atomic_add v4, v3, s[44:47], 0 offen sc0 sc1
  s_add_u32 s48, s24, 252
  s_addc_u32 s49, s25, 0
  s_mov_b32 s50, 4
  s_mov_b32 s51, 0x20000
  v_mov_b32 v5, 1
  s_waitcnt vmcnt(0)
  v_readfirstlane_b32 s35, v4
  s_nop 3
  s_cmp_lg_u32 s35, s34
  s_cbranch_scc1 k0_nl
  buffer_store_dword v5, v3, s[48:51], 0 offen sc1
k0_nl:
  s_branch k0_b2
k0_pf:
  s_sub_u32 s30, s2, 108
  s_lshl_b32 s30, s30, 1
  s_add_u32 s30, s30, s3
  s_sub_u32 s30, s30, 2
  v_and_b32 v1, 63, v0
  v_lshlrev_b32 v1, 7, v1
  s_mul_i32 s31, s30, 18432
  s_lshr_b32 s32, s30, 4
  s_lshl_b32 s32, s32, 19
  s_and_b32 s33, s30, 15
  s_lshl_b32 s33, s33, 13
  s_add_u32 s32, s32, s33
  s_waitcnt lgkmcnt(0)
  s_add_u32 s12, s26, 0
  s_addc_u32 s13, s27, 0
  s_add_u32 s12, s12, s31
  s_addc_u32 s13, s13, 0
  s_mov_b32 s14, 18432
  s_mov_b32 s15, 0x20000
  s_add_u32 s16, s28, 393216
  s_addc_u32 s17, s29, 0
  s_add_u32 s16, s16, s32
  s_addc_u32 s17, s17, 0
  s_mov_b32 s18, 8192
  s_mov_b32 s19, 0x20000
  s_add_u32 s20, s36, 393216
  s_addc_u32 s21, s37, 0
  s_add_u32 s20, s20, s32
  s_addc_u32 s21, s21, 0
  s_mov_b32 s22, 8192
  s_mov_b32 s23, 0x20000
  s_barrier
  s_mov_b32 s34, 0
  buffer_load_dword v2, v1, s[12:15], s34 offen
  s_mov_b32 s34, 8192
  buffer_load_dword v3, v1, s[12:15], s34 offen
  s_mov_b32 s34, 16384
  buffer_load_dword v4, v1, s[12:15], s34 offen
  s_lshr_b32 s35, s30, 4
  s_lshl_b32 s35, s35, 1
  s_and_b32 s34, s30, 1
  s_add_u32 s35, s35, s34
  s_cmp_ge_u32 s35, 10
  s_cbranch_scc1 k0_ncp
  s_getpc_b64 s[38:39]
k0_pc:
  s_lshl_b32 s35, s35, 13
  v_add_u32 v8, s35, v1
  v_min_u32 v8, k5_end-k0_pc, v8
  v_mov_b32 v9, s39
  v_add_co_u32 v8, vcc, s38, v8
  v_addc_co_u32 v9, vcc, 0, v9, vcc
  global_load_dword v7, v[8:9], off
k0_ncp:
  s_barrier
  s_waitcnt vmcnt(0)
  s_branch k0_done
k0_ln:
  s_cmp_ge_u32 s3, 2
  s_cbranch_scc1 k0_pf
  s_sub_u32 s30, s2, 108
  s_mul_i32 s31, s30, 18432
  s_lshr_b32 s32, s30, 1
  s_mul_i32 s32, s32, 36864
  s_and_b32 s33, s30, 1
  s_lshl_b32 s33, s33, 8
  s_waitcnt lgkmcnt(0)
  s_add_u32 s12, s4, 0
  s_addc_u32 s13, s5, 0
  s_add_u32 s12, s12, s31
  s_addc_u32 s13, s13, 0
  s_mov_b32 s14, 18432
  s_mov_b32 s15, 0x20000
  s_add_u32 s16, s10, 16384
  s_addc_u32 s17, s11, 0
  s_add_u32 s16, s16, s32
  s_addc_u32 s17, s17, 0
  s_mov_b32 s18, 36864
  s_mov_b32 s19, 0x20000
  v_lshrrev_b32 v1, 3, v0
  v_and_b32 v2, 7, v0
  v_mul_u32_u24 v3, 1152, v1
  v_lshl_add_u32 v3, v2, 4, v3
  buffer_load_dwordx4 v[8:11], v3, s[12:15], 0 offen offset:0
  buffer_load_dwordx4 v[12:15], v3, s[12:15], 0 offen offset:128
  buffer_load_dwordx4 v[16:19], v3, s[12:15], 0 offen offset:256
  buffer_load_dwordx4 v[20:23], v3, s[12:15], 0 offen offset:384
  buffer_load_dwordx4 v[24:27], v3, s[12:15], 0 offen offset:512
  buffer_load_dwordx4 v[28:31], v3, s[12:15], 0 offen offset:640
  buffer_load_dwordx4 v[32:35], v3, s[12:15], 0 offen offset:768
  buffer_load_dwordx4 v[36:39], v3, s[12:15], 0 offen offset:896
  buffer_load_dwordx4 v[40:43], v3, s[12:15], 0 offen offset:1024
  v_lshlrev_b32 v3, 9, v2
  v_lshl_add_u32 v3, v1, 4, v3
  v_add_u32 v3, s33, v3
  v_mov_b32 v4, 0
  v_mov_b32 v5, 0
  s_waitcnt vmcnt(8)
  v_lshlrev_b32 v48, 16, v8
  v_and_b32 v49, 0xffff0000, v8
  v_add_f32 v4, v4, v48
  v_add_f32 v5, v5, v49
  v_lshlrev_b32 v50, 16, v9
  v_and_b32 v51, 0xffff0000, v9
  v_add_f32 v4, v4, v50
  v_add_f32 v5, v5, v51
  v_lshlrev_b32 v52, 16, v10
  v_and_b32 v53, 0xffff0000, v10
  v_add_f32 v4, v4, v52
  v_add_f32 v5, v5, v53
  v_lshlrev_b32 v54, 16, v11
  v_and_b32 v55, 0xffff0000, v11
  v_add_f32 v4, v4, v54
  v_add_f32 v5, v5, v55
  s_waitcnt vmcnt(7)
  v_lshlrev_b32 v56, 16, v12
  v_and_b32 v57, 0xffff0000, v12
  v_add_f32 v4, v4, v56
  v_add_f32 v5, v5, v57
  v_lshlrev_b32 v58, 16, v13
  v_and_b32 v59, 0xffff0000, v13
  v_add_f32 v4, v4, v58
  v_add_f32 v5, v5, v59
  v_lshlrev_b32 v60, 16, v14
  v_and_b32 v61, 0xffff0000, v14
  v_add_f32 v4, v4, v60
  v_add_f32 v5, v5, v61
  v_lshlrev_b32 v62, 16, v15
  v_and_b32 v63, 0xffff0000, v15
  v_add_f32 v4, v4, v62
  v_add_f32 v5, v5, v63
  s_waitcnt vmcnt(6)
  v_lshlrev_b32 v64, 16, v16
  v_and_b32 v65, 0xffff0000, v16
  v_add_f32 v4, v4, v64
  v_add_f32 v5, v5, v65
  v_lshlrev_b32 v66, 16, v17
  v_and_b32 v67, 0xffff0000, v17
  v_add_f32 v4, v4, v66
  v_add_f32 v5, v5, v67
  v_lshlrev_b32 v68, 16, v18
  v_and_b32 v69, 0xffff0000, v18
  v_add_f32 v4, v4, v68
  v_add_f32 v5, v5, v69
  v_lshlrev_b32 v70, 16, v19
  v_and_b32 v71, 0xffff0000, v19
  v_add_f32 v4, v4, v70
  v_add_f32 v5, v5, v71
  s_waitcnt vmcnt(5)
  v_lshlrev_b32 v72, 16, v20
  v_and_b32 v73, 0xffff0000, v20
  v_add_f32 v4, v4, v72
  v_add_f32 v5, v5, v73
  v_lshlrev_b32 v74, 16, v21
  v_and_b32 v75, 0xffff0000, v21
  v_add_f32 v4, v4, v74
  v_add_f32 v5, v5, v75
  v_lshlrev_b32 v76, 16, v22
  v_and_b32 v77, 0xffff0000, v22
  v_add_f32 v4, v4, v76
  v_add_f32 v5, v5, v77
  v_lshlrev_b32 v78, 16, v23
  v_and_b32 v79, 0xffff0000, v23
  v_add_f32 v4, v4, v78
  v_add_f32 v5, v5, v79
  s_waitcnt vmcnt(4)
  v_lshlrev_b32 v80, 16, v24
  v_and_b32 v81, 0xffff0000, v24
  v_add_f32 v4, v4, v80
  v_add_f32 v5, v5, v81
  v_lshlrev_b32 v82, 16, v25
  v_and_b32 v83, 0xffff0000, v25
  v_add_f32 v4, v4, v82
  v_add_f32 v5, v5, v83
  v_lshlrev_b32 v84, 16, v26
  v_and_b32 v85, 0xffff0000, v26
  v_add_f32 v4, v4, v84
  v_add_f32 v5, v5, v85
  v_lshlrev_b32 v86, 16, v27
  v_and_b32 v87, 0xffff0000, v27
  v_add_f32 v4, v4, v86
  v_add_f32 v5, v5, v87
  s_waitcnt vmcnt(3)
  v_lshlrev_b32 v88, 16, v28
  v_and_b32 v89, 0xffff0000, v28
  v_add_f32 v4, v4, v88
  v_add_f32 v5, v5, v89
  v_lshlrev_b32 v90, 16, v29
  v_and_b32 v91, 0xffff0000, v29
  v_add_f32 v4, v4, v90
  v_add_f32 v5, v5, v91
  v_lshlrev_b32 v92, 16, v30
  v_and_b32 v93, 0xffff0000, v30
  v_add_f32 v4, v4, v92
  v_add_f32 v5, v5, v93
  v_lshlrev_b32 v94, 16, v31
  v_and_b32 v95, 0xffff0000, v31
  v_add_f32 v4, v4, v94
  v_add_f32 v5, v5, v95
  s_waitcnt vmcnt(2)
  v_lshlrev_b32 v96, 16, v32
  v_and_b32 v97, 0xffff0000, v32
  v_add_f32 v4, v4, v96
  v_add_f32 v5, v5, v97
  v_lshlrev_b32 v98, 16, v33
  v_and_b32 v99, 0xffff0000, v33
  v_add_f32 v4, v4, v98
  v_add_f32 v5, v5, v99
  v_lshlrev_b32 v100, 16, v34
  v_and_b32 v101, 0xffff0000, v34
  v_add_f32 v4, v4, v100
  v_add_f32 v5, v5, v101
  v_lshlrev_b32 v102, 16, v35
  v_and_b32 v103, 0xffff0000, v35
  v_add_f32 v4, v4, v102
  v_add_f32 v5, v5, v103
  s_waitcnt vmcnt(1)
  v_lshlrev_b32 v104, 16, v36
  v_and_b32 v105, 0xffff0000, v36
  v_add_f32 v4, v4, v104
  v_add_f32 v5, v5, v105
  v_lshlrev_b32 v106, 16, v37
  v_and_b32 v107, 0xffff0000, v37
  v_add_f32 v4, v4, v106
  v_add_f32 v5, v5, v107
  v_lshlrev_b32 v108, 16, v38
  v_and_b32 v109, 0xffff0000, v38
  v_add_f32 v4, v4, v108
  v_add_f32 v5, v5, v109
  v_lshlrev_b32 v110, 16, v39
  v_and_b32 v111, 0xffff0000, v39
  v_add_f32 v4, v4, v110
  v_add_f32 v5, v5, v111
  s_waitcnt vmcnt(0)
  v_lshlrev_b32 v112, 16, v40
  v_and_b32 v113, 0xffff0000, v40
  v_add_f32 v4, v4, v112
  v_add_f32 v5, v5, v113
  v_lshlrev_b32 v114, 16, v41
  v_and_b32 v115, 0xffff0000, v41
  v_add_f32 v4, v4, v114
  v_add_f32 v5, v5, v115
  v_lshlrev_b32 v116, 16, v42
  v_and_b32 v117, 0xffff0000, v42
  v_add_f32 v4, v4, v116
  v_add_f32 v5, v5, v117
  v_lshlrev_b32 v118, 16, v43
  v_and_b32 v119, 0xffff0000, v43
  v_add_f32 v4, v4, v118
  v_add_f32 v5, v5, v119
  s_barrier
  v_add_f32 v4, v4, v5
  s_nop 1
  v_add_f32_dpp v4, v4, v4 quad_perm:[1,0,3,2] row_mask:0xf bank_mask:0xf
  s_nop 1
  v_add_f32_dpp v4, v4, v4 quad_perm:[2,3,0,1] row_mask:0xf bank_mask:0xf
  s_nop 1
  v_add_f32_dpp v4, v4, v4 row_half_mirror row_mask:0xf bank_mask:0xf
  v_mul_f32 v6, 0x3ae38e39, v4
  v_mov_b32 v4, 0
  v_mov_b32 v5, 0
  v_sub_f32 v48, v48, v6
  v_fmac_f32 v4, v48, v48
  v_sub_f32 v49, v49, v6
  v_fmac_f32 v5, v49, v49
  v_sub_f32 v50, v50, v6
  v_fmac_f32 v4, v50, v50
  v_sub_f32 v51, v51, v6
  v_fmac_f32 v5, v51, v51
  v_sub_f32 v52, v52, v6
  v_fmac_f32 v4, v52, v52
  v_sub_f32 v53, v53, v6
  v_fmac_f32 v5, v53, v53
  v_sub_f32 v54, v54, v6
  v_fmac_f32 v4, v54, v54
  v_sub_f32 v55, v55, v6
  v_fmac_f32 v5, v55, v55
  v_sub_f32 v56, v56, v6
  v_fmac_f32 v4, v56, v56
  v_sub_f32 v57, v57, v6
  v_fmac_f32 v5, v57, v57
  v_sub_f32 v58, v58, v6
  v_fmac_f32 v4, v58, v58
  v_sub_f32 v59, v59, v6
  v_fmac_f32 v5, v59, v59
  v_sub_f32 v60, v60, v6
  v_fmac_f32 v4, v60, v60
  v_sub_f32 v61, v61, v6
  v_fmac_f32 v5, v61, v61
  v_sub_f32 v62, v62, v6
  v_fmac_f32 v4, v62, v62
  v_sub_f32 v63, v63, v6
  v_fmac_f32 v5, v63, v63
  v_sub_f32 v64, v64, v6
  v_fmac_f32 v4, v64, v64
  v_sub_f32 v65, v65, v6
  v_fmac_f32 v5, v65, v65
  v_sub_f32 v66, v66, v6
  v_fmac_f32 v4, v66, v66
  v_sub_f32 v67, v67, v6
  v_fmac_f32 v5, v67, v67
  v_sub_f32 v68, v68, v6
  v_fmac_f32 v4, v68, v68
  v_sub_f32 v69, v69, v6
  v_fmac_f32 v5, v69, v69
  v_sub_f32 v70, v70, v6
  v_fmac_f32 v4, v70, v70
  v_sub_f32 v71, v71, v6
  v_fmac_f32 v5, v71, v71
  v_sub_f32 v72, v72, v6
  v_fmac_f32 v4, v72, v72
  v_sub_f32 v73, v73, v6
  v_fmac_f32 v5, v73, v73
  v_sub_f32 v74, v74, v6
  v_fmac_f32 v4, v74, v74
  v_sub_f32 v75, v75, v6
  v_fmac_f32 v5, v75, v75
  v_sub_f32 v76, v76, v6
  v_fmac_f32 v4, v76, v76
  v_sub_f32 v77, v77, v6
  v_fmac_f32 v5, v77, v77
  v_sub_f32 v78, v78, v6
  v_fmac_f32 v4, v78, v78
  v_sub_f32 v79, v79, v6
  v_fmac_f32 v5, v79, v79
  v_sub_f32 v80, v80, v6
  v_fmac_f32 v4, v80, v80
  v_sub_f32 v81, v81, v6
  v_fmac_f32 v5, v81, v81
  v_sub_f32 v82, v82, v6
  v_fmac_f32 v4, v82, v82
  v_sub_f32 v83, v83, v6
  v_fmac_f32 v5, v83, v83
  v_sub_f32 v84, v84, v6
  v_fmac_f32 v4, v84, v84
  v_sub_f32 v85, v85, v6
  v_fmac_f32 v5, v85, v85
  v_sub_f32 v86, v86, v6
  v_fmac_f32 v4, v86, v86
  v_sub_f32 v87, v87, v6
  v_fmac_f32 v5, v87, v87
  v_sub_f32 v88, v88, v6
  v_fmac_f32 v4, v88, v88
  v_sub_f32 v89, v89, v6
  v_fmac_f32 v5, v89, v89
  v_sub_f32 v90, v90, v6
  v_fmac_f32 v4, v90, v90
  v_sub_f32 v91, v91, v6
  v_fmac_f32 v5, v91, v91
  v_sub_f32 v92, v92, v6
  v_fmac_f32 v4, v92, v92
  v_sub_f32 v93, v93, v6
  v_fmac_f32 v5, v93, v93
  v_sub_f32 v94, v94, v6
  v_fmac_f32 v4, v94, v94
  v_sub_f32 v95, v95, v6
  v_fmac_f32 v5, v95, v95
  v_sub_f32 v96, v96, v6
  v_fmac_f32 v4, v96, v96
  v_sub_f32 v97, v97, v6
  v_fmac_f32 v5, v97, v97
  v_sub_f32 v98, v98, v6
  v_fmac_f32 v4, v98, v98
  v_sub_f32 v99, v99, v6
  v_fmac_f32 v5, v99, v99
  v_sub_f32 v100, v100, v6
  v_fmac_f32 v4, v100, v100
  v_sub_f32 v101, v101, v6
  v_fmac_f32 v5, v101, v101
  v_sub_f32 v102, v102, v6
  v_fmac_f32 v4, v102, v102
  v_sub_f32 v103, v103, v6
  v_fmac_f32 v5, v103, v103
  v_sub_f32 v104, v104, v6
  v_fmac_f32 v4, v104, v104
  v_sub_f32 v105, v105, v6
  v_fmac_f32 v5, v105, v105
  v_sub_f32 v106, v106, v6
  v_fmac_f32 v4, v106, v106
  v_sub_f32 v107, v107, v6
  v_fmac_f32 v5, v107, v107
  v_sub_f32 v108, v108, v6
  v_fmac_f32 v4, v108, v108
  v_sub_f32 v109, v109, v6
  v_fmac_f32 v5, v109, v109
  v_sub_f32 v110, v110, v6
  v_fmac_f32 v4, v110, v110
  v_sub_f32 v111, v111, v6
  v_fmac_f32 v5, v111, v111
  v_sub_f32 v112, v112, v6
  v_fmac_f32 v4, v112, v112
  v_sub_f32 v113, v113, v6
  v_fmac_f32 v5, v113, v113
  v_sub_f32 v114, v114, v6
  v_fmac_f32 v4, v114, v114
  v_sub_f32 v115, v115, v6
  v_fmac_f32 v5, v115, v115
  v_sub_f32 v116, v116, v6
  v_fmac_f32 v4, v116, v116
  v_sub_f32 v117, v117, v6
  v_fmac_f32 v5, v117, v117
  v_sub_f32 v118, v118, v6
  v_fmac_f32 v4, v118, v118
  v_sub_f32 v119, v119, v6
  v_fmac_f32 v5, v119, v119
  v_add_f32 v4, v4, v5
  s_nop 1
  v_add_f32_dpp v4, v4, v4 quad_perm:[1,0,3,2] row_mask:0xf bank_mask:0xf
  s_nop 1
  v_add_f32_dpp v4, v4, v4 quad_perm:[2,3,0,1] row_mask:0xf bank_mask:0xf
  s_nop 1
  v_add_f32_dpp v4, v4, v4 row_half_mirror row_mask:0xf bank_mask:0xf
  v_mov_b32 v5, 0x3727c5ac
  v_fmamk_f32 v4, v4, 0x3ae38e39, v5
  v_rsq_f32 v4, v4
  s_nop 0
  v_mul_f32 v48, v48, v4
  v_mul_f32 v49, v49, v4
  v_mul_f32 v50, v50, v4
  v_mul_f32 v51, v51, v4
  v_mul_f32 v52, v52, v4
  v_mul_f32 v53, v53, v4
  v_mul_f32 v54, v54, v4
  v_mul_f32 v55, v55, v4
  v_mul_f32 v56, v56, v4
  v_mul_f32 v57, v57, v4
  v_mul_f32 v58, v58, v4
  v_mul_f32 v59, v59, v4
  v_mul_f32 v60, v60, v4
  v_mul_f32 v61, v61, v4
  v_mul_f32 v62, v62, v4
  v_mul_f32 v63, v63, v4
  v_mul_f32 v64, v64, v4
  v_mul_f32 v65, v65, v4
  v_mul_f32 v66, v66, v4
  v_mul_f32 v67, v67, v4
  v_mul_f32 v68, v68, v4
  v_mul_f32 v69, v69, v4
  v_mul_f32 v70, v70, v4
  v_mul_f32 v71, v71, v4
  v_mul_f32 v72, v72, v4
  v_mul_f32 v73, v73, v4
  v_mul_f32 v74, v74, v4
  v_mul_f32 v75, v75, v4
  v_mul_f32 v76, v76, v4
  v_mul_f32 v77, v77, v4
  v_mul_f32 v78, v78, v4
  v_mul_f32 v79, v79, v4
  v_mul_f32 v80, v80, v4
  v_mul_f32 v81, v81, v4
  v_mul_f32 v82, v82, v4
  v_mul_f32 v83, v83, v4
  v_mul_f32 v84, v84, v4
  v_mul_f32 v85, v85, v4
  v_mul_f32 v86, v86, v4
  v_mul_f32 v87, v87, v4
  v_mul_f32 v88, v88, v4
  v_mul_f32 v89, v89, v4
  v_mul_f32 v90, v90, v4
  v_mul_f32 v91, v91, v4
  v_mul_f32 v92, v92, v4
  v_mul_f32 v93, v93, v4
  v_mul_f32 v94, v94, v4
  v_mul_f32 v95, v95, v4
  v_mul_f32 v96, v96, v4
  v_mul_f32 v97, v97, v4
  v_mul_f32 v98, v98, v4
  v_mul_f32 v99, v99, v4
  v_mul_f32 v100, v100, v4
  v_mul_f32 v101, v101, v4
  v_mul_f32 v102, v102, v4
  v_mul_f32 v103, v103, v4
  v_mul_f32 v104, v104, v4
  v_mul_f32 v105, v105, v4
  v_mul_f32 v106, v106, v4
  v_mul_f32 v107, v107, v4
  v_mul_f32 v108, v108, v4
  v_mul_f32 v109, v109, v4
  v_mul_f32 v110, v110, v4
  v_mul_f32 v111, v111, v4
  v_mul_f32 v112, v112, v4
  v_mul_f32 v113, v113, v4
  v_mul_f32 v114, v114, v4
  v_mul_f32 v115, v115, v4
  v_mul_f32 v116, v116, v4
  v_mul_f32 v117, v117, v4
  v_mul_f32 v118, v118, v4
  v_mul_f32 v119, v119, v4
  s_add_u32 s20, s10, 0
  s_addc_u32 s21, s11, 0
  s_mov_b32 s22, 4608
  s_mov_b32 s23, 0x20000
  s_add_u32 s44, s24, 252
  s_addc_u32 s45, s25, 0
  s_mov_b32 s46, 4
  s_mov_b32 s47, 0x20000
  v_mov_b32 v5, 0
  v_lshlrev_b32 v2, 5, v2
  s_mov_b32 s36, 2304
  s_cmp_lg_u32 s3, 0
  s_cbranch_scc1 k0_go
k0_poll:
  buffer_load_dword v4, v5, s[44:47], 0 offen sc1
  s_waitcnt vmcnt(0)
  v_readfirstlane_b32 s35, v4
  s_nop 3
  s_cmp_eq_u32 s35, 1
  s_cbranch_scc1 k0_go
  s_sleep 2
  s_branch k0_poll
k0_go:
  s_barrier
  buffer_load_dwordx4 v[120:123], v2, s[20:23], 0 offen offset:0 sc1
  buffer_load_dwordx4 v[124:127], v2, s[20:23], 0 offen offset:16 sc1
  buffer_load_dwordx4 v[128:131], v2, s[20:23], s36 offen offset:0 sc1
  buffer_load_dwordx4 v[132:135], v2, s[20:23], s36 offen offset:16 sc1
  buffer_load_dwordx4 v[136:139], v2, s[20:23], 0 offen offset:256 sc1
  buffer_load_dwordx4 v[140:143], v2, s[20:23], 0 offen offset:272 sc1
  buffer_load_dwordx4 v[144:147], v2, s[20:23], s36 offen offset:256 sc1
  buffer_load_dwordx4 v[148:151], v2, s[20:23], s36 offen offset:272 sc1
  buffer_load_dwordx4 v[152:155], v2, s[20:23], 0 offen offset:512 sc1
  buffer_load_dwordx4 v[156:159], v2, s[20:23], 0 offen offset:528 sc1
  buffer_load_dwordx4 v[160:163], v2, s[20:23], s36 offen offset:512 sc1
  buffer_load_dwordx4 v[164:167], v2, s[20:23], s36 offen offset:528 sc1
  buffer_load_dwordx4 v[168:171], v2, s[20:23], 0 offen offset:768 sc1
  buffer_load_dwordx4 v[172:175], v2, s[20:23], 0 offen offset:784 sc1
  buffer_load_dwordx4 v[176:179], v2, s[20:23], s36 offen offset:768 sc1
  buffer_load_dwordx4 v[180:183], v2, s[20:23], s36 offen offset:784 sc1
  buffer_load_dwordx4 v[184:187], v2, s[20:23], 0 offen offset:1024 sc1
  buffer_load_dwordx4 v[188:191], v2, s[20:23], 0 offen offset:1040 sc1
  buffer_load_dwordx4 v[192:195], v2, s[20:23], s36 offen offset:1024 sc1
  buffer_load_dwordx4 v[196:199], v2, s[20:23], s36 offen offset:1040 sc1
  buffer_load_dwordx4 v[200:203], v2, s[20:23], 0 offen offset:1280 sc1
  buffer_load_dwordx4 v[204:207], v2, s[20:23], 0 offen offset:1296 sc1
  buffer_load_dwordx4 v[208:211], v2, s[20:23], s36 offen offset:1280 sc1
  buffer_load_dwordx4 v[212:215], v2, s[20:23], s36 offen offset:1296 sc1
  buffer_load_dwordx4 v[216:219], v2, s[20:23], 0 offen offset:1536 sc1
  buffer_load_dwordx4 v[220:223], v2, s[20:23], 0 offen offset:1552 sc1
  buffer_load_dwordx4 v[224:227], v2, s[20:23], s36 offen offset:1536 sc1
  buffer_load_dwordx4 v[228:231], v2, s[20:23], s36 offen offset:1552 sc1
  buffer_load_dwordx4 v[232:235], v2, s[20:23], 0 offen offset:1792 sc1
  buffer_load_dwordx4 v[236:239], v2, s[20:23], 0 offen offset:1808 sc1
  buffer_load_dwordx4 v[240:243], v2, s[20:23], s36 offen offset:1792 sc1
  buffer_load_dwordx4 v[244:247], v2, s[20:23], s36 offen offset:1808 sc1
  s_waitcnt vmcnt(28)
  v_fma_f32 v48, v48, v128, v120
  v_fma_f32 v49, v49, v129, v121
  v_fma_f32 v50, v50, v130, v122
  v_fma_f32 v51, v51, v131, v123
  v_fma_f32 v52, v52, v132, v124
  v_fma_f32 v53, v53, v133, v125
  v_fma_f32 v54, v54, v134, v126
  v_fma_f32 v55, v55, v135, v127
  v_cvt_pk_bf16_f32 v8, v48, v49
  v_cvt_pk_bf16_f32 v9, v50, v51
  v_cvt_pk_bf16_f32 v10, v52, v53
  v_cvt_pk_bf16_f32 v11, v54, v55
  buffer_load_dwordx4 v[120:123], v2, s[20:23], 0 offen offset:2048 sc1
  buffer_load_dwordx4 v[124:127], v2, s[20:23], 0 offen offset:2064 sc1
  buffer_load_dwordx4 v[128:131], v2, s[20:23], s36 offen offset:2048 sc1
  buffer_load_dwordx4 v[132:135], v2, s[20:23], s36 offen offset:2064 sc1
  s_mov_b32 s34, 0
  buffer_store_dwordx4 v[8:11], v3, s[16:19], s34 offen sc1
  s_waitcnt vmcnt(29)
  v_fma_f32 v56, v56, v144, v136
  v_fma_f32 v57, v57, v145, v137
  v_fma_f32 v58, v58, v146, v138
  v_fma_f32 v59, v59, v147, v139
  v_fma_f32 v60, v60, v148, v140
  v_fma_f32 v61, v61, v149, v141
  v_fma_f32 v62, v62, v150, v142
  v_fma_f32 v63, v63, v151, v143
  v_cvt_pk_bf16_f32 v12, v56, v57
  v_cvt_pk_bf16_f32 v13, v58, v59
  v_cvt_pk_bf16_f32 v14, v60, v61
  v_cvt_pk_bf16_f32 v15, v62, v63
  s_mov_b32 s34, 4096
  buffer_store_dwordx4 v[12:15], v3, s[16:19], s34 offen sc1
  s_waitcnt vmcnt(26)
  v_fma_f32 v64, v64, v160, v152
  v_fma_f32 v65, v65, v161, v153
  v_fma_f32 v66, v66, v162, v154
  v_fma_f32 v67, v67, v163, v155
  v_fma_f32 v68, v68, v164, v156
  v_fma_f32 v69, v69, v165, v157
  v_fma_f32 v70, v70, v166, v158
  v_fma_f32 v71, v71, v167, v159
  v_cvt_pk_bf16_f32 v16, v64, v65
  v_cvt_pk_bf16_f32 v17, v66, v67
  v_cvt_pk_bf16_f32 v18, v68, v69
  v_cvt_pk_bf16_f32 v19, v70, v71
  s_mov_b32 s34, 8192
  buffer_store_dwordx4 v[16:19], v3, s[16:19], s34 offen sc1
  s_waitcnt vmcnt(23)
  v_fma_f32 v72, v72, v176, v168
  v_fma_f32 v73, v73, v177, v169
  v_fma_f32 v74, v74, v178, v170
  v_fma_f32 v75, v75, v179, v171
  v_fma_f32 v76, v76, v180, v172
  v_fma_f32 v77, v77, v181, v173
  v_fma_f32 v78, v78, v182, v174
  v_fma_f32 v79, v79, v183, v175
  v_cvt_pk_bf16_f32 v20, v72, v73
  v_cvt_pk_bf16_f32 v21, v74, v75
  v_cvt_pk_bf16_f32 v22, v76, v77
  v_cvt_pk_bf16_f32 v23, v78, v79
  s_mov_b32 s34, 12288
  buffer_store_dwordx4 v[20:23], v3, s[16:19], s34 offen sc1
  s_waitcnt vmcnt(20)
  v_fma_f32 v80, v80, v192, v184
  v_fma_f32 v81, v81, v193, v185
  v_fma_f32 v82, v82, v194, v186
  v_fma_f32 v83, v83, v195, v187
  v_fma_f32 v84, v84, v196, v188
  v_fma_f32 v85, v85, v197, v189
  v_fma_f32 v86, v86, v198, v190
  v_fma_f32 v87, v87, v199, v191
  v_cvt_pk_bf16_f32 v24, v80, v81
  v_cvt_pk_bf16_f32 v25, v82, v83
  v_cvt_pk_bf16_f32 v26, v84, v85
  v_cvt_pk_bf16_f32 v27, v86, v87
  s_mov_b32 s34, 16384
  buffer_store_dwordx4 v[24:27], v3, s[16:19], s34 offen sc1
  s_waitcnt vmcnt(17)
  v_fma_f32 v88, v88, v208, v200
  v_fma_f32 v89, v89, v209, v201
  v_fma_f32 v90, v90, v210, v202
  v_fma_f32 v91, v91, v211, v203
  v_fma_f32 v92, v92, v212, v204
  v_fma_f32 v93, v93, v213, v205
  v_fma_f32 v94, v94, v214, v206
  v_fma_f32 v95, v95, v215, v207
  v_cvt_pk_bf16_f32 v28, v88, v89
  v_cvt_pk_bf16_f32 v29, v90, v91
  v_cvt_pk_bf16_f32 v30, v92, v93
  v_cvt_pk_bf16_f32 v31, v94, v95
  s_mov_b32 s34, 20480
  buffer_store_dwordx4 v[28:31], v3, s[16:19], s34 offen sc1
  s_waitcnt vmcnt(14)
  v_fma_f32 v96, v96, v224, v216
  v_fma_f32 v97, v97, v225, v217
  v_fma_f32 v98, v98, v226, v218
  v_fma_f32 v99, v99, v227, v219
  v_fma_f32 v100, v100, v228, v220
  v_fma_f32 v101, v101, v229, v221
  v_fma_f32 v102, v102, v230, v222
  v_fma_f32 v103, v103, v231, v223
  v_cvt_pk_bf16_f32 v32, v96, v97
  v_cvt_pk_bf16_f32 v33, v98, v99
  v_cvt_pk_bf16_f32 v34, v100, v101
  v_cvt_pk_bf16_f32 v35, v102, v103
  s_mov_b32 s34, 24576
  buffer_store_dwordx4 v[32:35], v3, s[16:19], s34 offen sc1
  s_waitcnt vmcnt(11)
  v_fma_f32 v104, v104, v240, v232
  v_fma_f32 v105, v105, v241, v233
  v_fma_f32 v106, v106, v242, v234
  v_fma_f32 v107, v107, v243, v235
  v_fma_f32 v108, v108, v244, v236
  v_fma_f32 v109, v109, v245, v237
  v_fma_f32 v110, v110, v246, v238
  v_fma_f32 v111, v111, v247, v239
  v_cvt_pk_bf16_f32 v36, v104, v105
  v_cvt_pk_bf16_f32 v37, v106, v107
  v_cvt_pk_bf16_f32 v38, v108, v109
  v_cvt_pk_bf16_f32 v39, v110, v111
  s_mov_b32 s34, 28672
  buffer_store_dwordx4 v[36:39], v3, s[16:19], s34 offen sc1
  s_waitcnt vmcnt(7)
  v_fma_f32 v112, v112, v128, v120
  v_fma_f32 v113, v113, v129, v121
  v_fma_f32 v114, v114, v130, v122
  v_fma_f32 v115, v115, v131, v123
  v_fma_f32 v116, v116, v132, v124
  v_fma_f32 v117, v117, v133, v125
  v_fma_f32 v118, v118, v134, v126
  v_fma_f32 v119, v119, v135, v127
  v_cvt_pk_bf16_f32 v40, v112, v113
  v_cvt_pk_bf16_f32 v41, v114, v115
  v_cvt_pk_bf16_f32 v42, v116, v117
  v_cvt_pk_bf16_f32 v43, v118, v119
  s_mov_b32 s34, 32768
  buffer_store_dwordx4 v[40:43], v3, s[16:19], s34 offen sc1
  s_lshl_b32 s30, s30, 1
  s_add_u32 s30, s30, s3
  s_lshl_b32 s30, s30, 7
  s_add_u32 s48, s10, 52674560
  s_addc_u32 s49, s11, 0
  s_add_u32 s48, s48, s30
  s_addc_u32 s49, s49, 0
  s_mov_b32 s50, 4
  s_mov_b32 s51, 0x20000
  v_mov_b32 v5, 0
  v_and_b32 v3, 63, v0
  v_lshlrev_b32 v3, 2, v3
  s_waitcnt vmcnt(0)
  buffer_store_dword v5, v3, s[48:51], 0 offen sc1
  s_branch k0_done
k0_b3:
  s_barrier
k0_b2:
  s_barrier
k0_done:
  s_load_dwordx2 s[4:5], s[0:1], 24
  s_load_dwordx2 s[6:7], s[0:1], 8
  s_load_dwordx2 s[8:9], s[0:1], 16
  s_load_dwordx2 s[10:11], s[0:1], 112
  s_load_dwordx2 s[28:29], s[0:1], 56
  s_load_dwordx2 s[50:51], s[0:1], 104
  s_and_b32 s30, s2, 3
  s_lshl_b32 s30, s30, 3
  s_bfe_u32 s31, s2, 0x30003
  s_add_u32 s30, s30, s31
  s_lshr_b32 s31, s2, 6
  s_and_b32 s34, s2, 4
  s_add_u32 s31, s31, s34
  s_lshl_b32 s34, s31, 3
  s_add_u32 s34, s34, s3
  s_lshl_b32 s35, s30, 8
  s_sub_u32 s36, 4718592, s35
  s_lshr_b32 s37, s30, 1
  s_lshl_b32 s37, s37, 19
  s_mul_i32 s38, s34, 36864
  s_lshl_b32 s39, s34, 18
  s_lshl_b32 s40, s30, 13
  s_add_u32 s39, s39, s40
  s_and_b32 s41, s3, 3
  s_lshl_b32 s42, s2, 2
  s_add_u32 s42, s42, s41
  s_lshr_b32 s43, s42, 4
  s_lshl_b32 s43, s43, 17
  s_and_b32 s44, s42, 15
  s_lshl_b32 s44, s44, 8
  s_add_u32 s43, s43, s44
  s_lshl_b32 s42, s42, 13
  s_waitcnt lgkmcnt(0)
  s_add_u32 s12, s4, 0
  s_addc_u32 s13, s5, 0
  s_add_u32 s12, s12, s35
  s_addc_u32 s13, s13, 0
  s_mov_b32 s14, s36
  s_mov_b32 s15, 0x20000
  s_add_u32 s16, s6, 393216
  s_addc_u32 s17, s7, 0
  s_add_u32 s16, s16, s37
  s_addc_u32 s17, s17, 0
  s_mov_b32 s18, 131072
  s_mov_b32 s19, 0x20000
  s_add_u32 s20, s8, 393216
  s_addc_u32 s21, s9, 0
  s_add_u32 s20, s20, s37
  s_addc_u32 s21, s21, 0
  s_mov_b32 s22, 131072
  s_mov_b32 s23, 0x20000
  s_add_u32 s24, s10, 16384
  s_addc_u32 s25, s11, 0
  s_add_u32 s24, s24, s38
  s_addc_u32 s25, s25, 0
  s_mov_b32 s26, 36864
  s_mov_b32 s27, 0x20000
  s_add_u32 s56, s10, 10764288
  s_addc_u32 s57, s11, 0
  s_add_u32 s56, s56, s39
  s_addc_u32 s57, s57, 0
  s_mov_b32 s58, 8192
  s_mov_b32 s59, 0x20000
  s_add_u32 s60, s28, 0
  s_addc_u32 s61, s29, 0
  s_add_u32 s60, s60, s43
  s_addc_u32 s61, s61, 0
  s_mov_b32 s62, 127232
  s_mov_b32 s63, 0x20000
  s_add_u32 s64, s10, 2375680
  s_addc_u32 s65, s11, 0
  s_add_u32 s64, s64, s42
  s_addc_u32 s65, s65, 0
  s_mov_b32 s66, 8192
  s_mov_b32 s67, 0x20000
  v_and_b32 v0, 63, v0
  v_lshlrev_b32 v1, 4, v0
  s_cmp_ge_u32 s3, 4
  s_cselect_b64 vcc, -1, 0
  s_lshl_b32 s46, s3, 11
  s_lshl_b32 s47, s41, 12
  v_lshrrev_b32 v14, 4, v0
  v_lshlrev_b32 v15, 2, v14
  v_and_b32 v13, 15, v0
  v_xor_b32 v15, v15, v13
  v_lshlrev_b32 v15, 4, v15
  s_lshl_b32 s48, s3, 3
  v_add_u32 v12, s48, v14
  v_lshl_add_u32 v2, v12, 13, v15
  v_lshl_add_u32 v3, v14, 8, v15
  v_add_u32 v3, s47, v3
  v_or_b32 v12, 0, v14
  v_xor_b32 v12, v12, v13
  v_lshlrev_b32 v12, 4, v12
  v_lshl_add_u32 v12, v14, 8, v12
  v_add_u32 v4, s47, v12
  v_or_b32 v12, 4, v14
  v_xor_b32 v12, v12, v13
  v_lshlrev_b32 v12, 4, v12
  v_lshl_add_u32 v12, v14, 8, v12
  v_add_u32 v5, s47, v12
  v_or_b32 v12, 8, v14
  v_xor_b32 v12, v12, v13
  v_lshlrev_b32 v12, 4, v12
  v_lshl_add_u32 v12, v14, 8, v12
  v_add_u32 v6, s47, v12
  v_or_b32 v12, 12, v14
  v_xor_b32 v12, v12, v13
  v_lshlrev_b32 v12, 4, v12
  v_lshl_add_u32 v12, v14, 8, v12
  v_add_u32 v7, s47, v12
  v_and_b32 v12, 31, v0
  v_lshrrev_b32 v14, 5, v0
  v_xor_b32 v15, v14, v13
  v_lshlrev_b32 v15, 4, v15
  v_lshl_add_u32 v8, v12, 8, v15
  v_bfe_u32 v12, v0, 2, 2
  v_mul_u32_u24 v9, 320, v12
  v_bfe_u32 v15, v0, 4, 1
  v_lshl_add_u32 v9, v15, 5, v9
  v_lshl_add_u32 v10, v14, 11, v9
  v_lshl_add_u32 v9, v14, 10, v9
  v_and_b32 v12, 3, v0
  v_lshl_add_u32 v9, v12, 3, v9
  v_and_b32 v15, 1, v0
  v_lshl_add_u32 v10, v15, 4, v10
  v_bfe_u32 v15, v0, 1, 1
  v_lshl_add_u32 v10, v15, 3, v10
  v_lshlrev_b32 v14, 7, v0
  s_cbranch_vccz k1_s1
  s_cmp_ge_u32 s2, 108
  s_cbranch_scc1 k1_ni
  s_lshl_b32 s49, s2, 2
  s_add_u32 s49, s49, s41
  s_lshl_b32 s48, s49, 8
  s_add_u32 s48, s48, 1114112
  s_sub_u32 s49, s49, 144
  s_lshl_b32 s49, s49, 11
  s_cmp_lt_u32 s2, 36
  s_cselect_b32 s49, s48, s49
  s_cselect_b32 s48, 16, 128
  s_lshl_b32 s48, s48, 4
  s_add_u32 s52, s10, 51560448
  s_addc_u32 s53, s11, 0
  s_add_u32 s52, s52, s49
  s_addc_u32 s53, s53, 0
  s_mov_b32 s54, s48
  s_mov_b32 s55, 0x20000
  v_mov_b32 v16, -1
  v_mov_b32 v17, -1
  v_mov_b32 v18, -1
  v_mov_b32 v19, -1
  buffer_store_dwordx4 v[16:19], v1, s[52:55], 0 offen sc1
  buffer_store_dwordx4 v[16:19], v1, s[52:55], 0 offen offset:1024 sc1
  s_waitcnt vmcnt(0)
k1_ni:
k1_s1:
  s_add_u32 m0, s46, 0
  s_mov_b32 s48, 0
  buffer_load_dwordx4 v2, s[12:15], s48 offen lds
  s_add_u32 m0, s46, 1024
  s_mov_b32 s48, 32768
  buffer_load_dwordx4 v2, s[12:15], s48 offen lds
  s_add_u32 m0, s46, 16384
  s_mov_b32 s48, 524288
  buffer_load_dwordx4 v2, s[12:15], s48 offen lds
  s_add_u32 m0, s46, 17408
  s_mov_b32 s48, 557056
  buffer_load_dwordx4 v2, s[12:15], s48 offen lds
  s_add_u32 m0, s46, 32768
  s_mov_b32 s48, 1048576
  buffer_load_dwordx4 v2, s[12:15], s48 offen lds
  s_add_u32 m0, s46, 33792
  s_mov_b32 s48, 1081344
  buffer_load_dwordx4 v2, s[12:15], s48 offen lds
  s_add_u32 m0, s46, 49152
  s_mov_b32 s48, 1572864
  buffer_load_dwordx4 v2, s[12:15], s48 offen lds
  s_add_u32 m0, s46, 50176
  s_mov_b32 s48, 1605632
  buffer_load_dwordx4 v2, s[12:15], s48 offen lds
  s_cbranch_vccz k1_s2
  s_add_u32 s52, s50, 252
  s_addc_u32 s53, s51, 0
  s_mov_b32 s54, 4
  s_mov_b32 s55, 0x20000
  s_barrier
  s_barrier
  s_cmp_lg_u32 s3, 4
  s_cbranch_scc1 k1_go
k1_poll:
  buffer_load_dword v12, v14, s[52:55], 0 offen sc1
  s_waitcnt vmcnt(0)
  v_readfirstlane_b32 s49, v12
  s_nop 3
  s_cmp_eq_u32 s49, 1
  s_cbranch_scc1 k1_p2
  s_sleep 2
  s_branch k1_poll
k1_p2:
  s_lshl_b32 s49, s31, 12
  s_add_u32 s52, s10, 52674560
  s_addc_u32 s53, s11, 0
  s_add_u32 s52, s52, s49
  s_addc_u32 s53, s53, 0
  s_mov_b32 s54, 4096
  s_mov_b32 s55, 0x20000
k1_p3:
  buffer_load_dword v12, v14, s[52:55], 0 offen sc1
  s_waitcnt vmcnt(0)
  v_cmp_ne_u32 s[48:49], 0, v12
  s_nop 4
  s_cmp_eq_u64 s[48:49], 0
  s_cbranch_scc1 k1_go
  s_sleep 2
  s_branch k1_p3
k1_go:
k1_s2:
  s_barrier
  s_mov_b32 s48, 0
  buffer_load_dwordx4 v[80:83], v1, s[24:27], s48 offen offset:0 sc1
  s_mov_b32 s48, 0
  buffer_load_dwordx4 v[84:87], v1, s[24:27], s48 offen offset:1024 sc1
  s_mov_b32 s48, 0
  buffer_load_dwordx4 v[88:91], v1, s[24:27], s48 offen offset:2048 sc1
  s_mov_b32 s48, 0
  buffer_load_dwordx4 v[92:95], v1, s[24:27], s48 offen offset:3072 sc1
  s_mov_b32 s48, 4096
  buffer_load_dwordx4 v[96:99], v1, s[24:27], s48 offen offset:0 sc1
  s_mov_b32 s48, 4096
  buffer_load_dwordx4 v[100:103], v1, s[24:27], s48 offen offset:1024 sc1
  s_mov_b32 s48, 4096
  buffer_load_dwordx4 v[104:107], v1, s[24:27], s48 offen offset:2048 sc1
  s_mov_b32 s48, 4096
  buffer_load_dwordx4 v[108:111], v1, s[24:27], s48 offen offset:3072 sc1
  s_mov_b32 s48, 8192
  buffer_load_dwordx4 v[112:115], v1, s[24:27], s48 offen offset:0 sc1
  s_mov_b32 s48, 8192
  buffer_load_dwordx4 v[116:119], v1, s[24:27], s48 offen offset:1024 sc1
  s_mov_b32 s48, 8192
  buffer_load_dwordx4 v[120:123], v1, s[24:27], s48 offen offset:2048 sc1
  s_mov_b32 s48, 8192
  buffer_load_dwordx4 v[124:127], v1, s[24:27], s48 offen offset:3072 sc1
  s_mov_b32 s48, 12288
  buffer_load_dwordx4 v[128:131], v1, s[24:27], s48 offen offset:0 sc1
  s_mov_b32 s48, 12288
  buffer_load_dwordx4 v[132:135], v1, s[24:27], s48 offen offset:1024 sc1
  s_mov_b32 s48, 12288
  buffer_load_dwordx4 v[136:139], v1, s[24:27], s48 offen offset:2048 sc1
  s_mov_b32 s48, 12288
  buffer_load_dwordx4 v[140:143], v1, s[24:27], s48 offen offset:3072 sc1
  s_cbranch_vccz k1_s3
  s_waitcnt vmcnt(22)
  s_barrier
k1_s3:
  s_waitcnt vmcnt(12)
  s_barrier
  s_add_u32 m0, s46, 65536
  s_mov_b32 s48, 2097152
  buffer_load_dwordx4 v2, s[12:15], s48 offen lds
  s_add_u32 m0, s46, 66560
  s_mov_b32 s48, 2129920
  buffer_load_dwordx4 v2, s[12:15], s48 offen lds
  v_xor_b32 v216, 0, v10
  v_add_u32 v216, 0, v216
  v_xor_b32 v217, 64, v10
  v_add_u32 v217, 0, v217
  v_xor_b32 v218, 128, v10
  v_add_u32 v218, 0, v218
  v_xor_b32 v219, 192, v10
  v_add_u32 v219, 0, v219
  ds_read_b64_tr_b16 v[176:177], v216 offset:0
  ds_read_b64_tr_b16 v[178:179], v216 offset:1024
  ds_read_b64_tr_b16 v[180:181], v217 offset:0
  ds_read_b64_tr_b16 v[182:183], v217 offset:1024
  ds_read_b64_tr_b16 v[184:185], v218 offset:0
  ds_read_b64_tr_b16 v[186:187], v218 offset:1024
  ds_read_b64_tr_b16 v[188:189], v219 offset:0
  ds_read_b64_tr_b16 v[190:191], v219 offset:1024
  s_waitcnt lgkmcnt(6)
  v_mfma_f32_32x32x16_bf16 v[16:31], v[176:179], v[80:83], 0
  ds_read_b64_tr_b16 v[192:193], v216 offset:4096
  ds_read_b64_tr_b16 v[194:195], v216 offset:5120
  s_waitcnt lgkmcnt(6)
  v_mfma_f32_32x32x16_bf16 v[32:47], v[180:183], v[80:83], 0
  ds_read_b64_tr_b16 v[196:197], v217 offset:4096
  ds_read_b64_tr_b16 v[198:199], v217 offset:5120
  s_waitcnt lgkmcnt(6)
  v_mfma_f32_32x32x16_bf16 v[48:63], v[184:187], v[80:83], 0
  ds_read_b64_tr_b16 v[200:201], v218 offset:4096
  ds_read_b64_tr_b16 v[202:203], v218 offset:5120
  s_waitcnt lgkmcnt(6)
  v_mfma_f32_32x32x16_bf16 v[64:79], v[188:191], v[80:83], 0
  ds_read_b64_tr_b16 v[204:205], v219 offset:4096
  ds_read_b64_tr_b16 v[206:207], v219 offset:5120
  s_waitcnt lgkmcnt(6)
  v_mfma_f32_32x32x16_bf16 v[16:31], v[192:195], v[84:87], v[16:31]
  ds_read_b64_tr_b16 v[176:177], v216 offset:8192
  ds_read_b64_tr_b16 v[178:179], v216 offset:9216
  s_waitcnt lgkmcnt(6)
  v_mfma_f32_32x32x16_bf16 v[32:47], v[196:199], v[84:87], v[32:47]
  ds_read_b64_tr_b16 v[180:181], v217 offset:8192
  ds_read_b64_tr_b16 v[182:183], v217 offset:9216
  s_waitcnt lgkmcnt(6)
  v_mfma_f32_32x32x16_bf16 v[48:63], v[200:203], v[84:87], v[48:63]
  ds_read_b64_tr_b16 v[184:185], v218 offset:8192
  ds_read_b64_tr_b16 v[186:187], v218 offset:9216
  s_waitcnt lgkmcnt(6)
  v_mfma_f32_32x32x16_bf16 v[64:79], v[204:207], v[84:87], v[64:79]
  ds_read_b64_tr_b16 v[188:189], v219 offset:8192
  ds_read_b64_tr_b16 v[190:191], v219 offset:9216
  s_waitcnt lgkmcnt(6)
  v_mfma_f32_32x32x16_bf16 v[16:31], v[176:179], v[88:91], v[16:31]
  ds_read_b64_tr_b16 v[192:193], v216 offset:12288
  ds_read_b64_tr_b16 v[194:195], v216 offset:13312
  s_waitcnt lgkmcnt(6)
  v_mfma_f32_32x32x16_bf16 v[32:47], v[180:183], v[88:91], v[32:47]
  ds_read_b64_tr_b16 v[196:197], v217 offset:12288
  ds_read_b64_tr_b16 v[198:199], v217 offset:13312
  s_waitcnt lgkmcnt(6)
  v_mfma_f32_32x32x16_bf16 v[48:63], v[184:187], v[88:91], v[48:63]
  ds_read_b64_tr_b16 v[200:201], v218 offset:12288
  ds_read_b64_tr_b16 v[202:203], v218 offset:13312
  s_waitcnt lgkmcnt(6)
  v_mfma_f32_32x32x16_bf16 v[64:79], v[188:191], v[88:91], v[64:79]
  ds_read_b64_tr_b16 v[204:205], v219 offset:12288
  ds_read_b64_tr_b16 v[206:207], v219 offset:13312
  s_waitcnt lgkmcnt(6)
  v_mfma_f32_32x32x16_bf16 v[16:31], v[192:195], v[92:95], v[16:31]
  s_waitcnt lgkmcnt(4)
  v_mfma_f32_32x32x16_bf16 v[32:47], v[196:199], v[92:95], v[32:47]
  s_waitcnt lgkmcnt(2)
  v_mfma_f32_32x32x16_bf16 v[48:63], v[200:203], v[92:95], v[48:63]
  s_waitcnt lgkmcnt(0)
  v_mfma_f32_32x32x16_bf16 v[64:79], v[204:207], v[92:95], v[64:79]
  s_waitcnt vmcnt(10)
  s_barrier
  s_add_u32 m0, s46, 81920
  s_mov_b32 s48, 2621440
  buffer_load_dwordx4 v2, s[12:15], s48 offen lds
  s_add_u32 m0, s46, 82944
  s_mov_b32 s48, 2654208
  buffer_load_dwordx4 v2, s[12:15], s48 offen lds
  s_mov_b32 s48, 16384
  buffer_load_dwordx4 v[80:83], v1, s[24:27], s48 offen offset:0 sc1
  s_mov_b32 s48, 16384
  buffer_load_dwordx4 v[84:87], v1, s[24:27], s48 offen offset:1024 sc1
  s_mov_b32 s48, 16384
  buffer_load_dwordx4 v[88:91], v1, s[24:27], s48 offen offset:2048 sc1
  s_mov_b32 s48, 16384
  buffer_load_dwordx4 v[92:95], v1, s[24:27], s48 offen offset:3072 sc1
  s_cbranch_vccz k1_s4
  s_add_u32 m0, s47, 0
  s_mov_b32 s48, 0
  buffer_load_dwordx4 v4, s[16:19], s48 offen offset:0 lds
  buffer_load_dwordx4 v5, s[16:19], s48 offen offset:1024 lds
  buffer_load_dwordx4 v6, s[16:19], s48 offen offset:2048 lds
  buffer_load_dwordx4 v7, s[16:19], s48 offen offset:3072 lds
k1_s4:
  v_xor_b32 v216, 0, v10
  v_add_u32 v216, 16384, v216
  v_xor_b32 v217, 64, v10
  v_add_u32 v217, 16384, v217
  v_xor_b32 v218, 128, v10
  v_add_u32 v218, 16384, v218
  v_xor_b32 v219, 192, v10
  v_add_u32 v219, 16384, v219
  ds_read_b64_tr_b16 v[176:177], v216 offset:0
  ds_read_b64_tr_b16 v[178:179], v216 offset:1024
  ds_read_b64_tr_b16 v[180:181], v217 offset:0
  ds_read_b64_tr_b16 v[182:183], v217 offset:1024
  ds_read_b64_tr_b16 v[184:185], v218 offset:0
  ds_read_b64_tr_b16 v[186:187], v218 offset:1024
  ds_read_b64_tr_b16 v[188:189], v219 offset:0
  ds_read_b64_tr_b16 v[190:191], v219 offset:1024
  s_waitcnt lgkmcnt(6)
  v_mfma_f32_32x32x16_bf16 v[16:31], v[176:179], v[96:99], v[16:31]
  ds_read_b64_tr_b16 v[192:193], v216 offset:4096
  ds_read_b64_tr_b16 v[194:195], v216 offset:5120
  s_waitcnt lgkmcnt(6)
  v_mfma_f32_32x32x16_bf16 v[32:47], v[180:183], v[96:99], v[32:47]
  ds_read_b64_tr_b16 v[196:197], v217 offset:4096
  ds_read_b64_tr_b16 v[198:199], v217 offset:5120
  s_waitcnt lgkmcnt(6)
  v_mfma_f32_32x32x16_bf16 v[48:63], v[184:187], v[96:99], v[48:63]
  ds_read_b64_tr_b16 v[200:201], v218 offset:4096
  ds_read_b64_tr_b16 v[202:203], v218 offset:5120
  s_waitcnt lgkmcnt(6)
  v_mfma_f32_32x32x16_bf16 v[64:79], v[188:191], v[96:99], v[64:79]
  ds_read_b64_tr_b16 v[204:205], v219 offset:4096
  ds_read_b64_tr_b16 v[206:207], v219 offset:5120
  s_waitcnt lgkmcnt(6)
  v_mfma_f32_32x32x16_bf16 v[16:31], v[192:195], v[100:103], v[16:31]
  ds_read_b64_tr_b16 v[176:177], v216 offset:8192
  ds_read_b64_tr_b16 v[178:179], v216 offset:9216
  s_waitcnt lgkmcnt(6)
  v_mfma_f32_32x32x16_bf16 v[32:47], v[196:199], v[100:103], v[32:47]
  ds_read_b64_tr_b16 v[180:181], v217 offset:8192
  ds_read_b64_tr_b16 v[182:183], v217 offset:9216
  s_waitcnt lgkmcnt(6)
  v_mfma_f32_32x32x16_bf16 v[48:63], v[200:203], v[100:103], v[48:63]
  ds_read_b64_tr_b16 v[184:185], v218 offset:8192
  ds_read_b64_tr_b16 v[186:187], v218 offset:9216
  s_waitcnt lgkmcnt(6)
  v_mfma_f32_32x32x16_bf16 v[64:79], v[204:207], v[100:103], v[64:79]
  ds_read_b64_tr_b16 v[188:189], v219 offset:8192
  ds_read_b64_tr_b16 v[190:191], v219 offset:9216
  s_waitcnt lgkmcnt(6)
  v_mfma_f32_32x32x16_bf16 v[16:31], v[176:179], v[104:107], v[16:31]
  ds_read_b64_tr_b16 v[192:193], v216 offset:12288
  ds_read_b64_tr_b16 v[194:195], v216 offset:13312
  s_waitcnt lgkmcnt(6)
  v_mfma_f32_32x32x16_bf16 v[32:47], v[180:183], v[104:107], v[32:47]
  ds_read_b64_tr_b16 v[196:197], v217 offset:12288
  ds_read_b64_tr_b16 v[198:199], v217 offset:13312
  s_waitcnt lgkmcnt(6)
  v_mfma_f32_32x32x16_bf16 v[48:63], v[184:187], v[104:107], v[48:63]
  ds_read_b64_tr_b16 v[200:201], v218 offset:12288
  ds_read_b64_tr_b16 v[202:203], v218 offset:13312
  s_waitcnt lgkmcnt(6)
  v_mfma_f32_32x32x16_bf16 v[64:79], v[188:191], v[104:107], v[64:79]
  ds_read_b64_tr_b16 v[204:205], v219 offset:12288
  ds_read_b64_tr_b16 v[206:207], v219 offset:13312
  s_waitcnt lgkmcnt(6)
  v_mfma_f32_32x32x16_bf16 v[16:31], v[192:195], v[108:111], v[16:31]
  s_waitcnt lgkmcnt(4)
  v_mfma_f32_32x32x16_bf16 v[32:47], v[196:199], v[108:111], v[32:47]
  s_waitcnt lgkmcnt(2)
  v_mfma_f32_32x32x16_bf16 v[48:63], v[200:203], v[108:111], v[48:63]
  s_waitcnt lgkmcnt(0)
  v_mfma_f32_32x32x16_bf16 v[64:79], v[204:207], v[108:111], v[64:79]
  s_cbranch_vccnz k1_s5
  s_waitcnt vmcnt(12)
k1_s5:
  s_cbranch_vccz k1_s6
  s_waitcnt vmcnt(16)
k1_s6:
  s_barrier
  s_add_u32 m0, s46, 98304
  s_mov_b32 s48, 3145728
  buffer_load_dwordx4 v2, s[12:15], s48 offen lds
  s_add_u32 m0, s46, 99328
  s_mov_b32 s48, 3178496
  buffer_load_dwordx4 v2, s[12:15], s48 offen lds
  s_mov_b32 s48, 20480
  buffer_load_dwordx4 v[96:99], v1, s[24:27], s48 offen offset:0 sc1
  s_mov_b32 s48, 20480
  buffer_load_dwordx4 v[100:103], v1, s[24:27], s48 offen offset:1024 sc1
  s_mov_b32 s48, 20480
  buffer_load_dwordx4 v[104:107], v1, s[24:27], s48 offen offset:2048 sc1
  s_mov_b32 s48, 20480
  buffer_load_dwordx4 v[108:111], v1, s[24:27], s48 offen offset:3072 sc1
  s_cbranch_vccz k1_s7
  s_add_u32 m0, s47, 16384
  s_mov_b32 s48, 16384
  buffer_load_dwordx4 v4, s[16:19], s48 offen offset:0 lds
  buffer_load_dwordx4 v5, s[16:19], s48 offen offset:1024 lds
  buffer_load_dwordx4 v6, s[16:19], s48 offen offset:2048 lds
  buffer_load_dwordx4 v7, s[16:19], s48 offen offset:3072 lds
k1_s7:
  v_xor_b32 v216, 0, v10
  v_add_u32 v216, 32768, v216
  v_xor_b32 v217, 64, v10
  v_add_u32 v217, 32768, v217
  v_xor_b32 v218, 128, v10
  v_add_u32 v218, 32768, v218
  v_xor_b32 v219, 192, v10
  v_add_u32 v219, 32768, v219
  ds_read_b64_tr_b16 v[176:177], v216 offset:0
  ds_read_b64_tr_b16 v[178:179], v216 offset:1024
  ds_read_b64_tr_b16 v[180:181], v217 offset:0
  ds_read_b64_tr_b16 v[182:183], v217 offset:1024
  ds_read_b64_tr_b16 v[184:185], v218 offset:0
  ds_read_b64_tr_b16 v[186:187], v218 offset:1024
  ds_read_b64_tr_b16 v[188:189], v219 offset:0
  ds_read_b64_tr_b16 v[190:191], v219 offset:1024
  s_waitcnt lgkmcnt(6)
  v_mfma_f32_32x32x16_bf16 v[16:31], v[176:179], v[112:115], v[16:31]
  ds_read_b64_tr_b16 v[192:193], v216 offset:4096
  ds_read_b64_tr_b16 v[194:195], v216 offset:5120
  s_waitcnt lgkmcnt(6)
  v_mfma_f32_32x32x16_bf16 v[32:47], v[180:183], v[112:115], v[32:47]
  ds_read_b64_tr_b16 v[196:197], v217 offset:4096
  ds_read_b64_tr_b16 v[198:199], v217 offset:5120
  s_waitcnt lgkmcnt(6)
  v_mfma_f32_32x32x16_bf16 v[48:63], v[184:187], v[112:115], v[48:63]
  ds_read_b64_tr_b16 v[200:201], v218 offset:4096
  ds_read_b64_tr_b16 v[202:203], v218 offset:5120
  s_waitcnt lgkmcnt(6)
  v_mfma_f32_32x32x16_bf16 v[64:79], v[188:191], v[112:115], v[64:79]
  ds_read_b64_tr_b16 v[204:205], v219 offset:4096
  ds_read_b64_tr_b16 v[206:207], v219 offset:5120
  s_waitcnt lgkmcnt(6)
  v_mfma_f32_32x32x16_bf16 v[16:31], v[192:195], v[116:119], v[16:31]
  ds_read_b64_tr_b16 v[176:177], v216 offset:8192
  ds_read_b64_tr_b16 v[178:179], v216 offset:9216
  s_waitcnt lgkmcnt(6)
  v_mfma_f32_32x32x16_bf16 v[32:47], v[196:199], v[116:119], v[32:47]
  ds_read_b64_tr_b16 v[180:181], v217 offset:8192
  ds_read_b64_tr_b16 v[182:183], v217 offset:9216
  s_waitcnt lgkmcnt(6)
  v_mfma_f32_32x32x16_bf16 v[48:63], v[200:203], v[116:119], v[48:63]
  ds_read_b64_tr_b16 v[184:185], v218 offset:8192
  ds_read_b64_tr_b16 v[186:187], v218 offset:9216
  s_waitcnt lgkmcnt(6)
  v_mfma_f32_32x32x16_bf16 v[64:79], v[204:207], v[116:119], v[64:79]
  ds_read_b64_tr_b16 v[188:189], v219 offset:8192
  ds_read_b64_tr_b16 v[190:191], v219 offset:9216
  s_waitcnt lgkmcnt(6)
  v_mfma_f32_32x32x16_bf16 v[16:31], v[176:179], v[120:123], v[16:31]
  ds_read_b64_tr_b16 v[192:193], v216 offset:12288
  ds_read_b64_tr_b16 v[194:195], v216 offset:13312
  s_waitcnt lgkmcnt(6)
  v_mfma_f32_32x32x16_bf16 v[32:47], v[180:183], v[120:123], v[32:47]
  ds_read_b64_tr_b16 v[196:197], v217 offset:12288
  ds_read_b64_tr_b16 v[198:199], v217 offset:13312
  s_waitcnt lgkmcnt(6)
  v_mfma_f32_32x32x16_bf16 v[48:63], v[184:187], v[120:123], v[48:63]
  ds_read_b64_tr_b16 v[200:201], v218 offset:12288
  ds_read_b64_tr_b16 v[202:203], v218 offset:13312
  s_waitcnt lgkmcnt(6)
  v_mfma_f32_32x32x16_bf16 v[64:79], v[188:191], v[120:123], v[64:79]
  ds_read_b64_tr_b16 v[204:205], v219 offset:12288
  ds_read_b64_tr_b16 v[206:207], v219 offset:13312
  s_waitcnt lgkmcnt(6)
  v_mfma_f32_32x32x16_bf16 v[16:31], v[192:195], v[124:127], v[16:31]
  s_waitcnt lgkmcnt(4)
  v_mfma_f32_32x32x16_bf16 v[32:47], v[196:199], v[124:127], v[32:47]
  s_waitcnt lgkmcnt(2)
  v_mfma_f32_32x32x16_bf16 v[48:63], v[200:203], v[124:127], v[48:63]
  s_waitcnt lgkmcnt(0)
  v_mfma_f32_32x32x16_bf16 v[64:79], v[204:207], v[124:127], v[64:79]
  s_cbranch_vccnz k1_s8
  s_waitcnt vmcnt(14)
k1_s8:
  s_cbranch_vccz k1_s9
  s_waitcnt vmcnt(20)
k1_s9:
  s_barrier
  s_add_u32 m0, s46, 114688
  s_mov_b32 s48, 3670016
  buffer_load_dwordx4 v2, s[12:15], s48 offen lds
  s_add_u32 m0, s46, 115712
  s_mov_b32 s48, 3702784
  buffer_load_dwordx4 v2, s[12:15], s48 offen lds
  s_mov_b32 s48, 24576
  buffer_load_dwordx4 v[112:115], v1, s[24:27], s48 offen offset:0 sc1
  s_mov_b32 s48, 24576
  buffer_load_dwordx4 v[116:119], v1, s[24:27], s48 offen offset:1024 sc1
  s_mov_b32 s48, 24576
  buffer_load_dwordx4 v[120:123], v1, s[24:27], s48 offen offset:2048 sc1
  s_mov_b32 s48, 24576
  buffer_load_dwordx4 v[124:127], v1, s[24:27], s48 offen offset:3072 sc1
  s_cbranch_vccz k1_s10
  s_add_u32 m0, s47, 32768
  s_mov_b32 s48, 0
  buffer_load_dwordx4 v3, s[20:23], s48 offen offset:0 lds
  buffer_load_dwordx4 v3, s[20:23], s48 offen offset:1024 lds
  buffer_load_dwordx4 v3, s[20:23], s48 offen offset:2048 lds
  buffer_load_dwordx4 v3, s[20:23], s48 offen offset:3072 lds
k1_s10:
  v_xor_b32 v216, 0, v10
  v_add_u32 v216, 49152, v216
  v_xor_b32 v217, 64, v10
  v_add_u32 v217, 49152, v217
  v_xor_b32 v218, 128, v10
  v_add_u32 v218, 49152, v218
  v_xor_b32 v219, 192, v10
  v_add_u32 v219, 49152, v219
  ds_read_b64_tr_b16 v[176:177], v216 offset:0
  ds_read_b64_tr_b16 v[178:179], v216 offset:1024
  ds_read_b64_tr_b16 v[180:181], v217 offset:0
  ds_read_b64_tr_b16 v[182:183], v217 offset:1024
  ds_read_b64_tr_b16 v[184:185], v218 offset:0
  ds_read_b64_tr_b16 v[186:187], v218 offset:1024
  ds_read_b64_tr_b16 v[188:189], v219 offset:0
  ds_read_b64_tr_b16 v[190:191], v219 offset:1024
  s_waitcnt lgkmcnt(6)
  v_mfma_f32_32x32x16_bf16 v[16:31], v[176:179], v[128:131], v[16:31]
  ds_read_b64_tr_b16 v[192:193], v216 offset:4096
  ds_read_b64_tr_b16 v[194:195], v216 offset:5120
  s_waitcnt lgkmcnt(6)
  v_mfma_f32_32x32x16_bf16 v[32:47], v[180:183], v[128:131], v[32:47]
  ds_read_b64_tr_b16 v[196:197], v217 offset:4096
  ds_read_b64_tr_b16 v[198:199], v217 offset:5120
  s_waitcnt lgkmcnt(6)
  v_mfma_f32_32x32x16_bf16 v[48:63], v[184:187], v[128:131], v[48:63]
  ds_read_b64_tr_b16 v[200:201], v218 offset:4096
  ds_read_b64_tr_b16 v[202:203], v218 offset:5120
  s_waitcnt lgkmcnt(6)
  v_mfma_f32_32x32x16_bf16 v[64:79], v[188:191], v[128:131], v[64:79]
  ds_read_b64_tr_b16 v[204:205], v219 offset:4096
  ds_read_b64_tr_b16 v[206:207], v219 offset:5120
  s_waitcnt lgkmcnt(6)
  v_mfma_f32_32x32x16_bf16 v[16:31], v[192:195], v[132:135], v[16:31]
  ds_read_b64_tr_b16 v[176:177], v216 offset:8192
  ds_read_b64_tr_b16 v[178:179], v216 offset:9216
  s_waitcnt lgkmcnt(6)
  v_mfma_f32_32x32x16_bf16 v[32:47], v[196:199], v[132:135], v[32:47]
  ds_read_b64_tr_b16 v[180:181], v217 offset:8192
  ds_read_b64_tr_b16 v[182:183], v217 offset:9216
  s_waitcnt lgkmcnt(6)
  v_mfma_f32_32x32x16_bf16 v[48:63], v[200:203], v[132:135], v[48:63]
  ds_read_b64_tr_b16 v[184:185], v218 offset:8192
  ds_read_b64_tr_b16 v[186:187], v218 offset:9216
  s_waitcnt lgkmcnt(6)
  v_mfma_f32_32x32x16_bf16 v[64:79], v[204:207], v[132:135], v[64:79]
  ds_read_b64_tr_b16 v[188:189], v219 offset:8192
  ds_read_b64_tr_b16 v[190:191], v219 offset:9216
  s_waitcnt lgkmcnt(6)
  v_mfma_f32_32x32x16_bf16 v[16:31], v[176:179], v[136:139], v[16:31]
  ds_read_b64_tr_b16 v[192:193], v216 offset:12288
  ds_read_b64_tr_b16 v[194:195], v216 offset:13312
  s_waitcnt lgkmcnt(6)
  v_mfma_f32_32x32x16_bf16 v[32:47], v[180:183], v[136:139], v[32:47]
  ds_read_b64_tr_b16 v[196:197], v217 offset:12288
  ds_read_b64_tr_b16 v[198:199], v217 offset:13312
  s_waitcnt lgkmcnt(6)
  v_mfma_f32_32x32x16_bf16 v[48:63], v[184:187], v[136:139], v[48:63]
  ds_read_b64_tr_b16 v[200:201], v218 offset:12288
  ds_read_b64_tr_b16 v[202:203], v218 offset:13312
  s_waitcnt lgkmcnt(6)
  v_mfma_f32_32x32x16_bf16 v[64:79], v[188:191], v[136:139], v[64:79]
  ds_read_b64_tr_b16 v[204:205], v219 offset:12288
  ds_read_b64_tr_b16 v[206:207], v219 offset:13312
  s_waitcnt lgkmcnt(6)
  v_mfma_f32_32x32x16_bf16 v[16:31], v[192:195], v[140:143], v[16:31]
  s_waitcnt lgkmcnt(4)
  v_mfma_f32_32x32x16_bf16 v[32:47], v[196:199], v[140:143], v[32:47]
  s_waitcnt lgkmcnt(2)
  v_mfma_f32_32x32x16_bf16 v[48:63], v[200:203], v[140:143], v[48:63]
  s_waitcnt lgkmcnt(0)
  v_mfma_f32_32x32x16_bf16 v[64:79], v[204:207], v[140:143], v[64:79]
  s_cbranch_vccnz k1_s11
  s_waitcnt vmcnt(12)
k1_s11:
  s_cbranch_vccz k1_s12
  s_waitcnt vmcnt(24)
k1_s12:
  s_barrier
  s_add_u32 m0, s46, 131072
  s_mov_b32 s48, 4194304
  buffer_load_dwordx4 v2, s[12:15], s48 offen lds
  s_add_u32 m0, s46, 132096
  s_mov_b32 s48, 4227072
  buffer_load_dwordx4 v2, s[12:15], s48 offen lds
  s_mov_b32 s48, 28672
  buffer_load_dwordx4 v[128:131], v1, s[24:27], s48 offen offset:0 sc1
  s_mov_b32 s48, 28672
  buffer_load_dwordx4 v[132:135], v1, s[24:27], s48 offen offset:1024 sc1
  s_mov_b32 s48, 28672
  buffer_load_dwordx4 v[136:139], v1, s[24:27], s48 offen offset:2048 sc1
  s_mov_b32 s48, 28672
  buffer_load_dwordx4 v[140:143], v1, s[24:27], s48 offen offset:3072 sc1
  s_cbranch_vccz k1_s13
  s_add_u32 m0, s47, 49152
  s_mov_b32 s48, 16384
  buffer_load_dwordx4 v3, s[20:23], s48 offen offset:0 lds
  buffer_load_dwordx4 v3, s[20:23], s48 offen offset:1024 lds
  buffer_load_dwordx4 v3, s[20:23], s48 offen offset:2048 lds
  buffer_load_dwordx4 v3, s[20:23], s48 offen offset:3072 lds
k1_s13:
  v_xor_b32 v216, 0, v10
  v_add_u32 v216, 65536, v216
  v_xor_b32 v217, 64, v10
  v_add_u32 v217, 65536, v217
  v_xor_b32 v218, 128, v10
  v_add_u32 v218, 65536, v218
  v_xor_b32 v219, 192, v10
  v_add_u32 v219, 65536, v219
  ds_read_b64_tr_b16 v[176:177], v216 offset:0
  ds_read_b64_tr_b16 v[178:179], v216 offset:1024
  ds_read_b64_tr_b16 v[180:181], v217 offset:0
  ds_read_b64_tr_b16 v[182:183], v217 offset:1024
  ds_read_b64_tr_b16 v[184:185], v218 offset:0
  ds_read_b64_tr_b16 v[186:187], v218 offset:1024
  ds_read_b64_tr_b16 v[188:189], v219 offset:0
  ds_read_b64_tr_b16 v[190:191], v219 offset:1024
  s_waitcnt lgkmcnt(6)
  v_mfma_f32_32x32x16_bf16 v[16:31], v[176:179], v[80:83], v[16:31]
  ds_read_b64_tr_b16 v[192:193], v216 offset:4096
  ds_read_b64_tr_b16 v[194:195], v216 offset:5120
  s_waitcnt lgkmcnt(6)
  v_mfma_f32_32x32x16_bf16 v[32:47], v[180:183], v[80:83], v[32:47]
  ds_read_b64_tr_b16 v[196:197], v217 offset:4096
  ds_read_b64_tr_b16 v[198:199], v217 offset:5120
  s_waitcnt lgkmcnt(6)
  v_mfma_f32_32x32x16_bf16 v[48:63], v[184:187], v[80:83], v[48:63]
  ds_read_b64_tr_b16 v[200:201], v218 offset:4096
  ds_read_b64_tr_b16 v[202:203], v218 offset:5120
  s_waitcnt lgkmcnt(6)
  v_mfma_f32_32x32x16_bf16 v[64:79], v[188:191], v[80:83], v[64:79]
  ds_read_b64_tr_b16 v[204:205], v219 offset:4096
  ds_read_b64_tr_b16 v[206:207], v219 offset:5120
  s_waitcnt lgkmcnt(6)
  v_mfma_f32_32x32x16_bf16 v[16:31], v[192:195], v[84:87], v[16:31]
  ds_read_b64_tr_b16 v[176:177], v216 offset:8192
  ds_read_b64_tr_b16 v[178:179], v216 offset:9216
  s_waitcnt lgkmcnt(6)
  v_mfma_f32_32x32x16_bf16 v[32:47], v[196:199], v[84:87], v[32:47]
  ds_read_b64_tr_b16 v[180:181], v217 offset:8192
  ds_read_b64_tr_b16 v[182:183], v217 offset:9216
  s_waitcnt lgkmcnt(6)
  v_mfma_f32_32x32x16_bf16 v[48:63], v[200:203], v[84:87], v[48:63]
  ds_read_b64_tr_b16 v[184:185], v218 offset:8192
  ds_read_b64_tr_b16 v[186:187], v218 offset:9216
  s_waitcnt lgkmcnt(6)
  v_mfma_f32_32x32x16_bf16 v[64:79], v[204:207], v[84:87], v[64:79]
  ds_read_b64_tr_b16 v[188:189], v219 offset:8192
  ds_read_b64_tr_b16 v[190:191], v219 offset:9216
  s_waitcnt lgkmcnt(6)
  v_mfma_f32_32x32x16_bf16 v[16:31], v[176:179], v[88:91], v[16:31]
  ds_read_b64_tr_b16 v[192:193], v216 offset:12288
  ds_read_b64_tr_b16 v[194:195], v216 offset:13312
  s_waitcnt lgkmcnt(6)
  v_mfma_f32_32x32x16_bf16 v[32:47], v[180:183], v[88:91], v[32:47]
  ds_read_b64_tr_b16 v[196:197], v217 offset:12288
  ds_read_b64_tr_b16 v[198:199], v217 offset:13312
  s_waitcnt lgkmcnt(6)
  v_mfma_f32_32x32x16_bf16 v[48:63], v[184:187], v[88:91], v[48:63]
  ds_read_b64_tr_b16 v[200:201], v218 offset:12288
  ds_read_b64_tr_b16 v[202:203], v218 offset:13312
  s_waitcnt lgkmcnt(6)
  v_mfma_f32_32x32x16_bf16 v[64:79], v[188:191], v[88:91], v[64:79]
  ds_read_b64_tr_b16 v[204:205], v219 offset:12288
  ds_read_b64_tr_b16 v[206:207], v219 offset:13312
  s_waitcnt lgkmcnt(6)
  v_mfma_f32_32x32x16_bf16 v[16:31], v[192:195], v[92:95], v[16:31]
  s_waitcnt lgkmcnt(4)
  v_mfma_f32_32x32x16_bf16 v[32:47], v[196:199], v[92:95], v[32:47]
  s_waitcnt lgkmcnt(2)
  v_mfma_f32_32x32x16_bf16 v[48:63], v[200:203], v[92:95], v[48:63]
  s_waitcnt lgkmcnt(0)
  v_mfma_f32_32x32x16_bf16 v[64:79], v[204:207], v[92:95], v[64:79]
  s_cbranch_vccnz k1_s14
  s_waitcnt vmcnt(12)
k1_s14:
  s_cbranch_vccz k1_s15
  s_waitcnt vmcnt(24)
k1_s15:
  s_barrier
  s_mov_b32 s48, 32768
  buffer_load_dwordx4 v[80:83], v1, s[24:27], s48 offen offset:0 sc1
  s_mov_b32 s48, 32768
  buffer_load_dwordx4 v[84:87], v1, s[24:27], s48 offen offset:1024 sc1
  s_mov_b32 s48, 32768
  buffer_load_dwordx4 v[88:91], v1, s[24:27], s48 offen offset:2048 sc1
  s_mov_b32 s48, 32768
  buffer_load_dwordx4 v[92:95], v1, s[24:27], s48 offen offset:3072 sc1
  s_cbranch_vccz k1_s16
  s_add_u32 m0, s47, 65536
  s_mov_b32 s48, 32768
  buffer_load_dwordx4 v4, s[16:19], s48 offen offset:0 lds
  buffer_load_dwordx4 v5, s[16:19], s48 offen offset:1024 lds
  buffer_load_dwordx4 v6, s[16:19], s48 offen offset:2048 lds
  buffer_load_dwordx4 v7, s[16:19], s48 offen offset:3072 lds
k1_s16:
  v_xor_b32 v216, 0, v10
  v_add_u32 v216, 81920, v216
  v_xor_b32 v217, 64, v10
  v_add_u32 v217, 81920, v217
  v_xor_b32 v218, 128, v10
  v_add_u32 v218, 81920, v218
  v_xor_b32 v219, 192, v10
  v_add_u32 v219, 81920, v219
  ds_read_b64_tr_b16 v[176:177], v216 offset:0
  ds_read_b64_tr_b16 v[178:179], v216 offset:1024
  ds_read_b64_tr_b16 v[180:181], v217 offset:0
  ds_read_b64_tr_b16 v[182:183], v217 offset:1024
  ds_read_b64_tr_b16 v[184:185], v218 offset:0
  ds_read_b64_tr_b16 v[186:187], v218 offset:1024
  ds_read_b64_tr_b16 v[188:189], v219 offset:0
  ds_read_b64_tr_b16 v[190:191], v219 offset:1024
  s_waitcnt lgkmcnt(6)
  v_mfma_f32_32x32x16_bf16 v[16:31], v[176:179], v[96:99], v[16:31]
  ds_read_b64_tr_b16 v[192:193], v216 offset:4096
  ds_read_b64_tr_b16 v[194:195], v216 offset:5120
  s_waitcnt lgkmcnt(6)
  v_mfma_f32_32x32x16_bf16 v[32:47], v[180:183], v[96:99], v[32:47]
  ds_read_b64_tr_b16 v[196:197], v217 offset:4096
  ds_read_b64_tr_b16 v[198:199], v217 offset:5120
  s_waitcnt lgkmcnt(6)
  v_mfma_f32_32x32x16_bf16 v[48:63], v[184:187], v[96:99], v[48:63]
  ds_read_b64_tr_b16 v[200:201], v218 offset:4096
  ds_read_b64_tr_b16 v[202:203], v218 offset:5120
  s_waitcnt lgkmcnt(6)
  v_mfma_f32_32x32x16_bf16 v[64:79], v[188:191], v[96:99], v[64:79]
  ds_read_b64_tr_b16 v[204:205], v219 offset:4096
  ds_read_b64_tr_b16 v[206:207], v219 offset:5120
  s_waitcnt lgkmcnt(6)
  v_mfma_f32_32x32x16_bf16 v[16:31], v[192:195], v[100:103], v[16:31]
  ds_read_b64_tr_b16 v[176:177], v216 offset:8192
  ds_read_b64_tr_b16 v[178:179], v216 offset:9216
  s_waitcnt lgkmcnt(6)
  v_mfma_f32_32x32x16_bf16 v[32:47], v[196:199], v[100:103], v[32:47]
  ds_read_b64_tr_b16 v[180:181], v217 offset:8192
  ds_read_b64_tr_b16 v[182:183], v217 offset:9216
  s_waitcnt lgkmcnt(6)
  v_mfma_f32_32x32x16_bf16 v[48:63], v[200:203], v[100:103], v[48:63]
  ds_read_b64_tr_b16 v[184:185], v218 offset:8192
  ds_read_b64_tr_b16 v[186:187], v218 offset:9216
  s_waitcnt lgkmcnt(6)
  v_mfma_f32_32x32x16_bf16 v[64:79], v[204:207], v[100:103], v[64:79]
  ds_read_b64_tr_b16 v[188:189], v219 offset:8192
  ds_read_b64_tr_b16 v[190:191], v219 offset:9216
  s_waitcnt lgkmcnt(6)
  v_mfma_f32_32x32x16_bf16 v[16:31], v[176:179], v[104:107], v[16:31]
  ds_read_b64_tr_b16 v[192:193], v216 offset:12288
  ds_read_b64_tr_b16 v[194:195], v216 offset:13312
  s_waitcnt lgkmcnt(6)
  v_mfma_f32_32x32x16_bf16 v[32:47], v[180:183], v[104:107], v[32:47]
  ds_read_b64_tr_b16 v[196:197], v217 offset:12288
  ds_read_b64_tr_b16 v[198:199], v217 offset:13312
  s_waitcnt lgkmcnt(6)
  v_mfma_f32_32x32x16_bf16 v[48:63], v[184:187], v[104:107], v[48:63]
  ds_read_b64_tr_b16 v[200:201], v218 offset:12288
  ds_read_b64_tr_b16 v[202:203], v218 offset:13312
  s_waitcnt lgkmcnt(6)
  v_mfma_f32_32x32x16_bf16 v[64:79], v[188:191], v[104:107], v[64:79]
  ds_read_b64_tr_b16 v[204:205], v219 offset:12288
  ds_read_b64_tr_b16 v[206:207], v219 offset:13312
  s_waitcnt lgkmcnt(6)
  v_mfma_f32_32x32x16_bf16 v[16:31], v[192:195], v[108:111], v[16:31]
  s_waitcnt lgkmcnt(4)
  v_mfma_f32_32x32x16_bf16 v[32:47], v[196:199], v[108:111], v[32:47]
  s_waitcnt lgkmcnt(2)
  v_mfma_f32_32x32x16_bf16 v[48:63], v[200:203], v[108:111], v[48:63]
  s_waitcnt lgkmcnt(0)
  v_mfma_f32_32x32x16_bf16 v[64:79], v[204:207], v[108:111], v[64:79]
  s_cbranch_vccnz k1_s17
  s_waitcnt vmcnt(10)
k1_s17:
  s_cbranch_vccz k1_s18
  s_waitcnt vmcnt(16)
k1_s18:
  s_barrier
  s_cbranch_vccz k1_s19
  s_add_u32 m0, s47, 81920
  s_mov_b32 s48, 49152
  buffer_load_dwordx4 v4, s[16:19], s48 offen offset:0 lds
  buffer_load_dwordx4 v5, s[16:19], s48 offen offset:1024 lds
  buffer_load_dwordx4 v6, s[16:19], s48 offen offset:2048 lds
  buffer_load_dwordx4 v7, s[16:19], s48 offen offset:3072 lds
k1_s19:
  v_xor_b32 v216, 0, v10
  v_add_u32 v216, 98304, v216
  v_xor_b32 v217, 64, v10
  v_add_u32 v217, 98304, v217
  v_xor_b32 v218, 128, v10
  v_add_u32 v218, 98304, v218
  v_xor_b32 v219, 192, v10
  v_add_u32 v219, 98304, v219
  ds_read_b64_tr_b16 v[176:177], v216 offset:0
  ds_read_b64_tr_b16 v[178:179], v216 offset:1024
  ds_read_b64_tr_b16 v[180:181], v217 offset:0
  ds_read_b64_tr_b16 v[182:183], v217 offset:1024
  ds_read_b64_tr_b16 v[184:185], v218 offset:0
  ds_read_b64_tr_b16 v[186:187], v218 offset:1024
  ds_read_b64_tr_b16 v[188:189], v219 offset:0
  ds_read_b64_tr_b16 v[190:191], v219 offset:1024
  s_waitcnt lgkmcnt(6)
  v_mfma_f32_32x32x16_bf16 v[16:31], v[176:179], v[112:115], v[16:31]
  ds_read_b64_tr_b16 v[192:193], v216 offset:4096
  ds_read_b64_tr_b16 v[194:195], v216 offset:5120
  s_waitcnt lgkmcnt(6)
  v_mfma_f32_32x32x16_bf16 v[32:47], v[180:183], v[112:115], v[32:47]
  ds_read_b64_tr_b16 v[196:197], v217 offset:4096
  ds_read_b64_tr_b16 v[198:199], v217 offset:5120
  s_waitcnt lgkmcnt(6)
  v_mfma_f32_32x32x16_bf16 v[48:63], v[184:187], v[112:115], v[48:63]
  ds_read_b64_tr_b16 v[200:201], v218 offset:4096
  ds_read_b64_tr_b16 v[202:203], v218 offset:5120
  s_waitcnt lgkmcnt(6)
  v_mfma_f32_32x32x16_bf16 v[64:79], v[188:191], v[112:115], v[64:79]
  ds_read_b64_tr_b16 v[204:205], v219 offset:4096
  ds_read_b64_tr_b16 v[206:207], v219 offset:5120
  s_waitcnt lgkmcnt(6)
  v_mfma_f32_32x32x16_bf16 v[16:31], v[192:195], v[116:119], v[16:31]
  ds_read_b64_tr_b16 v[176:177], v216 offset:8192
  ds_read_b64_tr_b16 v[178:179], v216 offset:9216
  s_waitcnt lgkmcnt(6)
  v_mfma_f32_32x32x16_bf16 v[32:47], v[196:199], v[116:119], v[32:47]
  ds_read_b64_tr_b16 v[180:181], v217 offset:8192
  ds_read_b64_tr_b16 v[182:183], v217 offset:9216
  s_waitcnt lgkmcnt(6)
  v_mfma_f32_32x32x16_bf16 v[48:63], v[200:203], v[116:119], v[48:63]
  ds_read_b64_tr_b16 v[184:185], v218 offset:8192
  ds_read_b64_tr_b16 v[186:187], v218 offset:9216
  s_waitcnt lgkmcnt(6)
  v_mfma_f32_32x32x16_bf16 v[64:79], v[204:207], v[116:119], v[64:79]
  ds_read_b64_tr_b16 v[188:189], v219 offset:8192
  ds_read_b64_tr_b16 v[190:191], v219 offset:9216
  s_waitcnt lgkmcnt(6)
  v_mfma_f32_32x32x16_bf16 v[16:31], v[176:179], v[120:123], v[16:31]
  ds_read_b64_tr_b16 v[192:193], v216 offset:12288
  ds_read_b64_tr_b16 v[194:195], v216 offset:13312
  s_waitcnt lgkmcnt(6)
  v_mfma_f32_32x32x16_bf16 v[32:47], v[180:183], v[120:123], v[32:47]
  ds_read_b64_tr_b16 v[196:197], v217 offset:12288
  ds_read_b64_tr_b16 v[198:199], v217 offset:13312
  s_waitcnt lgkmcnt(6)
  v_mfma_f32_32x32x16_bf16 v[48:63], v[184:187], v[120:123], v[48:63]
  ds_read_b64_tr_b16 v[200:201], v218 offset:12288
  ds_read_b64_tr_b16 v[202:203], v218 offset:13312
  s_waitcnt lgkmcnt(6)
  v_mfma_f32_32x32x16_bf16 v[64:79], v[188:191], v[120:123], v[64:79]
  ds_read_b64_tr_b16 v[204:205], v219 offset:12288
  ds_read_b64_tr_b16 v[206:207], v219 offset:13312
  s_waitcnt lgkmcnt(6)
  v_mfma_f32_32x32x16_bf16 v[16:31], v[192:195], v[124:127], v[16:31]
  s_waitcnt lgkmcnt(4)
  v_mfma_f32_32x32x16_bf16 v[32:47], v[196:199], v[124:127], v[32:47]
  s_waitcnt lgkmcnt(2)
  v_mfma_f32_32x32x16_bf16 v[48:63], v[200:203], v[124:127], v[48:63]
  s_waitcnt lgkmcnt(0)
  v_mfma_f32_32x32x16_bf16 v[64:79], v[204:207], v[124:127], v[64:79]
  s_cbranch_vccnz k1_s20
  s_waitcnt vmcnt(0)
k1_s20:
  s_cbranch_vccz k1_s21
  s_waitcnt vmcnt(8)
k1_s21:
  s_barrier
  v_xor_b32 v216, 0, v10
  v_add_u32 v216, 114688, v216
  v_xor_b32 v217, 64, v10
  v_add_u32 v217, 114688, v217
  v_xor_b32 v218, 128, v10
  v_add_u32 v218, 114688, v218
  v_xor_b32 v219, 192, v10
  v_add_u32 v219, 114688, v219
  ds_read_b64_tr_b16 v[176:177], v216 offset:0
  ds_read_b64_tr_b16 v[178:179], v216 offset:1024
  ds_read_b64_tr_b16 v[180:181], v217 offset:0
  ds_read_b64_tr_b16 v[182:183], v217 offset:1024
  ds_read_b64_tr_b16 v[184:185], v218 offset:0
  ds_read_b64_tr_b16 v[186:187], v218 offset:1024
  ds_read_b64_tr_b16 v[188:189], v219 offset:0
  ds_read_b64_tr_b16 v[190:191], v219 offset:1024
  s_waitcnt lgkmcnt(6)
  v_mfma_f32_32x32x16_bf16 v[16:31], v[176:179], v[128:131], v[16:31]
  ds_read_b64_tr_b16 v[192:193], v216 offset:4096
  ds_read_b64_tr_b16 v[194:195], v216 offset:5120
  s_waitcnt lgkmcnt(6)
  v_mfma_f32_32x32x16_bf16 v[32:47], v[180:183], v[128:131], v[32:47]
  ds_read_b64_tr_b16 v[196:197], v217 offset:4096
  ds_read_b64_tr_b16 v[198:199], v217 offset:5120
  s_waitcnt lgkmcnt(6)
  v_mfma_f32_32x32x16_bf16 v[48:63], v[184:187], v[128:131], v[48:63]
  ds_read_b64_tr_b16 v[200:201], v218 offset:4096
  ds_read_b64_tr_b16 v[202:203], v218 offset:5120
  s_waitcnt lgkmcnt(6)
  v_mfma_f32_32x32x16_bf16 v[64:79], v[188:191], v[128:131], v[64:79]
  ds_read_b64_tr_b16 v[204:205], v219 offset:4096
  ds_read_b64_tr_b16 v[206:207], v219 offset:5120
  s_waitcnt lgkmcnt(6)
  v_mfma_f32_32x32x16_bf16 v[16:31], v[192:195], v[132:135], v[16:31]
  ds_read_b64_tr_b16 v[176:177], v216 offset:8192
  ds_read_b64_tr_b16 v[178:179], v216 offset:9216
  s_waitcnt lgkmcnt(6)
  v_mfma_f32_32x32x16_bf16 v[32:47], v[196:199], v[132:135], v[32:47]
  ds_read_b64_tr_b16 v[180:181], v217 offset:8192
  ds_read_b64_tr_b16 v[182:183], v217 offset:9216
  s_waitcnt lgkmcnt(6)
  v_mfma_f32_32x32x16_bf16 v[48:63], v[200:203], v[132:135], v[48:63]
  ds_read_b64_tr_b16 v[184:185], v218 offset:8192
  ds_read_b64_tr_b16 v[186:187], v218 offset:9216
  s_waitcnt lgkmcnt(6)
  v_mfma_f32_32x32x16_bf16 v[64:79], v[204:207], v[132:135], v[64:79]
  ds_read_b64_tr_b16 v[188:189], v219 offset:8192
  ds_read_b64_tr_b16 v[190:191], v219 offset:9216
  s_waitcnt lgkmcnt(6)
  v_mfma_f32_32x32x16_bf16 v[16:31], v[176:179], v[136:139], v[16:31]
  ds_read_b64_tr_b16 v[192:193], v216 offset:12288
  ds_read_b64_tr_b16 v[194:195], v216 offset:13312
  s_waitcnt lgkmcnt(6)
  v_mfma_f32_32x32x16_bf16 v[32:47], v[180:183], v[136:139], v[32:47]
  ds_read_b64_tr_b16 v[196:197], v217 offset:12288
  ds_read_b64_tr_b16 v[198:199], v217 offset:13312
  s_waitcnt lgkmcnt(6)
  v_mfma_f32_32x32x16_bf16 v[48:63], v[184:187], v[136:139], v[48:63]
  ds_read_b64_tr_b16 v[200:201], v218 offset:12288
  ds_read_b64_tr_b16 v[202:203], v218 offset:13312
  s_waitcnt lgkmcnt(6)
  v_mfma_f32_32x32x16_bf16 v[64:79], v[188:191], v[136:139], v[64:79]
  ds_read_b64_tr_b16 v[204:205], v219 offset:12288
  ds_read_b64_tr_b16 v[206:207], v219 offset:13312
  v_xor_b32 v216, 0, v10
  v_add_u32 v216, 131072, v216
  v_xor_b32 v217, 64, v10
  v_add_u32 v217, 131072, v217
  v_xor_b32 v218, 128, v10
  v_add_u32 v218, 131072, v218
  v_xor_b32 v219, 192, v10
  v_add_u32 v219, 131072, v219
  s_waitcnt lgkmcnt(6)
  v_mfma_f32_32x32x16_bf16 v[16:31], v[192:195], v[140:143], v[16:31]
  ds_read_b64_tr_b16 v[176:177], v216 offset:0
  ds_read_b64_tr_b16 v[178:179], v216 offset:1024
  s_waitcnt lgkmcnt(6)
  v_mfma_f32_32x32x16_bf16 v[32:47], v[196:199], v[140:143], v[32:47]
  ds_read_b64_tr_b16 v[180:181], v217 offset:0
  ds_read_b64_tr_b16 v[182:183], v217 offset:1024
  s_waitcnt lgkmcnt(6)
  v_mfma_f32_32x32x16_bf16 v[48:63], v[200:203], v[140:143], v[48:63]
  ds_read_b64_tr_b16 v[184:185], v218 offset:0
  ds_read_b64_tr_b16 v[186:187], v218 offset:1024
  s_waitcnt lgkmcnt(6)
  v_mfma_f32_32x32x16_bf16 v[64:79], v[204:207], v[140:143], v[64:79]
  ds_read_b64_tr_b16 v[188:189], v219 offset:0
  ds_read_b64_tr_b16 v[190:191], v219 offset:1024
  s_waitcnt lgkmcnt(6)
  v_mfma_f32_32x32x16_bf16 v[16:31], v[176:179], v[80:83], v[16:31]
  ds_read_b64_tr_b16 v[192:193], v216 offset:4096
  ds_read_b64_tr_b16 v[194:195], v216 offset:5120
  s_waitcnt lgkmcnt(6)
  v_mfma_f32_32x32x16_bf16 v[32:47], v[180:183], v[80:83], v[32:47]
  ds_read_b64_tr_b16 v[196:197], v217 offset:4096
  ds_read_b64_tr_b16 v[198:199], v217 offset:5120
  s_waitcnt lgkmcnt(6)
  v_mfma_f32_32x32x16_bf16 v[48:63], v[184:187], v[80:83], v[48:63]
  ds_read_b64_tr_b16 v[200:201], v218 offset:4096
  ds_read_b64_tr_b16 v[202:203], v218 offset:5120
  s_waitcnt lgkmcnt(6)
  v_mfma_f32_32x32x16_bf16 v[64:79], v[188:191], v[80:83], v[64:79]
  ds_read_b64_tr_b16 v[204:205], v219 offset:4096
  ds_read_b64_tr_b16 v[206:207], v219 offset:5120
  s_waitcnt lgkmcnt(6)
  v_mfma_f32_32x32x16_bf16 v[16:31], v[192:195], v[84:87], v[16:31]
  ds_read_b64_tr_b16 v[176:177], v216 offset:8192
  ds_read_b64_tr_b16 v[178:179], v216 offset:9216
  s_waitcnt lgkmcnt(6)
  v_mfma_f32_32x32x16_bf16 v[32:47], v[196:199], v[84:87], v[32:47]
  ds_read_b64_tr_b16 v[180:181], v217 offset:8192
  ds_read_b64_tr_b16 v[182:183], v217 offset:9216
  s_waitcnt lgkmcnt(6)
  v_mfma_f32_32x32x16_bf16 v[48:63], v[200:203], v[84:87], v[48:63]
  ds_read_b64_tr_b16 v[184:185], v218 offset:8192
  ds_read_b64_tr_b16 v[186:187], v218 offset:9216
  s_waitcnt lgkmcnt(6)
  v_mfma_f32_32x32x16_bf16 v[64:79], v[204:207], v[84:87], v[64:79]
  ds_read_b64_tr_b16 v[188:189], v219 offset:8192
  ds_read_b64_tr_b16 v[190:191], v219 offset:9216
  s_waitcnt lgkmcnt(6)
  v_mfma_f32_32x32x16_bf16 v[16:31], v[176:179], v[88:91], v[16:31]
  ds_read_b64_tr_b16 v[192:193], v216 offset:12288
  ds_read_b64_tr_b16 v[194:195], v216 offset:13312
  s_waitcnt lgkmcnt(6)
  v_mfma_f32_32x32x16_bf16 v[32:47], v[180:183], v[88:91], v[32:47]
  ds_read_b64_tr_b16 v[196:197], v217 offset:12288
  ds_read_b64_tr_b16 v[198:199], v217 offset:13312
  s_waitcnt lgkmcnt(6)
  v_mfma_f32_32x32x16_bf16 v[48:63], v[184:187], v[88:91], v[48:63]
  ds_read_b64_tr_b16 v[200:201], v218 offset:12288
  ds_read_b64_tr_b16 v[202:203], v218 offset:13312
  s_waitcnt lgkmcnt(6)
  v_mfma_f32_32x32x16_bf16 v[64:79], v[188:191], v[88:91], v[64:79]
  ds_read_b64_tr_b16 v[204:205], v219 offset:12288
  ds_read_b64_tr_b16 v[206:207], v219 offset:13312
  v_xor_b32 v216, 0, v8
  v_add_u32 v216, 0, v216
  v_xor_b32 v217, 32, v8
  v_add_u32 v217, 0, v217
  v_xor_b32 v218, 64, v8
  v_add_u32 v218, 0, v218
  v_xor_b32 v219, 96, v8
  v_add_u32 v219, 0, v219
  v_xor_b32 v220, 128, v8
  v_add_u32 v220, 0, v220
  v_xor_b32 v221, 160, v8
  v_add_u32 v221, 0, v221
  v_xor_b32 v222, 192, v8
  v_add_u32 v222, 0, v222
  v_xor_b32 v223, 224, v8
  v_add_u32 v223, 0, v223
  s_waitcnt lgkmcnt(6)
  v_mfma_f32_32x32x16_bf16 v[16:31], v[192:195], v[92:95], v[16:31]
  ds_read_b128 v[176:179], v216 offset:0
  s_waitcnt lgkmcnt(5)
  v_mfma_f32_32x32x16_bf16 v[32:47], v[196:199], v[92:95], v[32:47]
  ds_read_b128 v[180:183], v216 offset:8192
  s_waitcnt lgkmcnt(4)
  v_mfma_f32_32x32x16_bf16 v[48:63], v[200:203], v[92:95], v[48:63]
  ds_read_b128 v[184:187], v216 offset:16384
  s_waitcnt lgkmcnt(3)
  v_mfma_f32_32x32x16_bf16 v[64:79], v[204:207], v[92:95], v[64:79]
  ds_read_b128 v[188:191], v216 offset:24576
  s_nop 7
  s_nop 3
  v_cvt_pk_bf16_f32 v144, v16, v17
  v_cvt_pk_bf16_f32 v145, v18, v19
  v_cvt_pk_bf16_f32 v146, v20, v21
  v_cvt_pk_bf16_f32 v147, v22, v23
  v_cvt_pk_bf16_f32 v148, v24, v25
  v_cvt_pk_bf16_f32 v149, v26, v27
  v_cvt_pk_bf16_f32 v150, v28, v29
  v_cvt_pk_bf16_f32 v151, v30, v31
  v_cvt_pk_bf16_f32 v152, v32, v33
  v_cvt_pk_bf16_f32 v153, v34, v35
  v_cvt_pk_bf16_f32 v154, v36, v37
  v_cvt_pk_bf16_f32 v155, v38, v39
  v_cvt_pk_bf16_f32 v156, v40, v41
  v_cvt_pk_bf16_f32 v157, v42, v43
  v_cvt_pk_bf16_f32 v158, v44, v45
  v_cvt_pk_bf16_f32 v159, v46, v47
  v_cvt_pk_bf16_f32 v160, v48, v49
  v_cvt_pk_bf16_f32 v161, v50, v51
  v_cvt_pk_bf16_f32 v162, v52, v53
  v_cvt_pk_bf16_f32 v163, v54, v55
  v_cvt_pk_bf16_f32 v164, v56, v57
  v_cvt_pk_bf16_f32 v165, v58, v59
  v_cvt_pk_bf16_f32 v166, v60, v61
  v_cvt_pk_bf16_f32 v167, v62, v63
  v_cvt_pk_bf16_f32 v168, v64, v65
  v_cvt_pk_bf16_f32 v169, v66, v67
  v_cvt_pk_bf16_f32 v170, v68, v69
  v_cvt_pk_bf16_f32 v171, v70, v71
  v_cvt_pk_bf16_f32 v172, v72, v73
  v_cvt_pk_bf16_f32 v173, v74, v75
  v_cvt_pk_bf16_f32 v174, v76, v77
  v_cvt_pk_bf16_f32 v175, v78, v79
  s_nop 1
  s_waitcnt lgkmcnt(3)
  v_mfma_f32_32x32x16_bf16 v[80:95], v[176:179], v[144:147], 0
  ds_read_b128 v[192:195], v217 offset:0
  s_waitcnt lgkmcnt(3)
  v_mfma_f32_32x32x16_bf16 v[96:111], v[180:183], v[144:147], 0
  ds_read_b128 v[196:199], v217 offset:8192
  s_waitcnt lgkmcnt(3)
  v_mfma_f32_32x32x16_bf16 v[112:127], v[184:187], v[144:147], 0
  ds_read_b128 v[200:203], v217 offset:16384
  s_waitcnt lgkmcnt(3)
  v_mfma_f32_32x32x16_bf16 v[128:143], v[188:191], v[144:147], 0
  ds_read_b128 v[204:207], v217 offset:24576
  s_waitcnt lgkmcnt(3)
  v_mfma_f32_32x32x16_bf16 v[80:95], v[192:195], v[148:151], v[80:95]
  ds_read_b128 v[176:179], v218 offset:0
  s_waitcnt lgkmcnt(3)
  v_mfma_f32_32x32x16_bf16 v[96:111], v[196:199], v[148:151], v[96:111]
  ds_read_b128 v[180:183], v218 offset:8192
  s_waitcnt lgkmcnt(3)
  v_mfma_f32_32x32x16_bf16 v[112:127], v[200:203], v[148:151], v[112:127]
  ds_read_b128 v[184:187], v218 offset:16384
  s_waitcnt lgkmcnt(3)
  v_mfma_f32_32x32x16_bf16 v[128:143], v[204:207], v[148:151], v[128:143]
  ds_read_b128 v[188:191], v218 offset:24576
  s_waitcnt lgkmcnt(3)
  v_mfma_f32_32x32x16_bf16 v[80:95], v[176:179], v[152:155], v[80:95]
  ds_read_b128 v[192:195], v219 offset:0
  s_waitcnt lgkmcnt(3)
  v_mfma_f32_32x32x16_bf16 v[96:111], v[180:183], v[152:155], v[96:111]
  ds_read_b128 v[196:199], v219 offset:8192
  s_waitcnt lgkmcnt(3)
  v_mfma_f32_32x32x16_bf16 v[112:127], v[184:187], v[152:155], v[112:127]
  ds_read_b128 v[200:203], v219 offset:16384
  s_waitcnt lgkmcnt(3)
  v_mfma_f32_32x32x16_bf16 v[128:143], v[188:191], v[152:155], v[128:143]
  ds_read_b128 v[204:207], v219 offset:24576
  s_waitcnt lgkmcnt(3)
  v_mfma_f32_32x32x16_bf16 v[80:95], v[192:195], v[156:159], v[80:95]
  ds_read_b128 v[176:179], v220 offset:0
  s_waitcnt lgkmcnt(3)
  v_mfma_f32_32x32x16_bf16 v[96:111], v[196:199], v[156:159], v[96:111]
  ds_read_b128 v[180:183], v220 offset:8192
  s_waitcnt lgkmcnt(3)
  v_mfma_f32_32x32x16_bf16 v[112:127], v[200:203], v[156:159], v[112:127]
  ds_read_b128 v[184:187], v220 offset:16384
  s_waitcnt lgkmcnt(3)
  v_mfma_f32_32x32x16_bf16 v[128:143], v[204:207], v[156:159], v[128:143]
  ds_read_b128 v[188:191], v220 offset:24576
  s_waitcnt lgkmcnt(3)
  v_mfma_f32_32x32x16_bf16 v[80:95], v[176:179], v[160:163], v[80:95]
  ds_read_b128 v[192:195], v221 offset:0
  s_waitcnt lgkmcnt(3)
  v_mfma_f32_32x32x16_bf16 v[96:111], v[180:183], v[160:163], v[96:111]
  ds_read_b128 v[196:199], v221 offset:8192
  s_waitcnt lgkmcnt(3)
  v_mfma_f32_32x32x16_bf16 v[112:127], v[184:187], v[160:163], v[112:127]
  ds_read_b128 v[200:203], v221 offset:16384
  s_waitcnt lgkmcnt(3)
  v_mfma_f32_32x32x16_bf16 v[128:143], v[188:191], v[160:163], v[128:143]
  ds_read_b128 v[204:207], v221 offset:24576
  s_waitcnt lgkmcnt(3)
  v_mfma_f32_32x32x16_bf16 v[80:95], v[192:195], v[164:167], v[80:95]
  ds_read_b128 v[176:179], v222 offset:0
  s_waitcnt lgkmcnt(3)
  v_mfma_f32_32x32x16_bf16 v[96:111], v[196:199], v[164:167], v[96:111]
  ds_read_b128 v[180:183], v222 offset:8192
  s_waitcnt lgkmcnt(3)
  v_mfma_f32_32x32x16_bf16 v[112:127], v[200:203], v[164:167], v[112:127]
  ds_read_b128 v[184:187], v222 offset:16384
  s_waitcnt lgkmcnt(3)
  v_mfma_f32_32x32x16_bf16 v[128:143], v[204:207], v[164:167], v[128:143]
  ds_read_b128 v[188:191], v222 offset:24576
  s_waitcnt lgkmcnt(3)
  v_mfma_f32_32x32x16_bf16 v[80:95], v[176:179], v[168:171], v[80:95]
  ds_read_b128 v[192:195], v223 offset:0
  s_waitcnt lgkmcnt(3)
  v_mfma_f32_32x32x16_bf16 v[96:111], v[180:183], v[168:171], v[96:111]
  ds_read_b128 v[196:199], v223 offset:8192
  s_waitcnt lgkmcnt(3)
  v_mfma_f32_32x32x16_bf16 v[112:127], v[184:187], v[168:171], v[112:127]
  ds_read_b128 v[200:203], v223 offset:16384
  s_waitcnt lgkmcnt(3)
  v_mfma_f32_32x32x16_bf16 v[128:143], v[188:191], v[168:171], v[128:143]
  ds_read_b128 v[204:207], v223 offset:24576
  s_waitcnt lgkmcnt(3)
  v_mfma_f32_32x32x16_bf16 v[80:95], v[192:195], v[172:175], v[80:95]
  s_waitcnt lgkmcnt(2)
  v_mfma_f32_32x32x16_bf16 v[96:111], v[196:199], v[172:175], v[96:111]
  s_waitcnt lgkmcnt(1)
  v_mfma_f32_32x32x16_bf16 v[112:127], v[200:203], v[172:175], v[112:127]
  s_waitcnt lgkmcnt(0)
  v_mfma_f32_32x32x16_bf16 v[128:143], v[204:207], v[172:175], v[128:143]
  s_mov_b32 s50, 0x3e0293ee
  s_cbranch_vccz k1_s22
  s_waitcnt vmcnt(0)
k1_s22:
  s_barrier
  s_cbranch_vccz k1_s23
  s_add_u32 m0, s47, 114688
  s_mov_b32 s48, 32768
  buffer_load_dwordx4 v3, s[20:23], s48 offen offset:0 lds
  buffer_load_dwordx4 v3, s[20:23], s48 offen offset:1024 lds
  buffer_load_dwordx4 v3, s[20:23], s48 offen offset:2048 lds
  buffer_load_dwordx4 v3, s[20:23], s48 offen offset:3072 lds
  s_add_u32 m0, s47, 131072
  s_mov_b32 s48, 49152
  buffer_load_dwordx4 v3, s[20:23], s48 offen offset:0 lds
  buffer_load_dwordx4 v3, s[20:23], s48 offen offset:1024 lds
  buffer_load_dwordx4 v3, s[20:23], s48 offen offset:2048 lds
  buffer_load_dwordx4 v3, s[20:23], s48 offen offset:3072 lds
  s_add_u32 m0, s47, 0
  s_mov_b32 s48, 65536
  buffer_load_dwordx4 v4, s[16:19], s48 offen offset:0 lds
  buffer_load_dwordx4 v5, s[16:19], s48 offen offset:1024 lds
  buffer_load_dwordx4 v6, s[16:19], s48 offen offset:2048 lds
  buffer_load_dwordx4 v7, s[16:19], s48 offen offset:3072 lds
  s_add_u32 m0, s47, 16384
  s_mov_b32 s48, 81920
  buffer_load_dwordx4 v4, s[16:19], s48 offen offset:0 lds
  buffer_load_dwordx4 v5, s[16:19], s48 offen offset:1024 lds
  buffer_load_dwordx4 v6, s[16:19], s48 offen offset:2048 lds
  buffer_load_dwordx4 v7, s[16:19], s48 offen offset:3072 lds
k1_s23:
  s_cbranch_vccnz k1_s24
  v_and_b32 v12, 15, v0
  v_lshlrev_b32 v12, 12, v12
  v_bfe_u32 v13, v0, 4, 1
  v_lshl_add_u32 v12, v13, 5, v12
  v_lshrrev_b32 v13, 5, v0
  v_lshl_add_u32 v12, v13, 4, v12
  s_mov_b32 s48, 65536
  buffer_load_dwordx4 v[224:227], v12, s[60:63], 0 offen offset:0
  buffer_load_dwordx4 v[228:231], v12, s[60:63], s48 offen offset:0
  buffer_load_dwordx4 v[232:235], v12, s[60:63], 0 offen offset:64
  buffer_load_dwordx4 v[236:239], v12, s[60:63], s48 offen offset:64
  buffer_load_dwordx4 v[240:243], v12, s[60:63], 0 offen offset:128
  buffer_load_dwordx4 v[244:247], v12, s[60:63], s48 offen offset:128
  buffer_load_dwordx4 v[248:251], v12, s[60:63], 0 offen offset:192
  buffer_load_dwordx4 v[252:255], v12, s[60:63], s48 offen offset:192
k1_s24:
  s_nop 7
  v_max3_f32 v212, v80, v81, v82
  v_max3_f32 v212, v212, v83, v84
  v_max3_f32 v212, v212, v85, v86
  v_max3_f32 v212, v212, v87, v88
  v_max3_f32 v212, v212, v89, v90
  v_max3_f32 v212, v212, v91, v92
  v_max3_f32 v212, v212, v93, v94
  v_max3_f32 v212, v212, v95, v96
  v_max3_f32 v212, v212, v97, v98
  v_max3_f32 v212, v212, v99, v100
  v_max3_f32 v212, v212, v101, v102
  v_max3_f32 v212, v212, v103, v104
  v_max3_f32 v212, v212, v105, v106
  v_max3_f32 v212, v212, v107, v108
  v_max3_f32 v212, v212, v109, v110
  v_max3_f32 v213, v112, v113, v114
  v_max3_f32 v213, v213, v115, v116
  v_max3_f32 v213, v213, v117, v118
  v_max3_f32 v213, v213, v119, v120
  v_max3_f32 v213, v213, v121, v122
  v_max3_f32 v213, v213, v123, v124
  v_max3_f32 v213, v213, v125, v126
  v_max3_f32 v213, v213, v127, v128
  v_max3_f32 v213, v213, v129, v130
  v_max3_f32 v213, v213, v131, v132
  v_max3_f32 v213, v213, v133, v134
  v_max3_f32 v213, v213, v135, v136
  v_max3_f32 v213, v213, v137, v138
  v_max3_f32 v213, v213, v139, v140
  v_max3_f32 v213, v213, v141, v142
  v_max3_f32 v212, v212, v111, v143
  v_max_f32 v212, v212, v213
  v_mov_b32 v213, v212
  s_nop 1
  v_permlane32_swap_b32 v212, v213
  s_nop 1
  v_max_f32 v212, v212, v213
  v_mov_b32 v208, v212
  v_mul_f32 v212, s50, v212
  v_mov_b32 v209, 0
  v_mov_b32 v214, 0
  v_mov_b32 v215, 0
  v_fma_f32 v80, v80, s50, -v212
  v_fma_f32 v81, v81, s50, -v212
  v_fma_f32 v82, v82, s50, -v212
  v_fma_f32 v83, v83, s50, -v212
  v_exp_f32 v80, v80
  v_exp_f32 v81, v81
  v_exp_f32 v82, v82
  v_exp_f32 v83, v83
  v_add_f32 v214, v214, v80
  v_add_f32 v215, v215, v81
  v_add_f32 v214, v214, v82
  v_add_f32 v215, v215, v83
  v_cvt_pk_bf16_f32 v80, v80, v81
  v_cvt_pk_bf16_f32 v81, v82, v83
  v_fma_f32 v84, v84, s50, -v212
  v_fma_f32 v85, v85, s50, -v212
  v_fma_f32 v86, v86, s50, -v212
  v_fma_f32 v87, v87, s50, -v212
  v_exp_f32 v84, v84
  v_exp_f32 v85, v85
  v_exp_f32 v86, v86
  v_exp_f32 v87, v87
  v_add_f32 v214, v214, v84
  v_add_f32 v215, v215, v85
  v_add_f32 v214, v214, v86
  v_add_f32 v215, v215, v87
  v_cvt_pk_bf16_f32 v82, v84, v85
  v_cvt_pk_bf16_f32 v83, v86, v87
  v_fma_f32 v88, v88, s50, -v212
  v_fma_f32 v89, v89, s50, -v212
  v_fma_f32 v90, v90, s50, -v212
  v_fma_f32 v91, v91, s50, -v212
  v_exp_f32 v88, v88
  v_exp_f32 v89, v89
  v_exp_f32 v90, v90
  v_exp_f32 v91, v91
  v_add_f32 v214, v214, v88
  v_add_f32 v215, v215, v89
  v_add_f32 v214, v214, v90
  v_add_f32 v215, v215, v91
  v_cvt_pk_bf16_f32 v84, v88, v89
  v_cvt_pk_bf16_f32 v85, v90, v91
  v_fma_f32 v92, v92, s50, -v212
  v_fma_f32 v93, v93, s50, -v212
  v_fma_f32 v94, v94, s50, -v212
  v_fma_f32 v95, v95, s50, -v212
  v_exp_f32 v92, v92
  v_exp_f32 v93, v93
  v_exp_f32 v94, v94
  v_exp_f32 v95, v95
  v_add_f32 v214, v214, v92
  v_add_f32 v215, v215, v93
  v_add_f32 v214, v214, v94
  v_add_f32 v215, v215, v95
  v_cvt_pk_bf16_f32 v86, v92, v93
  v_cvt_pk_bf16_f32 v87, v94, v95
  v_fma_f32 v96, v96, s50, -v212
  v_fma_f32 v97, v97, s50, -v212
  v_fma_f32 v98, v98, s50, -v212
  v_fma_f32 v99, v99, s50, -v212
  v_exp_f32 v96, v96
  v_exp_f32 v97, v97
  v_exp_f32 v98, v98
  v_exp_f32 v99, v99
  v_add_f32 v214, v214, v96
  v_add_f32 v215, v215, v97
  v_add_f32 v214, v214, v98
  v_add_f32 v215, v215, v99
  v_cvt_pk_bf16_f32 v88, v96, v97
  v_cvt_pk_bf16_f32 v89, v98, v99
  v_fma_f32 v100, v100, s50, -v212
  v_fma_f32 v101, v101, s50, -v212
  v_fma_f32 v102, v102, s50, -v212
  v_fma_f32 v103, v103, s50, -v212
  v_exp_f32 v100, v100
  v_exp_f32 v101, v101
  v_exp_f32 v102, v102
  v_exp_f32 v103, v103
  v_add_f32 v214, v214, v100
  v_add_f32 v215, v215, v101
  v_add_f32 v214, v214, v102
  v_add_f32 v215, v215, v103
  v_cvt_pk_bf16_f32 v90, v100, v101
  v_cvt_pk_bf16_f32 v91, v102, v103
  v_fma_f32 v104, v104, s50, -v212
  v_fma_f32 v105, v105, s50, -v212
  v_fma_f32 v106, v106, s50, -v212
  v_fma_f32 v107, v107, s50, -v212
  v_exp_f32 v104, v104
  v_exp_f32 v105, v105
  v_exp_f32 v106, v106
  v_exp_f32 v107, v107
  v_add_f32 v214, v214, v104
  v_add_f32 v215, v215, v105
  v_add_f32 v214, v214, v106
  v_add_f32 v215, v215, v107
  v_cvt_pk_bf16_f32 v92, v104, v105
  v_cvt_pk_bf16_f32 v93, v106, v107
  v_fma_f32 v108, v108, s50, -v212
  v_fma_f32 v109, v109, s50, -v212
  v_fma_f32 v110, v110, s50, -v212
  v_fma_f32 v111, v111, s50, -v212
  v_exp_f32 v108, v108
  v_exp_f32 v109, v109
  v_exp_f32 v110, v110
  v_exp_f32 v111, v111
  v_add_f32 v214, v214, v108
  v_add_f32 v215, v215, v109
  v_add_f32 v214, v214, v110
  v_add_f32 v215, v215, v111
  v_cvt_pk_bf16_f32 v94, v108, v109
  v_cvt_pk_bf16_f32 v95, v110, v111
  v_fma_f32 v112, v112, s50, -v212
  v_fma_f32 v113, v113, s50, -v212
  v_fma_f32 v114, v114, s50, -v212
  v_fma_f32 v115, v115, s50, -v212
  v_exp_f32 v112, v112
  v_exp_f32 v113, v113
  v_exp_f32 v114, v114
  v_exp_f32 v115, v115
  v_add_f32 v214, v214, v112
  v_add_f32 v215, v215, v113
  v_add_f32 v214, v214, v114
  v_add_f32 v215, v215, v115
  v_cvt_pk_bf16_f32 v96, v112, v113
  v_cvt_pk_bf16_f32 v97, v114, v115
  v_fma_f32 v116, v116, s50, -v212
  v_fma_f32 v117, v117, s50, -v212
  v_fma_f32 v118, v118, s50, -v212
  v_fma_f32 v119, v119, s50, -v212
  v_exp_f32 v116, v116
  v_exp_f32 v117, v117
  v_exp_f32 v118, v118
  v_exp_f32 v119, v119
  v_add_f32 v214, v214, v116
  v_add_f32 v215, v215, v117
  v_add_f32 v214, v214, v118
  v_add_f32 v215, v215, v119
  v_cvt_pk_bf16_f32 v98, v116, v117
  v_cvt_pk_bf16_f32 v99, v118, v119
  v_fma_f32 v120, v120, s50, -v212
  v_fma_f32 v121, v121, s50, -v212
  v_fma_f32 v122, v122, s50, -v212
  v_fma_f32 v123, v123, s50, -v212
  v_exp_f32 v120, v120
  v_exp_f32 v121, v121
  v_exp_f32 v122, v122
  v_exp_f32 v123, v123
  v_add_f32 v214, v214, v120
  v_add_f32 v215, v215, v121
  v_add_f32 v214, v214, v122
  v_add_f32 v215, v215, v123
  v_cvt_pk_bf16_f32 v100, v120, v121
  v_cvt_pk_bf16_f32 v101, v122, v123
  v_fma_f32 v124, v124, s50, -v212
  v_fma_f32 v125, v125, s50, -v212
  v_fma_f32 v126, v126, s50, -v212
  v_fma_f32 v127, v127, s50, -v212
  v_exp_f32 v124, v124
  v_exp_f32 v125, v125
  v_exp_f32 v126, v126
  v_exp_f32 v127, v127
  v_add_f32 v214, v214, v124
  v_add_f32 v215, v215, v125
  v_add_f32 v214, v214, v126
  v_add_f32 v215, v215, v127
  v_cvt_pk_bf16_f32 v102, v124, v125
  v_cvt_pk_bf16_f32 v103, v126, v127
  v_fma_f32 v128, v128, s50, -v212
  v_fma_f32 v129, v129, s50, -v212
  v_fma_f32 v130, v130, s50, -v212
  v_fma_f32 v131, v131, s50, -v212
  v_exp_f32 v128, v128
  v_exp_f32 v129, v129
  v_exp_f32 v130, v130
  v_exp_f32 v131, v131
  v_add_f32 v214, v214, v128
  v_add_f32 v215, v215, v129
  v_add_f32 v214, v214, v130
  v_add_f32 v215, v215, v131
  v_cvt_pk_bf16_f32 v104, v128, v129
  v_cvt_pk_bf16_f32 v105, v130, v131
  v_fma_f32 v132, v132, s50, -v212
  v_fma_f32 v133, v133, s50, -v212
  v_fma_f32 v134, v134, s50, -v212
  v_fma_f32 v135, v135, s50, -v212
  v_exp_f32 v132, v132
  v_exp_f32 v133, v133
  v_exp_f32 v134, v134
  v_exp_f32 v135, v135
  v_add_f32 v214, v214, v132
  v_add_f32 v215, v215, v133
  v_add_f32 v214, v214, v134
  v_add_f32 v215, v215, v135
  v_cvt_pk_bf16_f32 v106, v132, v133
  v_cvt_pk_bf16_f32 v107, v134, v135
  v_fma_f32 v136, v136, s50, -v212
  v_fma_f32 v137, v137, s50, -v212
  v_fma_f32 v138, v138, s50, -v212
  v_fma_f32 v139, v139, s50, -v212
  v_exp_f32 v136, v136
  v_exp_f32 v137, v137
  v_exp_f32 v138, v138
  v_exp_f32 v139, v139
  v_add_f32 v214, v214, v136
  v_add_f32 v215, v215, v137
  v_add_f32 v214, v214, v138
  v_add_f32 v215, v215, v139
  v_cvt_pk_bf16_f32 v108, v136, v137
  v_cvt_pk_bf16_f32 v109, v138, v139
  v_fma_f32 v140, v140, s50, -v212
  v_fma_f32 v141, v141, s50, -v212
  v_fma_f32 v142, v142, s50, -v212
  v_fma_f32 v143, v143, s50, -v212
  v_exp_f32 v140, v140
  v_exp_f32 v141, v141
  v_exp_f32 v142, v142
  v_exp_f32 v143, v143
  v_add_f32 v214, v214, v140
  v_add_f32 v215, v215, v141
  v_add_f32 v214, v214, v142
  v_add_f32 v215, v215, v143
  v_cvt_pk_bf16_f32 v110, v140, v141
  v_cvt_pk_bf16_f32 v111, v142, v143
  v_add_f32 v209, v209, v214
  v_add_f32 v209, v209, v215
  s_barrier
  v_xor_b32 v216, 0, v9
  v_add_u32 v216, 32768, v216
  v_xor_b32 v217, 64, v9
  v_add_u32 v217, 32768, v217
  v_xor_b32 v218, 128, v9
  v_add_u32 v218, 32768, v218
  v_xor_b32 v219, 192, v9
  v_add_u32 v219, 32768, v219
  ds_read_b64_tr_b16 v[176:177], v216 offset:0
  ds_read_b64_tr_b16 v[178:179], v216 offset:2048
  ds_read_b64_tr_b16 v[180:181], v217 offset:0
  ds_read_b64_tr_b16 v[182:183], v217 offset:2048
  ds_read_b64_tr_b16 v[184:185], v218 offset:0
  ds_read_b64_tr_b16 v[186:187], v218 offset:2048
  ds_read_b64_tr_b16 v[188:189], v219 offset:0
  ds_read_b64_tr_b16 v[190:191], v219 offset:2048
  s_waitcnt lgkmcnt(6)
  v_mfma_f32_32x32x16_bf16 v[16:31], v[176:179], v[80:83], 0
  ds_read_b64_tr_b16 v[192:193], v216 offset:4096
  ds_read_b64_tr_b16 v[194:195], v216 offset:6144
  s_waitcnt lgkmcnt(6)
  v_mfma_f32_32x32x16_bf16 v[32:47], v[180:183], v[80:83], 0
  ds_read_b64_tr_b16 v[196:197], v217 offset:4096
  ds_read_b64_tr_b16 v[198:199], v217 offset:6144
  s_waitcnt lgkmcnt(6)
  v_mfma_f32_32x32x16_bf16 v[48:63], v[184:187], v[80:83], 0
  ds_read_b64_tr_b16 v[200:201], v218 offset:4096
  ds_read_b64_tr_b16 v[202:203], v218 offset:6144
  s_waitcnt lgkmcnt(6)
  v_mfma_f32_32x32x16_bf16 v[64:79], v[188:191], v[80:83], 0
  ds_read_b64_tr_b16 v[204:205], v219 offset:4096
  ds_read_b64_tr_b16 v[206:207], v219 offset:6144
  s_waitcnt lgkmcnt(6)
  v_mfma_f32_32x32x16_bf16 v[16:31], v[192:195], v[84:87], v[16:31]
  ds_read_b64_tr_b16 v[176:177], v216 offset:8192
  ds_read_b64_tr_b16 v[178:179], v216 offset:10240
  s_waitcnt lgkmcnt(6)
  v_mfma_f32_32x32x16_bf16 v[32:47], v[196:199], v[84:87], v[32:47]
  ds_read_b64_tr_b16 v[180:181], v217 offset:8192
  ds_read_b64_tr_b16 v[182:183], v217 offset:10240
  s_waitcnt lgkmcnt(6)
  v_mfma_f32_32x32x16_bf16 v[48:63], v[200:203], v[84:87], v[48:63]
  ds_read_b64_tr_b16 v[184:185], v218 offset:8192
  ds_read_b64_tr_b16 v[186:187], v218 offset:10240
  s_waitcnt lgkmcnt(6)
  v_mfma_f32_32x32x16_bf16 v[64:79], v[204:207], v[84:87], v[64:79]
  ds_read_b64_tr_b16 v[188:189], v219 offset:8192
  ds_read_b64_tr_b16 v[190:191], v219 offset:10240
  s_waitcnt lgkmcnt(6)
  v_mfma_f32_32x32x16_bf16 v[16:31], v[176:179], v[88:91], v[16:31]
  ds_read_b64_tr_b16 v[192:193], v216 offset:12288
  ds_read_b64_tr_b16 v[194:195], v216 offset:14336
  s_waitcnt lgkmcnt(6)
  v_mfma_f32_32x32x16_bf16 v[32:47], v[180:183], v[88:91], v[32:47]
  ds_read_b64_tr_b16 v[196:197], v217 offset:12288
  ds_read_b64_tr_b16 v[198:199], v217 offset:14336
  s_waitcnt lgkmcnt(6)
  v_mfma_f32_32x32x16_bf16 v[48:63], v[184:187], v[88:91], v[48:63]
  ds_read_b64_tr_b16 v[200:201], v218 offset:12288
  ds_read_b64_tr_b16 v[202:203], v218 offset:14336
  s_waitcnt lgkmcnt(6)
  v_mfma_f32_32x32x16_bf16 v[64:79], v[188:191], v[88:91], v[64:79]
  ds_read_b64_tr_b16 v[204:205], v219 offset:12288
  ds_read_b64_tr_b16 v[206:207], v219 offset:14336
  s_waitcnt lgkmcnt(6)
  v_mfma_f32_32x32x16_bf16 v[16:31], v[192:195], v[92:95], v[16:31]
  ds_read_b64_tr_b16 v[176:177], v216 offset:16384
  ds_read_b64_tr_b16 v[178:179], v216 offset:18432
  s_waitcnt lgkmcnt(6)
  v_mfma_f32_32x32x16_bf16 v[32:47], v[196:199], v[92:95], v[32:47]
  ds_read_b64_tr_b16 v[180:181], v217 offset:16384
  ds_read_b64_tr_b16 v[182:183], v217 offset:18432
  s_waitcnt lgkmcnt(6)
  v_mfma_f32_32x32x16_bf16 v[48:63], v[200:203], v[92:95], v[48:63]
  ds_read_b64_tr_b16 v[184:185], v218 offset:16384
  ds_read_b64_tr_b16 v[186:187], v218 offset:18432
  s_waitcnt lgkmcnt(6)
  v_mfma_f32_32x32x16_bf16 v[64:79], v[204:207], v[92:95], v[64:79]
  ds_read_b64_tr_b16 v[188:189], v219 offset:16384
  ds_read_b64_tr_b16 v[190:191], v219 offset:18432
  s_waitcnt lgkmcnt(6)
  v_mfma_f32_32x32x16_bf16 v[16:31], v[176:179], v[96:99], v[16:31]
  ds_read_b64_tr_b16 v[192:193], v216 offset:20480
  ds_read_b64_tr_b16 v[194:195], v216 offset:22528
  s_waitcnt lgkmcnt(6)
  v_mfma_f32_32x32x16_bf16 v[32:47], v[180:183], v[96:99], v[32:47]
  ds_read_b64_tr_b16 v[196:197], v217 offset:20480
  ds_read_b64_tr_b16 v[198:199], v217 offset:22528
  s_waitcnt lgkmcnt(6)
  v_mfma_f32_32x32x16_bf16 v[48:63], v[184:187], v[96:99], v[48:63]
  ds_read_b64_tr_b16 v[200:201], v218 offset:20480
  ds_read_b64_tr_b16 v[202:203], v218 offset:22528
  s_waitcnt lgkmcnt(6)
  v_mfma_f32_32x32x16_bf16 v[64:79], v[188:191], v[96:99], v[64:79]
  ds_read_b64_tr_b16 v[204:205], v219 offset:20480
  ds_read_b64_tr_b16 v[206:207], v219 offset:22528
  s_waitcnt lgkmcnt(6)
  v_mfma_f32_32x32x16_bf16 v[16:31], v[192:195], v[100:103], v[16:31]
  ds_read_b64_tr_b16 v[176:177], v216 offset:24576
  ds_read_b64_tr_b16 v[178:179], v216 offset:26624
  s_waitcnt lgkmcnt(6)
  v_mfma_f32_32x32x16_bf16 v[32:47], v[196:199], v[100:103], v[32:47]
  ds_read_b64_tr_b16 v[180:181], v217 offset:24576
  ds_read_b64_tr_b16 v[182:183], v217 offset:26624
  s_waitcnt lgkmcnt(6)
  v_mfma_f32_32x32x16_bf16 v[48:63], v[200:203], v[100:103], v[48:63]
  ds_read_b64_tr_b16 v[184:185], v218 offset:24576
  ds_read_b64_tr_b16 v[186:187], v218 offset:26624
  s_waitcnt lgkmcnt(6)
  v_mfma_f32_32x32x16_bf16 v[64:79], v[204:207], v[100:103], v[64:79]
  ds_read_b64_tr_b16 v[188:189], v219 offset:24576
  ds_read_b64_tr_b16 v[190:191], v219 offset:26624
  s_waitcnt lgkmcnt(6)
  v_mfma_f32_32x32x16_bf16 v[16:31], v[176:179], v[104:107], v[16:31]
  ds_read_b64_tr_b16 v[192:193], v216 offset:28672
  ds_read_b64_tr_b16 v[194:195], v216 offset:30720
  s_waitcnt lgkmcnt(6)
  v_mfma_f32_32x32x16_bf16 v[32:47], v[180:183], v[104:107], v[32:47]
  ds_read_b64_tr_b16 v[196:197], v217 offset:28672
  ds_read_b64_tr_b16 v[198:199], v217 offset:30720
  s_waitcnt lgkmcnt(6)
  v_mfma_f32_32x32x16_bf16 v[48:63], v[184:187], v[104:107], v[48:63]
  ds_read_b64_tr_b16 v[200:201], v218 offset:28672
  ds_read_b64_tr_b16 v[202:203], v218 offset:30720
  s_waitcnt lgkmcnt(6)
  v_mfma_f32_32x32x16_bf16 v[64:79], v[188:191], v[104:107], v[64:79]
  ds_read_b64_tr_b16 v[204:205], v219 offset:28672
  ds_read_b64_tr_b16 v[206:207], v219 offset:30720
  v_xor_b32 v216, 0, v8
  v_add_u32 v216, 65536, v216
  v_xor_b32 v217, 32, v8
  v_add_u32 v217, 65536, v217
  v_xor_b32 v218, 64, v8
  v_add_u32 v218, 65536, v218
  v_xor_b32 v219, 96, v8
  v_add_u32 v219, 65536, v219
  v_xor_b32 v220, 128, v8
  v_add_u32 v220, 65536, v220
  v_xor_b32 v221, 160, v8
  v_add_u32 v221, 65536, v221
  v_xor_b32 v222, 192, v8
  v_add_u32 v222, 65536, v222
  v_xor_b32 v223, 224, v8
  v_add_u32 v223, 65536, v223
  s_waitcnt lgkmcnt(6)
  v_mfma_f32_32x32x16_bf16 v[16:31], v[192:195], v[108:111], v[16:31]
  ds_read_b128 v[176:179], v216 offset:0
  s_waitcnt lgkmcnt(5)
  v_mfma_f32_32x32x16_bf16 v[32:47], v[196:199], v[108:111], v[32:47]
  ds_read_b128 v[180:183], v216 offset:8192
  s_waitcnt lgkmcnt(4)
  v_mfma_f32_32x32x16_bf16 v[48:63], v[200:203], v[108:111], v[48:63]
  ds_read_b128 v[184:187], v216 offset:16384
  s_waitcnt lgkmcnt(3)
  v_mfma_f32_32x32x16_bf16 v[64:79], v[204:207], v[108:111], v[64:79]
  ds_read_b128 v[188:191], v216 offset:24576
  s_waitcnt lgkmcnt(3)
  v_mfma_f32_32x32x16_bf16 v[80:95], v[176:179], v[144:147], 0
  ds_read_b128 v[192:195], v217 offset:0
  s_waitcnt lgkmcnt(3)
  v_mfma_f32_32x32x16_bf16 v[96:111], v[180:183], v[144:147], 0
  ds_read_b128 v[196:199], v217 offset:8192
  s_waitcnt lgkmcnt(3)
  v_mfma_f32_32x32x16_bf16 v[112:127], v[184:187], v[144:147], 0
  ds_read_b128 v[200:203], v217 offset:16384
  s_waitcnt lgkmcnt(3)
  v_mfma_f32_32x32x16_bf16 v[128:143], v[188:191], v[144:147], 0
  ds_read_b128 v[204:207], v217 offset:24576
  s_waitcnt lgkmcnt(3)
  v_mfma_f32_32x32x16_bf16 v[80:95], v[192:195], v[148:151], v[80:95]
  ds_read_b128 v[176:179], v218 offset:0
  s_waitcnt lgkmcnt(3)
  v_mfma_f32_32x32x16_bf16 v[96:111], v[196:199], v[148:151], v[96:111]
  ds_read_b128 v[180:183], v218 offset:8192
  s_waitcnt lgkmcnt(3)
  v_mfma_f32_32x32x16_bf16 v[112:127], v[200:203], v[148:151], v[112:127]
  ds_read_b128 v[184:187], v218 offset:16384
  s_waitcnt lgkmcnt(3)
  v_mfma_f32_32x32x16_bf16 v[128:143], v[204:207], v[148:151], v[128:143]
  ds_read_b128 v[188:191], v218 offset:24576
  s_waitcnt lgkmcnt(3)
  v_mfma_f32_32x32x16_bf16 v[80:95], v[176:179], v[152:155], v[80:95]
  ds_read_b128 v[192:195], v219 offset:0
  s_waitcnt lgkmcnt(3)
  v_mfma_f32_32x32x16_bf16 v[96:111], v[180:183], v[152:155], v[96:111]
  ds_read_b128 v[196:199], v219 offset:8192
  s_waitcnt lgkmcnt(3)
  v_mfma_f32_32x32x16_bf16 v[112:127], v[184:187], v[152:155], v[112:127]
  ds_read_b128 v[200:203], v219 offset:16384
  s_waitcnt lgkmcnt(3)
  v_mfma_f32_32x32x16_bf16 v[128:143], v[188:191], v[152:155], v[128:143]
  ds_read_b128 v[204:207], v219 offset:24576
  s_waitcnt lgkmcnt(3)
  v_mfma_f32_32x32x16_bf16 v[80:95], v[192:195], v[156:159], v[80:95]
  ds_read_b128 v[176:179], v220 offset:0
  s_waitcnt lgkmcnt(3)
  v_mfma_f32_32x32x16_bf16 v[96:111], v[196:199], v[156:159], v[96:111]
  ds_read_b128 v[180:183], v220 offset:8192
  s_waitcnt lgkmcnt(3)
  v_mfma_f32_32x32x16_bf16 v[112:127], v[200:203], v[156:159], v[112:127]
  ds_read_b128 v[184:187], v220 offset:16384
  s_waitcnt lgkmcnt(3)
  v_mfma_f32_32x32x16_bf16 v[128:143], v[204:207], v[156:159], v[128:143]
  ds_read_b128 v[188:191], v220 offset:24576
  s_waitcnt lgkmcnt(3)
  v_mfma_f32_32x32x16_bf16 v[80:95], v[176:179], v[160:163], v[80:95]
  ds_read_b128 v[192:195], v221 offset:0
  s_waitcnt lgkmcnt(3)
  v_mfma_f32_32x32x16_bf16 v[96:111], v[180:183], v[160:163], v[96:111]
  ds_read_b128 v[196:199], v221 offset:8192
  s_waitcnt lgkmcnt(3)
  v_mfma_f32_32x32x16_bf16 v[112:127], v[184:187], v[160:163], v[112:127]
  ds_read_b128 v[200:203], v221 offset:16384
  s_waitcnt lgkmcnt(3)
  v_mfma_f32_32x32x16_bf16 v[128:143], v[188:191], v[160:163], v[128:143]
  ds_read_b128 v[204:207], v221 offset:24576
  s_waitcnt lgkmcnt(3)
  v_mfma_f32_32x32x16_bf16 v[80:95], v[192:195], v[164:167], v[80:95]
  ds_read_b128 v[176:179], v222 offset:0
  s_waitcnt lgkmcnt(3)
  v_mfma_f32_32x32x16_bf16 v[96:111], v[196:199], v[164:167], v[96:111]
  ds_read_b128 v[180:183], v222 offset:8192
  s_waitcnt lgkmcnt(3)
  v_mfma_f32_32x32x16_bf16 v[112:127], v[200:203], v[164:167], v[112:127]
  ds_read_b128 v[184:187], v222 offset:16384
  s_waitcnt lgkmcnt(3)
  v_mfma_f32_32x32x16_bf16 v[128:143], v[204:207], v[164:167], v[128:143]
  ds_read_b128 v[188:191], v222 offset:24576
  s_waitcnt lgkmcnt(3)
  v_mfma_f32_32x32x16_bf16 v[80:95], v[176:179], v[168:171], v[80:95]
  ds_read_b128 v[192:195], v223 offset:0
  s_waitcnt lgkmcnt(3)
  v_mfma_f32_32x32x16_bf16 v[96:111], v[180:183], v[168:171], v[96:111]
  ds_read_b128 v[196:199], v223 offset:8192
  s_waitcnt lgkmcnt(3)
  v_mfma_f32_32x32x16_bf16 v[112:127], v[184:187], v[168:171], v[112:127]
  ds_read_b128 v[200:203], v223 offset:16384
  s_waitcnt lgkmcnt(3)
  v_mfma_f32_32x32x16_bf16 v[128:143], v[188:191], v[168:171], v[128:143]
  ds_read_b128 v[204:207], v223 offset:24576
  s_waitcnt lgkmcnt(3)
  v_mfma_f32_32x32x16_bf16 v[80:95], v[192:195], v[172:175], v[80:95]
  s_waitcnt lgkmcnt(2)
  v_mfma_f32_32x32x16_bf16 v[96:111], v[196:199], v[172:175], v[96:111]
  s_waitcnt lgkmcnt(1)
  v_mfma_f32_32x32x16_bf16 v[112:127], v[200:203], v[172:175], v[112:127]
  s_waitcnt lgkmcnt(0)
  v_mfma_f32_32x32x16_bf16 v[128:143], v[204:207], v[172:175], v[128:143]
  s_waitcnt vmcnt(0)
  s_barrier
  s_cbranch_vccz k1_s25
  s_add_u32 m0, s47, 32768
  s_mov_b32 s48, 65536
  buffer_load_dwordx4 v3, s[20:23], s48 offen offset:0 lds
  buffer_load_dwordx4 v3, s[20:23], s48 offen offset:1024 lds
  buffer_load_dwordx4 v3, s[20:23], s48 offen offset:2048 lds
  buffer_load_dwordx4 v3, s[20:23], s48 offen offset:3072 lds
  s_add_u32 m0, s47, 49152
  s_mov_b32 s48, 81920
  buffer_load_dwordx4 v3, s[20:23], s48 offen offset:0 lds
  buffer_load_dwordx4 v3, s[20:23], s48 offen offset:1024 lds
  buffer_load_dwordx4 v3, s[20:23], s48 offen offset:2048 lds
  buffer_load_dwordx4 v3, s[20:23], s48 offen offset:3072 lds
  s_add_u32 m0, s47, 65536
  s_mov_b32 s48, 98304
  buffer_load_dwordx4 v4, s[16:19], s48 offen offset:0 lds
  buffer_load_dwordx4 v5, s[16:19], s48 offen offset:1024 lds
  buffer_load_dwordx4 v6, s[16:19], s48 offen offset:2048 lds
  buffer_load_dwordx4 v7, s[16:19], s48 offen offset:3072 lds
  s_add_u32 m0, s47, 81920
  s_mov_b32 s48, 114688
  buffer_load_dwordx4 v4, s[16:19], s48 offen offset:0 lds
  buffer_load_dwordx4 v5, s[16:19], s48 offen offset:1024 lds
  buffer_load_dwordx4 v6, s[16:19], s48 offen offset:2048 lds
  buffer_load_dwordx4 v7, s[16:19], s48 offen offset:3072 lds
k1_s25:
  s_cbranch_vccnz k1_s26
  s_mov_b32 s48, 4096
  buffer_store_dwordx4 v[224:227], v1, s[64:67], 0 offen offset:0 sc1
  buffer_store_dwordx4 v[228:231], v1, s[64:67], 0 offen offset:1024 sc1
  buffer_store_dwordx4 v[232:235], v1, s[64:67], 0 offen offset:2048 sc1
  buffer_store_dwordx4 v[236:239], v1, s[64:67], 0 offen offset:3072 sc1
  buffer_store_dwordx4 v[240:243], v1, s[64:67], s48 offen offset:0 sc1
  buffer_store_dwordx4 v[244:247], v1, s[64:67], s48 offen offset:1024 sc1
  buffer_store_dwordx4 v[248:251], v1, s[64:67], s48 offen offset:2048 sc1
  buffer_store_dwordx4 v[252:255], v1, s[64:67], s48 offen offset:3072 sc1
k1_s26:
  s_nop 7
  v_max3_f32 v212, v80, v81, v82
  v_max3_f32 v212, v212, v83, v84
  v_max3_f32 v212, v212, v85, v86
  v_max3_f32 v212, v212, v87, v88
  v_max3_f32 v212, v212, v89, v90
  v_max3_f32 v212, v212, v91, v92
  v_max3_f32 v212, v212, v93, v94
  v_max3_f32 v212, v212, v95, v96
  v_max3_f32 v212, v212, v97, v98
  v_max3_f32 v212, v212, v99, v100
  v_max3_f32 v212, v212, v101, v102
  v_max3_f32 v212, v212, v103, v104
  v_max3_f32 v212, v212, v105, v106
  v_max3_f32 v212, v212, v107, v108
  v_max3_f32 v212, v212, v109, v110
  v_max3_f32 v213, v112, v113, v114
  v_max3_f32 v213, v213, v115, v116
  v_max3_f32 v213, v213, v117, v118
  v_max3_f32 v213, v213, v119, v120
  v_max3_f32 v213, v213, v121, v122
  v_max3_f32 v213, v213, v123, v124
  v_max3_f32 v213, v213, v125, v126
  v_max3_f32 v213, v213, v127, v128
  v_max3_f32 v213, v213, v129, v130
  v_max3_f32 v213, v213, v131, v132
  v_max3_f32 v213, v213, v133, v134
  v_max3_f32 v213, v213, v135, v136
  v_max3_f32 v213, v213, v137, v138
  v_max3_f32 v213, v213, v139, v140
  v_max3_f32 v213, v213, v141, v142
  v_max3_f32 v212, v212, v111, v143
  v_max3_f32 v212, v212, v213, v208
  v_mov_b32 v213, v212
  s_nop 1
  v_permlane32_swap_b32 v212, v213
  s_nop 1
  v_max_f32 v212, v212, v213
  v_sub_f32 v210, v208, v212
  v_mul_f32 v210, s50, v210
  v_exp_f32 v210, v210
  v_mov_b32 v208, v212
  v_mul_f32 v212, s50, v212
  v_mul_f32 v209, v209, v210
  v_mov_b32 v214, 0
  v_mov_b32 v215, 0
  v_fma_f32 v80, v80, s50, -v212
  v_fma_f32 v81, v81, s50, -v212
  v_fma_f32 v82, v82, s50, -v212
  v_fma_f32 v83, v83, s50, -v212
  v_exp_f32 v80, v80
  v_exp_f32 v81, v81
  v_exp_f32 v82, v82
  v_exp_f32 v83, v83
  v_mul_f32 v16, v16, v210
  v_mul_f32 v17, v17, v210
  v_mul_f32 v18, v18, v210
  v_mul_f32 v19, v19, v210
  v_add_f32 v214, v214, v80
  v_add_f32 v215, v215, v81
  v_add_f32 v214, v214, v82
  v_add_f32 v215, v215, v83
  v_cvt_pk_bf16_f32 v80, v80, v81
  v_cvt_pk_bf16_f32 v81, v82, v83
  v_fma_f32 v84, v84, s50, -v212
  v_fma_f32 v85, v85, s50, -v212
  v_fma_f32 v86, v86, s50, -v212
  v_fma_f32 v87, v87, s50, -v212
  v_exp_f32 v84, v84
  v_exp_f32 v85, v85
  v_exp_f32 v86, v86
  v_exp_f32 v87, v87
  v_mul_f32 v20, v20, v210
  v_mul_f32 v21, v21, v210
  v_mul_f32 v22, v22, v210
  v_mul_f32 v23, v23, v210
  v_add_f32 v214, v214, v84
  v_add_f32 v215, v215, v85
  v_add_f32 v214, v214, v86
  v_add_f32 v215, v215, v87
  v_cvt_pk_bf16_f32 v82, v84, v85
  v_cvt_pk_bf16_f32 v83, v86, v87
  v_fma_f32 v88, v88, s50, -v212
  v_fma_f32 v89, v89, s50, -v212
  v_fma_f32 v90, v90, s50, -v212
  v_fma_f32 v91, v91, s50, -v212
  v_exp_f32 v88, v88
  v_exp_f32 v89, v89
  v_exp_f32 v90, v90
  v_exp_f32 v91, v91
  v_mul_f32 v24, v24, v210
  v_mul_f32 v25, v25, v210
  v_mul_f32 v26, v26, v210
  v_mul_f32 v27, v27, v210
  v_add_f32 v214, v214, v88
  v_add_f32 v215, v215, v89
  v_add_f32 v214, v214, v90
  v_add_f32 v215, v215, v91
  v_cvt_pk_bf16_f32 v84, v88, v89
  v_cvt_pk_bf16_f32 v85, v90, v91
  v_fma_f32 v92, v92, s50, -v212
  v_fma_f32 v93, v93, s50, -v212
  v_fma_f32 v94, v94, s50, -v212
  v_fma_f32 v95, v95, s50, -v212
  v_exp_f32 v92, v92
  v_exp_f32 v93, v93
  v_exp_f32 v94, v94
  v_exp_f32 v95, v95
  v_mul_f32 v28, v28, v210
  v_mul_f32 v29, v29, v210
  v_mul_f32 v30, v30, v210
  v_mul_f32 v31, v31, v210
  v_add_f32 v214, v214, v92
  v_add_f32 v215, v215, v93
  v_add_f32 v214, v214, v94
  v_add_f32 v215, v215, v95
  v_cvt_pk_bf16_f32 v86, v92, v93
  v_cvt_pk_bf16_f32 v87, v94, v95
  v_fma_f32 v96, v96, s50, -v212
  v_fma_f32 v97, v97, s50, -v212
  v_fma_f32 v98, v98, s50, -v212
  v_fma_f32 v99, v99, s50, -v212
  v_exp_f32 v96, v96
  v_exp_f32 v97, v97
  v_exp_f32 v98, v98
  v_exp_f32 v99, v99
  v_mul_f32 v32, v32, v210
  v_mul_f32 v33, v33, v210
  v_mul_f32 v34, v34, v210
  v_mul_f32 v35, v35, v210
  v_add_f32 v214, v214, v96
  v_add_f32 v215, v215, v97
  v_add_f32 v214, v214, v98
  v_add_f32 v215, v215, v99
  v_cvt_pk_bf16_f32 v88, v96, v97
  v_cvt_pk_bf16_f32 v89, v98, v99
  v_fma_f32 v100, v100, s50, -v212
  v_fma_f32 v101, v101, s50, -v212
  v_fma_f32 v102, v102, s50, -v212
  v_fma_f32 v103, v103, s50, -v212
  v_exp_f32 v100, v100
  v_exp_f32 v101, v101
  v_exp_f32 v102, v102
  v_exp_f32 v103, v103
  v_mul_f32 v36, v36, v210
  v_mul_f32 v37, v37, v210
  v_mul_f32 v38, v38, v210
  v_mul_f32 v39, v39, v210
  v_add_f32 v214, v214, v100
  v_add_f32 v215, v215, v101
  v_add_f32 v214, v214, v102
  v_add_f32 v215, v215, v103
  v_cvt_pk_bf16_f32 v90, v100, v101
  v_cvt_pk_bf16_f32 v91, v102, v103
  v_fma_f32 v104, v104, s50, -v212
  v_fma_f32 v105, v105, s50, -v212
  v_fma_f32 v106, v106, s50, -v212
  v_fma_f32 v107, v107, s50, -v212
  v_exp_f32 v104, v104
  v_exp_f32 v105, v105
  v_exp_f32 v106, v106
  v_exp_f32 v107, v107
  v_mul_f32 v40, v40, v210
  v_mul_f32 v41, v41, v210
  v_mul_f32 v42, v42, v210
  v_mul_f32 v43, v43, v210
  v_add_f32 v214, v214, v104
  v_add_f32 v215, v215, v105
  v_add_f32 v214, v214, v106
  v_add_f32 v215, v215, v107
  v_cvt_pk_bf16_f32 v92, v104, v105
  v_cvt_pk_bf16_f32 v93, v106, v107
  v_fma_f32 v108, v108, s50, -v212
  v_fma_f32 v109, v109, s50, -v212
  v_fma_f32 v110, v110, s50, -v212
  v_fma_f32 v111, v111, s50, -v212
  v_exp_f32 v108, v108
  v_exp_f32 v109, v109
  v_exp_f32 v110, v110
  v_exp_f32 v111, v111
  v_mul_f32 v44, v44, v210
  v_mul_f32 v45, v45, v210
  v_mul_f32 v46, v46, v210
  v_mul_f32 v47, v47, v210
  v_add_f32 v214, v214, v108
  v_add_f32 v215, v215, v109
  v_add_f32 v214, v214, v110
  v_add_f32 v215, v215, v111
  v_cvt_pk_bf16_f32 v94, v108, v109
  v_cvt_pk_bf16_f32 v95, v110, v111
  v_fma_f32 v112, v112, s50, -v212
  v_fma_f32 v113, v113, s50, -v212
  v_fma_f32 v114, v114, s50, -v212
  v_fma_f32 v115, v115, s50, -v212
  v_exp_f32 v112, v112
  v_exp_f32 v113, v113
  v_exp_f32 v114, v114
  v_exp_f32 v115, v115
  v_mul_f32 v48, v48, v210
  v_mul_f32 v49, v49, v210
  v_mul_f32 v50, v50, v210
  v_mul_f32 v51, v51, v210
  v_add_f32 v214, v214, v112
  v_add_f32 v215, v215, v113
  v_add_f32 v214, v214, v114
  v_add_f32 v215, v215, v115
  v_cvt_pk_bf16_f32 v96, v112, v113
  v_cvt_pk_bf16_f32 v97, v114, v115
  v_fma_f32 v116, v116, s50, -v212
  v_fma_f32 v117, v117, s50, -v212
  v_fma_f32 v118, v118, s50, -v212
  v_fma_f32 v119, v119, s50, -v212
  v_exp_f32 v116, v116
  v_exp_f32 v117, v117
  v_exp_f32 v118, v118
  v_exp_f32 v119, v119
  v_mul_f32 v52, v52, v210
  v_mul_f32 v53, v53, v210
  v_mul_f32 v54, v54, v210
  v_mul_f32 v55, v55, v210
  v_add_f32 v214, v214, v116
  v_add_f32 v215, v215, v117
  v_add_f32 v214, v214, v118
  v_add_f32 v215, v215, v119
  v_cvt_pk_bf16_f32 v98, v116, v117
  v_cvt_pk_bf16_f32 v99, v118, v119
  v_fma_f32 v120, v120, s50, -v212
  v_fma_f32 v121, v121, s50, -v212
  v_fma_f32 v122, v122, s50, -v212
  v_fma_f32 v123, v123, s50, -v212
  v_exp_f32 v120, v120
  v_exp_f32 v121, v121
  v_exp_f32 v122, v122
  v_exp_f32 v123, v123
  v_mul_f32 v56, v56, v210
  v_mul_f32 v57, v57, v210
  v_mul_f32 v58, v58, v210
  v_mul_f32 v59, v59, v210
  v_add_f32 v214, v214, v120
  v_add_f32 v215, v215, v121
  v_add_f32 v214, v214, v122
  v_add_f32 v215, v215, v123
  v_cvt_pk_bf16_f32 v100, v120, v121
  v_cvt_pk_bf16_f32 v101, v122, v123
  v_fma_f32 v124, v124, s50, -v212
  v_fma_f32 v125, v125, s50, -v212
  v_fma_f32 v126, v126, s50, -v212
  v_fma_f32 v127, v127, s50, -v212
  v_exp_f32 v124, v124
  v_exp_f32 v125, v125
  v_exp_f32 v126, v126
  v_exp_f32 v127, v127
  v_mul_f32 v60, v60, v210
  v_mul_f32 v61, v61, v210
  v_mul_f32 v62, v62, v210
  v_mul_f32 v63, v63, v210
  v_add_f32 v214, v214, v124
  v_add_f32 v215, v215, v125
  v_add_f32 v214, v214, v126
  v_add_f32 v215, v215, v127
  v_cvt_pk_bf16_f32 v102, v124, v125
  v_cvt_pk_bf16_f32 v103, v126, v127
  v_fma_f32 v128, v128, s50, -v212
  v_fma_f32 v129, v129, s50, -v212
  v_fma_f32 v130, v130, s50, -v212
  v_fma_f32 v131, v131, s50, -v212
  v_exp_f32 v128, v128
  v_exp_f32 v129, v129
  v_exp_f32 v130, v130
  v_exp_f32 v131, v131
  v_mul_f32 v64, v64, v210
  v_mul_f32 v65, v65, v210
  v_mul_f32 v66, v66, v210
  v_mul_f32 v67, v67, v210
  v_add_f32 v214, v214, v128
  v_add_f32 v215, v215, v129
  v_add_f32 v214, v214, v130
  v_add_f32 v215, v215, v131
  v_cvt_pk_bf16_f32 v104, v128, v129
  v_cvt_pk_bf16_f32 v105, v130, v131
  v_fma_f32 v132, v132, s50, -v212
  v_fma_f32 v133, v133, s50, -v212
  v_fma_f32 v134, v134, s50, -v212
  v_fma_f32 v135, v135, s50, -v212
  v_exp_f32 v132, v132
  v_exp_f32 v133, v133
  v_exp_f32 v134, v134
  v_exp_f32 v135, v135
  v_mul_f32 v68, v68, v210
  v_mul_f32 v69, v69, v210
  v_mul_f32 v70, v70, v210
  v_mul_f32 v71, v71, v210
  v_add_f32 v214, v214, v132
  v_add_f32 v215, v215, v133
  v_add_f32 v214, v214, v134
  v_add_f32 v215, v215, v135
  v_cvt_pk_bf16_f32 v106, v132, v133
  v_cvt_pk_bf16_f32 v107, v134, v135
  v_fma_f32 v136, v136, s50, -v212
  v_fma_f32 v137, v137, s50, -v212
  v_fma_f32 v138, v138, s50, -v212
  v_fma_f32 v139, v139, s50, -v212
  v_exp_f32 v136, v136
  v_exp_f32 v137, v137
  v_exp_f32 v138, v138
  v_exp_f32 v139, v139
  v_mul_f32 v72, v72, v210
  v_mul_f32 v73, v73, v210
  v_mul_f32 v74, v74, v210
  v_mul_f32 v75, v75, v210
  v_add_f32 v214, v214, v136
  v_add_f32 v215, v215, v137
  v_add_f32 v214, v214, v138
  v_add_f32 v215, v215, v139
  v_cvt_pk_bf16_f32 v108, v136, v137
  v_cvt_pk_bf16_f32 v109, v138, v139
  v_fma_f32 v140, v140, s50, -v212
  v_fma_f32 v141, v141, s50, -v212
  v_fma_f32 v142, v142, s50, -v212
  v_fma_f32 v143, v143, s50, -v212
  v_exp_f32 v140, v140
  v_exp_f32 v141, v141
  v_exp_f32 v142, v142
  v_exp_f32 v143, v143
  v_mul_f32 v76, v76, v210
  v_mul_f32 v77, v77, v210
  v_mul_f32 v78, v78, v210
  v_mul_f32 v79, v79, v210
  v_add_f32 v214, v214, v140
  v_add_f32 v215, v215, v141
  v_add_f32 v214, v214, v142
  v_add_f32 v215, v215, v143
  v_cvt_pk_bf16_f32 v110, v140, v141
  v_cvt_pk_bf16_f32 v111, v142, v143
  v_add_f32 v209, v209, v214
  v_add_f32 v209, v209, v215
  s_barrier
  v_xor_b32 v216, 0, v9
  v_add_u32 v216, 114688, v216
  v_xor_b32 v217, 64, v9
  v_add_u32 v217, 114688, v217
  v_xor_b32 v218, 128, v9
  v_add_u32 v218, 114688, v218
  v_xor_b32 v219, 192, v9
  v_add_u32 v219, 114688, v219
  ds_read_b64_tr_b16 v[176:177], v216 offset:0
  ds_read_b64_tr_b16 v[178:179], v216 offset:2048
  ds_read_b64_tr_b16 v[180:181], v217 offset:0
  ds_read_b64_tr_b16 v[182:183], v217 offset:2048
  ds_read_b64_tr_b16 v[184:185], v218 offset:0
  ds_read_b64_tr_b16 v[186:187], v218 offset:2048
  ds_read_b64_tr_b16 v[188:189], v219 offset:0
  ds_read_b64_tr_b16 v[190:191], v219 offset:2048
  s_waitcnt lgkmcnt(6)
  v_mfma_f32_32x32x16_bf16 v[16:31], v[176:179], v[80:83], v[16:31]
  ds_read_b64_tr_b16 v[192:193], v216 offset:4096
  ds_read_b64_tr_b16 v[194:195], v216 offset:6144
  s_waitcnt lgkmcnt(6)
  v_mfma_f32_32x32x16_bf16 v[32:47], v[180:183], v[80:83], v[32:47]
  ds_read_b64_tr_b16 v[196:197], v217 offset:4096
  ds_read_b64_tr_b16 v[198:199], v217 offset:6144
  s_waitcnt lgkmcnt(6)
  v_mfma_f32_32x32x16_bf16 v[48:63], v[184:187], v[80:83], v[48:63]
  ds_read_b64_tr_b16 v[200:201], v218 offset:4096
  ds_read_b64_tr_b16 v[202:203], v218 offset:6144
  s_waitcnt lgkmcnt(6)
  v_mfma_f32_32x32x16_bf16 v[64:79], v[188:191], v[80:83], v[64:79]
  ds_read_b64_tr_b16 v[204:205], v219 offset:4096
  ds_read_b64_tr_b16 v[206:207], v219 offset:6144
  s_waitcnt lgkmcnt(6)
  v_mfma_f32_32x32x16_bf16 v[16:31], v[192:195], v[84:87], v[16:31]
  ds_read_b64_tr_b16 v[176:177], v216 offset:8192
  ds_read_b64_tr_b16 v[178:179], v216 offset:10240
  s_waitcnt lgkmcnt(6)
  v_mfma_f32_32x32x16_bf16 v[32:47], v[196:199], v[84:87], v[32:47]
  ds_read_b64_tr_b16 v[180:181], v217 offset:8192
  ds_read_b64_tr_b16 v[182:183], v217 offset:10240
  s_waitcnt lgkmcnt(6)
  v_mfma_f32_32x32x16_bf16 v[48:63], v[200:203], v[84:87], v[48:63]
  ds_read_b64_tr_b16 v[184:185], v218 offset:8192
  ds_read_b64_tr_b16 v[186:187], v218 offset:10240
  s_waitcnt lgkmcnt(6)
  v_mfma_f32_32x32x16_bf16 v[64:79], v[204:207], v[84:87], v[64:79]
  ds_read_b64_tr_b16 v[188:189], v219 offset:8192
  ds_read_b64_tr_b16 v[190:191], v219 offset:10240
  s_waitcnt lgkmcnt(6)
  v_mfma_f32_32x32x16_bf16 v[16:31], v[176:179], v[88:91], v[16:31]
  ds_read_b64_tr_b16 v[192:193], v216 offset:12288
  ds_read_b64_tr_b16 v[194:195], v216 offset:14336
  s_waitcnt lgkmcnt(6)
  v_mfma_f32_32x32x16_bf16 v[32:47], v[180:183], v[88:91], v[32:47]
  ds_read_b64_tr_b16 v[196:197], v217 offset:12288
  ds_read_b64_tr_b16 v[198:199], v217 offset:14336
  s_waitcnt lgkmcnt(6)
  v_mfma_f32_32x32x16_bf16 v[48:63], v[184:187], v[88:91], v[48:63]
  ds_read_b64_tr_b16 v[200:201], v218 offset:12288
  ds_read_b64_tr_b16 v[202:203], v218 offset:14336
  s_waitcnt lgkmcnt(6)
  v_mfma_f32_32x32x16_bf16 v[64:79], v[188:191], v[88:91], v[64:79]
  ds_read_b64_tr_b16 v[204:205], v219 offset:12288
  ds_read_b64_tr_b16 v[206:207], v219 offset:14336
  s_waitcnt lgkmcnt(6)
  v_mfma_f32_32x32x16_bf16 v[16:31], v[192:195], v[92:95], v[16:31]
  ds_read_b64_tr_b16 v[176:177], v216 offset:16384
  ds_read_b64_tr_b16 v[178:179], v216 offset:18432
  s_waitcnt lgkmcnt(6)
  v_mfma_f32_32x32x16_bf16 v[32:47], v[196:199], v[92:95], v[32:47]
  ds_read_b64_tr_b16 v[180:181], v217 offset:16384
  ds_read_b64_tr_b16 v[182:183], v217 offset:18432
  s_waitcnt lgkmcnt(6)
  v_mfma_f32_32x32x16_bf16 v[48:63], v[200:203], v[92:95], v[48:63]
  ds_read_b64_tr_b16 v[184:185], v218 offset:16384
  ds_read_b64_tr_b16 v[186:187], v218 offset:18432
  s_waitcnt lgkmcnt(6)
  v_mfma_f32_32x32x16_bf16 v[64:79], v[204:207], v[92:95], v[64:79]
  ds_read_b64_tr_b16 v[188:189], v219 offset:16384
  ds_read_b64_tr_b16 v[190:191], v219 offset:18432
  s_waitcnt lgkmcnt(6)
  v_mfma_f32_32x32x16_bf16 v[16:31], v[176:179], v[96:99], v[16:31]
  ds_read_b64_tr_b16 v[192:193], v216 offset:20480
  ds_read_b64_tr_b16 v[194:195], v216 offset:22528
  s_waitcnt lgkmcnt(6)
  v_mfma_f32_32x32x16_bf16 v[32:47], v[180:183], v[96:99], v[32:47]
  ds_read_b64_tr_b16 v[196:197], v217 offset:20480
  ds_read_b64_tr_b16 v[198:199], v217 offset:22528
  s_waitcnt lgkmcnt(6)
  v_mfma_f32_32x32x16_bf16 v[48:63], v[184:187], v[96:99], v[48:63]
  ds_read_b64_tr_b16 v[200:201], v218 offset:20480
  ds_read_b64_tr_b16 v[202:203], v218 offset:22528
  s_waitcnt lgkmcnt(6)
  v_mfma_f32_32x32x16_bf16 v[64:79], v[188:191], v[96:99], v[64:79]
  ds_read_b64_tr_b16 v[204:205], v219 offset:20480
  ds_read_b64_tr_b16 v[206:207], v219 offset:22528
  s_waitcnt lgkmcnt(6)
  v_mfma_f32_32x32x16_bf16 v[16:31], v[192:195], v[100:103], v[16:31]
  ds_read_b64_tr_b16 v[176:177], v216 offset:24576
  ds_read_b64_tr_b16 v[178:179], v216 offset:26624
  s_waitcnt lgkmcnt(6)
  v_mfma_f32_32x32x16_bf16 v[32:47], v[196:199], v[100:103], v[32:47]
  ds_read_b64_tr_b16 v[180:181], v217 offset:24576
  ds_read_b64_tr_b16 v[182:183], v217 offset:26624
  s_waitcnt lgkmcnt(6)
  v_mfma_f32_32x32x16_bf16 v[48:63], v[200:203], v[100:103], v[48:63]
  ds_read_b64_tr_b16 v[184:185], v218 offset:24576
  ds_read_b64_tr_b16 v[186:187], v218 offset:26624
  s_waitcnt lgkmcnt(6)
  v_mfma_f32_32x32x16_bf16 v[64:79], v[204:207], v[100:103], v[64:79]
  ds_read_b64_tr_b16 v[188:189], v219 offset:24576
  ds_read_b64_tr_b16 v[190:191], v219 offset:26624
  s_waitcnt lgkmcnt(6)
  v_mfma_f32_32x32x16_bf16 v[16:31], v[176:179], v[104:107], v[16:31]
  ds_read_b64_tr_b16 v[192:193], v216 offset:28672
  ds_read_b64_tr_b16 v[194:195], v216 offset:30720
  s_waitcnt lgkmcnt(6)
  v_mfma_f32_32x32x16_bf16 v[32:47], v[180:183], v[104:107], v[32:47]
  ds_read_b64_tr_b16 v[196:197], v217 offset:28672
  ds_read_b64_tr_b16 v[198:199], v217 offset:30720
  s_waitcnt lgkmcnt(6)
  v_mfma_f32_32x32x16_bf16 v[48:63], v[184:187], v[104:107], v[48:63]
  ds_read_b64_tr_b16 v[200:201], v218 offset:28672
  ds_read_b64_tr_b16 v[202:203], v218 offset:30720
  s_waitcnt lgkmcnt(6)
  v_mfma_f32_32x32x16_bf16 v[64:79], v[188:191], v[104:107], v[64:79]
  ds_read_b64_tr_b16 v[204:205], v219 offset:28672
  ds_read_b64_tr_b16 v[206:207], v219 offset:30720
  v_xor_b32 v216, 0, v8
  v_add_u32 v216, 0, v216
  v_xor_b32 v217, 32, v8
  v_add_u32 v217, 0, v217
  v_xor_b32 v218, 64, v8
  v_add_u32 v218, 0, v218
  v_xor_b32 v219, 96, v8
  v_add_u32 v219, 0, v219
  v_xor_b32 v220, 128, v8
  v_add_u32 v220, 0, v220
  v_xor_b32 v221, 160, v8
  v_add_u32 v221, 0, v221
  v_xor_b32 v222, 192, v8
  v_add_u32 v222, 0, v222
  v_xor_b32 v223, 224, v8
  v_add_u32 v223, 0, v223
  s_waitcnt lgkmcnt(6)
  v_mfma_f32_32x32x16_bf16 v[16:31], v[192:195], v[108:111], v[16:31]
  ds_read_b128 v[176:179], v216 offset:0
  s_waitcnt lgkmcnt(5)
  v_mfma_f32_32x32x16_bf16 v[32:47], v[196:199], v[108:111], v[32:47]
  ds_read_b128 v[180:183], v216 offset:8192
  s_waitcnt lgkmcnt(4)
  v_mfma_f32_32x32x16_bf16 v[48:63], v[200:203], v[108:111], v[48:63]
  ds_read_b128 v[184:187], v216 offset:16384
  s_waitcnt lgkmcnt(3)
  v_mfma_f32_32x32x16_bf16 v[64:79], v[204:207], v[108:111], v[64:79]
  ds_read_b128 v[188:191], v216 offset:24576
  s_waitcnt lgkmcnt(3)
  v_mfma_f32_32x32x16_bf16 v[80:95], v[176:179], v[144:147], 0
  ds_read_b128 v[192:195], v217 offset:0
  s_waitcnt lgkmcnt(3)
  v_mfma_f32_32x32x16_bf16 v[96:111], v[180:183], v[144:147], 0
  ds_read_b128 v[196:199], v217 offset:8192
  s_waitcnt lgkmcnt(3)
  v_mfma_f32_32x32x16_bf16 v[112:127], v[184:187], v[144:147], 0
  ds_read_b128 v[200:203], v217 offset:16384
  s_waitcnt lgkmcnt(3)
  v_mfma_f32_32x32x16_bf16 v[128:143], v[188:191], v[144:147], 0
  ds_read_b128 v[204:207], v217 offset:24576
  s_waitcnt lgkmcnt(3)
  v_mfma_f32_32x32x16_bf16 v[80:95], v[192:195], v[148:151], v[80:95]
  ds_read_b128 v[176:179], v218 offset:0
  s_waitcnt lgkmcnt(3)
  v_mfma_f32_32x32x16_bf16 v[96:111], v[196:199], v[148:151], v[96:111]
  ds_read_b128 v[180:183], v218 offset:8192
  s_waitcnt lgkmcnt(3)
  v_mfma_f32_32x32x16_bf16 v[112:127], v[200:203], v[148:151], v[112:127]
  ds_read_b128 v[184:187], v218 offset:16384
  s_waitcnt lgkmcnt(3)
  v_mfma_f32_32x32x16_bf16 v[128:143], v[204:207], v[148:151], v[128:143]
  ds_read_b128 v[188:191], v218 offset:24576
  s_waitcnt lgkmcnt(3)
  v_mfma_f32_32x32x16_bf16 v[80:95], v[176:179], v[152:155], v[80:95]
  ds_read_b128 v[192:195], v219 offset:0
  s_waitcnt lgkmcnt(3)
  v_mfma_f32_32x32x16_bf16 v[96:111], v[180:183], v[152:155], v[96:111]
  ds_read_b128 v[196:199], v219 offset:8192
  s_waitcnt lgkmcnt(3)
  v_mfma_f32_32x32x16_bf16 v[112:127], v[184:187], v[152:155], v[112:127]
  ds_read_b128 v[200:203], v219 offset:16384
  s_waitcnt lgkmcnt(3)
  v_mfma_f32_32x32x16_bf16 v[128:143], v[188:191], v[152:155], v[128:143]
  ds_read_b128 v[204:207], v219 offset:24576
  s_waitcnt lgkmcnt(3)
  v_mfma_f32_32x32x16_bf16 v[80:95], v[192:195], v[156:159], v[80:95]
  ds_read_b128 v[176:179], v220 offset:0
  s_waitcnt lgkmcnt(3)
  v_mfma_f32_32x32x16_bf16 v[96:111], v[196:199], v[156:159], v[96:111]
  ds_read_b128 v[180:183], v220 offset:8192
  s_waitcnt lgkmcnt(3)
  v_mfma_f32_32x32x16_bf16 v[112:127], v[200:203], v[156:159], v[112:127]
  ds_read_b128 v[184:187], v220 offset:16384
  s_waitcnt lgkmcnt(3)
  v_mfma_f32_32x32x16_bf16 v[128:143], v[204:207], v[156:159], v[128:143]
  ds_read_b128 v[188:191], v220 offset:24576
  s_waitcnt lgkmcnt(3)
  v_mfma_f32_32x32x16_bf16 v[80:95], v[176:179], v[160:163], v[80:95]
  ds_read_b128 v[192:195], v221 offset:0
  s_waitcnt lgkmcnt(3)
  v_mfma_f32_32x32x16_bf16 v[96:111], v[180:183], v[160:163], v[96:111]
  ds_read_b128 v[196:199], v221 offset:8192
  s_waitcnt lgkmcnt(3)
  v_mfma_f32_32x32x16_bf16 v[112:127], v[184:187], v[160:163], v[112:127]
  ds_read_b128 v[200:203], v221 offset:16384
  s_waitcnt lgkmcnt(3)
  v_mfma_f32_32x32x16_bf16 v[128:143], v[188:191], v[160:163], v[128:143]
  ds_read_b128 v[204:207], v221 offset:24576
  s_waitcnt lgkmcnt(3)
  v_mfma_f32_32x32x16_bf16 v[80:95], v[192:195], v[164:167], v[80:95]
  ds_read_b128 v[176:179], v222 offset:0
  s_waitcnt lgkmcnt(3)
  v_mfma_f32_32x32x16_bf16 v[96:111], v[196:199], v[164:167], v[96:111]
  ds_read_b128 v[180:183], v222 offset:8192
  s_waitcnt lgkmcnt(3)
  v_mfma_f32_32x32x16_bf16 v[112:127], v[200:203], v[164:167], v[112:127]
  ds_read_b128 v[184:187], v222 offset:16384
  s_waitcnt lgkmcnt(3)
  v_mfma_f32_32x32x16_bf16 v[128:143], v[204:207], v[164:167], v[128:143]
  ds_read_b128 v[188:191], v222 offset:24576
  s_waitcnt lgkmcnt(3)
  v_mfma_f32_32x32x16_bf16 v[80:95], v[176:179], v[168:171], v[80:95]
  ds_read_b128 v[192:195], v223 offset:0
  s_waitcnt lgkmcnt(3)
  v_mfma_f32_32x32x16_bf16 v[96:111], v[180:183], v[168:171], v[96:111]
  ds_read_b128 v[196:199], v223 offset:8192
  s_waitcnt lgkmcnt(3)
  v_mfma_f32_32x32x16_bf16 v[112:127], v[184:187], v[168:171], v[112:127]
  ds_read_b128 v[200:203], v223 offset:16384
  s_waitcnt lgkmcnt(3)
  v_mfma_f32_32x32x16_bf16 v[128:143], v[188:191], v[168:171], v[128:143]
  ds_read_b128 v[204:207], v223 offset:24576
  s_waitcnt lgkmcnt(3)
  v_mfma_f32_32x32x16_bf16 v[80:95], v[192:195], v[172:175], v[80:95]
  s_waitcnt lgkmcnt(2)
  v_mfma_f32_32x32x16_bf16 v[96:111], v[196:199], v[172:175], v[96:111]
  s_waitcnt lgkmcnt(1)
  v_mfma_f32_32x32x16_bf16 v[112:127], v[200:203], v[172:175], v[112:127]
  s_waitcnt lgkmcnt(0)
  v_mfma_f32_32x32x16_bf16 v[128:143], v[204:207], v[172:175], v[128:143]
  s_cbranch_vccz k1_s27
  s_waitcnt vmcnt(0)
k1_s27:
  s_barrier
  s_cbranch_vccz k1_s28
  s_add_u32 m0, s47, 114688
  s_mov_b32 s48, 98304
  buffer_load_dwordx4 v3, s[20:23], s48 offen offset:0 lds
  buffer_load_dwordx4 v3, s[20:23], s48 offen offset:1024 lds
  buffer_load_dwordx4 v3, s[20:23], s48 offen offset:2048 lds
  buffer_load_dwordx4 v3, s[20:23], s48 offen offset:3072 lds
  s_add_u32 m0, s47, 131072
  s_mov_b32 s48, 114688
  buffer_load_dwordx4 v3, s[20:23], s48 offen offset:0 lds
  buffer_load_dwordx4 v3, s[20:23], s48 offen offset:1024 lds
  buffer_load_dwordx4 v3, s[20:23], s48 offen offset:2048 lds
  buffer_load_dwordx4 v3, s[20:23], s48 offen offset:3072 lds
k1_s28:
  s_load_dwordx2 s[4:5], s[0:1], 32
  s_load_dwordx2 s[6:7], s[0:1], 48
  s_load_dwordx2 s[8:9], s[0:1], 72
  s_load_dwordx2 s[28:29], s[0:1], 104
  s_lshl_b32 s41, s2, 3
  s_add_u32 s41, s41, s3
  v_lshlrev_b32 v13, 6, v0
  v_mov_b32 v14, -1
  v_lshlrev_b32 v15, 2, v0
  s_lshl_b32 s42, s41, 7
  s_waitcnt lgkmcnt(0)
  s_add_u32 s24, s4, 0
  s_addc_u32 s25, s5, 0
  s_mov_b32 s26, 4718592
  s_mov_b32 s27, 0x20000
  s_mul_i32 s48, s41, 2304
  buffer_load_dword v2, v13, s[24:27], s48 offen
  s_add_u32 s24, s6, 0
  s_addc_u32 s25, s7, 0
  s_mov_b32 s26, 5308416
  s_mov_b32 s27, 0x20000
  s_mul_i32 s48, s41, 2592
  buffer_load_dword v2, v13, s[24:27], s48 offen
  s_add_u32 s24, s8, 0
  s_addc_u32 s25, s9, 0
  s_mov_b32 s26, 2654208
  s_mov_b32 s27, 0x20000
  s_mul_i32 s48, s41, 1296
  buffer_load_dword v2, v13, s[24:27], s48 offen
  s_add_u32 s24, s10, 51298304
  s_addc_u32 s25, s11, 0
  s_add_u32 s24, s24, s42
  s_addc_u32 s25, s25, 0
  s_mov_b32 s26, 128
  s_mov_b32 s27, 0x20000
  buffer_store_dword v14, v15, s[24:27], 0 offen
  s_lshl_b32 s42, s42, 1
  s_add_u32 s24, s10, 52150272
  s_addc_u32 s25, s11, 0
  s_add_u32 s24, s24, s42
  s_addc_u32 s25, s25, 0
  s_mov_b32 s26, 256
  s_mov_b32 s27, 0x20000
  buffer_store_dword v14, v15, s[24:27], 0 offen
  s_nop 7
  v_max3_f32 v212, v80, v81, v82
  v_max3_f32 v212, v212, v83, v84
  v_max3_f32 v212, v212, v85, v86
  v_max3_f32 v212, v212, v87, v88
  v_max3_f32 v212, v212, v89, v90
  v_max3_f32 v212, v212, v91, v92
  v_max3_f32 v212, v212, v93, v94
  v_max3_f32 v212, v212, v95, v96
  v_max3_f32 v212, v212, v97, v98
  v_max3_f32 v212, v212, v99, v100
  v_max3_f32 v212, v212, v101, v102
  v_max3_f32 v212, v212, v103, v104
  v_max3_f32 v212, v212, v105, v106
  v_max3_f32 v212, v212, v107, v108
  v_max3_f32 v212, v212, v109, v110
  v_max3_f32 v213, v112, v113, v114
  v_max3_f32 v213, v213, v115, v116
  v_max3_f32 v213, v213, v117, v118
  v_max3_f32 v213, v213, v119, v120
  v_max3_f32 v213, v213, v121, v122
  v_max3_f32 v213, v213, v123, v124
  v_max3_f32 v213, v213, v125, v126
  v_max3_f32 v213, v213, v127, v128
  v_max3_f32 v213, v213, v129, v130
  v_max3_f32 v213, v213, v131, v132
  v_max3_f32 v213, v213, v133, v134
  v_max3_f32 v213, v213, v135, v136
  v_max3_f32 v213, v213, v137, v138
  v_max3_f32 v213, v213, v139, v140
  v_max3_f32 v213, v213, v141, v142
  v_max3_f32 v212, v212, v111, v143
  v_max3_f32 v212, v212, v213, v208
  v_mov_b32 v213, v212
  s_nop 1
  v_permlane32_swap_b32 v212, v213
  s_nop 1
  v_max_f32 v212, v212, v213
  v_sub_f32 v210, v208, v212
  v_mul_f32 v210, s50, v210
  v_exp_f32 v210, v210
  v_mov_b32 v208, v212
  v_mul_f32 v212, s50, v212
  v_mul_f32 v209, v209, v210
  v_mov_b32 v214, 0
  v_mov_b32 v215, 0
  v_fma_f32 v80, v80, s50, -v212
  v_fma_f32 v81, v81, s50, -v212
  v_fma_f32 v82, v82, s50, -v212
  v_fma_f32 v83, v83, s50, -v212
  v_exp_f32 v80, v80
  v_exp_f32 v81, v81
  v_exp_f32 v82, v82
  v_exp_f32 v83, v83
  v_mul_f32 v16, v16, v210
  v_mul_f32 v17, v17, v210
  v_mul_f32 v18, v18, v210
  v_mul_f32 v19, v19, v210
  v_add_f32 v214, v214, v80
  v_add_f32 v215, v215, v81
  v_add_f32 v214, v214, v82
  v_add_f32 v215, v215, v83
  v_cvt_pk_bf16_f32 v80, v80, v81
  v_cvt_pk_bf16_f32 v81, v82, v83
  v_fma_f32 v84, v84, s50, -v212
  v_fma_f32 v85, v85, s50, -v212
  v_fma_f32 v86, v86, s50, -v212
  v_fma_f32 v87, v87, s50, -v212
  v_exp_f32 v84, v84
  v_exp_f32 v85, v85
  v_exp_f32 v86, v86
  v_exp_f32 v87, v87
  v_mul_f32 v20, v20, v210
  v_mul_f32 v21, v21, v210
  v_mul_f32 v22, v22, v210
  v_mul_f32 v23, v23, v210
  v_add_f32 v214, v214, v84
  v_add_f32 v215, v215, v85
  v_add_f32 v214, v214, v86
  v_add_f32 v215, v215, v87
  v_cvt_pk_bf16_f32 v82, v84, v85
  v_cvt_pk_bf16_f32 v83, v86, v87
  v_fma_f32 v88, v88, s50, -v212
  v_fma_f32 v89, v89, s50, -v212
  v_fma_f32 v90, v90, s50, -v212
  v_fma_f32 v91, v91, s50, -v212
  v_exp_f32 v88, v88
  v_exp_f32 v89, v89
  v_exp_f32 v90, v90
  v_exp_f32 v91, v91
  v_mul_f32 v24, v24, v210
  v_mul_f32 v25, v25, v210
  v_mul_f32 v26, v26, v210
  v_mul_f32 v27, v27, v210
  v_add_f32 v214, v214, v88
  v_add_f32 v215, v215, v89
  v_add_f32 v214, v214, v90
  v_add_f32 v215, v215, v91
  v_cvt_pk_bf16_f32 v84, v88, v89
  v_cvt_pk_bf16_f32 v85, v90, v91
  v_fma_f32 v92, v92, s50, -v212
  v_fma_f32 v93, v93, s50, -v212
  v_fma_f32 v94, v94, s50, -v212
  v_fma_f32 v95, v95, s50, -v212
  v_exp_f32 v92, v92
  v_exp_f32 v93, v93
  v_exp_f32 v94, v94
  v_exp_f32 v95, v95
  v_mul_f32 v28, v28, v210
  v_mul_f32 v29, v29, v210
  v_mul_f32 v30, v30, v210
  v_mul_f32 v31, v31, v210
  v_add_f32 v214, v214, v92
  v_add_f32 v215, v215, v93
  v_add_f32 v214, v214, v94
  v_add_f32 v215, v215, v95
  v_cvt_pk_bf16_f32 v86, v92, v93
  v_cvt_pk_bf16_f32 v87, v94, v95
  v_fma_f32 v96, v96, s50, -v212
  v_fma_f32 v97, v97, s50, -v212
  v_fma_f32 v98, v98, s50, -v212
  v_fma_f32 v99, v99, s50, -v212
  v_exp_f32 v96, v96
  v_exp_f32 v97, v97
  v_exp_f32 v98, v98
  v_exp_f32 v99, v99
  v_mul_f32 v32, v32, v210
  v_mul_f32 v33, v33, v210
  v_mul_f32 v34, v34, v210
  v_mul_f32 v35, v35, v210
  v_add_f32 v214, v214, v96
  v_add_f32 v215, v215, v97
  v_add_f32 v214, v214, v98
  v_add_f32 v215, v215, v99
  v_cvt_pk_bf16_f32 v88, v96, v97
  v_cvt_pk_bf16_f32 v89, v98, v99
  v_fma_f32 v100, v100, s50, -v212
  v_fma_f32 v101, v101, s50, -v212
  v_fma_f32 v102, v102, s50, -v212
  v_fma_f32 v103, v103, s50, -v212
  v_exp_f32 v100, v100
  v_exp_f32 v101, v101
  v_exp_f32 v102, v102
  v_exp_f32 v103, v103
  v_mul_f32 v36, v36, v210
  v_mul_f32 v37, v37, v210
  v_mul_f32 v38, v38, v210
  v_mul_f32 v39, v39, v210
  v_add_f32 v214, v214, v100
  v_add_f32 v215, v215, v101
  v_add_f32 v214, v214, v102
  v_add_f32 v215, v215, v103
  v_cvt_pk_bf16_f32 v90, v100, v101
  v_cvt_pk_bf16_f32 v91, v102, v103
  v_fma_f32 v104, v104, s50, -v212
  v_fma_f32 v105, v105, s50, -v212
  v_fma_f32 v106, v106, s50, -v212
  v_fma_f32 v107, v107, s50, -v212
  v_exp_f32 v104, v104
  v_exp_f32 v105, v105
  v_exp_f32 v106, v106
  v_exp_f32 v107, v107
  v_mul_f32 v40, v40, v210
  v_mul_f32 v41, v41, v210
  v_mul_f32 v42, v42, v210
  v_mul_f32 v43, v43, v210
  v_add_f32 v214, v214, v104
  v_add_f32 v215, v215, v105
  v_add_f32 v214, v214, v106
  v_add_f32 v215, v215, v107
  v_cvt_pk_bf16_f32 v92, v104, v105
  v_cvt_pk_bf16_f32 v93, v106, v107
  v_fma_f32 v108, v108, s50, -v212
  v_fma_f32 v109, v109, s50, -v212
  v_fma_f32 v110, v110, s50, -v212
  v_fma_f32 v111, v111, s50, -v212
  v_exp_f32 v108, v108
  v_exp_f32 v109, v109
  v_exp_f32 v110, v110
  v_exp_f32 v111, v111
  v_mul_f32 v44, v44, v210
  v_mul_f32 v45, v45, v210
  v_mul_f32 v46, v46, v210
  v_mul_f32 v47, v47, v210
  v_add_f32 v214, v214, v108
  v_add_f32 v215, v215, v109
  v_add_f32 v214, v214, v110
  v_add_f32 v215, v215, v111
  v_cvt_pk_bf16_f32 v94, v108, v109
  v_cvt_pk_bf16_f32 v95, v110, v111
  v_fma_f32 v112, v112, s50, -v212
  v_fma_f32 v113, v113, s50, -v212
  v_fma_f32 v114, v114, s50, -v212
  v_fma_f32 v115, v115, s50, -v212
  v_exp_f32 v112, v112
  v_exp_f32 v113, v113
  v_exp_f32 v114, v114
  v_exp_f32 v115, v115
  v_mul_f32 v48, v48, v210
  v_mul_f32 v49, v49, v210
  v_mul_f32 v50, v50, v210
  v_mul_f32 v51, v51, v210
  v_add_f32 v214, v214, v112
  v_add_f32 v215, v215, v113
  v_add_f32 v214, v214, v114
  v_add_f32 v215, v215, v115
  v_cvt_pk_bf16_f32 v96, v112, v113
  v_cvt_pk_bf16_f32 v97, v114, v115
  v_fma_f32 v116, v116, s50, -v212
  v_fma_f32 v117, v117, s50, -v212
  v_fma_f32 v118, v118, s50, -v212
  v_fma_f32 v119, v119, s50, -v212
  v_exp_f32 v116, v116
  v_exp_f32 v117, v117
  v_exp_f32 v118, v118
  v_exp_f32 v119, v119
  v_mul_f32 v52, v52, v210
  v_mul_f32 v53, v53, v210
  v_mul_f32 v54, v54, v210
  v_mul_f32 v55, v55, v210
  v_add_f32 v214, v214, v116
  v_add_f32 v215, v215, v117
  v_add_f32 v214, v214, v118
  v_add_f32 v215, v215, v119
  v_cvt_pk_bf16_f32 v98, v116, v117
  v_cvt_pk_bf16_f32 v99, v118, v119
  v_fma_f32 v120, v120, s50, -v212
  v_fma_f32 v121, v121, s50, -v212
  v_fma_f32 v122, v122, s50, -v212
  v_fma_f32 v123, v123, s50, -v212
  v_exp_f32 v120, v120
  v_exp_f32 v121, v121
  v_exp_f32 v122, v122
  v_exp_f32 v123, v123
  v_mul_f32 v56, v56, v210
  v_mul_f32 v57, v57, v210
  v_mul_f32 v58, v58, v210
  v_mul_f32 v59, v59, v210
  v_add_f32 v214, v214, v120
  v_add_f32 v215, v215, v121
  v_add_f32 v214, v214, v122
  v_add_f32 v215, v215, v123
  v_cvt_pk_bf16_f32 v100, v120, v121
  v_cvt_pk_bf16_f32 v101, v122, v123
  v_fma_f32 v124, v124, s50, -v212
  v_fma_f32 v125, v125, s50, -v212
  v_fma_f32 v126, v126, s50, -v212
  v_fma_f32 v127, v127, s50, -v212
  v_exp_f32 v124, v124
  v_exp_f32 v125, v125
  v_exp_f32 v126, v126
  v_exp_f32 v127, v127
  v_mul_f32 v60, v60, v210
  v_mul_f32 v61, v61, v210
  v_mul_f32 v62, v62, v210
  v_mul_f32 v63, v63, v210
  v_add_f32 v214, v214, v124
  v_add_f32 v215, v215, v125
  v_add_f32 v214, v214, v126
  v_add_f32 v215, v215, v127
  v_cvt_pk_bf16_f32 v102, v124, v125
  v_cvt_pk_bf16_f32 v103, v126, v127
  v_fma_f32 v128, v128, s50, -v212
  v_fma_f32 v129, v129, s50, -v212
  v_fma_f32 v130, v130, s50, -v212
  v_fma_f32 v131, v131, s50, -v212
  v_exp_f32 v128, v128
  v_exp_f32 v129, v129
  v_exp_f32 v130, v130
  v_exp_f32 v131, v131
  v_mul_f32 v64, v64, v210
  v_mul_f32 v65, v65, v210
  v_mul_f32 v66, v66, v210
  v_mul_f32 v67, v67, v210
  v_add_f32 v214, v214, v128
  v_add_f32 v215, v215, v129
  v_add_f32 v214, v214, v130
  v_add_f32 v215, v215, v131
  v_cvt_pk_bf16_f32 v104, v128, v129
  v_cvt_pk_bf16_f32 v105, v130, v131
  v_fma_f32 v132, v132, s50, -v212
  v_fma_f32 v133, v133, s50, -v212
  v_fma_f32 v134, v134, s50, -v212
  v_fma_f32 v135, v135, s50, -v212
  v_exp_f32 v132, v132
  v_exp_f32 v133, v133
  v_exp_f32 v134, v134
  v_exp_f32 v135, v135
  v_mul_f32 v68, v68, v210
  v_mul_f32 v69, v69, v210
  v_mul_f32 v70, v70, v210
  v_mul_f32 v71, v71, v210
  v_add_f32 v214, v214, v132
  v_add_f32 v215, v215, v133
  v_add_f32 v214, v214, v134
  v_add_f32 v215, v215, v135
  v_cvt_pk_bf16_f32 v106, v132, v133
  v_cvt_pk_bf16_f32 v107, v134, v135
  v_fma_f32 v136, v136, s50, -v212
  v_fma_f32 v137, v137, s50, -v212
  v_fma_f32 v138, v138, s50, -v212
  v_fma_f32 v139, v139, s50, -v212
  v_exp_f32 v136, v136
  v_exp_f32 v137, v137
  v_exp_f32 v138, v138
  v_exp_f32 v139, v139
  v_mul_f32 v72, v72, v210
  v_mul_f32 v73, v73, v210
  v_mul_f32 v74, v74, v210
  v_mul_f32 v75, v75, v210
  v_add_f32 v214, v214, v136
  v_add_f32 v215, v215, v137
  v_add_f32 v214, v214, v138
  v_add_f32 v215, v215, v139
  v_cvt_pk_bf16_f32 v108, v136, v137
  v_cvt_pk_bf16_f32 v109, v138, v139
  v_fma_f32 v140, v140, s50, -v212
  v_fma_f32 v141, v141, s50, -v212
  v_fma_f32 v142, v142, s50, -v212
  v_fma_f32 v143, v143, s50, -v212
  v_exp_f32 v140, v140
  v_exp_f32 v141, v141
  v_exp_f32 v142, v142
  v_exp_f32 v143, v143
  v_mul_f32 v76, v76, v210
  v_mul_f32 v77, v77, v210
  v_mul_f32 v78, v78, v210
  v_mul_f32 v79, v79, v210
  v_add_f32 v214, v214, v140
  v_add_f32 v215, v215, v141
  v_add_f32 v214, v214, v142
  v_add_f32 v215, v215, v143
  v_cvt_pk_bf16_f32 v110, v140, v141
  v_cvt_pk_bf16_f32 v111, v142, v143
  v_add_f32 v209, v209, v214
  v_add_f32 v209, v209, v215
  s_barrier
  v_xor_b32 v216, 0, v9
  v_add_u32 v216, 32768, v216
  v_xor_b32 v217, 64, v9
  v_add_u32 v217, 32768, v217
  v_xor_b32 v218, 128, v9
  v_add_u32 v218, 32768, v218
  v_xor_b32 v219, 192, v9
  v_add_u32 v219, 32768, v219
  ds_read_b64_tr_b16 v[176:177], v216 offset:0
  ds_read_b64_tr_b16 v[178:179], v216 offset:2048
  ds_read_b64_tr_b16 v[180:181], v217 offset:0
  ds_read_b64_tr_b16 v[182:183], v217 offset:2048
  ds_read_b64_tr_b16 v[184:185], v218 offset:0
  ds_read_b64_tr_b16 v[186:187], v218 offset:2048
  ds_read_b64_tr_b16 v[188:189], v219 offset:0
  ds_read_b64_tr_b16 v[190:191], v219 offset:2048
  s_waitcnt lgkmcnt(6)
  v_mfma_f32_32x32x16_bf16 v[16:31], v[176:179], v[80:83], v[16:31]
  ds_read_b64_tr_b16 v[192:193], v216 offset:4096
  ds_read_b64_tr_b16 v[194:195], v216 offset:6144
  s_waitcnt lgkmcnt(6)
  v_mfma_f32_32x32x16_bf16 v[32:47], v[180:183], v[80:83], v[32:47]
  ds_read_b64_tr_b16 v[196:197], v217 offset:4096
  ds_read_b64_tr_b16 v[198:199], v217 offset:6144
  s_waitcnt lgkmcnt(6)
  v_mfma_f32_32x32x16_bf16 v[48:63], v[184:187], v[80:83], v[48:63]
  ds_read_b64_tr_b16 v[200:201], v218 offset:4096
  ds_read_b64_tr_b16 v[202:203], v218 offset:6144
  s_waitcnt lgkmcnt(6)
  v_mfma_f32_32x32x16_bf16 v[64:79], v[188:191], v[80:83], v[64:79]
  ds_read_b64_tr_b16 v[204:205], v219 offset:4096
  ds_read_b64_tr_b16 v[206:207], v219 offset:6144
  s_waitcnt lgkmcnt(6)
  v_mfma_f32_32x32x16_bf16 v[16:31], v[192:195], v[84:87], v[16:31]
  ds_read_b64_tr_b16 v[176:177], v216 offset:8192
  ds_read_b64_tr_b16 v[178:179], v216 offset:10240
  s_waitcnt lgkmcnt(6)
  v_mfma_f32_32x32x16_bf16 v[32:47], v[196:199], v[84:87], v[32:47]
  ds_read_b64_tr_b16 v[180:181], v217 offset:8192
  ds_read_b64_tr_b16 v[182:183], v217 offset:10240
  s_waitcnt lgkmcnt(6)
  v_mfma_f32_32x32x16_bf16 v[48:63], v[200:203], v[84:87], v[48:63]
  ds_read_b64_tr_b16 v[184:185], v218 offset:8192
  ds_read_b64_tr_b16 v[186:187], v218 offset:10240
  s_waitcnt lgkmcnt(6)
  v_mfma_f32_32x32x16_bf16 v[64:79], v[204:207], v[84:87], v[64:79]
  ds_read_b64_tr_b16 v[188:189], v219 offset:8192
  ds_read_b64_tr_b16 v[190:191], v219 offset:10240
  s_waitcnt lgkmcnt(6)
  v_mfma_f32_32x32x16_bf16 v[16:31], v[176:179], v[88:91], v[16:31]
  ds_read_b64_tr_b16 v[192:193], v216 offset:12288
  ds_read_b64_tr_b16 v[194:195], v216 offset:14336
  s_waitcnt lgkmcnt(6)
  v_mfma_f32_32x32x16_bf16 v[32:47], v[180:183], v[88:91], v[32:47]
  ds_read_b64_tr_b16 v[196:197], v217 offset:12288
  ds_read_b64_tr_b16 v[198:199], v217 offset:14336
  s_waitcnt lgkmcnt(6)
  v_mfma_f32_32x32x16_bf16 v[48:63], v[184:187], v[88:91], v[48:63]
  ds_read_b64_tr_b16 v[200:201], v218 offset:12288
  ds_read_b64_tr_b16 v[202:203], v218 offset:14336
  s_waitcnt lgkmcnt(6)
  v_mfma_f32_32x32x16_bf16 v[64:79], v[188:191], v[88:91], v[64:79]
  ds_read_b64_tr_b16 v[204:205], v219 offset:12288
  ds_read_b64_tr_b16 v[206:207], v219 offset:14336
  s_waitcnt lgkmcnt(6)
  v_mfma_f32_32x32x16_bf16 v[16:31], v[192:195], v[92:95], v[16:31]
  ds_read_b64_tr_b16 v[176:177], v216 offset:16384
  ds_read_b64_tr_b16 v[178:179], v216 offset:18432
  s_waitcnt lgkmcnt(6)
  v_mfma_f32_32x32x16_bf16 v[32:47], v[196:199], v[92:95], v[32:47]
  ds_read_b64_tr_b16 v[180:181], v217 offset:16384
  ds_read_b64_tr_b16 v[182:183], v217 offset:18432
  s_waitcnt lgkmcnt(6)
  v_mfma_f32_32x32x16_bf16 v[48:63], v[200:203], v[92:95], v[48:63]
  ds_read_b64_tr_b16 v[184:185], v218 offset:16384
  ds_read_b64_tr_b16 v[186:187], v218 offset:18432
  s_waitcnt lgkmcnt(6)
  v_mfma_f32_32x32x16_bf16 v[64:79], v[204:207], v[92:95], v[64:79]
  ds_read_b64_tr_b16 v[188:189], v219 offset:16384
  ds_read_b64_tr_b16 v[190:191], v219 offset:18432
  s_waitcnt lgkmcnt(6)
  v_mfma_f32_32x32x16_bf16 v[16:31], v[176:179], v[96:99], v[16:31]
  ds_read_b64_tr_b16 v[192:193], v216 offset:20480
  ds_read_b64_tr_b16 v[194:195], v216 offset:22528
  s_waitcnt lgkmcnt(6)
  v_mfma_f32_32x32x16_bf16 v[32:47], v[180:183], v[96:99], v[32:47]
  ds_read_b64_tr_b16 v[196:197], v217 offset:20480
  ds_read_b64_tr_b16 v[198:199], v217 offset:22528
  s_waitcnt lgkmcnt(6)
  v_mfma_f32_32x32x16_bf16 v[48:63], v[184:187], v[96:99], v[48:63]
  ds_read_b64_tr_b16 v[200:201], v218 offset:20480
  ds_read_b64_tr_b16 v[202:203], v218 offset:22528
  s_waitcnt lgkmcnt(6)
  v_mfma_f32_32x32x16_bf16 v[64:79], v[188:191], v[96:99], v[64:79]
  ds_read_b64_tr_b16 v[204:205], v219 offset:20480
  ds_read_b64_tr_b16 v[206:207], v219 offset:22528
  s_waitcnt lgkmcnt(6)
  v_mfma_f32_32x32x16_bf16 v[16:31], v[192:195], v[100:103], v[16:31]
  ds_read_b64_tr_b16 v[176:177], v216 offset:24576
  ds_read_b64_tr_b16 v[178:179], v216 offset:26624
  s_waitcnt lgkmcnt(6)
  v_mfma_f32_32x32x16_bf16 v[32:47], v[196:199], v[100:103], v[32:47]
  ds_read_b64_tr_b16 v[180:181], v217 offset:24576
  ds_read_b64_tr_b16 v[182:183], v217 offset:26624
  s_waitcnt lgkmcnt(6)
  v_mfma_f32_32x32x16_bf16 v[48:63], v[200:203], v[100:103], v[48:63]
  ds_read_b64_tr_b16 v[184:185], v218 offset:24576
  ds_read_b64_tr_b16 v[186:187], v218 offset:26624
  s_waitcnt lgkmcnt(6)
  v_mfma_f32_32x32x16_bf16 v[64:79], v[204:207], v[100:103], v[64:79]
  ds_read_b64_tr_b16 v[188:189], v219 offset:24576
  ds_read_b64_tr_b16 v[190:191], v219 offset:26624
  s_waitcnt lgkmcnt(6)
  v_mfma_f32_32x32x16_bf16 v[16:31], v[176:179], v[104:107], v[16:31]
  ds_read_b64_tr_b16 v[192:193], v216 offset:28672
  ds_read_b64_tr_b16 v[194:195], v216 offset:30720
  s_waitcnt lgkmcnt(6)
  v_mfma_f32_32x32x16_bf16 v[32:47], v[180:183], v[104:107], v[32:47]
  ds_read_b64_tr_b16 v[196:197], v217 offset:28672
  ds_read_b64_tr_b16 v[198:199], v217 offset:30720
  s_waitcnt lgkmcnt(6)
  v_mfma_f32_32x32x16_bf16 v[48:63], v[184:187], v[104:107], v[48:63]
  ds_read_b64_tr_b16 v[200:201], v218 offset:28672
  ds_read_b64_tr_b16 v[202:203], v218 offset:30720
  s_waitcnt lgkmcnt(6)
  v_mfma_f32_32x32x16_bf16 v[64:79], v[188:191], v[104:107], v[64:79]
  ds_read_b64_tr_b16 v[204:205], v219 offset:28672
  ds_read_b64_tr_b16 v[206:207], v219 offset:30720
  v_xor_b32 v216, 0, v8
  v_add_u32 v216, 65536, v216
  v_xor_b32 v217, 32, v8
  v_add_u32 v217, 65536, v217
  v_xor_b32 v218, 64, v8
  v_add_u32 v218, 65536, v218
  v_xor_b32 v219, 96, v8
  v_add_u32 v219, 65536, v219
  v_xor_b32 v220, 128, v8
  v_add_u32 v220, 65536, v220
  v_xor_b32 v221, 160, v8
  v_add_u32 v221, 65536, v221
  v_xor_b32 v222, 192, v8
  v_add_u32 v222, 65536, v222
  v_xor_b32 v223, 224, v8
  v_add_u32 v223, 65536, v223
  s_waitcnt lgkmcnt(6)
  v_mfma_f32_32x32x16_bf16 v[16:31], v[192:195], v[108:111], v[16:31]
  ds_read_b128 v[176:179], v216 offset:0
  s_waitcnt lgkmcnt(5)
  v_mfma_f32_32x32x16_bf16 v[32:47], v[196:199], v[108:111], v[32:47]
  ds_read_b128 v[180:183], v216 offset:8192
  s_waitcnt lgkmcnt(4)
  v_mfma_f32_32x32x16_bf16 v[48:63], v[200:203], v[108:111], v[48:63]
  ds_read_b128 v[184:187], v216 offset:16384
  s_waitcnt lgkmcnt(3)
  v_mfma_f32_32x32x16_bf16 v[64:79], v[204:207], v[108:111], v[64:79]
  ds_read_b128 v[188:191], v216 offset:24576
  s_waitcnt lgkmcnt(3)
  v_mfma_f32_32x32x16_bf16 v[80:95], v[176:179], v[144:147], 0
  ds_read_b128 v[192:195], v217 offset:0
  s_waitcnt lgkmcnt(3)
  v_mfma_f32_32x32x16_bf16 v[96:111], v[180:183], v[144:147], 0
  ds_read_b128 v[196:199], v217 offset:8192
  s_waitcnt lgkmcnt(3)
  v_mfma_f32_32x32x16_bf16 v[112:127], v[184:187], v[144:147], 0
  ds_read_b128 v[200:203], v217 offset:16384
  s_waitcnt lgkmcnt(3)
  v_mfma_f32_32x32x16_bf16 v[128:143], v[188:191], v[144:147], 0
  ds_read_b128 v[204:207], v217 offset:24576
  s_waitcnt lgkmcnt(3)
  v_mfma_f32_32x32x16_bf16 v[80:95], v[192:195], v[148:151], v[80:95]
  ds_read_b128 v[176:179], v218 offset:0
  s_waitcnt lgkmcnt(3)
  v_mfma_f32_32x32x16_bf16 v[96:111], v[196:199], v[148:151], v[96:111]
  ds_read_b128 v[180:183], v218 offset:8192
  s_waitcnt lgkmcnt(3)
  v_mfma_f32_32x32x16_bf16 v[112:127], v[200:203], v[148:151], v[112:127]
  ds_read_b128 v[184:187], v218 offset:16384
  s_waitcnt lgkmcnt(3)
  v_mfma_f32_32x32x16_bf16 v[128:143], v[204:207], v[148:151], v[128:143]
  ds_read_b128 v[188:191], v218 offset:24576
  s_waitcnt lgkmcnt(3)
  v_mfma_f32_32x32x16_bf16 v[80:95], v[176:179], v[152:155], v[80:95]
  ds_read_b128 v[192:195], v219 offset:0
  s_waitcnt lgkmcnt(3)
  v_mfma_f32_32x32x16_bf16 v[96:111], v[180:183], v[152:155], v[96:111]
  ds_read_b128 v[196:199], v219 offset:8192
  s_waitcnt lgkmcnt(3)
  v_mfma_f32_32x32x16_bf16 v[112:127], v[184:187], v[152:155], v[112:127]
  ds_read_b128 v[200:203], v219 offset:16384
  s_waitcnt lgkmcnt(3)
  v_mfma_f32_32x32x16_bf16 v[128:143], v[188:191], v[152:155], v[128:143]
  ds_read_b128 v[204:207], v219 offset:24576
  s_waitcnt lgkmcnt(3)
  v_mfma_f32_32x32x16_bf16 v[80:95], v[192:195], v[156:159], v[80:95]
  ds_read_b128 v[176:179], v220 offset:0
  s_waitcnt lgkmcnt(3)
  v_mfma_f32_32x32x16_bf16 v[96:111], v[196:199], v[156:159], v[96:111]
  ds_read_b128 v[180:183], v220 offset:8192
  s_waitcnt lgkmcnt(3)
  v_mfma_f32_32x32x16_bf16 v[112:127], v[200:203], v[156:159], v[112:127]
  ds_read_b128 v[184:187], v220 offset:16384
  s_waitcnt lgkmcnt(3)
  v_mfma_f32_32x32x16_bf16 v[128:143], v[204:207], v[156:159], v[128:143]
  ds_read_b128 v[188:191], v220 offset:24576
  s_waitcnt lgkmcnt(3)
  v_mfma_f32_32x32x16_bf16 v[80:95], v[176:179], v[160:163], v[80:95]
  ds_read_b128 v[192:195], v221 offset:0
  s_waitcnt lgkmcnt(3)
  v_mfma_f32_32x32x16_bf16 v[96:111], v[180:183], v[160:163], v[96:111]
  ds_read_b128 v[196:199], v221 offset:8192
  s_waitcnt lgkmcnt(3)
  v_mfma_f32_32x32x16_bf16 v[112:127], v[184:187], v[160:163], v[112:127]
  ds_read_b128 v[200:203], v221 offset:16384
  s_waitcnt lgkmcnt(3)
  v_mfma_f32_32x32x16_bf16 v[128:143], v[188:191], v[160:163], v[128:143]
  ds_read_b128 v[204:207], v221 offset:24576
  s_waitcnt lgkmcnt(3)
  v_mfma_f32_32x32x16_bf16 v[80:95], v[192:195], v[164:167], v[80:95]
  ds_read_b128 v[176:179], v222 offset:0
  s_waitcnt lgkmcnt(3)
  v_mfma_f32_32x32x16_bf16 v[96:111], v[196:199], v[164:167], v[96:111]
  ds_read_b128 v[180:183], v222 offset:8192
  s_waitcnt lgkmcnt(3)
  v_mfma_f32_32x32x16_bf16 v[112:127], v[200:203], v[164:167], v[112:127]
  ds_read_b128 v[184:187], v222 offset:16384
  s_waitcnt lgkmcnt(3)
  v_mfma_f32_32x32x16_bf16 v[128:143], v[204:207], v[164:167], v[128:143]
  ds_read_b128 v[188:191], v222 offset:24576
  s_waitcnt lgkmcnt(3)
  v_mfma_f32_32x32x16_bf16 v[80:95], v[176:179], v[168:171], v[80:95]
  ds_read_b128 v[192:195], v223 offset:0
  s_waitcnt lgkmcnt(3)
  v_mfma_f32_32x32x16_bf16 v[96:111], v[180:183], v[168:171], v[96:111]
  ds_read_b128 v[196:199], v223 offset:8192
  s_waitcnt lgkmcnt(3)
  v_mfma_f32_32x32x16_bf16 v[112:127], v[184:187], v[168:171], v[112:127]
  ds_read_b128 v[200:203], v223 offset:16384
  s_waitcnt lgkmcnt(3)
  v_mfma_f32_32x32x16_bf16 v[128:143], v[188:191], v[168:171], v[128:143]
  ds_read_b128 v[204:207], v223 offset:24576
  s_waitcnt lgkmcnt(3)
  v_mfma_f32_32x32x16_bf16 v[80:95], v[192:195], v[172:175], v[80:95]
  s_waitcnt lgkmcnt(2)
  v_mfma_f32_32x32x16_bf16 v[96:111], v[196:199], v[172:175], v[96:111]
  s_waitcnt lgkmcnt(1)
  v_mfma_f32_32x32x16_bf16 v[112:127], v[200:203], v[172:175], v[112:127]
  s_waitcnt lgkmcnt(0)
  v_mfma_f32_32x32x16_bf16 v[128:143], v[204:207], v[172:175], v[128:143]
  s_cbranch_vccz k1_s29
  s_waitcnt vmcnt(5)
k1_s29:
  s_barrier
  s_nop 7
  v_max3_f32 v212, v80, v81, v82
  v_max3_f32 v212, v212, v83, v84
  v_max3_f32 v212, v212, v85, v86
  v_max3_f32 v212, v212, v87, v88
  v_max3_f32 v212, v212, v89, v90
  v_max3_f32 v212, v212, v91, v92
  v_max3_f32 v212, v212, v93, v94
  v_max3_f32 v212, v212, v95, v96
  v_max3_f32 v212, v212, v97, v98
  v_max3_f32 v212, v212, v99, v100
  v_max3_f32 v212, v212, v101, v102
  v_max3_f32 v212, v212, v103, v104
  v_max3_f32 v212, v212, v105, v106
  v_max3_f32 v212, v212, v107, v108
  v_max3_f32 v212, v212, v109, v110
  v_max3_f32 v213, v112, v113, v114
  v_max3_f32 v213, v213, v115, v116
  v_max3_f32 v213, v213, v117, v118
  v_max3_f32 v213, v213, v119, v120
  v_max3_f32 v213, v213, v121, v122
  v_max3_f32 v213, v213, v123, v124
  v_max3_f32 v213, v213, v125, v126
  v_max3_f32 v213, v213, v127, v128
  v_max3_f32 v213, v213, v129, v130
  v_max3_f32 v213, v213, v131, v132
  v_max3_f32 v213, v213, v133, v134
  v_max3_f32 v213, v213, v135, v136
  v_max3_f32 v213, v213, v137, v138
  v_max3_f32 v213, v213, v139, v140
  v_max3_f32 v213, v213, v141, v142
  v_max3_f32 v212, v212, v111, v143
  v_max3_f32 v212, v212, v213, v208
  v_mov_b32 v213, v212
  s_nop 1
  v_permlane32_swap_b32 v212, v213
  s_nop 1
  v_max_f32 v212, v212, v213
  v_sub_f32 v210, v208, v212
  v_mul_f32 v210, s50, v210
  v_exp_f32 v210, v210
  v_mov_b32 v208, v212
  v_mul_f32 v212, s50, v212
  v_mul_f32 v209, v209, v210
  v_mov_b32 v214, 0
  v_mov_b32 v215, 0
  v_fma_f32 v80, v80, s50, -v212
  v_fma_f32 v81, v81, s50, -v212
  v_fma_f32 v82, v82, s50, -v212
  v_fma_f32 v83, v83, s50, -v212
  v_exp_f32 v80, v80
  v_exp_f32 v81, v81
  v_exp_f32 v82, v82
  v_exp_f32 v83, v83
  v_mul_f32 v16, v16, v210
  v_mul_f32 v17, v17, v210
  v_mul_f32 v18, v18, v210
  v_mul_f32 v19, v19, v210
  v_add_f32 v214, v214, v80
  v_add_f32 v215, v215, v81
  v_add_f32 v214, v214, v82
  v_add_f32 v215, v215, v83
  v_cvt_pk_bf16_f32 v80, v80, v81
  v_cvt_pk_bf16_f32 v81, v82, v83
  v_fma_f32 v84, v84, s50, -v212
  v_fma_f32 v85, v85, s50, -v212
  v_fma_f32 v86, v86, s50, -v212
  v_fma_f32 v87, v87, s50, -v212
  v_exp_f32 v84, v84
  v_exp_f32 v85, v85
  v_exp_f32 v86, v86
  v_exp_f32 v87, v87
  v_mul_f32 v20, v20, v210
  v_mul_f32 v21, v21, v210
  v_mul_f32 v22, v22, v210
  v_mul_f32 v23, v23, v210
  v_add_f32 v214, v214, v84
  v_add_f32 v215, v215, v85
  v_add_f32 v214, v214, v86
  v_add_f32 v215, v215, v87
  v_cvt_pk_bf16_f32 v82, v84, v85
  v_cvt_pk_bf16_f32 v83, v86, v87
  v_fma_f32 v88, v88, s50, -v212
  v_fma_f32 v89, v89, s50, -v212
  v_fma_f32 v90, v90, s50, -v212
  v_fma_f32 v91, v91, s50, -v212
  v_exp_f32 v88, v88
  v_exp_f32 v89, v89
  v_exp_f32 v90, v90
  v_exp_f32 v91, v91
  v_mul_f32 v24, v24, v210
  v_mul_f32 v25, v25, v210
  v_mul_f32 v26, v26, v210
  v_mul_f32 v27, v27, v210
  v_add_f32 v214, v214, v88
  v_add_f32 v215, v215, v89
  v_add_f32 v214, v214, v90
  v_add_f32 v215, v215, v91
  v_cvt_pk_bf16_f32 v84, v88, v89
  v_cvt_pk_bf16_f32 v85, v90, v91
  v_fma_f32 v92, v92, s50, -v212
  v_fma_f32 v93, v93, s50, -v212
  v_fma_f32 v94, v94, s50, -v212
  v_fma_f32 v95, v95, s50, -v212
  v_exp_f32 v92, v92
  v_exp_f32 v93, v93
  v_exp_f32 v94, v94
  v_exp_f32 v95, v95
  v_mul_f32 v28, v28, v210
  v_mul_f32 v29, v29, v210
  v_mul_f32 v30, v30, v210
  v_mul_f32 v31, v31, v210
  v_add_f32 v214, v214, v92
  v_add_f32 v215, v215, v93
  v_add_f32 v214, v214, v94
  v_add_f32 v215, v215, v95
  v_cvt_pk_bf16_f32 v86, v92, v93
  v_cvt_pk_bf16_f32 v87, v94, v95
  v_fma_f32 v96, v96, s50, -v212
  v_fma_f32 v97, v97, s50, -v212
  v_fma_f32 v98, v98, s50, -v212
  v_fma_f32 v99, v99, s50, -v212
  v_exp_f32 v96, v96
  v_exp_f32 v97, v97
  v_exp_f32 v98, v98
  v_exp_f32 v99, v99
  v_mul_f32 v32, v32, v210
  v_mul_f32 v33, v33, v210
  v_mul_f32 v34, v34, v210
  v_mul_f32 v35, v35, v210
  v_add_f32 v214, v214, v96
  v_add_f32 v215, v215, v97
  v_add_f32 v214, v214, v98
  v_add_f32 v215, v215, v99
  v_cvt_pk_bf16_f32 v88, v96, v97
  v_cvt_pk_bf16_f32 v89, v98, v99
  v_fma_f32 v100, v100, s50, -v212
  v_fma_f32 v101, v101, s50, -v212
  v_fma_f32 v102, v102, s50, -v212
  v_fma_f32 v103, v103, s50, -v212
  v_exp_f32 v100, v100
  v_exp_f32 v101, v101
  v_exp_f32 v102, v102
  v_exp_f32 v103, v103
  v_mul_f32 v36, v36, v210
  v_mul_f32 v37, v37, v210
  v_mul_f32 v38, v38, v210
  v_mul_f32 v39, v39, v210
  v_add_f32 v214, v214, v100
  v_add_f32 v215, v215, v101
  v_add_f32 v214, v214, v102
  v_add_f32 v215, v215, v103
  v_cvt_pk_bf16_f32 v90, v100, v101
  v_cvt_pk_bf16_f32 v91, v102, v103
  v_fma_f32 v104, v104, s50, -v212
  v_fma_f32 v105, v105, s50, -v212
  v_fma_f32 v106, v106, s50, -v212
  v_fma_f32 v107, v107, s50, -v212
  v_exp_f32 v104, v104
  v_exp_f32 v105, v105
  v_exp_f32 v106, v106
  v_exp_f32 v107, v107
  v_mul_f32 v40, v40, v210
  v_mul_f32 v41, v41, v210
  v_mul_f32 v42, v42, v210
  v_mul_f32 v43, v43, v210
  v_add_f32 v214, v214, v104
  v_add_f32 v215, v215, v105
  v_add_f32 v214, v214, v106
  v_add_f32 v215, v215, v107
  v_cvt_pk_bf16_f32 v92, v104, v105
  v_cvt_pk_bf16_f32 v93, v106, v107
  v_fma_f32 v108, v108, s50, -v212
  v_fma_f32 v109, v109, s50, -v212
  v_fma_f32 v110, v110, s50, -v212
  v_fma_f32 v111, v111, s50, -v212
  v_exp_f32 v108, v108
  v_exp_f32 v109, v109
  v_exp_f32 v110, v110
  v_exp_f32 v111, v111
  v_mul_f32 v44, v44, v210
  v_mul_f32 v45, v45, v210
  v_mul_f32 v46, v46, v210
  v_mul_f32 v47, v47, v210
  v_add_f32 v214, v214, v108
  v_add_f32 v215, v215, v109
  v_add_f32 v214, v214, v110
  v_add_f32 v215, v215, v111
  v_cvt_pk_bf16_f32 v94, v108, v109
  v_cvt_pk_bf16_f32 v95, v110, v111
  v_fma_f32 v112, v112, s50, -v212
  v_fma_f32 v113, v113, s50, -v212
  v_fma_f32 v114, v114, s50, -v212
  v_fma_f32 v115, v115, s50, -v212
  v_exp_f32 v112, v112
  v_exp_f32 v113, v113
  v_exp_f32 v114, v114
  v_exp_f32 v115, v115
  v_mul_f32 v48, v48, v210
  v_mul_f32 v49, v49, v210
  v_mul_f32 v50, v50, v210
  v_mul_f32 v51, v51, v210
  v_add_f32 v214, v214, v112
  v_add_f32 v215, v215, v113
  v_add_f32 v214, v214, v114
  v_add_f32 v215, v215, v115
  v_cvt_pk_bf16_f32 v96, v112, v113
  v_cvt_pk_bf16_f32 v97, v114, v115
  v_fma_f32 v116, v116, s50, -v212
  v_fma_f32 v117, v117, s50, -v212
  v_fma_f32 v118, v118, s50, -v212
  v_fma_f32 v119, v119, s50, -v212
  v_exp_f32 v116, v116
  v_exp_f32 v117, v117
  v_exp_f32 v118, v118
  v_exp_f32 v119, v119
  v_mul_f32 v52, v52, v210
  v_mul_f32 v53, v53, v210
  v_mul_f32 v54, v54, v210
  v_mul_f32 v55, v55, v210
  v_add_f32 v214, v214, v116
  v_add_f32 v215, v215, v117
  v_add_f32 v214, v214, v118
  v_add_f32 v215, v215, v119
  v_cvt_pk_bf16_f32 v98, v116, v117
  v_cvt_pk_bf16_f32 v99, v118, v119
  v_fma_f32 v120, v120, s50, -v212
  v_fma_f32 v121, v121, s50, -v212
  v_fma_f32 v122, v122, s50, -v212
  v_fma_f32 v123, v123, s50, -v212
  v_exp_f32 v120, v120
  v_exp_f32 v121, v121
  v_exp_f32 v122, v122
  v_exp_f32 v123, v123
  v_mul_f32 v56, v56, v210
  v_mul_f32 v57, v57, v210
  v_mul_f32 v58, v58, v210
  v_mul_f32 v59, v59, v210
  v_add_f32 v214, v214, v120
  v_add_f32 v215, v215, v121
  v_add_f32 v214, v214, v122
  v_add_f32 v215, v215, v123
  v_cvt_pk_bf16_f32 v100, v120, v121
  v_cvt_pk_bf16_f32 v101, v122, v123
  v_fma_f32 v124, v124, s50, -v212
  v_fma_f32 v125, v125, s50, -v212
  v_fma_f32 v126, v126, s50, -v212
  v_fma_f32 v127, v127, s50, -v212
  v_exp_f32 v124, v124
  v_exp_f32 v125, v125
  v_exp_f32 v126, v126
  v_exp_f32 v127, v127
  v_mul_f32 v60, v60, v210
  v_mul_f32 v61, v61, v210
  v_mul_f32 v62, v62, v210
  v_mul_f32 v63, v63, v210
  v_add_f32 v214, v214, v124
  v_add_f32 v215, v215, v125
  v_add_f32 v214, v214, v126
  v_add_f32 v215, v215, v127
  v_cvt_pk_bf16_f32 v102, v124, v125
  v_cvt_pk_bf16_f32 v103, v126, v127
  v_fma_f32 v128, v128, s50, -v212
  v_fma_f32 v129, v129, s50, -v212
  v_fma_f32 v130, v130, s50, -v212
  v_fma_f32 v131, v131, s50, -v212
  v_exp_f32 v128, v128
  v_exp_f32 v129, v129
  v_exp_f32 v130, v130
  v_exp_f32 v131, v131
  v_mul_f32 v64, v64, v210
  v_mul_f32 v65, v65, v210
  v_mul_f32 v66, v66, v210
  v_mul_f32 v67, v67, v210
  v_add_f32 v214, v214, v128
  v_add_f32 v215, v215, v129
  v_add_f32 v214, v214, v130
  v_add_f32 v215, v215, v131
  v_cvt_pk_bf16_f32 v104, v128, v129
  v_cvt_pk_bf16_f32 v105, v130, v131
  v_fma_f32 v132, v132, s50, -v212
  v_fma_f32 v133, v133, s50, -v212
  v_fma_f32 v134, v134, s50, -v212
  v_fma_f32 v135, v135, s50, -v212
  v_exp_f32 v132, v132
  v_exp_f32 v133, v133
  v_exp_f32 v134, v134
  v_exp_f32 v135, v135
  v_mul_f32 v68, v68, v210
  v_mul_f32 v69, v69, v210
  v_mul_f32 v70, v70, v210
  v_mul_f32 v71, v71, v210
  v_add_f32 v214, v214, v132
  v_add_f32 v215, v215, v133
  v_add_f32 v214, v214, v134
  v_add_f32 v215, v215, v135
  v_cvt_pk_bf16_f32 v106, v132, v133
  v_cvt_pk_bf16_f32 v107, v134, v135
  v_fma_f32 v136, v136, s50, -v212
  v_fma_f32 v137, v137, s50, -v212
  v_fma_f32 v138, v138, s50, -v212
  v_fma_f32 v139, v139, s50, -v212
  v_exp_f32 v136, v136
  v_exp_f32 v137, v137
  v_exp_f32 v138, v138
  v_exp_f32 v139, v139
  v_mul_f32 v72, v72, v210
  v_mul_f32 v73, v73, v210
  v_mul_f32 v74, v74, v210
  v_mul_f32 v75, v75, v210
  v_add_f32 v214, v214, v136
  v_add_f32 v215, v215, v137
  v_add_f32 v214, v214, v138
  v_add_f32 v215, v215, v139
  v_cvt_pk_bf16_f32 v108, v136, v137
  v_cvt_pk_bf16_f32 v109, v138, v139
  v_fma_f32 v140, v140, s50, -v212
  v_fma_f32 v141, v141, s50, -v212
  v_fma_f32 v142, v142, s50, -v212
  v_fma_f32 v143, v143, s50, -v212
  v_exp_f32 v140, v140
  v_exp_f32 v141, v141
  v_exp_f32 v142, v142
  v_exp_f32 v143, v143
  v_mul_f32 v76, v76, v210
  v_mul_f32 v77, v77, v210
  v_mul_f32 v78, v78, v210
  v_mul_f32 v79, v79, v210
  v_add_f32 v214, v214, v140
  v_add_f32 v215, v215, v141
  v_add_f32 v214, v214, v142
  v_add_f32 v215, v215, v143
  v_cvt_pk_bf16_f32 v110, v140, v141
  v_cvt_pk_bf16_f32 v111, v142, v143
  v_add_f32 v209, v209, v214
  v_add_f32 v209, v209, v215
  s_barrier
  v_xor_b32 v216, 0, v9
  v_add_u32 v216, 114688, v216
  v_xor_b32 v217, 64, v9
  v_add_u32 v217, 114688, v217
  v_xor_b32 v218, 128, v9
  v_add_u32 v218, 114688, v218
  v_xor_b32 v219, 192, v9
  v_add_u32 v219, 114688, v219
  ds_read_b64_tr_b16 v[176:177], v216 offset:0
  ds_read_b64_tr_b16 v[178:179], v216 offset:2048
  ds_read_b64_tr_b16 v[180:181], v217 offset:0
  ds_read_b64_tr_b16 v[182:183], v217 offset:2048
  ds_read_b64_tr_b16 v[184:185], v218 offset:0
  ds_read_b64_tr_b16 v[186:187], v218 offset:2048
  ds_read_b64_tr_b16 v[188:189], v219 offset:0
  ds_read_b64_tr_b16 v[190:191], v219 offset:2048
  s_waitcnt lgkmcnt(6)
  v_mfma_f32_32x32x16_bf16 v[16:31], v[176:179], v[80:83], v[16:31]
  ds_read_b64_tr_b16 v[192:193], v216 offset:4096
  ds_read_b64_tr_b16 v[194:195], v216 offset:6144
  s_waitcnt lgkmcnt(6)
  v_mfma_f32_32x32x16_bf16 v[32:47], v[180:183], v[80:83], v[32:47]
  ds_read_b64_tr_b16 v[196:197], v217 offset:4096
  ds_read_b64_tr_b16 v[198:199], v217 offset:6144
  s_waitcnt lgkmcnt(6)
  v_mfma_f32_32x32x16_bf16 v[48:63], v[184:187], v[80:83], v[48:63]
  ds_read_b64_tr_b16 v[200:201], v218 offset:4096
  ds_read_b64_tr_b16 v[202:203], v218 offset:6144
  s_waitcnt lgkmcnt(6)
  v_mfma_f32_32x32x16_bf16 v[64:79], v[188:191], v[80:83], v[64:79]
  ds_read_b64_tr_b16 v[204:205], v219 offset:4096
  ds_read_b64_tr_b16 v[206:207], v219 offset:6144
  s_waitcnt lgkmcnt(6)
  v_mfma_f32_32x32x16_bf16 v[16:31], v[192:195], v[84:87], v[16:31]
  ds_read_b64_tr_b16 v[176:177], v216 offset:8192
  ds_read_b64_tr_b16 v[178:179], v216 offset:10240
  s_waitcnt lgkmcnt(6)
  v_mfma_f32_32x32x16_bf16 v[32:47], v[196:199], v[84:87], v[32:47]
  ds_read_b64_tr_b16 v[180:181], v217 offset:8192
  ds_read_b64_tr_b16 v[182:183], v217 offset:10240
  s_waitcnt lgkmcnt(6)
  v_mfma_f32_32x32x16_bf16 v[48:63], v[200:203], v[84:87], v[48:63]
  ds_read_b64_tr_b16 v[184:185], v218 offset:8192
  ds_read_b64_tr_b16 v[186:187], v218 offset:10240
  s_waitcnt lgkmcnt(6)
  v_mfma_f32_32x32x16_bf16 v[64:79], v[204:207], v[84:87], v[64:79]
  ds_read_b64_tr_b16 v[188:189], v219 offset:8192
  ds_read_b64_tr_b16 v[190:191], v219 offset:10240
  s_waitcnt lgkmcnt(6)
  v_mfma_f32_32x32x16_bf16 v[16:31], v[176:179], v[88:91], v[16:31]
  ds_read_b64_tr_b16 v[192:193], v216 offset:12288
  ds_read_b64_tr_b16 v[194:195], v216 offset:14336
  s_waitcnt lgkmcnt(6)
  v_mfma_f32_32x32x16_bf16 v[32:47], v[180:183], v[88:91], v[32:47]
  ds_read_b64_tr_b16 v[196:197], v217 offset:12288
  ds_read_b64_tr_b16 v[198:199], v217 offset:14336
  s_waitcnt lgkmcnt(6)
  v_mfma_f32_32x32x16_bf16 v[48:63], v[184:187], v[88:91], v[48:63]
  ds_read_b64_tr_b16 v[200:201], v218 offset:12288
  ds_read_b64_tr_b16 v[202:203], v218 offset:14336
  s_waitcnt lgkmcnt(6)
  v_mfma_f32_32x32x16_bf16 v[64:79], v[188:191], v[88:91], v[64:79]
  ds_read_b64_tr_b16 v[204:205], v219 offset:12288
  ds_read_b64_tr_b16 v[206:207], v219 offset:14336
  s_waitcnt lgkmcnt(6)
  v_mfma_f32_32x32x16_bf16 v[16:31], v[192:195], v[92:95], v[16:31]
  ds_read_b64_tr_b16 v[176:177], v216 offset:16384
  ds_read_b64_tr_b16 v[178:179], v216 offset:18432
  s_waitcnt lgkmcnt(6)
  v_mfma_f32_32x32x16_bf16 v[32:47], v[196:199], v[92:95], v[32:47]
  ds_read_b64_tr_b16 v[180:181], v217 offset:16384
  ds_read_b64_tr_b16 v[182:183], v217 offset:18432
  s_waitcnt lgkmcnt(6)
  v_mfma_f32_32x32x16_bf16 v[48:63], v[200:203], v[92:95], v[48:63]
  ds_read_b64_tr_b16 v[184:185], v218 offset:16384
  ds_read_b64_tr_b16 v[186:187], v218 offset:18432
  s_waitcnt lgkmcnt(6)
  v_mfma_f32_32x32x16_bf16 v[64:79], v[204:207], v[92:95], v[64:79]
  ds_read_b64_tr_b16 v[188:189], v219 offset:16384
  ds_read_b64_tr_b16 v[190:191], v219 offset:18432
  s_waitcnt lgkmcnt(6)
  v_mfma_f32_32x32x16_bf16 v[16:31], v[176:179], v[96:99], v[16:31]
  ds_read_b64_tr_b16 v[192:193], v216 offset:20480
  ds_read_b64_tr_b16 v[194:195], v216 offset:22528
  s_waitcnt lgkmcnt(6)
  v_mfma_f32_32x32x16_bf16 v[32:47], v[180:183], v[96:99], v[32:47]
  ds_read_b64_tr_b16 v[196:197], v217 offset:20480
  ds_read_b64_tr_b16 v[198:199], v217 offset:22528
  s_waitcnt lgkmcnt(6)
  v_mfma_f32_32x32x16_bf16 v[48:63], v[184:187], v[96:99], v[48:63]
  ds_read_b64_tr_b16 v[200:201], v218 offset:20480
  ds_read_b64_tr_b16 v[202:203], v218 offset:22528
  s_waitcnt lgkmcnt(6)
  v_mfma_f32_32x32x16_bf16 v[64:79], v[188:191], v[96:99], v[64:79]
  ds_read_b64_tr_b16 v[204:205], v219 offset:20480
  ds_read_b64_tr_b16 v[206:207], v219 offset:22528
  s_waitcnt lgkmcnt(6)
  v_mfma_f32_32x32x16_bf16 v[16:31], v[192:195], v[100:103], v[16:31]
  ds_read_b64_tr_b16 v[176:177], v216 offset:24576
  ds_read_b64_tr_b16 v[178:179], v216 offset:26624
  s_waitcnt lgkmcnt(6)
  v_mfma_f32_32x32x16_bf16 v[32:47], v[196:199], v[100:103], v[32:47]
  ds_read_b64_tr_b16 v[180:181], v217 offset:24576
  ds_read_b64_tr_b16 v[182:183], v217 offset:26624
  s_waitcnt lgkmcnt(6)
  v_mfma_f32_32x32x16_bf16 v[48:63], v[200:203], v[100:103], v[48:63]
  ds_read_b64_tr_b16 v[184:185], v218 offset:24576
  ds_read_b64_tr_b16 v[186:187], v218 offset:26624
  s_waitcnt lgkmcnt(6)
  v_mfma_f32_32x32x16_bf16 v[64:79], v[204:207], v[100:103], v[64:79]
  ds_read_b64_tr_b16 v[188:189], v219 offset:24576
  ds_read_b64_tr_b16 v[190:191], v219 offset:26624
  s_waitcnt lgkmcnt(6)
  v_mfma_f32_32x32x16_bf16 v[16:31], v[176:179], v[104:107], v[16:31]
  ds_read_b64_tr_b16 v[192:193], v216 offset:28672
  ds_read_b64_tr_b16 v[194:195], v216 offset:30720
  s_waitcnt lgkmcnt(6)
  v_mfma_f32_32x32x16_bf16 v[32:47], v[180:183], v[104:107], v[32:47]
  ds_read_b64_tr_b16 v[196:197], v217 offset:28672
  ds_read_b64_tr_b16 v[198:199], v217 offset:30720
  s_waitcnt lgkmcnt(6)
  v_mfma_f32_32x32x16_bf16 v[48:63], v[184:187], v[104:107], v[48:63]
  ds_read_b64_tr_b16 v[200:201], v218 offset:28672
  ds_read_b64_tr_b16 v[202:203], v218 offset:30720
  s_waitcnt lgkmcnt(6)
  v_mfma_f32_32x32x16_bf16 v[64:79], v[188:191], v[104:107], v[64:79]
  ds_read_b64_tr_b16 v[204:205], v219 offset:28672
  ds_read_b64_tr_b16 v[206:207], v219 offset:30720
  s_waitcnt lgkmcnt(6)
  v_mfma_f32_32x32x16_bf16 v[16:31], v[192:195], v[108:111], v[16:31]
  s_waitcnt lgkmcnt(4)
  v_mfma_f32_32x32x16_bf16 v[32:47], v[196:199], v[108:111], v[32:47]
  s_waitcnt lgkmcnt(2)
  v_mfma_f32_32x32x16_bf16 v[48:63], v[200:203], v[108:111], v[48:63]
  s_waitcnt lgkmcnt(0)
  v_mfma_f32_32x32x16_bf16 v[64:79], v[204:207], v[108:111], v[64:79]
  s_cbranch_vccnz k1_s30
  s_barrier
k1_s30:
  s_getpc_b64 s[96:97]
pc_4700_v224:
  v_lshlrev_b32 v14, 7, v0
  s_lshl_b32 s98, s3, 13
  v_add_u32 v14, s98, v14
  v_add_u32 v14, k2_body-pc_4700_v224, v14
  v_min_u32 v14, k5_end-pc_4700_v224, v14
  v_mov_b32 v15, 0
  v_lshl_add_u64 v[14:15], v[14:15], 0, s[96:97]
  global_load_dword v224, v[14:15], off
  s_add_u32 s40, s28, 4
  s_addc_u32 s41, s29, 0
  s_mov_b32 s42, 4
  s_mov_b32 s43, 0x20000
  buffer_load_dword v225, v1, s[40:43], 0 offen sc1
  v_mov_b32 v213, v209
  s_nop 1
  v_permlane32_swap_b32 v209, v213
  s_nop 1
  v_add_f32 v209, v209, v213
  v_rcp_f32 v209, v209
  v_bfe_u32 v12, v0, 4, 1
  v_lshlrev_b32 v12, 10, v12
  s_mov_b32 s48, 4096
  v_and_b32 v13, 15, v0
  v_lshl_add_u32 v12, v13, 4, v12
  v_lshrrev_b32 v13, 5, v0
  v_lshl_add_u32 v12, v13, 8, v12
  s_nop 4
  v_mul_f32 v16, v16, v209
  v_mul_f32 v17, v17, v209
  v_mul_f32 v18, v18, v209
  v_mul_f32 v19, v19, v209
  v_mul_f32 v20, v20, v209
  v_mul_f32 v21, v21, v209
  v_mul_f32 v22, v22, v209
  v_mul_f32 v23, v23, v209
  v_mul_f32 v24, v24, v209
  v_mul_f32 v25, v25, v209
  v_mul_f32 v26, v26, v209
  v_mul_f32 v27, v27, v209
  v_mul_f32 v28, v28, v209
  v_mul_f32 v29, v29, v209
  v_mul_f32 v30, v30, v209
  v_mul_f32 v31, v31, v209
  v_cvt_pk_bf16_f32 v80, v16, v17
  v_cvt_pk_bf16_f32 v81, v18, v19
  v_cvt_pk_bf16_f32 v82, v24, v25
  v_cvt_pk_bf16_f32 v83, v26, v27
  buffer_store_dwordx4 v[80:83], v12, s[56:59], 0 offen offset:0 sc1
  v_cvt_pk_bf16_f32 v84, v20, v21
  v_cvt_pk_bf16_f32 v85, v22, v23
  v_cvt_pk_bf16_f32 v86, v28, v29
  v_cvt_pk_bf16_f32 v87, v30, v31
  buffer_store_dwordx4 v[84:87], v12, s[56:59], 0 offen offset:512 sc1
  v_mul_f32 v32, v32, v209
  v_mul_f32 v33, v33, v209
  v_mul_f32 v34, v34, v209
  v_mul_f32 v35, v35, v209
  v_mul_f32 v36, v36, v209
  v_mul_f32 v37, v37, v209
  v_mul_f32 v38, v38, v209
  v_mul_f32 v39, v39, v209
  v_mul_f32 v40, v40, v209
  v_mul_f32 v41, v41, v209
  v_mul_f32 v42, v42, v209
  v_mul_f32 v43, v43, v209
  v_mul_f32 v44, v44, v209
  v_mul_f32 v45, v45, v209
  v_mul_f32 v46, v46, v209
  v_mul_f32 v47, v47, v209
  v_cvt_pk_bf16_f32 v88, v32, v33
  v_cvt_pk_bf16_f32 v89, v34, v35
  v_cvt_pk_bf16_f32 v90, v40, v41
  v_cvt_pk_bf16_f32 v91, v42, v43
  buffer_store_dwordx4 v[88:91], v12, s[56:59], 0 offen offset:2048 sc1
  v_cvt_pk_bf16_f32 v92, v36, v37
  v_cvt_pk_bf16_f32 v93, v38, v39
  v_cvt_pk_bf16_f32 v94, v44, v45
  v_cvt_pk_bf16_f32 v95, v46, v47
  buffer_store_dwordx4 v[92:95], v12, s[56:59], 0 offen offset:2560 sc1
  v_mul_f32 v48, v48, v209
  v_mul_f32 v49, v49, v209
  v_mul_f32 v50, v50, v209
  v_mul_f32 v51, v51, v209
  v_mul_f32 v52, v52, v209
  v_mul_f32 v53, v53, v209
  v_mul_f32 v54, v54, v209
  v_mul_f32 v55, v55, v209
  v_mul_f32 v56, v56, v209
  v_mul_f32 v57, v57, v209
  v_mul_f32 v58, v58, v209
  v_mul_f32 v59, v59, v209
  v_mul_f32 v60, v60, v209
  v_mul_f32 v61, v61, v209
  v_mul_f32 v62, v62, v209
  v_mul_f32 v63, v63, v209
  v_cvt_pk_bf16_f32 v96, v48, v49
  v_cvt_pk_bf16_f32 v97, v50, v51
  v_cvt_pk_bf16_f32 v98, v56, v57
  v_cvt_pk_bf16_f32 v99, v58, v59
  buffer_store_dwordx4 v[96:99], v12, s[56:59], s48 offen offset:0 sc1
  v_cvt_pk_bf16_f32 v100, v52, v53
  v_cvt_pk_bf16_f32 v101, v54, v55
  v_cvt_pk_bf16_f32 v102, v60, v61
  v_cvt_pk_bf16_f32 v103, v62, v63
  buffer_store_dwordx4 v[100:103], v12, s[56:59], s48 offen offset:512 sc1
  v_mul_f32 v64, v64, v209
  v_mul_f32 v65, v65, v209
  v_mul_f32 v66, v66, v209
  v_mul_f32 v67, v67, v209
  v_mul_f32 v68, v68, v209
  v_mul_f32 v69, v69, v209
  v_mul_f32 v70, v70, v209
  v_mul_f32 v71, v71, v209
  v_mul_f32 v72, v72, v209
  v_mul_f32 v73, v73, v209
  v_mul_f32 v74, v74, v209
  v_mul_f32 v75, v75, v209
  v_mul_f32 v76, v76, v209
  v_mul_f32 v77, v77, v209
  v_mul_f32 v78, v78, v209
  v_mul_f32 v79, v79, v209
  v_cvt_pk_bf16_f32 v104, v64, v65
  v_cvt_pk_bf16_f32 v105, v66, v67
  v_cvt_pk_bf16_f32 v106, v72, v73
  v_cvt_pk_bf16_f32 v107, v74, v75
  buffer_store_dwordx4 v[104:107], v12, s[56:59], s48 offen offset:2048 sc1
  v_cvt_pk_bf16_f32 v108, v68, v69
  v_cvt_pk_bf16_f32 v109, v70, v71
  v_cvt_pk_bf16_f32 v110, v76, v77
  v_cvt_pk_bf16_f32 v111, v78, v79
  buffer_store_dwordx4 v[108:111], v12, s[56:59], s48 offen offset:2560 sc1
  s_lshl_b32 s48, s34, 5
  s_add_u32 s48, s48, s30
  s_lshl_b32 s48, s48, 7
  s_add_u32 s52, s10, 51822592
  s_addc_u32 s53, s11, 0
  s_add_u32 s52, s52, s48
  s_addc_u32 s53, s53, 0
  s_mov_b32 s54, 4
  s_mov_b32 s55, 0x20000
  v_mov_b32 v13, 0
k1_ma:
  s_waitcnt vmcnt(0)
  v_readfirstlane_b32 s48, v225
  s_nop 3
  s_cmp_ge_u32 s48, 72
  s_cbranch_scc1 k1_mb
  s_sleep 2
  buffer_load_dword v225, v1, s[40:43], 0 offen sc1
  s_branch k1_ma
k1_mb:
  buffer_store_dword v13, v1, s[52:55], 0 offen sc1
  s_cbranch_vccnz k1_end
k2_body:
  s_cmp_ge_u32 s2, 240
  s_cbranch_scc1 k2_end
  s_load_dwordx2 s[4:5], s[0:1], 0
  s_load_dwordx2 s[6:7], s[0:1], 32
  s_load_dwordx2 s[8:9], s[0:1], 48
  s_load_dwordx2 s[28:29], s[0:1], 104
  s_cmp_ge_u32 s2, 192
  s_cbranch_scc1 k2_uv
  s_bfe_u32 s52, s2, 0x20001
  s_and_b32 s50, s52, 1
  s_lshr_b32 s51, s52, 1
  s_and_b32 s30, s2, 1
  s_lshl_b32 s30, s30, 3
  s_bfe_u32 s31, s2, 0x30003
  s_add_u32 s30, s30, s31
  s_lshr_b32 s53, s2, 6
  s_lshl_b32 s33, s30, 2
  s_add_u32 s33, s33, s3
  s_lshl_b32 s34, s33, 1
  s_add_u32 s34, s34, s50
  s_lshl_b32 s31, s53, 1
  s_add_u32 s31, s31, s51
  s_mul_i32 s35, s53, 384
  s_mul_i32 s36, s52, 1179648
  s_add_u32 s35, s35, s36
  s_sub_u32 s36, 4718592, s35
  s_mul_i32 s37, s33, 262144
  s_mul_i32 s38, s52, 65536
  s_add_u32 s37, s37, s38
  s_mul_i32 s38, s34, 18432
  s_mul_i32 s39, s31, 192
  s_add_u32 s38, s38, s39
  s_lshl_b32 s39, s39, 1
  s_mul_i32 s40, s33, 3
  s_add_u32 s40, s40, s53
  s_mul_i32 s41, s40, 36864
  s_lshl_b32 s40, s40, 9
  s_waitcnt lgkmcnt(0)
  s_add_u32 s12, s6, 0
  s_addc_u32 s13, s7, 0
  s_add_u32 s12, s12, s35
  s_addc_u32 s13, s13, 0
  s_mov_b32 s14, s36
  s_mov_b32 s15, 0x20000
  s_add_u32 s16, s10, 10764288
  s_addc_u32 s17, s11, 0
  s_add_u32 s16, s16, s37
  s_addc_u32 s17, s17, 0
  s_mov_b32 s18, 65536
  s_mov_b32 s19, 0x20000
  s_add_u32 s20, s4, 0
  s_addc_u32 s21, s5, 0
  s_add_u32 s20, s20, s38
  s_addc_u32 s21, s21, 0
  s_mov_b32 s22, 17472
  s_mov_b32 s23, 0x20000
  s_add_u32 s24, s10, 0
  s_addc_u32 s25, s11, 0
  s_add_u32 s24, s24, s39
  s_addc_u32 s25, s25, 0
  s_mov_b32 s26, 13824
  s_mov_b32 s27, 0x20000
  s_add_u32 s56, s10, 52740096
  s_addc_u32 s57, s11, 0
  s_add_u32 s56, s56, s41
  s_addc_u32 s57, s57, 0
  s_mov_b32 s58, 36864
  s_mov_b32 s59, 0x20000
  s_add_u32 s60, s10, 51560448
  s_addc_u32 s61, s11, 0
  s_add_u32 s60, s60, s40
  s_addc_u32 s61, s61, 0
  s_mov_b32 s62, 512
  s_mov_b32 s63, 0x20000
  s_mov_b32 s44, 0
  s_mov_b32 s45, 0
  v_and_b32 v0, 63, v0
  v_lshlrev_b32 v1, 4, v0
  s_mul_i32 s46, s3, 6144
  s_lshl_b32 s48, s50, 10
  v_add_u32 v16, s48, v1
  v_xor_b32 v17, 0x400, v16
  s_mul_i32 s49, s51, 12
  s_lshr_b32 s48, s46, 4
  s_add_u32 s48, s48, 0
  v_add_u32 v14, s48, v0
  v_mul_u32_u24 v15, 2731, v14
  v_lshrrev_b32 v15, 16, v15
  v_mul_u32_u24 v2, 24, v15
  v_sub_u32 v14, v14, v2
  v_and_b32 v2, 6, v15
  v_xor_b32 v14, v14, v2
  v_add_u32 v14, s49, v14
  v_subrev_u32 v2, 24, v14
  v_min_u32 v14, v14, v2
  v_mul_u32_u24 v2, 1152, v15
  v_lshl_add_u32 v2, v14, 4, v2
  s_lshr_b32 s48, s46, 4
  s_add_u32 s48, s48, 64
  v_add_u32 v14, s48, v0
  v_mul_u32_u24 v15, 2731, v14
  v_lshrrev_b32 v15, 16, v15
  v_mul_u32_u24 v3, 24, v15
  v_sub_u32 v14, v14, v3
  v_and_b32 v3, 6, v15
  v_xor_b32 v14, v14, v3
  v_add_u32 v14, s49, v14
  v_subrev_u32 v3, 24, v14
  v_min_u32 v14, v14, v3
  v_mul_u32_u24 v3, 1152, v15
  v_lshl_add_u32 v3, v14, 4, v3
  s_lshr_b32 s48, s46, 4
  s_add_u32 s48, s48, 128
  v_add_u32 v14, s48, v0
  v_mul_u32_u24 v15, 2731, v14
  v_lshrrev_b32 v15, 16, v15
  v_mul_u32_u24 v4, 24, v15
  v_sub_u32 v14, v14, v4
  v_and_b32 v4, 6, v15
  v_xor_b32 v14, v14, v4
  v_add_u32 v14, s49, v14
  v_subrev_u32 v4, 24, v14
  v_min_u32 v14, v14, v4
  v_mul_u32_u24 v4, 1152, v15
  v_lshl_add_u32 v4, v14, 4, v4
  s_lshr_b32 s48, s46, 4
  s_add_u32 s48, s48, 192
  v_add_u32 v14, s48, v0
  v_mul_u32_u24 v15, 2731, v14
  v_lshrrev_b32 v15, 16, v15
  v_mul_u32_u24 v5, 24, v15
  v_sub_u32 v14, v14, v5
  v_and_b32 v5, 6, v15
  v_xor_b32 v14, v14, v5
  v_add_u32 v14, s49, v14
  v_subrev_u32 v5, 24, v14
  v_min_u32 v14, v14, v5
  v_mul_u32_u24 v5, 1152, v15
  v_lshl_add_u32 v5, v14, 4, v5
  s_lshr_b32 s48, s46, 4
  s_add_u32 s48, s48, 256
  v_add_u32 v14, s48, v0
  v_mul_u32_u24 v15, 2731, v14
  v_lshrrev_b32 v15, 16, v15
  v_mul_u32_u24 v6, 24, v15
  v_sub_u32 v14, v14, v6
  v_and_b32 v6, 6, v15
  v_xor_b32 v14, v14, v6
  v_add_u32 v14, s49, v14
  v_subrev_u32 v6, 24, v14
  v_min_u32 v14, v14, v6
  v_mul_u32_u24 v6, 1152, v15
  v_lshl_add_u32 v6, v14, 4, v6
  s_lshr_b32 s48, s46, 4
  s_add_u32 s48, s48, 320
  v_add_u32 v14, s48, v0
  v_mul_u32_u24 v15, 2731, v14
  v_lshrrev_b32 v15, 16, v15
  v_mul_u32_u24 v7, 24, v15
  v_sub_u32 v14, v14, v7
  v_and_b32 v7, 6, v15
  v_xor_b32 v14, v14, v7
  v_add_u32 v14, s49, v14
  v_subrev_u32 v7, 24, v14
  v_min_u32 v14, v14, v7
  v_mul_u32_u24 v7, 1152, v15
  v_lshl_add_u32 v7, v14, 4, v7
  v_and_b32 v18, 15, v0
  v_mul_u32_u24 v18, 1152, v18
  v_lshrrev_b32 v19, 4, v0
  v_lshl_add_u32 v18, v19, 3, v18
  v_lshlrev_b32 v19, 4, v19
  s_add_u32 m0, s46, 0
  s_nop 0
  buffer_load_dwordx4 v2, s[12:15], s44 offen lds
  s_add_u32 m0, s46, 1024
  s_nop 0
  buffer_load_dwordx4 v3, s[12:15], s44 offen lds
  s_add_u32 m0, s46, 2048
  s_nop 0
  buffer_load_dwordx4 v4, s[12:15], s44 offen lds
  s_add_u32 m0, s46, 3072
  s_nop 0
  buffer_load_dwordx4 v5, s[12:15], s44 offen lds
  s_add_u32 m0, s46, 4096
  s_nop 0
  buffer_load_dwordx4 v6, s[12:15], s44 offen lds
  s_add_u32 m0, s46, 5120
  s_nop 0
  buffer_load_dwordx4 v7, s[12:15], s44 offen lds
  s_add_u32 s44, s44, 73728
  s_add_u32 m0, s46, 24576
  s_nop 0
  buffer_load_dwordx4 v2, s[12:15], s44 offen lds
  s_add_u32 m0, s46, 25600
  s_nop 0
  buffer_load_dwordx4 v3, s[12:15], s44 offen lds
  s_add_u32 m0, s46, 26624
  s_nop 0
  buffer_load_dwordx4 v4, s[12:15], s44 offen lds
  s_add_u32 m0, s46, 27648
  s_nop 0
  buffer_load_dwordx4 v5, s[12:15], s44 offen lds
  s_add_u32 m0, s46, 28672
  s_nop 0
  buffer_load_dwordx4 v6, s[12:15], s44 offen lds
  s_add_u32 m0, s46, 29696
  s_nop 0
  buffer_load_dwordx4 v7, s[12:15], s44 offen lds
  s_add_u32 s44, s44, 73728
  s_lshl_b32 s48, s33, 2
  s_add_u32 s48, s48, s52
  s_lshl_b32 s48, s48, 10
  v_lshlrev_b32 v12, 7, v0
  s_add_u32 s40, s10, 51822592
  s_addc_u32 s41, s11, 0
  s_add_u32 s40, s40, s48
  s_addc_u32 s41, s41, 0
  s_mov_b32 s42, 1024
  s_mov_b32 s43, 0x20000
k2_p0:
  buffer_load_dword v13, v12, s[40:43], 0 offen sc1
  s_waitcnt vmcnt(0)
  v_cmp_ne_u32 vcc, 0, v13
  s_nop 1
  s_cbranch_vccz k2_rdy
  s_sleep 1
  s_branch k2_p0
k2_rdy:
  buffer_load_dwordx4 v[180:183], v16, s[16:19], s45 offen offset:0 sc1
  buffer_load_dwordx4 v[184:187], v17, s[16:19], s45 offen offset:0 sc1
  buffer_load_dwordx4 v[188:191], v16, s[16:19], s45 offen offset:2048 sc1
  buffer_load_dwordx4 v[192:195], v17, s[16:19], s45 offen offset:2048 sc1
  s_add_u32 s45, s45, 4096
  buffer_load_dwordx4 v[196:199], v16, s[16:19], s45 offen offset:0 sc1
  buffer_load_dwordx4 v[200:203], v17, s[16:19], s45 offen offset:0 sc1
  buffer_load_dwordx4 v[204:207], v16, s[16:19], s45 offen offset:2048 sc1
  buffer_load_dwordx4 v[208:211], v17, s[16:19], s45 offen offset:2048 sc1
  s_add_u32 s45, s45, 4096
  v_lshrrev_b32 v14, 2, v0
  v_mul_u32_u24 v8, 384, v14
  v_and_b32 v14, 3, v0
  v_lshl_add_u32 v8, v14, 3, v8
  v_bfe_u32 v14, v0, 3, 2
  v_xor_b32 v14, 0, v14
  v_lshl_add_u32 v244, v14, 5, v8
  v_add_u32 v248, 49152, v244
  v_bfe_u32 v14, v0, 3, 2
  v_xor_b32 v14, 1, v14
  v_lshl_add_u32 v245, v14, 5, v8
  v_add_u32 v249, 49152, v245
  v_bfe_u32 v14, v0, 3, 2
  v_xor_b32 v14, 2, v14
  v_lshl_add_u32 v246, v14, 5, v8
  v_add_u32 v250, 49152, v246
  v_bfe_u32 v14, v0, 3, 2
  v_xor_b32 v14, 3, v14
  v_lshl_add_u32 v247, v14, 5, v8
  v_add_u32 v251, 49152, v247
  v_mov_b32 v20, 0
  v_mov_b32 v21, 0
  v_mov_b32 v22, 0
  v_mov_b32 v23, 0
  v_mov_b32 v24, 0
  v_mov_b32 v25, 0
  v_mov_b32 v26, 0
  v_mov_b32 v27, 0
  v_mov_b32 v28, 0
  v_mov_b32 v29, 0
  v_mov_b32 v30, 0
  v_mov_b32 v31, 0
  v_mov_b32 v32, 0
  v_mov_b32 v33, 0
  v_mov_b32 v34, 0
  v_mov_b32 v35, 0
  v_mov_b32 v36, 0
  v_mov_b32 v37, 0
  v_mov_b32 v38, 0
  v_mov_b32 v39, 0
  v_mov_b32 v40, 0
  v_mov_b32 v41, 0
  v_mov_b32 v42, 0
  v_mov_b32 v43, 0
  v_mov_b32 v44, 0
  v_mov_b32 v45, 0
  v_mov_b32 v46, 0
  v_mov_b32 v47, 0
  v_mov_b32 v48, 0
  v_mov_b32 v49, 0
  v_mov_b32 v50, 0
  v_mov_b32 v51, 0
  v_mov_b32 v52, 0
  v_mov_b32 v53, 0
  v_mov_b32 v54, 0
  v_mov_b32 v55, 0
  v_mov_b32 v56, 0
  v_mov_b32 v57, 0
  v_mov_b32 v58, 0
  v_mov_b32 v59, 0
  v_mov_b32 v60, 0
  v_mov_b32 v61, 0
  v_mov_b32 v62, 0
  v_mov_b32 v63, 0
  v_mov_b32 v64, 0
  v_mov_b32 v65, 0
  v_mov_b32 v66, 0
  v_mov_b32 v67, 0
  v_mov_b32 v68, 0
  v_mov_b32 v69, 0
  v_mov_b32 v70, 0
  v_mov_b32 v71, 0
  v_mov_b32 v72, 0
  v_mov_b32 v73, 0
  v_mov_b32 v74, 0
  v_mov_b32 v75, 0
  v_mov_b32 v76, 0
  v_mov_b32 v77, 0
  v_mov_b32 v78, 0
  v_mov_b32 v79, 0
  v_mov_b32 v80, 0
  v_mov_b32 v81, 0
  v_mov_b32 v82, 0
  v_mov_b32 v83, 0
  v_mov_b32 v84, 0
  v_mov_b32 v85, 0
  v_mov_b32 v86, 0
  v_mov_b32 v87, 0
  v_mov_b32 v88, 0
  v_mov_b32 v89, 0
  v_mov_b32 v90, 0
  v_mov_b32 v91, 0
  v_mov_b32 v92, 0
  v_mov_b32 v93, 0
  v_mov_b32 v94, 0
  v_mov_b32 v95, 0
  v_mov_b32 v96, 0
  v_mov_b32 v97, 0
  v_mov_b32 v98, 0
  v_mov_b32 v99, 0
  v_mov_b32 v100, 0
  v_mov_b32 v101, 0
  v_mov_b32 v102, 0
  v_mov_b32 v103, 0
  v_mov_b32 v104, 0
  v_mov_b32 v105, 0
  v_mov_b32 v106, 0
  v_mov_b32 v107, 0
  v_mov_b32 v108, 0
  v_mov_b32 v109, 0
  v_mov_b32 v110, 0
  v_mov_b32 v111, 0
  v_mov_b32 v112, 0
  v_mov_b32 v113, 0
  v_mov_b32 v114, 0
  v_mov_b32 v115, 0
  s_waitcnt vmcnt(4)
  s_barrier
  ds_read_b64_tr_b16 v[116:117], v244 offset:0
  ds_read_b64_tr_b16 v[118:119], v244 offset:6144
  ds_read_b64_tr_b16 v[120:121], v245 offset:0
  ds_read_b64_tr_b16 v[122:123], v245 offset:6144
  ds_read_b64_tr_b16 v[124:125], v246 offset:0
  ds_read_b64_tr_b16 v[126:127], v246 offset:6144
  ds_read_b64_tr_b16 v[128:129], v247 offset:0
  ds_read_b64_tr_b16 v[130:131], v247 offset:6144
  ds_read_b64_tr_b16 v[132:133], v244 offset:128
  ds_read_b64_tr_b16 v[134:135], v244 offset:6272
  ds_read_b64_tr_b16 v[136:137], v245 offset:128
  ds_read_b64_tr_b16 v[138:139], v245 offset:6272
  ds_read_b64_tr_b16 v[140:141], v246 offset:128
  ds_read_b64_tr_b16 v[142:143], v246 offset:6272
  ds_read_b64_tr_b16 v[144:145], v247 offset:128
  ds_read_b64_tr_b16 v[146:147], v247 offset:6272
  ds_read_b64_tr_b16 v[148:149], v244 offset:256
  ds_read_b64_tr_b16 v[150:151], v244 offset:6400
  ds_read_b64_tr_b16 v[152:153], v245 offset:256
  ds_read_b64_tr_b16 v[154:155], v245 offset:6400
  ds_read_b64_tr_b16 v[156:157], v246 offset:256
  ds_read_b64_tr_b16 v[158:159], v246 offset:6400
  ds_read_b64_tr_b16 v[160:161], v247 offset:256
  ds_read_b64_tr_b16 v[162:163], v247 offset:6400
  s_add_u32 m0, s46, 49152
  s_nop 0
  buffer_load_dwordx4 v2, s[12:15], s44 offen lds
  s_add_u32 m0, s46, 50176
  s_nop 0
  buffer_load_dwordx4 v3, s[12:15], s44 offen lds
  s_add_u32 m0, s46, 51200
  s_nop 0
  buffer_load_dwordx4 v4, s[12:15], s44 offen lds
  s_add_u32 m0, s46, 52224
  s_nop 0
  buffer_load_dwordx4 v5, s[12:15], s44 offen lds
  s_add_u32 m0, s46, 53248
  s_nop 0
  buffer_load_dwordx4 v6, s[12:15], s44 offen lds
  s_mov_b32 s47, 3
k2_loop:
  s_waitcnt lgkmcnt(12)
  s_add_u32 m0, s46, 54272
  v_mfma_f32_16x16x32_bf16 v[20:23], v[116:119], v[180:183], v[20:23]
  ds_read_b64_tr_b16 v[164:165], v244 offset:12288
  ds_read_b64_tr_b16 v[166:167], v244 offset:18432
  buffer_load_dwordx4 v7, s[12:15], s44 offen lds
  s_add_u32 s44, s44, 73728
  v_mfma_f32_16x16x32_bf16 v[68:71], v[116:119], v[184:187], v[68:71]
  ds_read_b64_tr_b16 v[168:169], v245 offset:12288
  v_mfma_f32_16x16x32_bf16 v[24:27], v[120:123], v[180:183], v[24:27]
  ds_read_b64_tr_b16 v[170:171], v245 offset:18432
  v_mfma_f32_16x16x32_bf16 v[72:75], v[120:123], v[184:187], v[72:75]
  ds_read_b64_tr_b16 v[172:173], v246 offset:12288
  v_mfma_f32_16x16x32_bf16 v[28:31], v[124:127], v[180:183], v[28:31]
  ds_read_b64_tr_b16 v[174:175], v246 offset:18432
  buffer_load_dwordx4 v[212:215], v16, s[16:19], s45 offen offset:0 sc1
  v_mfma_f32_16x16x32_bf16 v[76:79], v[124:127], v[184:187], v[76:79]
  ds_read_b64_tr_b16 v[176:177], v247 offset:12288
  v_mfma_f32_16x16x32_bf16 v[32:35], v[128:131], v[180:183], v[32:35]
  ds_read_b64_tr_b16 v[178:179], v247 offset:18432
  v_mfma_f32_16x16x32_bf16 v[80:83], v[128:131], v[184:187], v[80:83]
  ds_read_b64_tr_b16 v[116:117], v244 offset:12416
  v_mfma_f32_16x16x32_bf16 v[36:39], v[132:135], v[180:183], v[36:39]
  ds_read_b64_tr_b16 v[118:119], v244 offset:18560
  buffer_load_dwordx4 v[216:219], v17, s[16:19], s45 offen offset:0 sc1
  v_mfma_f32_16x16x32_bf16 v[84:87], v[132:135], v[184:187], v[84:87]
  ds_read_b64_tr_b16 v[120:121], v245 offset:12416
  v_mfma_f32_16x16x32_bf16 v[40:43], v[136:139], v[180:183], v[40:43]
  ds_read_b64_tr_b16 v[122:123], v245 offset:18560
  v_mfma_f32_16x16x32_bf16 v[88:91], v[136:139], v[184:187], v[88:91]
  ds_read_b64_tr_b16 v[124:125], v246 offset:12416
  ds_read_b64_tr_b16 v[126:127], v246 offset:18560
  s_waitcnt lgkmcnt(14)
  v_mfma_f32_16x16x32_bf16 v[44:47], v[140:143], v[180:183], v[44:47]
  ds_read_b64_tr_b16 v[128:129], v247 offset:12416
  buffer_load_dwordx4 v[220:223], v16, s[16:19], s45 offen offset:2048 sc1
  v_mfma_f32_16x16x32_bf16 v[92:95], v[140:143], v[184:187], v[92:95]
  ds_read_b64_tr_b16 v[130:131], v247 offset:18560
  v_mfma_f32_16x16x32_bf16 v[48:51], v[144:147], v[180:183], v[48:51]
  ds_read_b64_tr_b16 v[132:133], v244 offset:12544
  v_mfma_f32_16x16x32_bf16 v[96:99], v[144:147], v[184:187], v[96:99]
  ds_read_b64_tr_b16 v[134:135], v244 offset:18688
  v_mfma_f32_16x16x32_bf16 v[52:55], v[148:151], v[180:183], v[52:55]
  ds_read_b64_tr_b16 v[136:137], v245 offset:12544
  buffer_load_dwordx4 v[224:227], v17, s[16:19], s45 offen offset:2048 sc1
  s_add_u32 s45, s45, 4096
  v_mfma_f32_16x16x32_bf16 v[100:103], v[148:151], v[184:187], v[100:103]
  ds_read_b64_tr_b16 v[138:139], v245 offset:18688
  v_mfma_f32_16x16x32_bf16 v[56:59], v[152:155], v[180:183], v[56:59]
  ds_read_b64_tr_b16 v[140:141], v246 offset:12544
  v_mfma_f32_16x16x32_bf16 v[104:107], v[152:155], v[184:187], v[104:107]
  ds_read_b64_tr_b16 v[142:143], v246 offset:18688
  v_mfma_f32_16x16x32_bf16 v[60:63], v[156:159], v[180:183], v[60:63]
  ds_read_b64_tr_b16 v[144:145], v247 offset:12544
  v_mfma_f32_16x16x32_bf16 v[108:111], v[156:159], v[184:187], v[108:111]
  ds_read_b64_tr_b16 v[146:147], v247 offset:18688
  v_mfma_f32_16x16x32_bf16 v[64:67], v[160:163], v[180:183], v[64:67]
  v_mfma_f32_16x16x32_bf16 v[112:115], v[160:163], v[184:187], v[112:115]
  s_waitcnt vmcnt(10)
  s_barrier
  s_waitcnt lgkmcnt(12)
  s_add_u32 m0, s46, 73728
  v_mfma_f32_16x16x32_bf16 v[20:23], v[164:167], v[188:191], v[20:23]
  ds_read_b64_tr_b16 v[148:149], v244 offset:24576
  ds_read_b64_tr_b16 v[150:151], v244 offset:30720
  buffer_load_dwordx4 v2, s[12:15], s44 offen lds
  v_mfma_f32_16x16x32_bf16 v[68:71], v[164:167], v[192:195], v[68:71]
  ds_read_b64_tr_b16 v[152:153], v245 offset:24576
  v_mfma_f32_16x16x32_bf16 v[24:27], v[168:171], v[188:191], v[24:27]
  ds_read_b64_tr_b16 v[154:155], v245 offset:30720
  v_mfma_f32_16x16x32_bf16 v[72:75], v[168:171], v[192:195], v[72:75]
  ds_read_b64_tr_b16 v[156:157], v246 offset:24576
  s_add_u32 m0, s46, 74752
  v_mfma_f32_16x16x32_bf16 v[28:31], v[172:175], v[188:191], v[28:31]
  ds_read_b64_tr_b16 v[158:159], v246 offset:30720
  buffer_load_dwordx4 v3, s[12:15], s44 offen lds
  v_mfma_f32_16x16x32_bf16 v[76:79], v[172:175], v[192:195], v[76:79]
  ds_read_b64_tr_b16 v[160:161], v247 offset:24576
  v_mfma_f32_16x16x32_bf16 v[32:35], v[176:179], v[188:191], v[32:35]
  ds_read_b64_tr_b16 v[162:163], v247 offset:30720
  v_mfma_f32_16x16x32_bf16 v[80:83], v[176:179], v[192:195], v[80:83]
  ds_read_b64_tr_b16 v[164:165], v244 offset:24704
  s_add_u32 m0, s46, 75776
  v_mfma_f32_16x16x32_bf16 v[36:39], v[116:119], v[188:191], v[36:39]
  ds_read_b64_tr_b16 v[166:167], v244 offset:30848
  buffer_load_dwordx4 v4, s[12:15], s44 offen lds
  v_mfma_f32_16x16x32_bf16 v[84:87], v[116:119], v[192:195], v[84:87]
  ds_read_b64_tr_b16 v[168:169], v245 offset:24704
  v_mfma_f32_16x16x32_bf16 v[40:43], v[120:123], v[188:191], v[40:43]
  ds_read_b64_tr_b16 v[170:171], v245 offset:30848
  v_mfma_f32_16x16x32_bf16 v[88:91], v[120:123], v[192:195], v[88:91]
  ds_read_b64_tr_b16 v[172:173], v246 offset:24704
  ds_read_b64_tr_b16 v[174:175], v246 offset:30848
  s_waitcnt lgkmcnt(14)
  s_add_u32 m0, s46, 76800
  v_mfma_f32_16x16x32_bf16 v[44:47], v[124:127], v[188:191], v[44:47]
  ds_read_b64_tr_b16 v[176:177], v247 offset:24704
  buffer_load_dwordx4 v5, s[12:15], s44 offen lds
  v_mfma_f32_16x16x32_bf16 v[92:95], v[124:127], v[192:195], v[92:95]
  ds_read_b64_tr_b16 v[178:179], v247 offset:30848
  v_mfma_f32_16x16x32_bf16 v[48:51], v[128:131], v[188:191], v[48:51]
  ds_read_b64_tr_b16 v[116:117], v244 offset:24832
  v_mfma_f32_16x16x32_bf16 v[96:99], v[128:131], v[192:195], v[96:99]
  ds_read_b64_tr_b16 v[118:119], v244 offset:30976
  s_add_u32 m0, s46, 77824
  v_mfma_f32_16x16x32_bf16 v[52:55], v[132:135], v[188:191], v[52:55]
  ds_read_b64_tr_b16 v[120:121], v245 offset:24832
  buffer_load_dwordx4 v6, s[12:15], s44 offen lds
  v_mfma_f32_16x16x32_bf16 v[100:103], v[132:135], v[192:195], v[100:103]
  ds_read_b64_tr_b16 v[122:123], v245 offset:30976
  v_mfma_f32_16x16x32_bf16 v[56:59], v[136:139], v[188:191], v[56:59]
  ds_read_b64_tr_b16 v[124:125], v246 offset:24832
  v_mfma_f32_16x16x32_bf16 v[104:107], v[136:139], v[192:195], v[104:107]
  ds_read_b64_tr_b16 v[126:127], v246 offset:30976
  v_mfma_f32_16x16x32_bf16 v[60:63], v[140:143], v[188:191], v[60:63]
  ds_read_b64_tr_b16 v[128:129], v247 offset:24832
  v_mfma_f32_16x16x32_bf16 v[108:111], v[140:143], v[192:195], v[108:111]
  ds_read_b64_tr_b16 v[130:131], v247 offset:30976
  v_mfma_f32_16x16x32_bf16 v[64:67], v[144:147], v[188:191], v[64:67]
  v_mfma_f32_16x16x32_bf16 v[112:115], v[144:147], v[192:195], v[112:115]
  s_waitcnt lgkmcnt(12)
  s_add_u32 m0, s46, 78848
  v_mfma_f32_16x16x32_bf16 v[20:23], v[148:151], v[196:199], v[20:23]
  ds_read_b64_tr_b16 v[132:133], v244 offset:36864
  ds_read_b64_tr_b16 v[134:135], v244 offset:43008
  buffer_load_dwordx4 v7, s[12:15], s44 offen lds
  s_add_u32 s44, s44, 73728
  v_mfma_f32_16x16x32_bf16 v[68:71], v[148:151], v[200:203], v[68:71]
  ds_read_b64_tr_b16 v[136:137], v245 offset:36864
  v_mfma_f32_16x16x32_bf16 v[24:27], v[152:155], v[196:199], v[24:27]
  ds_read_b64_tr_b16 v[138:139], v245 offset:43008
  v_mfma_f32_16x16x32_bf16 v[72:75], v[152:155], v[200:203], v[72:75]
  ds_read_b64_tr_b16 v[140:141], v246 offset:36864
  v_mfma_f32_16x16x32_bf16 v[28:31], v[156:159], v[196:199], v[28:31]
  ds_read_b64_tr_b16 v[142:143], v246 offset:43008
  buffer_load_dwordx4 v[228:231], v16, s[16:19], s45 offen offset:0 sc1
  v_mfma_f32_16x16x32_bf16 v[76:79], v[156:159], v[200:203], v[76:79]
  ds_read_b64_tr_b16 v[144:145], v247 offset:36864
  v_mfma_f32_16x16x32_bf16 v[32:35], v[160:163], v[196:199], v[32:35]
  ds_read_b64_tr_b16 v[146:147], v247 offset:43008
  v_mfma_f32_16x16x32_bf16 v[80:83], v[160:163], v[200:203], v[80:83]
  ds_read_b64_tr_b16 v[148:149], v244 offset:36992
  v_mfma_f32_16x16x32_bf16 v[36:39], v[164:167], v[196:199], v[36:39]
  ds_read_b64_tr_b16 v[150:151], v244 offset:43136
  buffer_load_dwordx4 v[232:235], v17, s[16:19], s45 offen offset:0 sc1
  v_mfma_f32_16x16x32_bf16 v[84:87], v[164:167], v[200:203], v[84:87]
  ds_read_b64_tr_b16 v[152:153], v245 offset:36992
  v_mfma_f32_16x16x32_bf16 v[40:43], v[168:171], v[196:199], v[40:43]
  ds_read_b64_tr_b16 v[154:155], v245 offset:43136
  v_mfma_f32_16x16x32_bf16 v[88:91], v[168:171], v[200:203], v[88:91]
  ds_read_b64_tr_b16 v[156:157], v246 offset:36992
  ds_read_b64_tr_b16 v[158:159], v246 offset:43136
  s_waitcnt lgkmcnt(14)
  v_mfma_f32_16x16x32_bf16 v[44:47], v[172:175], v[196:199], v[44:47]
  ds_read_b64_tr_b16 v[160:161], v247 offset:36992
  buffer_load_dwordx4 v[236:239], v16, s[16:19], s45 offen offset:2048 sc1
  v_mfma_f32_16x16x32_bf16 v[92:95], v[172:175], v[200:203], v[92:95]
  ds_read_b64_tr_b16 v[162:163], v247 offset:43136
  v_mfma_f32_16x16x32_bf16 v[48:51], v[176:179], v[196:199], v[48:51]
  ds_read_b64_tr_b16 v[164:165], v244 offset:37120
  v_mfma_f32_16x16x32_bf16 v[96:99], v[176:179], v[200:203], v[96:99]
  ds_read_b64_tr_b16 v[166:167], v244 offset:43264
  v_mfma_f32_16x16x32_bf16 v[52:55], v[116:119], v[196:199], v[52:55]
  ds_read_b64_tr_b16 v[168:169], v245 offset:37120
  buffer_load_dwordx4 v[240:243], v17, s[16:19], s45 offen offset:2048 sc1
  s_add_u32 s45, s45, 4096
  v_mfma_f32_16x16x32_bf16 v[100:103], v[116:119], v[200:203], v[100:103]
  ds_read_b64_tr_b16 v[170:171], v245 offset:43264
  v_mfma_f32_16x16x32_bf16 v[56:59], v[120:123], v[196:199], v[56:59]
  ds_read_b64_tr_b16 v[172:173], v246 offset:37120
  v_mfma_f32_16x16x32_bf16 v[104:107], v[120:123], v[200:203], v[104:107]
  ds_read_b64_tr_b16 v[174:175], v246 offset:43264
  v_mfma_f32_16x16x32_bf16 v[60:63], v[124:127], v[196:199], v[60:63]
  ds_read_b64_tr_b16 v[176:177], v247 offset:37120
  v_mfma_f32_16x16x32_bf16 v[108:111], v[124:127], v[200:203], v[108:111]
  ds_read_b64_tr_b16 v[178:179], v247 offset:43264
  v_mfma_f32_16x16x32_bf16 v[64:67], v[128:131], v[196:199], v[64:67]
  v_mfma_f32_16x16x32_bf16 v[112:115], v[128:131], v[200:203], v[112:115]
  s_waitcnt vmcnt(10)
  s_barrier
  s_waitcnt lgkmcnt(12)
  s_add_u32 m0, s46, 0
  v_mfma_f32_16x16x32_bf16 v[20:23], v[132:135], v[204:207], v[20:23]
  ds_read_b64_tr_b16 v[116:117], v248 offset:0
  ds_read_b64_tr_b16 v[118:119], v248 offset:6144
  buffer_load_dwordx4 v2, s[12:15], s44 offen lds
  v_mfma_f32_16x16x32_bf16 v[68:71], v[132:135], v[208:211], v[68:71]
  ds_read_b64_tr_b16 v[120:121], v249 offset:0
  v_mfma_f32_16x16x32_bf16 v[24:27], v[136:139], v[204:207], v[24:27]
  ds_read_b64_tr_b16 v[122:123], v249 offset:6144
  v_mfma_f32_16x16x32_bf16 v[72:75], v[136:139], v[208:211], v[72:75]
  ds_read_b64_tr_b16 v[124:125], v250 offset:0
  s_add_u32 m0, s46, 1024
  v_mfma_f32_16x16x32_bf16 v[28:31], v[140:143], v[204:207], v[28:31]
  ds_read_b64_tr_b16 v[126:127], v250 offset:6144
  buffer_load_dwordx4 v3, s[12:15], s44 offen lds
  v_mfma_f32_16x16x32_bf16 v[76:79], v[140:143], v[208:211], v[76:79]
  ds_read_b64_tr_b16 v[128:129], v251 offset:0
  v_mfma_f32_16x16x32_bf16 v[32:35], v[144:147], v[204:207], v[32:35]
  ds_read_b64_tr_b16 v[130:131], v251 offset:6144
  v_mfma_f32_16x16x32_bf16 v[80:83], v[144:147], v[208:211], v[80:83]
  ds_read_b64_tr_b16 v[132:133], v248 offset:128
  s_add_u32 m0, s46, 2048
  v_mfma_f32_16x16x32_bf16 v[36:39], v[148:151], v[204:207], v[36:39]
  ds_read_b64_tr_b16 v[134:135], v248 offset:6272
  buffer_load_dwordx4 v4, s[12:15], s44 offen lds
  v_mfma_f32_16x16x32_bf16 v[84:87], v[148:151], v[208:211], v[84:87]
  ds_read_b64_tr_b16 v[136:137], v249 offset:128
  v_mfma_f32_16x16x32_bf16 v[40:43], v[152:155], v[204:207], v[40:43]
  ds_read_b64_tr_b16 v[138:139], v249 offset:6272
  v_mfma_f32_16x16x32_bf16 v[88:91], v[152:155], v[208:211], v[88:91]
  ds_read_b64_tr_b16 v[140:141], v250 offset:128
  ds_read_b64_tr_b16 v[142:143], v250 offset:6272
  s_waitcnt lgkmcnt(14)
  s_add_u32 m0, s46, 3072
  v_mfma_f32_16x16x32_bf16 v[44:47], v[156:159], v[204:207], v[44:47]
  ds_read_b64_tr_b16 v[144:145], v251 offset:128
  buffer_load_dwordx4 v5, s[12:15], s44 offen lds
  v_mfma_f32_16x16x32_bf16 v[92:95], v[156:159], v[208:211], v[92:95]
  ds_read_b64_tr_b16 v[146:147], v251 offset:6272
  v_mfma_f32_16x16x32_bf16 v[48:51], v[160:163], v[204:207], v[48:51]
  ds_read_b64_tr_b16 v[148:149], v248 offset:256
  v_mfma_f32_16x16x32_bf16 v[96:99], v[160:163], v[208:211], v[96:99]
  ds_read_b64_tr_b16 v[150:151], v248 offset:6400
  s_add_u32 m0, s46, 4096
  v_mfma_f32_16x16x32_bf16 v[52:55], v[164:167], v[204:207], v[52:55]
  ds_read_b64_tr_b16 v[152:153], v249 offset:256
  buffer_load_dwordx4 v6, s[12:15], s44 offen lds
  v_mfma_f32_16x16x32_bf16 v[100:103], v[164:167], v[208:211], v[100:103]
  ds_read_b64_tr_b16 v[154:155], v249 offset:6400
  v_mfma_f32_16x16x32_bf16 v[56:59], v[168:171], v[204:207], v[56:59]
  ds_read_b64_tr_b16 v[156:157], v250 offset:256
  v_mfma_f32_16x16x32_bf16 v[104:107], v[168:171], v[208:211], v[104:107]
  ds_read_b64_tr_b16 v[158:159], v250 offset:6400
  v_mfma_f32_16x16x32_bf16 v[60:63], v[172:175], v[204:207], v[60:63]
  ds_read_b64_tr_b16 v[160:161], v251 offset:256
  v_mfma_f32_16x16x32_bf16 v[108:111], v[172:175], v[208:211], v[108:111]
  ds_read_b64_tr_b16 v[162:163], v251 offset:6400
  v_mfma_f32_16x16x32_bf16 v[64:67], v[176:179], v[204:207], v[64:67]
  v_mfma_f32_16x16x32_bf16 v[112:115], v[176:179], v[208:211], v[112:115]
  s_waitcnt lgkmcnt(12)
  s_add_u32 m0, s46, 5120
  v_mfma_f32_16x16x32_bf16 v[20:23], v[116:119], v[212:215], v[20:23]
  ds_read_b64_tr_b16 v[164:165], v248 offset:12288
  ds_read_b64_tr_b16 v[166:167], v248 offset:18432
  buffer_load_dwordx4 v7, s[12:15], s44 offen lds
  s_add_u32 s44, s44, 73728
  v_mfma_f32_16x16x32_bf16 v[68:71], v[116:119], v[216:219], v[68:71]
  ds_read_b64_tr_b16 v[168:169], v249 offset:12288
  v_mfma_f32_16x16x32_bf16 v[24:27], v[120:123], v[212:215], v[24:27]
  ds_read_b64_tr_b16 v[170:171], v249 offset:18432
  v_mfma_f32_16x16x32_bf16 v[72:75], v[120:123], v[216:219], v[72:75]
  ds_read_b64_tr_b16 v[172:173], v250 offset:12288
  v_mfma_f32_16x16x32_bf16 v[28:31], v[124:127], v[212:215], v[28:31]
  ds_read_b64_tr_b16 v[174:175], v250 offset:18432
  buffer_load_dwordx4 v[180:183], v16, s[16:19], s45 offen offset:0 sc1
  v_mfma_f32_16x16x32_bf16 v[76:79], v[124:127], v[216:219], v[76:79]
  ds_read_b64_tr_b16 v[176:177], v251 offset:12288
  v_mfma_f32_16x16x32_bf16 v[32:35], v[128:131], v[212:215], v[32:35]
  ds_read_b64_tr_b16 v[178:179], v251 offset:18432
  v_mfma_f32_16x16x32_bf16 v[80:83], v[128:131], v[216:219], v[80:83]
  ds_read_b64_tr_b16 v[116:117], v248 offset:12416
  v_mfma_f32_16x16x32_bf16 v[36:39], v[132:135], v[212:215], v[36:39]
  ds_read_b64_tr_b16 v[118:119], v248 offset:18560
  buffer_load_dwordx4 v[184:187], v17, s[16:19], s45 offen offset:0 sc1
  v_mfma_f32_16x16x32_bf16 v[84:87], v[132:135], v[216:219], v[84:87]
  ds_read_b64_tr_b16 v[120:121], v249 offset:12416
  v_mfma_f32_16x16x32_bf16 v[40:43], v[136:139], v[212:215], v[40:43]
  ds_read_b64_tr_b16 v[122:123], v249 offset:18560
  v_mfma_f32_16x16x32_bf16 v[88:91], v[136:139], v[216:219], v[88:91]
  ds_read_b64_tr_b16 v[124:125], v250 offset:12416
  ds_read_b64_tr_b16 v[126:127], v250 offset:18560
  s_waitcnt lgkmcnt(14)
  v_mfma_f32_16x16x32_bf16 v[44:47], v[140:143], v[212:215], v[44:47]
  ds_read_b64_tr_b16 v[128:129], v251 offset:12416
  buffer_load_dwordx4 v[188:191], v16, s[16:19], s45 offen offset:2048 sc1
  v_mfma_f32_16x16x32_bf16 v[92:95], v[140:143], v[216:219], v[92:95]
  ds_read_b64_tr_b16 v[130:131], v251 offset:18560
  v_mfma_f32_16x16x32_bf16 v[48:51], v[144:147], v[212:215], v[48:51]
  ds_read_b64_tr_b16 v[132:133], v248 offset:12544
  v_mfma_f32_16x16x32_bf16 v[96:99], v[144:147], v[216:219], v[96:99]
  ds_read_b64_tr_b16 v[134:135], v248 offset:18688
  v_mfma_f32_16x16x32_bf16 v[52:55], v[148:151], v[212:215], v[52:55]
  ds_read_b64_tr_b16 v[136:137], v249 offset:12544
  buffer_load_dwordx4 v[192:195], v17, s[16:19], s45 offen offset:2048 sc1
  s_add_u32 s45, s45, 4096
  v_mfma_f32_16x16x32_bf16 v[100:103], v[148:151], v[216:219], v[100:103]
  ds_read_b64_tr_b16 v[138:139], v249 offset:18688
  v_mfma_f32_16x16x32_bf16 v[56:59], v[152:155], v[212:215], v[56:59]
  ds_read_b64_tr_b16 v[140:141], v250 offset:12544
  v_mfma_f32_16x16x32_bf16 v[104:107], v[152:155], v[216:219], v[104:107]
  ds_read_b64_tr_b16 v[142:143], v250 offset:18688
  v_mfma_f32_16x16x32_bf16 v[60:63], v[156:159], v[212:215], v[60:63]
  ds_read_b64_tr_b16 v[144:145], v251 offset:12544
  v_mfma_f32_16x16x32_bf16 v[108:111], v[156:159], v[216:219], v[108:111]
  ds_read_b64_tr_b16 v[146:147], v251 offset:18688
  v_mfma_f32_16x16x32_bf16 v[64:67], v[160:163], v[212:215], v[64:67]
  v_mfma_f32_16x16x32_bf16 v[112:115], v[160:163], v[216:219], v[112:115]
  s_waitcnt vmcnt(10)
  s_barrier
  s_waitcnt lgkmcnt(12)
  s_add_u32 m0, s46, 24576
  v_mfma_f32_16x16x32_bf16 v[20:23], v[164:167], v[220:223], v[20:23]
  ds_read_b64_tr_b16 v[148:149], v248 offset:24576
  ds_read_b64_tr_b16 v[150:151], v248 offset:30720
  buffer_load_dwordx4 v2, s[12:15], s44 offen lds
  v_mfma_f32_16x16x32_bf16 v[68:71], v[164:167], v[224:227], v[68:71]
  ds_read_b64_tr_b16 v[152:153], v249 offset:24576
  v_mfma_f32_16x16x32_bf16 v[24:27], v[168:171], v[220:223], v[24:27]
  ds_read_b64_tr_b16 v[154:155], v249 offset:30720
  v_mfma_f32_16x16x32_bf16 v[72:75], v[168:171], v[224:227], v[72:75]
  ds_read_b64_tr_b16 v[156:157], v250 offset:24576
  s_add_u32 m0, s46, 25600
  v_mfma_f32_16x16x32_bf16 v[28:31], v[172:175], v[220:223], v[28:31]
  ds_read_b64_tr_b16 v[158:159], v250 offset:30720
  buffer_load_dwordx4 v3, s[12:15], s44 offen lds
  v_mfma_f32_16x16x32_bf16 v[76:79], v[172:175], v[224:227], v[76:79]
  ds_read_b64_tr_b16 v[160:161], v251 offset:24576
  v_mfma_f32_16x16x32_bf16 v[32:35], v[176:179], v[220:223], v[32:35]
  ds_read_b64_tr_b16 v[162:163], v251 offset:30720
  v_mfma_f32_16x16x32_bf16 v[80:83], v[176:179], v[224:227], v[80:83]
  ds_read_b64_tr_b16 v[164:165], v248 offset:24704
  s_add_u32 m0, s46, 26624
  v_mfma_f32_16x16x32_bf16 v[36:39], v[116:119], v[220:223], v[36:39]
  ds_read_b64_tr_b16 v[166:167], v248 offset:30848
  buffer_load_dwordx4 v4, s[12:15], s44 offen lds
  v_mfma_f32_16x16x32_bf16 v[84:87], v[116:119], v[224:227], v[84:87]
  ds_read_b64_tr_b16 v[168:169], v249 offset:24704
  v_mfma_f32_16x16x32_bf16 v[40:43], v[120:123], v[220:223], v[40:43]
  ds_read_b64_tr_b16 v[170:171], v249 offset:30848
  v_mfma_f32_16x16x32_bf16 v[88:91], v[120:123], v[224:227], v[88:91]
  ds_read_b64_tr_b16 v[172:173], v250 offset:24704
  ds_read_b64_tr_b16 v[174:175], v250 offset:30848
  s_waitcnt lgkmcnt(14)
  s_add_u32 m0, s46, 27648
  v_mfma_f32_16x16x32_bf16 v[44:47], v[124:127], v[220:223], v[44:47]
  ds_read_b64_tr_b16 v[176:177], v251 offset:24704
  buffer_load_dwordx4 v5, s[12:15], s44 offen lds
  v_mfma_f32_16x16x32_bf16 v[92:95], v[124:127], v[224:227], v[92:95]
  ds_read_b64_tr_b16 v[178:179], v251 offset:30848
  v_mfma_f32_16x16x32_bf16 v[48:51], v[128:131], v[220:223], v[48:51]
  ds_read_b64_tr_b16 v[116:117], v248 offset:24832
  v_mfma_f32_16x16x32_bf16 v[96:99], v[128:131], v[224:227], v[96:99]
  ds_read_b64_tr_b16 v[118:119], v248 offset:30976
  s_add_u32 m0, s46, 28672
  v_mfma_f32_16x16x32_bf16 v[52:55], v[132:135], v[220:223], v[52:55]
  ds_read_b64_tr_b16 v[120:121], v249 offset:24832
  buffer_load_dwordx4 v6, s[12:15], s44 offen lds
  v_mfma_f32_16x16x32_bf16 v[100:103], v[132:135], v[224:227], v[100:103]
  ds_read_b64_tr_b16 v[122:123], v249 offset:30976
  v_mfma_f32_16x16x32_bf16 v[56:59], v[136:139], v[220:223], v[56:59]
  ds_read_b64_tr_b16 v[124:125], v250 offset:24832
  v_mfma_f32_16x16x32_bf16 v[104:107], v[136:139], v[224:227], v[104:107]
  ds_read_b64_tr_b16 v[126:127], v250 offset:30976
  v_mfma_f32_16x16x32_bf16 v[60:63], v[140:143], v[220:223], v[60:63]
  ds_read_b64_tr_b16 v[128:129], v251 offset:24832
  v_mfma_f32_16x16x32_bf16 v[108:111], v[140:143], v[224:227], v[108:111]
  ds_read_b64_tr_b16 v[130:131], v251 offset:30976
  v_mfma_f32_16x16x32_bf16 v[64:67], v[144:147], v[220:223], v[64:67]
  v_mfma_f32_16x16x32_bf16 v[112:115], v[144:147], v[224:227], v[112:115]
  s_waitcnt lgkmcnt(12)
  s_add_u32 m0, s46, 29696
  v_mfma_f32_16x16x32_bf16 v[20:23], v[148:151], v[228:231], v[20:23]
  ds_read_b64_tr_b16 v[132:133], v248 offset:36864
  ds_read_b64_tr_b16 v[134:135], v248 offset:43008
  buffer_load_dwordx4 v7, s[12:15], s44 offen lds
  s_add_u32 s44, s44, 73728
  v_mfma_f32_16x16x32_bf16 v[68:71], v[148:151], v[232:235], v[68:71]
  ds_read_b64_tr_b16 v[136:137], v249 offset:36864
  v_mfma_f32_16x16x32_bf16 v[24:27], v[152:155], v[228:231], v[24:27]
  ds_read_b64_tr_b16 v[138:139], v249 offset:43008
  v_mfma_f32_16x16x32_bf16 v[72:75], v[152:155], v[232:235], v[72:75]
  ds_read_b64_tr_b16 v[140:141], v250 offset:36864
  v_mfma_f32_16x16x32_bf16 v[28:31], v[156:159], v[228:231], v[28:31]
  ds_read_b64_tr_b16 v[142:143], v250 offset:43008
  buffer_load_dwordx4 v[196:199], v16, s[16:19], s45 offen offset:0 sc1
  v_mfma_f32_16x16x32_bf16 v[76:79], v[156:159], v[232:235], v[76:79]
  ds_read_b64_tr_b16 v[144:145], v251 offset:36864
  v_mfma_f32_16x16x32_bf16 v[32:35], v[160:163], v[228:231], v[32:35]
  ds_read_b64_tr_b16 v[146:147], v251 offset:43008
  v_mfma_f32_16x16x32_bf16 v[80:83], v[160:163], v[232:235], v[80:83]
  ds_read_b64_tr_b16 v[148:149], v248 offset:36992
  v_mfma_f32_16x16x32_bf16 v[36:39], v[164:167], v[228:231], v[36:39]
  ds_read_b64_tr_b16 v[150:151], v248 offset:43136
  buffer_load_dwordx4 v[200:203], v17, s[16:19], s45 offen offset:0 sc1
  v_mfma_f32_16x16x32_bf16 v[84:87], v[164:167], v[232:235], v[84:87]
  ds_read_b64_tr_b16 v[152:153], v249 offset:36992
  v_mfma_f32_16x16x32_bf16 v[40:43], v[168:171], v[228:231], v[40:43]
  ds_read_b64_tr_b16 v[154:155], v249 offset:43136
  v_mfma_f32_16x16x32_bf16 v[88:91], v[168:171], v[232:235], v[88:91]
  ds_read_b64_tr_b16 v[156:157], v250 offset:36992
  ds_read_b64_tr_b16 v[158:159], v250 offset:43136
  s_waitcnt lgkmcnt(14)
  v_mfma_f32_16x16x32_bf16 v[44:47], v[172:175], v[228:231], v[44:47]
  ds_read_b64_tr_b16 v[160:161], v251 offset:36992
  buffer_load_dwordx4 v[204:207], v16, s[16:19], s45 offen offset:2048 sc1
  v_mfma_f32_16x16x32_bf16 v[92:95], v[172:175], v[232:235], v[92:95]
  ds_read_b64_tr_b16 v[162:163], v251 offset:43136
  v_mfma_f32_16x16x32_bf16 v[48:51], v[176:179], v[228:231], v[48:51]
  ds_read_b64_tr_b16 v[164:165], v248 offset:37120
  v_mfma_f32_16x16x32_bf16 v[96:99], v[176:179], v[232:235], v[96:99]
  ds_read_b64_tr_b16 v[166:167], v248 offset:43264
  v_mfma_f32_16x16x32_bf16 v[52:55], v[116:119], v[228:231], v[52:55]
  ds_read_b64_tr_b16 v[168:169], v249 offset:37120
  buffer_load_dwordx4 v[208:211], v17, s[16:19], s45 offen offset:2048 sc1
  s_add_u32 s45, s45, 4096
  v_mfma_f32_16x16x32_bf16 v[100:103], v[116:119], v[232:235], v[100:103]
  ds_read_b64_tr_b16 v[170:171], v249 offset:43264
  v_mfma_f32_16x16x32_bf16 v[56:59], v[120:123], v[228:231], v[56:59]
  ds_read_b64_tr_b16 v[172:173], v250 offset:37120
  v_mfma_f32_16x16x32_bf16 v[104:107], v[120:123], v[232:235], v[104:107]
  ds_read_b64_tr_b16 v[174:175], v250 offset:43264
  v_mfma_f32_16x16x32_bf16 v[60:63], v[124:127], v[228:231], v[60:63]
  ds_read_b64_tr_b16 v[176:177], v251 offset:37120
  v_mfma_f32_16x16x32_bf16 v[108:111], v[124:127], v[232:235], v[108:111]
  ds_read_b64_tr_b16 v[178:179], v251 offset:43264
  v_mfma_f32_16x16x32_bf16 v[64:67], v[128:131], v[228:231], v[64:67]
  v_mfma_f32_16x16x32_bf16 v[112:115], v[128:131], v[232:235], v[112:115]
  s_waitcnt vmcnt(10)
  s_barrier
  s_waitcnt lgkmcnt(12)
  s_add_u32 m0, s46, 49152
  v_mfma_f32_16x16x32_bf16 v[20:23], v[132:135], v[236:239], v[20:23]
  ds_read_b64_tr_b16 v[116:117], v244 offset:0
  ds_read_b64_tr_b16 v[118:119], v244 offset:6144
  buffer_load_dwordx4 v2, s[12:15], s44 offen lds
  v_mfma_f32_16x16x32_bf16 v[68:71], v[132:135], v[240:243], v[68:71]
  ds_read_b64_tr_b16 v[120:121], v245 offset:0
  v_mfma_f32_16x16x32_bf16 v[24:27], v[136:139], v[236:239], v[24:27]
  ds_read_b64_tr_b16 v[122:123], v245 offset:6144
  v_mfma_f32_16x16x32_bf16 v[72:75], v[136:139], v[240:243], v[72:75]
  ds_read_b64_tr_b16 v[124:125], v246 offset:0
  s_add_u32 m0, s46, 50176
  v_mfma_f32_16x16x32_bf16 v[28:31], v[140:143], v[236:239], v[28:31]
  ds_read_b64_tr_b16 v[126:127], v246 offset:6144
  buffer_load_dwordx4 v3, s[12:15], s44 offen lds
  v_mfma_f32_16x16x32_bf16 v[76:79], v[140:143], v[240:243], v[76:79]
  ds_read_b64_tr_b16 v[128:129], v247 offset:0
  v_mfma_f32_16x16x32_bf16 v[32:35], v[144:147], v[236:239], v[32:35]
  ds_read_b64_tr_b16 v[130:131], v247 offset:6144
  v_mfma_f32_16x16x32_bf16 v[80:83], v[144:147], v[240:243], v[80:83]
  ds_read_b64_tr_b16 v[132:133], v244 offset:128
  s_add_u32 m0, s46, 51200
  v_mfma_f32_16x16x32_bf16 v[36:39], v[148:151], v[236:239], v[36:39]
  ds_read_b64_tr_b16 v[134:135], v244 offset:6272
  buffer_load_dwordx4 v4, s[12:15], s44 offen lds
  v_mfma_f32_16x16x32_bf16 v[84:87], v[148:151], v[240:243], v[84:87]
  ds_read_b64_tr_b16 v[136:137], v245 offset:128
  v_mfma_f32_16x16x32_bf16 v[40:43], v[152:155], v[236:239], v[40:43]
  ds_read_b64_tr_b16 v[138:139], v245 offset:6272
  v_mfma_f32_16x16x32_bf16 v[88:91], v[152:155], v[240:243], v[88:91]
  ds_read_b64_tr_b16 v[140:141], v246 offset:128
  ds_read_b64_tr_b16 v[142:143], v246 offset:6272
  s_waitcnt lgkmcnt(14)
  s_add_u32 m0, s46, 52224
  v_mfma_f32_16x16x32_bf16 v[44:47], v[156:159], v[236:239], v[44:47]
  ds_read_b64_tr_b16 v[144:145], v247 offset:128
  buffer_load_dwordx4 v5, s[12:15], s44 offen lds
  v_mfma_f32_16x16x32_bf16 v[92:95], v[156:159], v[240:243], v[92:95]
  ds_read_b64_tr_b16 v[146:147], v247 offset:6272
  v_mfma_f32_16x16x32_bf16 v[48:51], v[160:163], v[236:239], v[48:51]
  ds_read_b64_tr_b16 v[148:149], v244 offset:256
  v_mfma_f32_16x16x32_bf16 v[96:99], v[160:163], v[240:243], v[96:99]
  ds_read_b64_tr_b16 v[150:151], v244 offset:6400
  s_add_u32 m0, s46, 53248
  v_mfma_f32_16x16x32_bf16 v[52:55], v[164:167], v[236:239], v[52:55]
  ds_read_b64_tr_b16 v[152:153], v245 offset:256
  buffer_load_dwordx4 v6, s[12:15], s44 offen lds
  v_mfma_f32_16x16x32_bf16 v[100:103], v[164:167], v[240:243], v[100:103]
  ds_read_b64_tr_b16 v[154:155], v245 offset:6400
  v_mfma_f32_16x16x32_bf16 v[56:59], v[168:171], v[236:239], v[56:59]
  ds_read_b64_tr_b16 v[156:157], v246 offset:256
  v_mfma_f32_16x16x32_bf16 v[104:107], v[168:171], v[240:243], v[104:107]
  ds_read_b64_tr_b16 v[158:159], v246 offset:6400
  v_mfma_f32_16x16x32_bf16 v[60:63], v[172:175], v[236:239], v[60:63]
  ds_read_b64_tr_b16 v[160:161], v247 offset:256
  v_mfma_f32_16x16x32_bf16 v[108:111], v[172:175], v[240:243], v[108:111]
  ds_read_b64_tr_b16 v[162:163], v247 offset:6400
  v_mfma_f32_16x16x32_bf16 v[64:67], v[176:179], v[236:239], v[64:67]
  v_mfma_f32_16x16x32_bf16 v[112:115], v[176:179], v[240:243], v[112:115]
  s_sub_u32 s47, s47, 1
  s_cmp_lg_u32 s47, 0
  s_cbranch_scc1 k2_loop
  s_waitcnt lgkmcnt(12)
  s_add_u32 m0, s46, 54272
  v_mfma_f32_16x16x32_bf16 v[20:23], v[116:119], v[180:183], v[20:23]
  ds_read_b64_tr_b16 v[164:165], v244 offset:12288
  ds_read_b64_tr_b16 v[166:167], v244 offset:18432
  buffer_load_dwordx4 v7, s[12:15], s44 offen lds
  s_add_u32 s44, s44, 73728
  v_mfma_f32_16x16x32_bf16 v[68:71], v[116:119], v[184:187], v[68:71]
  ds_read_b64_tr_b16 v[168:169], v245 offset:12288
  v_mfma_f32_16x16x32_bf16 v[24:27], v[120:123], v[180:183], v[24:27]
  ds_read_b64_tr_b16 v[170:171], v245 offset:18432
  v_mfma_f32_16x16x32_bf16 v[72:75], v[120:123], v[184:187], v[72:75]
  ds_read_b64_tr_b16 v[172:173], v246 offset:12288
  v_mfma_f32_16x16x32_bf16 v[28:31], v[124:127], v[180:183], v[28:31]
  ds_read_b64_tr_b16 v[174:175], v246 offset:18432
  buffer_load_dwordx4 v[212:215], v16, s[16:19], s45 offen offset:0 sc1
  v_mfma_f32_16x16x32_bf16 v[76:79], v[124:127], v[184:187], v[76:79]
  ds_read_b64_tr_b16 v[176:177], v247 offset:12288
  v_mfma_f32_16x16x32_bf16 v[32:35], v[128:131], v[180:183], v[32:35]
  ds_read_b64_tr_b16 v[178:179], v247 offset:18432
  v_mfma_f32_16x16x32_bf16 v[80:83], v[128:131], v[184:187], v[80:83]
  ds_read_b64_tr_b16 v[116:117], v244 offset:12416
  v_mfma_f32_16x16x32_bf16 v[36:39], v[132:135], v[180:183], v[36:39]
  ds_read_b64_tr_b16 v[118:119], v244 offset:18560
  buffer_load_dwordx4 v[216:219], v17, s[16:19], s45 offen offset:0 sc1
  v_mfma_f32_16x16x32_bf16 v[84:87], v[132:135], v[184:187], v[84:87]
  ds_read_b64_tr_b16 v[120:121], v245 offset:12416
  v_mfma_f32_16x16x32_bf16 v[40:43], v[136:139], v[180:183], v[40:43]
  ds_read_b64_tr_b16 v[122:123], v245 offset:18560
  v_mfma_f32_16x16x32_bf16 v[88:91], v[136:139], v[184:187], v[88:91]
  ds_read_b64_tr_b16 v[124:125], v246 offset:12416
  ds_read_b64_tr_b16 v[126:127], v246 offset:18560
  s_waitcnt lgkmcnt(14)
  v_mfma_f32_16x16x32_bf16 v[44:47], v[140:143], v[180:183], v[44:47]
  ds_read_b64_tr_b16 v[128:129], v247 offset:12416
  buffer_load_dwordx4 v[220:223], v16, s[16:19], s45 offen offset:2048 sc1
  v_mfma_f32_16x16x32_bf16 v[92:95], v[140:143], v[184:187], v[92:95]
  ds_read_b64_tr_b16 v[130:131], v247 offset:18560
  v_mfma_f32_16x16x32_bf16 v[48:51], v[144:147], v[180:183], v[48:51]
  ds_read_b64_tr_b16 v[132:133], v244 offset:12544
  v_mfma_f32_16x16x32_bf16 v[96:99], v[144:147], v[184:187], v[96:99]
  ds_read_b64_tr_b16 v[134:135], v244 offset:18688
  v_mfma_f32_16x16x32_bf16 v[52:55], v[148:151], v[180:183], v[52:55]
  ds_read_b64_tr_b16 v[136:137], v245 offset:12544
  buffer_load_dwordx4 v[224:227], v17, s[16:19], s45 offen offset:2048 sc1
  s_add_u32 s45, s45, 4096
  v_mfma_f32_16x16x32_bf16 v[100:103], v[148:151], v[184:187], v[100:103]
  ds_read_b64_tr_b16 v[138:139], v245 offset:18688
  v_mfma_f32_16x16x32_bf16 v[56:59], v[152:155], v[180:183], v[56:59]
  ds_read_b64_tr_b16 v[140:141], v246 offset:12544
  v_mfma_f32_16x16x32_bf16 v[104:107], v[152:155], v[184:187], v[104:107]
  ds_read_b64_tr_b16 v[142:143], v246 offset:18688
  v_mfma_f32_16x16x32_bf16 v[60:63], v[156:159], v[180:183], v[60:63]
  ds_read_b64_tr_b16 v[144:145], v247 offset:12544
  s_getpc_b64 s[96:97]
pc_5252_v252:
  v_lshlrev_b32 v14, 7, v0
  s_lshl_b32 s98, s3, 13
  v_add_u32 v14, s98, v14
  v_add_u32 v14, k3_kernel-pc_5252_v252, v14
  v_min_u32 v14, k5_end-pc_5252_v252, v14
  v_mov_b32 v15, 0
  v_lshl_add_u64 v[14:15], v[14:15], 0, s[96:97]
  global_load_dword v252, v[14:15], off
  v_mfma_f32_16x16x32_bf16 v[108:111], v[156:159], v[184:187], v[108:111]
  ds_read_b64_tr_b16 v[146:147], v247 offset:18688
  v_mfma_f32_16x16x32_bf16 v[64:67], v[160:163], v[180:183], v[64:67]
  v_mfma_f32_16x16x32_bf16 v[112:115], v[160:163], v[184:187], v[112:115]
  s_waitcnt vmcnt(11)
  s_barrier
  s_waitcnt lgkmcnt(12)
  s_add_u32 m0, s46, 73728
  v_mfma_f32_16x16x32_bf16 v[20:23], v[164:167], v[188:191], v[20:23]
  ds_read_b64_tr_b16 v[148:149], v244 offset:24576
  ds_read_b64_tr_b16 v[150:151], v244 offset:30720
  buffer_load_dwordx4 v2, s[12:15], s44 offen lds
  v_mfma_f32_16x16x32_bf16 v[68:71], v[164:167], v[192:195], v[68:71]
  ds_read_b64_tr_b16 v[152:153], v245 offset:24576
  v_mfma_f32_16x16x32_bf16 v[24:27], v[168:171], v[188:191], v[24:27]
  ds_read_b64_tr_b16 v[154:155], v245 offset:30720
  v_mfma_f32_16x16x32_bf16 v[72:75], v[168:171], v[192:195], v[72:75]
  ds_read_b64_tr_b16 v[156:157], v246 offset:24576
  s_add_u32 m0, s46, 74752
  v_mfma_f32_16x16x32_bf16 v[28:31], v[172:175], v[188:191], v[28:31]
  ds_read_b64_tr_b16 v[158:159], v246 offset:30720
  buffer_load_dwordx4 v3, s[12:15], s44 offen lds
  v_mfma_f32_16x16x32_bf16 v[76:79], v[172:175], v[192:195], v[76:79]
  ds_read_b64_tr_b16 v[160:161], v247 offset:24576
  v_mfma_f32_16x16x32_bf16 v[32:35], v[176:179], v[188:191], v[32:35]
  ds_read_b64_tr_b16 v[162:163], v247 offset:30720
  v_mfma_f32_16x16x32_bf16 v[80:83], v[176:179], v[192:195], v[80:83]
  ds_read_b64_tr_b16 v[164:165], v244 offset:24704
  s_add_u32 m0, s46, 75776
  v_mfma_f32_16x16x32_bf16 v[36:39], v[116:119], v[188:191], v[36:39]
  ds_read_b64_tr_b16 v[166:167], v244 offset:30848
  buffer_load_dwordx4 v4, s[12:15], s44 offen lds
  v_mfma_f32_16x16x32_bf16 v[84:87], v[116:119], v[192:195], v[84:87]
  ds_read_b64_tr_b16 v[168:169], v245 offset:24704
  v_mfma_f32_16x16x32_bf16 v[40:43], v[120:123], v[188:191], v[40:43]
  ds_read_b64_tr_b16 v[170:171], v245 offset:30848
  v_mfma_f32_16x16x32_bf16 v[88:91], v[120:123], v[192:195], v[88:91]
  ds_read_b64_tr_b16 v[172:173], v246 offset:24704
  ds_read_b64_tr_b16 v[174:175], v246 offset:30848
  s_waitcnt lgkmcnt(14)
  s_add_u32 m0, s46, 76800
  v_mfma_f32_16x16x32_bf16 v[44:47], v[124:127], v[188:191], v[44:47]
  ds_read_b64_tr_b16 v[176:177], v247 offset:24704
  buffer_load_dwordx4 v5, s[12:15], s44 offen lds
  v_mfma_f32_16x16x32_bf16 v[92:95], v[124:127], v[192:195], v[92:95]
  ds_read_b64_tr_b16 v[178:179], v247 offset:30848
  v_mfma_f32_16x16x32_bf16 v[48:51], v[128:131], v[188:191], v[48:51]
  ds_read_b64_tr_b16 v[116:117], v244 offset:24832
  v_mfma_f32_16x16x32_bf16 v[96:99], v[128:131], v[192:195], v[96:99]
  ds_read_b64_tr_b16 v[118:119], v244 offset:30976
  s_add_u32 m0, s46, 77824
  v_mfma_f32_16x16x32_bf16 v[52:55], v[132:135], v[188:191], v[52:55]
  ds_read_b64_tr_b16 v[120:121], v245 offset:24832
  buffer_load_dwordx4 v6, s[12:15], s44 offen lds
  v_mfma_f32_16x16x32_bf16 v[100:103], v[132:135], v[192:195], v[100:103]
  ds_read_b64_tr_b16 v[122:123], v245 offset:30976
  v_mfma_f32_16x16x32_bf16 v[56:59], v[136:139], v[188:191], v[56:59]
  ds_read_b64_tr_b16 v[124:125], v246 offset:24832
  v_mfma_f32_16x16x32_bf16 v[104:107], v[136:139], v[192:195], v[104:107]
  ds_read_b64_tr_b16 v[126:127], v246 offset:30976
  v_mfma_f32_16x16x32_bf16 v[60:63], v[140:143], v[188:191], v[60:63]
  ds_read_b64_tr_b16 v[128:129], v247 offset:24832
  v_mfma_f32_16x16x32_bf16 v[108:111], v[140:143], v[192:195], v[108:111]
  ds_read_b64_tr_b16 v[130:131], v247 offset:30976
  v_mfma_f32_16x16x32_bf16 v[64:67], v[144:147], v[188:191], v[64:67]
  v_mfma_f32_16x16x32_bf16 v[112:115], v[144:147], v[192:195], v[112:115]
  s_waitcnt lgkmcnt(12)
  s_add_u32 m0, s46, 78848
  v_mfma_f32_16x16x32_bf16 v[20:23], v[148:151], v[196:199], v[20:23]
  ds_read_b64_tr_b16 v[132:133], v244 offset:36864
  ds_read_b64_tr_b16 v[134:135], v244 offset:43008
  buffer_load_dwordx4 v7, s[12:15], s44 offen lds
  s_add_u32 s44, s44, 73728
  v_mfma_f32_16x16x32_bf16 v[68:71], v[148:151], v[200:203], v[68:71]
  ds_read_b64_tr_b16 v[136:137], v245 offset:36864
  v_mfma_f32_16x16x32_bf16 v[24:27], v[152:155], v[196:199], v[24:27]
  ds_read_b64_tr_b16 v[138:139], v245 offset:43008
  v_mfma_f32_16x16x32_bf16 v[72:75], v[152:155], v[200:203], v[72:75]
  ds_read_b64_tr_b16 v[140:141], v246 offset:36864
  v_mfma_f32_16x16x32_bf16 v[28:31], v[156:159], v[196:199], v[28:31]
  ds_read_b64_tr_b16 v[142:143], v246 offset:43008
  buffer_load_dwordx4 v[228:231], v16, s[16:19], s45 offen offset:0 sc1
  v_mfma_f32_16x16x32_bf16 v[76:79], v[156:159], v[200:203], v[76:79]
  ds_read_b64_tr_b16 v[144:145], v247 offset:36864
  v_mfma_f32_16x16x32_bf16 v[32:35], v[160:163], v[196:199], v[32:35]
  ds_read_b64_tr_b16 v[146:147], v247 offset:43008
  v_mfma_f32_16x16x32_bf16 v[80:83], v[160:163], v[200:203], v[80:83]
  ds_read_b64_tr_b16 v[148:149], v244 offset:36992
  v_mfma_f32_16x16x32_bf16 v[36:39], v[164:167], v[196:199], v[36:39]
  ds_read_b64_tr_b16 v[150:151], v244 offset:43136
  buffer_load_dwordx4 v[232:235], v17, s[16:19], s45 offen offset:0 sc1
  v_mfma_f32_16x16x32_bf16 v[84:87], v[164:167], v[200:203], v[84:87]
  ds_read_b64_tr_b16 v[152:153], v245 offset:36992
  v_mfma_f32_16x16x32_bf16 v[40:43], v[168:171], v[196:199], v[40:43]
  ds_read_b64_tr_b16 v[154:155], v245 offset:43136
  v_mfma_f32_16x16x32_bf16 v[88:91], v[168:171], v[200:203], v[88:91]
  ds_read_b64_tr_b16 v[156:157], v246 offset:36992
  ds_read_b64_tr_b16 v[158:159], v246 offset:43136
  s_waitcnt lgkmcnt(14)
  v_mfma_f32_16x16x32_bf16 v[44:47], v[172:175], v[196:199], v[44:47]
  ds_read_b64_tr_b16 v[160:161], v247 offset:36992
  buffer_load_dwordx4 v[236:239], v16, s[16:19], s45 offen offset:2048 sc1
  v_mfma_f32_16x16x32_bf16 v[92:95], v[172:175], v[200:203], v[92:95]
  ds_read_b64_tr_b16 v[162:163], v247 offset:43136
  v_mfma_f32_16x16x32_bf16 v[48:51], v[176:179], v[196:199], v[48:51]
  ds_read_b64_tr_b16 v[164:165], v244 offset:37120
  v_mfma_f32_16x16x32_bf16 v[96:99], v[176:179], v[200:203], v[96:99]
  ds_read_b64_tr_b16 v[166:167], v244 offset:43264
  v_mfma_f32_16x16x32_bf16 v[52:55], v[116:119], v[196:199], v[52:55]
  ds_read_b64_tr_b16 v[168:169], v245 offset:37120
  buffer_load_dwordx4 v[240:243], v17, s[16:19], s45 offen offset:2048 sc1
  s_add_u32 s45, s45, 4096
  v_mfma_f32_16x16x32_bf16 v[100:103], v[116:119], v[200:203], v[100:103]
  ds_read_b64_tr_b16 v[170:171], v245 offset:43264
  v_mfma_f32_16x16x32_bf16 v[56:59], v[120:123], v[196:199], v[56:59]
  ds_read_b64_tr_b16 v[172:173], v246 offset:37120
  v_mfma_f32_16x16x32_bf16 v[104:107], v[120:123], v[200:203], v[104:107]
  ds_read_b64_tr_b16 v[174:175], v246 offset:43264
  v_mfma_f32_16x16x32_bf16 v[60:63], v[124:127], v[196:199], v[60:63]
  ds_read_b64_tr_b16 v[176:177], v247 offset:37120
  v_mfma_f32_16x16x32_bf16 v[108:111], v[124:127], v[200:203], v[108:111]
  ds_read_b64_tr_b16 v[178:179], v247 offset:43264
  v_mfma_f32_16x16x32_bf16 v[64:67], v[128:131], v[196:199], v[64:67]
  v_mfma_f32_16x16x32_bf16 v[112:115], v[128:131], v[200:203], v[112:115]
  s_waitcnt vmcnt(11)
  s_barrier
  s_waitcnt lgkmcnt(12)
  v_mfma_f32_16x16x32_bf16 v[20:23], v[132:135], v[204:207], v[20:23]
  ds_read_b64_tr_b16 v[116:117], v248 offset:0
  ds_read_b64_tr_b16 v[118:119], v248 offset:6144
  v_mfma_f32_16x16x32_bf16 v[68:71], v[132:135], v[208:211], v[68:71]
  ds_read_b64_tr_b16 v[120:121], v249 offset:0
  v_mfma_f32_16x16x32_bf16 v[24:27], v[136:139], v[204:207], v[24:27]
  ds_read_b64_tr_b16 v[122:123], v249 offset:6144
  v_mfma_f32_16x16x32_bf16 v[72:75], v[136:139], v[208:211], v[72:75]
  ds_read_b64_tr_b16 v[124:125], v250 offset:0
  v_mfma_f32_16x16x32_bf16 v[28:31], v[140:143], v[204:207], v[28:31]
  ds_read_b64_tr_b16 v[126:127], v250 offset:6144
  v_mfma_f32_16x16x32_bf16 v[76:79], v[140:143], v[208:211], v[76:79]
  ds_read_b64_tr_b16 v[128:129], v251 offset:0
  v_mfma_f32_16x16x32_bf16 v[32:35], v[144:147], v[204:207], v[32:35]
  ds_read_b64_tr_b16 v[130:131], v251 offset:6144
  v_mfma_f32_16x16x32_bf16 v[80:83], v[144:147], v[208:211], v[80:83]
  ds_read_b64_tr_b16 v[132:133], v248 offset:128
  v_mfma_f32_16x16x32_bf16 v[36:39], v[148:151], v[204:207], v[36:39]
  ds_read_b64_tr_b16 v[134:135], v248 offset:6272
  v_mfma_f32_16x16x32_bf16 v[84:87], v[148:151], v[208:211], v[84:87]
  ds_read_b64_tr_b16 v[136:137], v249 offset:128
  v_mfma_f32_16x16x32_bf16 v[40:43], v[152:155], v[204:207], v[40:43]
  ds_read_b64_tr_b16 v[138:139], v249 offset:6272
  v_mfma_f32_16x16x32_bf16 v[88:91], v[152:155], v[208:211], v[88:91]
  ds_read_b64_tr_b16 v[140:141], v250 offset:128
  ds_read_b64_tr_b16 v[142:143], v250 offset:6272
  s_waitcnt lgkmcnt(14)
  v_mfma_f32_16x16x32_bf16 v[44:47], v[156:159], v[204:207], v[44:47]
  ds_read_b64_tr_b16 v[144:145], v251 offset:128
  v_mfma_f32_16x16x32_bf16 v[92:95], v[156:159], v[208:211], v[92:95]
  ds_read_b64_tr_b16 v[146:147], v251 offset:6272
  v_mfma_f32_16x16x32_bf16 v[48:51], v[160:163], v[204:207], v[48:51]
  ds_read_b64_tr_b16 v[148:149], v248 offset:256
  v_mfma_f32_16x16x32_bf16 v[96:99], v[160:163], v[208:211], v[96:99]
  ds_read_b64_tr_b16 v[150:151], v248 offset:6400
  v_mfma_f32_16x16x32_bf16 v[52:55], v[164:167], v[204:207], v[52:55]
  ds_read_b64_tr_b16 v[152:153], v249 offset:256
  v_mfma_f32_16x16x32_bf16 v[100:103], v[164:167], v[208:211], v[100:103]
  ds_read_b64_tr_b16 v[154:155], v249 offset:6400
  v_mfma_f32_16x16x32_bf16 v[56:59], v[168:171], v[204:207], v[56:59]
  ds_read_b64_tr_b16 v[156:157], v250 offset:256
  v_mfma_f32_16x16x32_bf16 v[104:107], v[168:171], v[208:211], v[104:107]
  ds_read_b64_tr_b16 v[158:159], v250 offset:6400
  v_mfma_f32_16x16x32_bf16 v[60:63], v[172:175], v[204:207], v[60:63]
  ds_read_b64_tr_b16 v[160:161], v251 offset:256
  v_mfma_f32_16x16x32_bf16 v[108:111], v[172:175], v[208:211], v[108:111]
  ds_read_b64_tr_b16 v[162:163], v251 offset:6400
  v_mfma_f32_16x16x32_bf16 v[64:67], v[176:179], v[204:207], v[64:67]
  v_mfma_f32_16x16x32_bf16 v[112:115], v[176:179], v[208:211], v[112:115]
  s_waitcnt lgkmcnt(12)
  v_mfma_f32_16x16x32_bf16 v[20:23], v[116:119], v[212:215], v[20:23]
  ds_read_b64_tr_b16 v[164:165], v248 offset:12288
  ds_read_b64_tr_b16 v[166:167], v248 offset:18432
  v_mfma_f32_16x16x32_bf16 v[68:71], v[116:119], v[216:219], v[68:71]
  ds_read_b64_tr_b16 v[168:169], v249 offset:12288
  v_mfma_f32_16x16x32_bf16 v[24:27], v[120:123], v[212:215], v[24:27]
  ds_read_b64_tr_b16 v[170:171], v249 offset:18432
  v_mfma_f32_16x16x32_bf16 v[72:75], v[120:123], v[216:219], v[72:75]
  ds_read_b64_tr_b16 v[172:173], v250 offset:12288
  v_mfma_f32_16x16x32_bf16 v[28:31], v[124:127], v[212:215], v[28:31]
  ds_read_b64_tr_b16 v[174:175], v250 offset:18432
  v_mfma_f32_16x16x32_bf16 v[76:79], v[124:127], v[216:219], v[76:79]
  ds_read_b64_tr_b16 v[176:177], v251 offset:12288
  v_mfma_f32_16x16x32_bf16 v[32:35], v[128:131], v[212:215], v[32:35]
  ds_read_b64_tr_b16 v[178:179], v251 offset:18432
  v_mfma_f32_16x16x32_bf16 v[80:83], v[128:131], v[216:219], v[80:83]
  ds_read_b64_tr_b16 v[116:117], v248 offset:12416
  v_mfma_f32_16x16x32_bf16 v[36:39], v[132:135], v[212:215], v[36:39]
  ds_read_b64_tr_b16 v[118:119], v248 offset:18560
  v_mfma_f32_16x16x32_bf16 v[84:87], v[132:135], v[216:219], v[84:87]
  ds_read_b64_tr_b16 v[120:121], v249 offset:12416
  v_mfma_f32_16x16x32_bf16 v[40:43], v[136:139], v[212:215], v[40:43]
  ds_read_b64_tr_b16 v[122:123], v249 offset:18560
  v_mfma_f32_16x16x32_bf16 v[88:91], v[136:139], v[216:219], v[88:91]
  ds_read_b64_tr_b16 v[124:125], v250 offset:12416
  ds_read_b64_tr_b16 v[126:127], v250 offset:18560
  s_waitcnt lgkmcnt(14)
  v_mfma_f32_16x16x32_bf16 v[44:47], v[140:143], v[212:215], v[44:47]
  ds_read_b64_tr_b16 v[128:129], v251 offset:12416
  v_mfma_f32_16x16x32_bf16 v[92:95], v[140:143], v[216:219], v[92:95]
  ds_read_b64_tr_b16 v[130:131], v251 offset:18560
  v_mfma_f32_16x16x32_bf16 v[48:51], v[144:147], v[212:215], v[48:51]
  ds_read_b64_tr_b16 v[132:133], v248 offset:12544
  v_mfma_f32_16x16x32_bf16 v[96:99], v[144:147], v[216:219], v[96:99]
  ds_read_b64_tr_b16 v[134:135], v248 offset:18688
  v_mfma_f32_16x16x32_bf16 v[52:55], v[148:151], v[212:215], v[52:55]
  ds_read_b64_tr_b16 v[136:137], v249 offset:12544
  v_mfma_f32_16x16x32_bf16 v[100:103], v[148:151], v[216:219], v[100:103]
  ds_read_b64_tr_b16 v[138:139], v249 offset:18688
  v_mfma_f32_16x16x32_bf16 v[56:59], v[152:155], v[212:215], v[56:59]
  ds_read_b64_tr_b16 v[140:141], v250 offset:12544
  v_mfma_f32_16x16x32_bf16 v[104:107], v[152:155], v[216:219], v[104:107]
  ds_read_b64_tr_b16 v[142:143], v250 offset:18688
  v_mfma_f32_16x16x32_bf16 v[60:63], v[156:159], v[212:215], v[60:63]
  ds_read_b64_tr_b16 v[144:145], v251 offset:12544
  v_mfma_f32_16x16x32_bf16 v[108:111], v[156:159], v[216:219], v[108:111]
  ds_read_b64_tr_b16 v[146:147], v251 offset:18688
  v_mfma_f32_16x16x32_bf16 v[64:67], v[160:163], v[212:215], v[64:67]
  v_mfma_f32_16x16x32_bf16 v[112:115], v[160:163], v[216:219], v[112:115]
  s_waitcnt vmcnt(0)
  s_barrier
  s_waitcnt lgkmcnt(12)
  v_mfma_f32_16x16x32_bf16 v[20:23], v[164:167], v[220:223], v[20:23]
  ds_read_b64_tr_b16 v[148:149], v248 offset:24576
  ds_read_b64_tr_b16 v[150:151], v248 offset:30720
  v_mfma_f32_16x16x32_bf16 v[68:71], v[164:167], v[224:227], v[68:71]
  ds_read_b64_tr_b16 v[152:153], v249 offset:24576
  v_mfma_f32_16x16x32_bf16 v[24:27], v[168:171], v[220:223], v[24:27]
  ds_read_b64_tr_b16 v[154:155], v249 offset:30720
  v_mfma_f32_16x16x32_bf16 v[72:75], v[168:171], v[224:227], v[72:75]
  ds_read_b64_tr_b16 v[156:157], v250 offset:24576
  v_mfma_f32_16x16x32_bf16 v[28:31], v[172:175], v[220:223], v[28:31]
  ds_read_b64_tr_b16 v[158:159], v250 offset:30720
  v_mfma_f32_16x16x32_bf16 v[76:79], v[172:175], v[224:227], v[76:79]
  ds_read_b64_tr_b16 v[160:161], v251 offset:24576
  v_mfma_f32_16x16x32_bf16 v[32:35], v[176:179], v[220:223], v[32:35]
  ds_read_b64_tr_b16 v[162:163], v251 offset:30720
  v_mfma_f32_16x16x32_bf16 v[80:83], v[176:179], v[224:227], v[80:83]
  ds_read_b64_tr_b16 v[164:165], v248 offset:24704
  v_mfma_f32_16x16x32_bf16 v[36:39], v[116:119], v[220:223], v[36:39]
  ds_read_b64_tr_b16 v[166:167], v248 offset:30848
  v_mfma_f32_16x16x32_bf16 v[84:87], v[116:119], v[224:227], v[84:87]
  ds_read_b64_tr_b16 v[168:169], v249 offset:24704
  v_mfma_f32_16x16x32_bf16 v[40:43], v[120:123], v[220:223], v[40:43]
  ds_read_b64_tr_b16 v[170:171], v249 offset:30848
  v_mfma_f32_16x16x32_bf16 v[88:91], v[120:123], v[224:227], v[88:91]
  ds_read_b64_tr_b16 v[172:173], v250 offset:24704
  ds_read_b64_tr_b16 v[174:175], v250 offset:30848
  s_waitcnt lgkmcnt(14)
  v_mfma_f32_16x16x32_bf16 v[44:47], v[124:127], v[220:223], v[44:47]
  ds_read_b64_tr_b16 v[176:177], v251 offset:24704
  v_mfma_f32_16x16x32_bf16 v[92:95], v[124:127], v[224:227], v[92:95]
  ds_read_b64_tr_b16 v[178:179], v251 offset:30848
  v_mfma_f32_16x16x32_bf16 v[48:51], v[128:131], v[220:223], v[48:51]
  ds_read_b64_tr_b16 v[116:117], v248 offset:24832
  v_mfma_f32_16x16x32_bf16 v[96:99], v[128:131], v[224:227], v[96:99]
  ds_read_b64_tr_b16 v[118:119], v248 offset:30976
  v_mfma_f32_16x16x32_bf16 v[52:55], v[132:135], v[220:223], v[52:55]
  ds_read_b64_tr_b16 v[120:121], v249 offset:24832
  v_mfma_f32_16x16x32_bf16 v[100:103], v[132:135], v[224:227], v[100:103]
  ds_read_b64_tr_b16 v[122:123], v249 offset:30976
  v_mfma_f32_16x16x32_bf16 v[56:59], v[136:139], v[220:223], v[56:59]
  ds_read_b64_tr_b16 v[124:125], v250 offset:24832
  v_mfma_f32_16x16x32_bf16 v[104:107], v[136:139], v[224:227], v[104:107]
  ds_read_b64_tr_b16 v[126:127], v250 offset:30976
  v_mfma_f32_16x16x32_bf16 v[60:63], v[140:143], v[220:223], v[60:63]
  ds_read_b64_tr_b16 v[128:129], v251 offset:24832
  v_mfma_f32_16x16x32_bf16 v[108:111], v[140:143], v[224:227], v[108:111]
  ds_read_b64_tr_b16 v[130:131], v251 offset:30976
  v_mfma_f32_16x16x32_bf16 v[64:67], v[144:147], v[220:223], v[64:67]
  v_mfma_f32_16x16x32_bf16 v[112:115], v[144:147], v[224:227], v[112:115]
  s_waitcnt lgkmcnt(12)
  v_mfma_f32_16x16x32_bf16 v[20:23], v[148:151], v[228:231], v[20:23]
  ds_read_b64_tr_b16 v[132:133], v248 offset:36864
  ds_read_b64_tr_b16 v[134:135], v248 offset:43008
  v_mfma_f32_16x16x32_bf16 v[68:71], v[148:151], v[232:235], v[68:71]
  ds_read_b64_tr_b16 v[136:137], v249 offset:36864
  v_mfma_f32_16x16x32_bf16 v[24:27], v[152:155], v[228:231], v[24:27]
  ds_read_b64_tr_b16 v[138:139], v249 offset:43008
  v_mfma_f32_16x16x32_bf16 v[72:75], v[152:155], v[232:235], v[72:75]
  ds_read_b64_tr_b16 v[140:141], v250 offset:36864
  v_mfma_f32_16x16x32_bf16 v[28:31], v[156:159], v[228:231], v[28:31]
  ds_read_b64_tr_b16 v[142:143], v250 offset:43008
  v_mfma_f32_16x16x32_bf16 v[76:79], v[156:159], v[232:235], v[76:79]
  ds_read_b64_tr_b16 v[144:145], v251 offset:36864
  v_mfma_f32_16x16x32_bf16 v[32:35], v[160:163], v[228:231], v[32:35]
  ds_read_b64_tr_b16 v[146:147], v251 offset:43008
  v_mfma_f32_16x16x32_bf16 v[80:83], v[160:163], v[232:235], v[80:83]
  ds_read_b64_tr_b16 v[148:149], v248 offset:36992
  v_mfma_f32_16x16x32_bf16 v[36:39], v[164:167], v[228:231], v[36:39]
  ds_read_b64_tr_b16 v[150:151], v248 offset:43136
  v_mfma_f32_16x16x32_bf16 v[84:87], v[164:167], v[232:235], v[84:87]
  ds_read_b64_tr_b16 v[152:153], v249 offset:36992
  v_mfma_f32_16x16x32_bf16 v[40:43], v[168:171], v[228:231], v[40:43]
  ds_read_b64_tr_b16 v[154:155], v249 offset:43136
  v_mfma_f32_16x16x32_bf16 v[88:91], v[168:171], v[232:235], v[88:91]
  ds_read_b64_tr_b16 v[156:157], v250 offset:36992
  ds_read_b64_tr_b16 v[158:159], v250 offset:43136
  s_waitcnt lgkmcnt(14)
  v_mfma_f32_16x16x32_bf16 v[44:47], v[172:175], v[228:231], v[44:47]
  ds_read_b64_tr_b16 v[160:161], v251 offset:36992
  v_mfma_f32_16x16x32_bf16 v[92:95], v[172:175], v[232:235], v[92:95]
  ds_read_b64_tr_b16 v[162:163], v251 offset:43136
  v_mfma_f32_16x16x32_bf16 v[48:51], v[176:179], v[228:231], v[48:51]
  ds_read_b64_tr_b16 v[164:165], v248 offset:37120
  v_mfma_f32_16x16x32_bf16 v[96:99], v[176:179], v[232:235], v[96:99]
  ds_read_b64_tr_b16 v[166:167], v248 offset:43264
  v_mfma_f32_16x16x32_bf16 v[52:55], v[116:119], v[228:231], v[52:55]
  ds_read_b64_tr_b16 v[168:169], v249 offset:37120
  v_mfma_f32_16x16x32_bf16 v[100:103], v[116:119], v[232:235], v[100:103]
  ds_read_b64_tr_b16 v[170:171], v249 offset:43264
  v_mfma_f32_16x16x32_bf16 v[56:59], v[120:123], v[228:231], v[56:59]
  ds_read_b64_tr_b16 v[172:173], v250 offset:37120
  v_mfma_f32_16x16x32_bf16 v[104:107], v[120:123], v[232:235], v[104:107]
  ds_read_b64_tr_b16 v[174:175], v250 offset:43264
  v_mfma_f32_16x16x32_bf16 v[60:63], v[124:127], v[228:231], v[60:63]
  ds_read_b64_tr_b16 v[176:177], v251 offset:37120
  v_mfma_f32_16x16x32_bf16 v[108:111], v[124:127], v[232:235], v[108:111]
  ds_read_b64_tr_b16 v[178:179], v251 offset:43264
  v_mfma_f32_16x16x32_bf16 v[64:67], v[128:131], v[228:231], v[64:67]
  v_mfma_f32_16x16x32_bf16 v[112:115], v[128:131], v[232:235], v[112:115]
  s_waitcnt lgkmcnt(12)
  v_mfma_f32_16x16x32_bf16 v[20:23], v[132:135], v[236:239], v[20:23]
  v_mfma_f32_16x16x32_bf16 v[68:71], v[132:135], v[240:243], v[68:71]
  v_mfma_f32_16x16x32_bf16 v[24:27], v[136:139], v[236:239], v[24:27]
  v_mfma_f32_16x16x32_bf16 v[72:75], v[136:139], v[240:243], v[72:75]
  v_mfma_f32_16x16x32_bf16 v[28:31], v[140:143], v[236:239], v[28:31]
  v_mfma_f32_16x16x32_bf16 v[76:79], v[140:143], v[240:243], v[76:79]
  v_mfma_f32_16x16x32_bf16 v[32:35], v[144:147], v[236:239], v[32:35]
  v_mfma_f32_16x16x32_bf16 v[80:83], v[144:147], v[240:243], v[80:83]
  v_mfma_f32_16x16x32_bf16 v[36:39], v[148:151], v[236:239], v[36:39]
  v_mfma_f32_16x16x32_bf16 v[84:87], v[148:151], v[240:243], v[84:87]
  v_mfma_f32_16x16x32_bf16 v[40:43], v[152:155], v[236:239], v[40:43]
  v_mfma_f32_16x16x32_bf16 v[88:91], v[152:155], v[240:243], v[88:91]
  s_waitcnt lgkmcnt(0)
  v_mfma_f32_16x16x32_bf16 v[44:47], v[156:159], v[236:239], v[44:47]
  v_mfma_f32_16x16x32_bf16 v[92:95], v[156:159], v[240:243], v[92:95]
  v_mfma_f32_16x16x32_bf16 v[48:51], v[160:163], v[236:239], v[48:51]
  v_mfma_f32_16x16x32_bf16 v[96:99], v[160:163], v[240:243], v[96:99]
  v_mfma_f32_16x16x32_bf16 v[52:55], v[164:167], v[236:239], v[52:55]
  v_mfma_f32_16x16x32_bf16 v[100:103], v[164:167], v[240:243], v[100:103]
  v_mfma_f32_16x16x32_bf16 v[56:59], v[168:171], v[236:239], v[56:59]
  v_mfma_f32_16x16x32_bf16 v[104:107], v[168:171], v[240:243], v[104:107]
  v_mfma_f32_16x16x32_bf16 v[60:63], v[172:175], v[236:239], v[60:63]
  v_mfma_f32_16x16x32_bf16 v[108:111], v[172:175], v[240:243], v[108:111]
  v_mfma_f32_16x16x32_bf16 v[64:67], v[176:179], v[236:239], v[64:67]
  v_mfma_f32_16x16x32_bf16 v[112:115], v[176:179], v[240:243], v[112:115]
  s_nop 7
  s_nop 3
  v_cvt_pk_bf16_f32 v44, v44, v45
  v_cvt_pk_bf16_f32 v45, v46, v47
  v_cvt_pk_bf16_f32 v46, v48, v49
  v_cvt_pk_bf16_f32 v47, v50, v51
  v_cvt_pk_bf16_f32 v48, v52, v53
  v_cvt_pk_bf16_f32 v49, v54, v55
  v_cvt_pk_bf16_f32 v50, v56, v57
  v_cvt_pk_bf16_f32 v51, v58, v59
  v_cvt_pk_bf16_f32 v52, v60, v61
  v_cvt_pk_bf16_f32 v53, v62, v63
  v_cvt_pk_bf16_f32 v54, v64, v65
  v_cvt_pk_bf16_f32 v55, v66, v67
  s_xor_b32 s48, s52, 2
  s_mul_i32 s48, s48, 9216
  s_add_u32 s48, s48, 3072
  buffer_store_dwordx4 v[44:47], v1, s[56:59], s48 offen offset:0 sc1
  buffer_store_dwordx4 v[48:51], v1, s[56:59], s48 offen offset:1024 sc1
  buffer_store_dwordx4 v[52:55], v1, s[56:59], s48 offen offset:2048 sc1
  v_cvt_pk_bf16_f32 v68, v68, v69
  v_cvt_pk_bf16_f32 v69, v70, v71
  v_cvt_pk_bf16_f32 v70, v72, v73
  v_cvt_pk_bf16_f32 v71, v74, v75
  v_cvt_pk_bf16_f32 v72, v76, v77
  v_cvt_pk_bf16_f32 v73, v78, v79
  v_cvt_pk_bf16_f32 v74, v80, v81
  v_cvt_pk_bf16_f32 v75, v82, v83
  v_cvt_pk_bf16_f32 v76, v84, v85
  v_cvt_pk_bf16_f32 v77, v86, v87
  v_cvt_pk_bf16_f32 v78, v88, v89
  v_cvt_pk_bf16_f32 v79, v90, v91
  s_xor_b32 s48, s52, 1
  s_mul_i32 s48, s48, 9216
  s_add_u32 s48, s48, 0
  buffer_store_dwordx4 v[68:71], v1, s[56:59], s48 offen offset:0 sc1
  buffer_store_dwordx4 v[72:75], v1, s[56:59], s48 offen offset:1024 sc1
  buffer_store_dwordx4 v[76:79], v1, s[56:59], s48 offen offset:2048 sc1
  v_cvt_pk_bf16_f32 v92, v92, v93
  v_cvt_pk_bf16_f32 v93, v94, v95
  v_cvt_pk_bf16_f32 v94, v96, v97
  v_cvt_pk_bf16_f32 v95, v98, v99
  v_cvt_pk_bf16_f32 v96, v100, v101
  v_cvt_pk_bf16_f32 v97, v102, v103
  v_cvt_pk_bf16_f32 v98, v104, v105
  v_cvt_pk_bf16_f32 v99, v106, v107
  v_cvt_pk_bf16_f32 v100, v108, v109
  v_cvt_pk_bf16_f32 v101, v110, v111
  v_cvt_pk_bf16_f32 v102, v112, v113
  v_cvt_pk_bf16_f32 v103, v114, v115
  s_xor_b32 s48, s52, 3
  s_mul_i32 s48, s48, 9216
  s_add_u32 s48, s48, 6144
  buffer_store_dwordx4 v[92:95], v1, s[56:59], s48 offen offset:0 sc1
  buffer_store_dwordx4 v[96:99], v1, s[56:59], s48 offen offset:1024 sc1
  buffer_store_dwordx4 v[100:103], v1, s[56:59], s48 offen offset:2048 sc1
  v_lshlrev_b32 v2, 7, v0
  v_lshlrev_b32 v3, 9, v0
  s_lshl_b32 s48, s52, 7
  v_add_u32 v3, s48, v3
  v_mov_b32 v4, 0
  s_mul_i32 s49, s52, 9216
  s_waitcnt vmcnt(0)
  buffer_store_dword v4, v3, s[60:63], 0 offen sc1
  buffer_load_dwordx2 v[140:141], v18, s[20:23], 0 offen offset:0
  buffer_load_dwordx2 v[142:143], v18, s[20:23], 0 offen offset:32
  buffer_load_dwordx2 v[144:145], v18, s[20:23], 0 offen offset:64
  buffer_load_dwordx2 v[146:147], v18, s[20:23], 0 offen offset:96
  buffer_load_dwordx2 v[148:149], v18, s[20:23], 0 offen offset:128
  buffer_load_dwordx2 v[150:151], v18, s[20:23], 0 offen offset:160
  s_mov_b32 s48, 4608
  buffer_load_dwordx4 v[152:155], v19, s[24:27], s48 offen offset:0 sc1
  s_mov_b32 s48, 4608
  buffer_load_dwordx4 v[156:159], v19, s[24:27], s48 offen offset:64 sc1
  s_mov_b32 s48, 4608
  buffer_load_dwordx4 v[160:163], v19, s[24:27], s48 offen offset:128 sc1
  s_mov_b32 s48, 4608
  buffer_load_dwordx4 v[164:167], v19, s[24:27], s48 offen offset:192 sc1
  s_mov_b32 s48, 4608
  buffer_load_dwordx4 v[168:171], v19, s[24:27], s48 offen offset:256 sc1
  s_mov_b32 s48, 4608
  buffer_load_dwordx4 v[172:175], v19, s[24:27], s48 offen offset:320 sc1
  s_mov_b32 s48, 9216
  buffer_load_dwordx4 v[176:179], v19, s[24:27], s48 offen offset:0 sc1
  s_mov_b32 s48, 9216
  buffer_load_dwordx4 v[180:183], v19, s[24:27], s48 offen offset:64 sc1
  s_mov_b32 s48, 9216
  buffer_load_dwordx4 v[184:187], v19, s[24:27], s48 offen offset:128 sc1
  s_mov_b32 s48, 9216
  buffer_load_dwordx4 v[188:191], v19, s[24:27], s48 offen offset:192 sc1
  s_mov_b32 s48, 9216
  buffer_load_dwordx4 v[192:195], v19, s[24:27], s48 offen offset:256 sc1
  s_mov_b32 s48, 9216
  buffer_load_dwordx4 v[196:199], v19, s[24:27], s48 offen offset:320 sc1
k2_xp:
  buffer_load_dword v4, v2, s[60:63], 0 offen sc1
  s_waitcnt vmcnt(0)
  v_cmp_ne_u32 vcc, 0, v4
  s_nop 1
  s_cbranch_vccz k2_xg
  s_sleep 1
  s_branch k2_xp
k2_xg:
  s_add_u32 s48, s49, 0
  buffer_load_dwordx4 v[80:83], v1, s[56:59], s48 offen offset:0 sc1
  buffer_load_dwordx4 v[84:87], v1, s[56:59], s48 offen offset:1024 sc1
  buffer_load_dwordx4 v[88:91], v1, s[56:59], s48 offen offset:2048 sc1
  s_add_u32 s48, s49, 3072
  buffer_load_dwordx4 v[56:59], v1, s[56:59], s48 offen offset:0 sc1
  buffer_load_dwordx4 v[60:63], v1, s[56:59], s48 offen offset:1024 sc1
  buffer_load_dwordx4 v[64:67], v1, s[56:59], s48 offen offset:2048 sc1
  s_add_u32 s48, s49, 6144
  buffer_load_dwordx4 v[104:107], v1, s[56:59], s48 offen offset:0 sc1
  buffer_load_dwordx4 v[108:111], v1, s[56:59], s48 offen offset:1024 sc1
  buffer_load_dwordx4 v[112:115], v1, s[56:59], s48 offen offset:2048 sc1
  s_waitcnt vmcnt(6)
  v_lshlrev_b32 v4, 16, v80
  v_and_b32 v5, 0xffff0000, v80
  v_add_f32 v20, v20, v4
  v_add_f32 v21, v21, v5
  v_lshlrev_b32 v4, 16, v81
  v_and_b32 v5, 0xffff0000, v81
  v_add_f32 v22, v22, v4
  v_add_f32 v23, v23, v5
  v_lshlrev_b32 v4, 16, v82
  v_and_b32 v5, 0xffff0000, v82
  v_add_f32 v24, v24, v4
  v_add_f32 v25, v25, v5
  v_lshlrev_b32 v4, 16, v83
  v_and_b32 v5, 0xffff0000, v83
  v_add_f32 v26, v26, v4
  v_add_f32 v27, v27, v5
  v_lshlrev_b32 v4, 16, v84
  v_and_b32 v5, 0xffff0000, v84
  v_add_f32 v28, v28, v4
  v_add_f32 v29, v29, v5
  v_lshlrev_b32 v4, 16, v85
  v_and_b32 v5, 0xffff0000, v85
  v_add_f32 v30, v30, v4
  v_add_f32 v31, v31, v5
  v_lshlrev_b32 v4, 16, v86
  v_and_b32 v5, 0xffff0000, v86
  v_add_f32 v32, v32, v4
  v_add_f32 v33, v33, v5
  v_lshlrev_b32 v4, 16, v87
  v_and_b32 v5, 0xffff0000, v87
  v_add_f32 v34, v34, v4
  v_add_f32 v35, v35, v5
  v_lshlrev_b32 v4, 16, v88
  v_and_b32 v5, 0xffff0000, v88
  v_add_f32 v36, v36, v4
  v_add_f32 v37, v37, v5
  v_lshlrev_b32 v4, 16, v89
  v_and_b32 v5, 0xffff0000, v89
  v_add_f32 v38, v38, v4
  v_add_f32 v39, v39, v5
  v_lshlrev_b32 v4, 16, v90
  v_and_b32 v5, 0xffff0000, v90
  v_add_f32 v40, v40, v4
  v_add_f32 v41, v41, v5
  v_lshlrev_b32 v4, 16, v91
  v_and_b32 v5, 0xffff0000, v91
  v_add_f32 v42, v42, v4
  v_add_f32 v43, v43, v5
  s_waitcnt vmcnt(3)
  v_lshlrev_b32 v4, 16, v56
  v_and_b32 v5, 0xffff0000, v56
  v_add_f32 v20, v20, v4
  v_add_f32 v21, v21, v5
  v_lshlrev_b32 v4, 16, v57
  v_and_b32 v5, 0xffff0000, v57
  v_add_f32 v22, v22, v4
  v_add_f32 v23, v23, v5
  v_lshlrev_b32 v4, 16, v58
  v_and_b32 v5, 0xffff0000, v58
  v_add_f32 v24, v24, v4
  v_add_f32 v25, v25, v5
  v_lshlrev_b32 v4, 16, v59
  v_and_b32 v5, 0xffff0000, v59
  v_add_f32 v26, v26, v4
  v_add_f32 v27, v27, v5
  v_lshlrev_b32 v4, 16, v60
  v_and_b32 v5, 0xffff0000, v60
  v_add_f32 v28, v28, v4
  v_add_f32 v29, v29, v5
  v_lshlrev_b32 v4, 16, v61
  v_and_b32 v5, 0xffff0000, v61
  v_add_f32 v30, v30, v4
  v_add_f32 v31, v31, v5
  v_lshlrev_b32 v4, 16, v62
  v_and_b32 v5, 0xffff0000, v62
  v_add_f32 v32, v32, v4
  v_add_f32 v33, v33, v5
  v_lshlrev_b32 v4, 16, v63
  v_and_b32 v5, 0xffff0000, v63
  v_add_f32 v34, v34, v4
  v_add_f32 v35, v35, v5
  v_lshlrev_b32 v4, 16, v64
  v_and_b32 v5, 0xffff0000, v64
  v_add_f32 v36, v36, v4
  v_add_f32 v37, v37, v5
  v_lshlrev_b32 v4, 16, v65
  v_and_b32 v5, 0xffff0000, v65
  v_add_f32 v38, v38, v4
  v_add_f32 v39, v39, v5
  v_lshlrev_b32 v4, 16, v66
  v_and_b32 v5, 0xffff0000, v66
  v_add_f32 v40, v40, v4
  v_add_f32 v41, v41, v5
  v_lshlrev_b32 v4, 16, v67
  v_and_b32 v5, 0xffff0000, v67
  v_add_f32 v42, v42, v4
  v_add_f32 v43, v43, v5
  s_waitcnt vmcnt(0)
  v_lshlrev_b32 v4, 16, v104
  v_and_b32 v5, 0xffff0000, v104
  v_add_f32 v20, v20, v4
  v_add_f32 v21, v21, v5
  v_lshlrev_b32 v4, 16, v105
  v_and_b32 v5, 0xffff0000, v105
  v_add_f32 v22, v22, v4
  v_add_f32 v23, v23, v5
  v_lshlrev_b32 v4, 16, v106
  v_and_b32 v5, 0xffff0000, v106
  v_add_f32 v24, v24, v4
  v_add_f32 v25, v25, v5
  v_lshlrev_b32 v4, 16, v107
  v_and_b32 v5, 0xffff0000, v107
  v_add_f32 v26, v26, v4
  v_add_f32 v27, v27, v5
  v_lshlrev_b32 v4, 16, v108
  v_and_b32 v5, 0xffff0000, v108
  v_add_f32 v28, v28, v4
  v_add_f32 v29, v29, v5
  v_lshlrev_b32 v4, 16, v109
  v_and_b32 v5, 0xffff0000, v109
  v_add_f32 v30, v30, v4
  v_add_f32 v31, v31, v5
  v_lshlrev_b32 v4, 16, v110
  v_and_b32 v5, 0xffff0000, v110
  v_add_f32 v32, v32, v4
  v_add_f32 v33, v33, v5
  v_lshlrev_b32 v4, 16, v111
  v_and_b32 v5, 0xffff0000, v111
  v_add_f32 v34, v34, v4
  v_add_f32 v35, v35, v5
  v_lshlrev_b32 v4, 16, v112
  v_and_b32 v5, 0xffff0000, v112
  v_add_f32 v36, v36, v4
  v_add_f32 v37, v37, v5
  v_lshlrev_b32 v4, 16, v113
  v_and_b32 v5, 0xffff0000, v113
  v_add_f32 v38, v38, v4
  v_add_f32 v39, v39, v5
  v_lshlrev_b32 v4, 16, v114
  v_and_b32 v5, 0xffff0000, v114
  v_add_f32 v40, v40, v4
  v_add_f32 v41, v41, v5
  v_lshlrev_b32 v4, 16, v115
  v_and_b32 v5, 0xffff0000, v115
  v_add_f32 v42, v42, v4
  v_add_f32 v43, v43, v5
  s_mul_i32 s35, s34, 6
  s_add_u32 s35, s35, s31
  s_mul_i32 s35, s35, 3072
  s_lshr_b32 s36, s34, 1
  s_mul_i32 s36, s36, 36864
  s_mul_i32 s37, s31, 6144
  s_add_u32 s36, s36, s37
  s_and_b32 s37, s34, 1
  s_lshl_b32 s37, s37, 10
  s_add_u32 s36, s36, s37
  s_lshl_b32 s37, s31, 14
  s_lshl_b32 s38, s34, 7
  s_add_u32 s37, s37, s38
  s_add_u32 s12, s10, 27541504
  s_addc_u32 s13, s11, 0
  s_add_u32 s12, s12, s35
  s_addc_u32 s13, s13, 0
  s_mov_b32 s14, 3072
  s_mov_b32 s15, 0x20000
  s_add_u32 s16, s10, 29900800
  s_addc_u32 s17, s11, 0
  s_add_u32 s16, s16, s36
  s_addc_u32 s17, s17, 0
  s_mov_b32 s18, 5120
  s_mov_b32 s19, 0x20000
  s_add_u32 s20, s10, 32260096
  s_addc_u32 s21, s11, 0
  s_add_u32 s20, s20, s37
  s_addc_u32 s21, s21, 0
  s_mov_b32 s22, 128
  s_mov_b32 s23, 0x20000
  v_mov_b32 v2, 0
  v_mov_b32 v3, 0
  v_lshlrev_b32 v4, 16, v140
  v_and_b32 v5, 0xffff0000, v140
  v_fmac_f32 v4, v20, v152
  v_fmac_f32 v5, v21, v153
  v_cvt_pk_bf16_f32 v116, v4, v5
  v_lshlrev_b32 v4, 16, v116
  v_and_b32 v5, 0xffff0000, v116
  v_add_f32 v2, v2, v4
  v_fmac_f32 v3, v4, v4
  v_add_f32 v2, v2, v5
  v_fmac_f32 v3, v5, v5
  v_mul_f32 v4, v4, v176
  v_mul_f32 v5, v5, v177
  v_cvt_pk_bf16_f32 v128, v4, v5
  v_lshlrev_b32 v4, 16, v141
  v_and_b32 v5, 0xffff0000, v141
  v_fmac_f32 v4, v22, v154
  v_fmac_f32 v5, v23, v155
  v_cvt_pk_bf16_f32 v117, v4, v5
  v_lshlrev_b32 v4, 16, v117
  v_and_b32 v5, 0xffff0000, v117
  v_add_f32 v2, v2, v4
  v_fmac_f32 v3, v4, v4
  v_add_f32 v2, v2, v5
  v_fmac_f32 v3, v5, v5
  v_mul_f32 v4, v4, v178
  v_mul_f32 v5, v5, v179
  v_cvt_pk_bf16_f32 v129, v4, v5
  v_lshlrev_b32 v4, 16, v142
  v_and_b32 v5, 0xffff0000, v142
  v_fmac_f32 v4, v24, v156
  v_fmac_f32 v5, v25, v157
  v_cvt_pk_bf16_f32 v118, v4, v5
  v_lshlrev_b32 v4, 16, v118
  v_and_b32 v5, 0xffff0000, v118
  v_add_f32 v2, v2, v4
  v_fmac_f32 v3, v4, v4
  v_add_f32 v2, v2, v5
  v_fmac_f32 v3, v5, v5
  v_mul_f32 v4, v4, v180
  v_mul_f32 v5, v5, v181
  v_cvt_pk_bf16_f32 v130, v4, v5
  v_lshlrev_b32 v4, 16, v143
  v_and_b32 v5, 0xffff0000, v143
  v_fmac_f32 v4, v26, v158
  v_fmac_f32 v5, v27, v159
  v_cvt_pk_bf16_f32 v119, v4, v5
  v_lshlrev_b32 v4, 16, v119
  v_and_b32 v5, 0xffff0000, v119
  v_add_f32 v2, v2, v4
  v_fmac_f32 v3, v4, v4
  v_add_f32 v2, v2, v5
  v_fmac_f32 v3, v5, v5
  v_mul_f32 v4, v4, v182
  v_mul_f32 v5, v5, v183
  v_cvt_pk_bf16_f32 v131, v4, v5
  s_mov_b32 s48, 0
  buffer_store_dwordx4 v[116:119], v1, s[12:15], 0 offen offset:0 sc1
  buffer_store_dwordx4 v[128:131], v1, s[16:19], s48 offen sc1
  v_lshlrev_b32 v4, 16, v144
  v_and_b32 v5, 0xffff0000, v144
  v_fmac_f32 v4, v28, v160
  v_fmac_f32 v5, v29, v161
  v_cvt_pk_bf16_f32 v120, v4, v5
  v_lshlrev_b32 v4, 16, v120
  v_and_b32 v5, 0xffff0000, v120
  v_add_f32 v2, v2, v4
  v_fmac_f32 v3, v4, v4
  v_add_f32 v2, v2, v5
  v_fmac_f32 v3, v5, v5
  v_mul_f32 v4, v4, v184
  v_mul_f32 v5, v5, v185
  v_cvt_pk_bf16_f32 v132, v4, v5
  v_lshlrev_b32 v4, 16, v145
  v_and_b32 v5, 0xffff0000, v145
  v_fmac_f32 v4, v30, v162
  v_fmac_f32 v5, v31, v163
  v_cvt_pk_bf16_f32 v121, v4, v5
  v_lshlrev_b32 v4, 16, v121
  v_and_b32 v5, 0xffff0000, v121
  v_add_f32 v2, v2, v4
  v_fmac_f32 v3, v4, v4
  v_add_f32 v2, v2, v5
  v_fmac_f32 v3, v5, v5
  v_mul_f32 v4, v4, v186
  v_mul_f32 v5, v5, v187
  v_cvt_pk_bf16_f32 v133, v4, v5
  v_lshlrev_b32 v4, 16, v146
  v_and_b32 v5, 0xffff0000, v146
  v_fmac_f32 v4, v32, v164
  v_fmac_f32 v5, v33, v165
  v_cvt_pk_bf16_f32 v122, v4, v5
  v_lshlrev_b32 v4, 16, v122
  v_and_b32 v5, 0xffff0000, v122
  v_add_f32 v2, v2, v4
  v_fmac_f32 v3, v4, v4
  v_add_f32 v2, v2, v5
  v_fmac_f32 v3, v5, v5
  v_mul_f32 v4, v4, v188
  v_mul_f32 v5, v5, v189
  v_cvt_pk_bf16_f32 v134, v4, v5
  v_lshlrev_b32 v4, 16, v147
  v_and_b32 v5, 0xffff0000, v147
  v_fmac_f32 v4, v34, v166
  v_fmac_f32 v5, v35, v167
  v_cvt_pk_bf16_f32 v123, v4, v5
  v_lshlrev_b32 v4, 16, v123
  v_and_b32 v5, 0xffff0000, v123
  v_add_f32 v2, v2, v4
  v_fmac_f32 v3, v4, v4
  v_add_f32 v2, v2, v5
  v_fmac_f32 v3, v5, v5
  v_mul_f32 v4, v4, v190
  v_mul_f32 v5, v5, v191
  v_cvt_pk_bf16_f32 v135, v4, v5
  s_mov_b32 s48, 2048
  buffer_store_dwordx4 v[120:123], v1, s[12:15], 0 offen offset:1024 sc1
  buffer_store_dwordx4 v[132:135], v1, s[16:19], s48 offen sc1
  v_lshlrev_b32 v4, 16, v148
  v_and_b32 v5, 0xffff0000, v148
  v_fmac_f32 v4, v36, v168
  v_fmac_f32 v5, v37, v169
  v_cvt_pk_bf16_f32 v124, v4, v5
  v_lshlrev_b32 v4, 16, v124
  v_and_b32 v5, 0xffff0000, v124
  v_add_f32 v2, v2, v4
  v_fmac_f32 v3, v4, v4
  v_add_f32 v2, v2, v5
  v_fmac_f32 v3, v5, v5
  v_mul_f32 v4, v4, v192
  v_mul_f32 v5, v5, v193
  v_cvt_pk_bf16_f32 v136, v4, v5
  v_lshlrev_b32 v4, 16, v149
  v_and_b32 v5, 0xffff0000, v149
  v_fmac_f32 v4, v38, v170
  v_fmac_f32 v5, v39, v171
  v_cvt_pk_bf16_f32 v125, v4, v5
  v_lshlrev_b32 v4, 16, v125
  v_and_b32 v5, 0xffff0000, v125
  v_add_f32 v2, v2, v4
  v_fmac_f32 v3, v4, v4
  v_add_f32 v2, v2, v5
  v_fmac_f32 v3, v5, v5
  v_mul_f32 v4, v4, v194
  v_mul_f32 v5, v5, v195
  v_cvt_pk_bf16_f32 v137, v4, v5
  v_lshlrev_b32 v4, 16, v150
  v_and_b32 v5, 0xffff0000, v150
  v_fmac_f32 v4, v40, v172
  v_fmac_f32 v5, v41, v173
  v_cvt_pk_bf16_f32 v126, v4, v5
  v_lshlrev_b32 v4, 16, v126
  v_and_b32 v5, 0xffff0000, v126
  v_add_f32 v2, v2, v4
  v_fmac_f32 v3, v4, v4
  v_add_f32 v2, v2, v5
  v_fmac_f32 v3, v5, v5
  v_mul_f32 v4, v4, v196
  v_mul_f32 v5, v5, v197
  v_cvt_pk_bf16_f32 v138, v4, v5
  v_lshlrev_b32 v4, 16, v151
  v_and_b32 v5, 0xffff0000, v151
  v_fmac_f32 v4, v42, v174
  v_fmac_f32 v5, v43, v175
  v_cvt_pk_bf16_f32 v127, v4, v5
  v_lshlrev_b32 v4, 16, v127
  v_and_b32 v5, 0xffff0000, v127
  v_add_f32 v2, v2, v4
  v_fmac_f32 v3, v4, v4
  v_add_f32 v2, v2, v5
  v_fmac_f32 v3, v5, v5
  v_mul_f32 v4, v4, v198
  v_mul_f32 v5, v5, v199
  v_cvt_pk_bf16_f32 v139, v4, v5
  s_mov_b32 s48, 4096
  buffer_store_dwordx4 v[124:127], v1, s[12:15], 0 offen offset:2048 sc1
  buffer_store_dwordx4 v[136:139], v1, s[16:19], s48 offen sc1
  v_mov_b32 v4, v2
  v_mov_b32 v5, v3
  s_nop 1
  v_permlane16_swap_b32 v2, v4
  v_permlane16_swap_b32 v3, v5
  s_nop 1
  v_add_f32 v2, v2, v4
  v_add_f32 v3, v3, v5
  v_mov_b32 v4, v2
  v_mov_b32 v5, v3
  s_nop 1
  v_permlane32_swap_b32 v2, v4
  v_permlane32_swap_b32 v3, v5
  s_nop 1
  v_add_f32 v2, v2, v4
  v_add_f32 v3, v3, v5
  v_lshlrev_b32 v4, 3, v0
  buffer_store_dwordx2 v[2:3], v4, s[20:23], 0 offen
  s_endpgm
k2_uv:
  s_sub_u32 s30, s2, 192
  s_mul_i32 s30, s30, 3
  s_add_u32 s33, s30, 3
  s_lshl_b32 s48, s3, 6
  v_add_u32 v0, s48, v0
  s_waitcnt lgkmcnt(0)
  s_add_u32 s16, s10, 0
  s_addc_u32 s17, s11, 0
  s_mov_b32 s18, 13824
  s_mov_b32 s19, 0x20000
  s_add_u32 s20, s10, 32358400
  s_addc_u32 s21, s11, 0
  s_mov_b32 s22, 65536
  s_mov_b32 s23, 0x20000
  v_and_b32 v6, 0xfc, v0
  s_mov_b32 s48, 9216
  buffer_load_dword v60, v6, s[16:19], s48 offen offset:0 sc1
  s_mov_b32 s48, 9216
  buffer_load_dword v61, v6, s[16:19], s48 offen offset:256 sc1
  s_mov_b32 s48, 9216
  buffer_load_dword v62, v6, s[16:19], s48 offen offset:512 sc1
  s_mov_b32 s48, 9216
  buffer_load_dword v63, v6, s[16:19], s48 offen offset:768 sc1
  s_mov_b32 s48, 9216
  buffer_load_dword v64, v6, s[16:19], s48 offen offset:1024 sc1
  s_mov_b32 s48, 9216
  buffer_load_dword v65, v6, s[16:19], s48 offen offset:1280 sc1
  s_mov_b32 s48, 9216
  buffer_load_dword v66, v6, s[16:19], s48 offen offset:1536 sc1
  s_mov_b32 s48, 9216
  buffer_load_dword v67, v6, s[16:19], s48 offen offset:1792 sc1
  s_mov_b32 s48, 9216
  buffer_load_dword v68, v6, s[16:19], s48 offen offset:2048 sc1
  s_mov_b32 s48, 6912
  buffer_load_dword v69, v6, s[16:19], s48 offen offset:0 sc1
  s_mov_b32 s48, 6912
  buffer_load_dword v70, v6, s[16:19], s48 offen offset:256 sc1
  s_mov_b32 s48, 6912
  buffer_load_dword v71, v6, s[16:19], s48 offen offset:512 sc1
  s_mov_b32 s48, 6912
  buffer_load_dword v72, v6, s[16:19], s48 offen offset:768 sc1
  s_mov_b32 s48, 6912
  buffer_load_dword v73, v6, s[16:19], s48 offen offset:1024 sc1
  s_mov_b32 s48, 6912
  buffer_load_dword v74, v6, s[16:19], s48 offen offset:1280 sc1
  s_mov_b32 s48, 6912
  buffer_load_dword v75, v6, s[16:19], s48 offen offset:1536 sc1
  s_mov_b32 s48, 6912
  buffer_load_dword v76, v6, s[16:19], s48 offen offset:1792 sc1
  s_mov_b32 s48, 6912
  buffer_load_dword v77, v6, s[16:19], s48 offen offset:2048 sc1
k2_uvl:
  s_lshl_b32 s31, s30, 6
  s_sub_u32 s32, 5308416, s31
  s_add_u32 s12, s8, 0
  s_addc_u32 s13, s9, 0
  s_add_u32 s12, s12, s31
  s_addc_u32 s13, s13, 0
  s_mov_b32 s14, s32
  s_mov_b32 s15, 0x20000
  v_lshrrev_b32 v3, 2, v0
  v_mul_u32_u24 v4, 9216, v3
  v_and_b32 v5, 3, v0
  v_lshl_add_u32 v4, v5, 4, v4
  s_mov_b32 s40, 0
  buffer_load_dwordx4 v[20:23], v4, s[12:15], s40 offen
  s_mov_b32 s40, 589824
  buffer_load_dwordx4 v[24:27], v4, s[12:15], s40 offen
  s_mov_b32 s40, 1179648
  buffer_load_dwordx4 v[28:31], v4, s[12:15], s40 offen
  s_mov_b32 s40, 1769472
  buffer_load_dwordx4 v[32:35], v4, s[12:15], s40 offen
  s_mov_b32 s40, 2359296
  buffer_load_dwordx4 v[36:39], v4, s[12:15], s40 offen
  s_mov_b32 s40, 2949120
  buffer_load_dwordx4 v[40:43], v4, s[12:15], s40 offen
  s_mov_b32 s40, 3538944
  buffer_load_dwordx4 v[44:47], v4, s[12:15], s40 offen
  s_mov_b32 s40, 4128768
  buffer_load_dwordx4 v[48:51], v4, s[12:15], s40 offen
  s_mov_b32 s40, 4718592
  buffer_load_dwordx4 v[52:55], v4, s[12:15], s40 offen
  v_mov_b32 v80, 0
  v_mov_b32 v81, 0
  v_mov_b32 v82, 0
  v_mov_b32 v83, 0
  v_mov_b32 v84, 0
  v_mov_b32 v85, 0
  v_mov_b32 v86, 0
  v_mov_b32 v87, 0
  v_mov_b32 v88, 0
  v_mov_b32 v89, 0
  v_mov_b32 v90, 0
  v_mov_b32 v91, 0
  v_mov_b32 v92, 0
  v_mov_b32 v93, 0
  v_mov_b32 v94, 0
  v_mov_b32 v95, 0
  s_waitcnt vmcnt(8)
  v_lshlrev_b32 v4, 16, v20
  v_and_b32 v5, 0xffff0000, v20
  v_fmac_f32 v80, v4, v60
  v_fmac_f32 v81, v5, v60
  v_fmac_f32 v88, v4, v69
  v_fmac_f32 v89, v5, v69
  v_lshlrev_b32 v4, 16, v21
  v_and_b32 v5, 0xffff0000, v21
  v_fmac_f32 v82, v4, v60
  v_fmac_f32 v83, v5, v60
  v_fmac_f32 v90, v4, v69
  v_fmac_f32 v91, v5, v69
  v_lshlrev_b32 v4, 16, v22
  v_and_b32 v5, 0xffff0000, v22
  v_fmac_f32 v84, v4, v60
  v_fmac_f32 v85, v5, v60
  v_fmac_f32 v92, v4, v69
  v_fmac_f32 v93, v5, v69
  v_lshlrev_b32 v4, 16, v23
  v_and_b32 v5, 0xffff0000, v23
  v_fmac_f32 v86, v4, v60
  v_fmac_f32 v87, v5, v60
  v_fmac_f32 v94, v4, v69
  v_fmac_f32 v95, v5, v69
  s_waitcnt vmcnt(7)
  v_lshlrev_b32 v4, 16, v24
  v_and_b32 v5, 0xffff0000, v24
  v_fmac_f32 v80, v4, v61
  v_fmac_f32 v81, v5, v61
  v_fmac_f32 v88, v4, v70
  v_fmac_f32 v89, v5, v70
  v_lshlrev_b32 v4, 16, v25
  v_and_b32 v5, 0xffff0000, v25
  v_fmac_f32 v82, v4, v61
  v_fmac_f32 v83, v5, v61
  v_fmac_f32 v90, v4, v70
  v_fmac_f32 v91, v5, v70
  v_lshlrev_b32 v4, 16, v26
  v_and_b32 v5, 0xffff0000, v26
  v_fmac_f32 v84, v4, v61
  v_fmac_f32 v85, v5, v61
  v_fmac_f32 v92, v4, v70
  v_fmac_f32 v93, v5, v70
  v_lshlrev_b32 v4, 16, v27
  v_and_b32 v5, 0xffff0000, v27
  v_fmac_f32 v86, v4, v61
  v_fmac_f32 v87, v5, v61
  v_fmac_f32 v94, v4, v70
  v_fmac_f32 v95, v5, v70
  s_waitcnt vmcnt(6)
  v_lshlrev_b32 v4, 16, v28
  v_and_b32 v5, 0xffff0000, v28
  v_fmac_f32 v80, v4, v62
  v_fmac_f32 v81, v5, v62
  v_fmac_f32 v88, v4, v71
  v_fmac_f32 v89, v5, v71
  v_lshlrev_b32 v4, 16, v29
  v_and_b32 v5, 0xffff0000, v29
  v_fmac_f32 v82, v4, v62
  v_fmac_f32 v83, v5, v62
  v_fmac_f32 v90, v4, v71
  v_fmac_f32 v91, v5, v71
  v_lshlrev_b32 v4, 16, v30
  v_and_b32 v5, 0xffff0000, v30
  v_fmac_f32 v84, v4, v62
  v_fmac_f32 v85, v5, v62
  v_fmac_f32 v92, v4, v71
  v_fmac_f32 v93, v5, v71
  v_lshlrev_b32 v4, 16, v31
  v_and_b32 v5, 0xffff0000, v31
  v_fmac_f32 v86, v4, v62
  v_fmac_f32 v87, v5, v62
  v_fmac_f32 v94, v4, v71
  v_fmac_f32 v95, v5, v71
  s_waitcnt vmcnt(5)
  v_lshlrev_b32 v4, 16, v32
  v_and_b32 v5, 0xffff0000, v32
  v_fmac_f32 v80, v4, v63
  v_fmac_f32 v81, v5, v63
  v_fmac_f32 v88, v4, v72
  v_fmac_f32 v89, v5, v72
  v_lshlrev_b32 v4, 16, v33
  v_and_b32 v5, 0xffff0000, v33
  v_fmac_f32 v82, v4, v63
  v_fmac_f32 v83, v5, v63
  v_fmac_f32 v90, v4, v72
  v_fmac_f32 v91, v5, v72
  v_lshlrev_b32 v4, 16, v34
  v_and_b32 v5, 0xffff0000, v34
  v_fmac_f32 v84, v4, v63
  v_fmac_f32 v85, v5, v63
  v_fmac_f32 v92, v4, v72
  v_fmac_f32 v93, v5, v72
  v_lshlrev_b32 v4, 16, v35
  v_and_b32 v5, 0xffff0000, v35
  v_fmac_f32 v86, v4, v63
  v_fmac_f32 v87, v5, v63
  v_fmac_f32 v94, v4, v72
  v_fmac_f32 v95, v5, v72
  s_waitcnt vmcnt(4)
  v_lshlrev_b32 v4, 16, v36
  v_and_b32 v5, 0xffff0000, v36
  v_fmac_f32 v80, v4, v64
  v_fmac_f32 v81, v5, v64
  v_fmac_f32 v88, v4, v73
  v_fmac_f32 v89, v5, v73
  v_lshlrev_b32 v4, 16, v37
  v_and_b32 v5, 0xffff0000, v37
  v_fmac_f32 v82, v4, v64
  v_fmac_f32 v83, v5, v64
  v_fmac_f32 v90, v4, v73
  v_fmac_f32 v91, v5, v73
  v_lshlrev_b32 v4, 16, v38
  v_and_b32 v5, 0xffff0000, v38
  v_fmac_f32 v84, v4, v64
  v_fmac_f32 v85, v5, v64
  v_fmac_f32 v92, v4, v73
  v_fmac_f32 v93, v5, v73
  v_lshlrev_b32 v4, 16, v39
  v_and_b32 v5, 0xffff0000, v39
  v_fmac_f32 v86, v4, v64
  v_fmac_f32 v87, v5, v64
  v_fmac_f32 v94, v4, v73
  v_fmac_f32 v95, v5, v73
  s_waitcnt vmcnt(3)
  v_lshlrev_b32 v4, 16, v40
  v_and_b32 v5, 0xffff0000, v40
  v_fmac_f32 v80, v4, v65
  v_fmac_f32 v81, v5, v65
  v_fmac_f32 v88, v4, v74
  v_fmac_f32 v89, v5, v74
  v_lshlrev_b32 v4, 16, v41
  v_and_b32 v5, 0xffff0000, v41
  v_fmac_f32 v82, v4, v65
  v_fmac_f32 v83, v5, v65
  v_fmac_f32 v90, v4, v74
  v_fmac_f32 v91, v5, v74
  v_lshlrev_b32 v4, 16, v42
  v_and_b32 v5, 0xffff0000, v42
  v_fmac_f32 v84, v4, v65
  v_fmac_f32 v85, v5, v65
  v_fmac_f32 v92, v4, v74
  v_fmac_f32 v93, v5, v74
  v_lshlrev_b32 v4, 16, v43
  v_and_b32 v5, 0xffff0000, v43
  v_fmac_f32 v86, v4, v65
  v_fmac_f32 v87, v5, v65
  v_fmac_f32 v94, v4, v74
  v_fmac_f32 v95, v5, v74
  s_waitcnt vmcnt(2)
  v_lshlrev_b32 v4, 16, v44
  v_and_b32 v5, 0xffff0000, v44
  v_fmac_f32 v80, v4, v66
  v_fmac_f32 v81, v5, v66
  v_fmac_f32 v88, v4, v75
  v_fmac_f32 v89, v5, v75
  v_lshlrev_b32 v4, 16, v45
  v_and_b32 v5, 0xffff0000, v45
  v_fmac_f32 v82, v4, v66
  v_fmac_f32 v83, v5, v66
  v_fmac_f32 v90, v4, v75
  v_fmac_f32 v91, v5, v75
  v_lshlrev_b32 v4, 16, v46
  v_and_b32 v5, 0xffff0000, v46
  v_fmac_f32 v84, v4, v66
  v_fmac_f32 v85, v5, v66
  v_fmac_f32 v92, v4, v75
  v_fmac_f32 v93, v5, v75
  v_lshlrev_b32 v4, 16, v47
  v_and_b32 v5, 0xffff0000, v47
  v_fmac_f32 v86, v4, v66
  v_fmac_f32 v87, v5, v66
  v_fmac_f32 v94, v4, v75
  v_fmac_f32 v95, v5, v75
  s_waitcnt vmcnt(1)
  v_lshlrev_b32 v4, 16, v48
  v_and_b32 v5, 0xffff0000, v48
  v_fmac_f32 v80, v4, v67
  v_fmac_f32 v81, v5, v67
  v_fmac_f32 v88, v4, v76
  v_fmac_f32 v89, v5, v76
  v_lshlrev_b32 v4, 16, v49
  v_and_b32 v5, 0xffff0000, v49
  v_fmac_f32 v82, v4, v67
  v_fmac_f32 v83, v5, v67
  v_fmac_f32 v90, v4, v76
  v_fmac_f32 v91, v5, v76
  v_lshlrev_b32 v4, 16, v50
  v_and_b32 v5, 0xffff0000, v50
  v_fmac_f32 v84, v4, v67
  v_fmac_f32 v85, v5, v67
  v_fmac_f32 v92, v4, v76
  v_fmac_f32 v93, v5, v76
  v_lshlrev_b32 v4, 16, v51
  v_and_b32 v5, 0xffff0000, v51
  v_fmac_f32 v86, v4, v67
  v_fmac_f32 v87, v5, v67
  v_fmac_f32 v94, v4, v76
  v_fmac_f32 v95, v5, v76
  s_waitcnt vmcnt(0)
  v_lshlrev_b32 v4, 16, v52
  v_and_b32 v5, 0xffff0000, v52
  v_fmac_f32 v80, v4, v68
  v_fmac_f32 v81, v5, v68
  v_fmac_f32 v88, v4, v77
  v_fmac_f32 v89, v5, v77
  v_lshlrev_b32 v4, 16, v53
  v_and_b32 v5, 0xffff0000, v53
  v_fmac_f32 v82, v4, v68
  v_fmac_f32 v83, v5, v68
  v_fmac_f32 v90, v4, v77
  v_fmac_f32 v91, v5, v77
  v_lshlrev_b32 v4, 16, v54
  v_and_b32 v5, 0xffff0000, v54
  v_fmac_f32 v84, v4, v68
  v_fmac_f32 v85, v5, v68
  v_fmac_f32 v92, v4, v77
  v_fmac_f32 v93, v5, v77
  v_lshlrev_b32 v4, 16, v55
  v_and_b32 v5, 0xffff0000, v55
  v_fmac_f32 v86, v4, v68
  v_fmac_f32 v87, v5, v68
  v_fmac_f32 v94, v4, v77
  v_fmac_f32 v95, v5, v77
  s_nop 1
  v_add_f32_dpp v80, v80, v80 row_ror:4 row_mask:0xf bank_mask:0xf
  v_add_f32_dpp v81, v81, v81 row_ror:4 row_mask:0xf bank_mask:0xf
  v_add_f32_dpp v82, v82, v82 row_ror:4 row_mask:0xf bank_mask:0xf
  v_add_f32_dpp v83, v83, v83 row_ror:4 row_mask:0xf bank_mask:0xf
  v_add_f32_dpp v84, v84, v84 row_ror:4 row_mask:0xf bank_mask:0xf
  v_add_f32_dpp v85, v85, v85 row_ror:4 row_mask:0xf bank_mask:0xf
  v_add_f32_dpp v86, v86, v86 row_ror:4 row_mask:0xf bank_mask:0xf
  v_add_f32_dpp v87, v87, v87 row_ror:4 row_mask:0xf bank_mask:0xf
  v_add_f32_dpp v88, v88, v88 row_ror:4 row_mask:0xf bank_mask:0xf
  v_add_f32_dpp v89, v89, v89 row_ror:4 row_mask:0xf bank_mask:0xf
  v_add_f32_dpp v90, v90, v90 row_ror:4 row_mask:0xf bank_mask:0xf
  v_add_f32_dpp v91, v91, v91 row_ror:4 row_mask:0xf bank_mask:0xf
  v_add_f32_dpp v92, v92, v92 row_ror:4 row_mask:0xf bank_mask:0xf
  v_add_f32_dpp v93, v93, v93 row_ror:4 row_mask:0xf bank_mask:0xf
  v_add_f32_dpp v94, v94, v94 row_ror:4 row_mask:0xf bank_mask:0xf
  v_add_f32_dpp v95, v95, v95 row_ror:4 row_mask:0xf bank_mask:0xf
  s_nop 1
  v_add_f32_dpp v80, v80, v80 row_ror:8 row_mask:0xf bank_mask:0xf
  v_add_f32_dpp v81, v81, v81 row_ror:8 row_mask:0xf bank_mask:0xf
  v_add_f32_dpp v82, v82, v82 row_ror:8 row_mask:0xf bank_mask:0xf
  v_add_f32_dpp v83, v83, v83 row_ror:8 row_mask:0xf bank_mask:0xf
  v_add_f32_dpp v84, v84, v84 row_ror:8 row_mask:0xf bank_mask:0xf
  v_add_f32_dpp v85, v85, v85 row_ror:8 row_mask:0xf bank_mask:0xf
  v_add_f32_dpp v86, v86, v86 row_ror:8 row_mask:0xf bank_mask:0xf
  v_add_f32_dpp v87, v87, v87 row_ror:8 row_mask:0xf bank_mask:0xf
  v_add_f32_dpp v88, v88, v88 row_ror:8 row_mask:0xf bank_mask:0xf
  v_add_f32_dpp v89, v89, v89 row_ror:8 row_mask:0xf bank_mask:0xf
  v_add_f32_dpp v90, v90, v90 row_ror:8 row_mask:0xf bank_mask:0xf
  v_add_f32_dpp v91, v91, v91 row_ror:8 row_mask:0xf bank_mask:0xf
  v_add_f32_dpp v92, v92, v92 row_ror:8 row_mask:0xf bank_mask:0xf
  v_add_f32_dpp v93, v93, v93 row_ror:8 row_mask:0xf bank_mask:0xf
  v_add_f32_dpp v94, v94, v94 row_ror:8 row_mask:0xf bank_mask:0xf
  v_add_f32_dpp v95, v95, v95 row_ror:8 row_mask:0xf bank_mask:0xf
  v_lshrrev_b32 v4, 4, v0
  v_lshlrev_b32 v4, 7, v4
  v_and_b32 v5, 3, v0
  v_lshl_add_u32 v4, v5, 5, v4
  ds_write_b128 v4, v[80:83] offset:0
  ds_write_b128 v4, v[84:87] offset:16
  ds_write_b128 v4, v[88:91] offset:2048
  ds_write_b128 v4, v[92:95] offset:2064
  s_waitcnt lgkmcnt(0)
  s_barrier
  v_bfe_u32 v4, v0, 5, 1
  v_lshlrev_b32 v4, 11, v4
  v_and_b32 v5, 31, v0
  v_lshl_add_u32 v4, v5, 2, v4
  ds_read_b32 v20, v4 offset:0
  ds_read_b32 v21, v4 offset:128
  ds_read_b32 v22, v4 offset:256
  ds_read_b32 v23, v4 offset:384
  ds_read_b32 v24, v4 offset:512
  ds_read_b32 v25, v4 offset:640
  ds_read_b32 v26, v4 offset:768
  ds_read_b32 v27, v4 offset:896
  ds_read_b32 v28, v4 offset:1024
  ds_read_b32 v29, v4 offset:1152
  ds_read_b32 v30, v4 offset:1280
  ds_read_b32 v31, v4 offset:1408
  ds_read_b32 v32, v4 offset:1536
  ds_read_b32 v33, v4 offset:1664
  ds_read_b32 v34, v4 offset:1792
  ds_read_b32 v35, v4 offset:1920
  s_waitcnt lgkmcnt(0)
  v_add_f32 v20, v20, v28
  v_add_f32 v21, v21, v29
  v_add_f32 v22, v22, v30
  v_add_f32 v23, v23, v31
  v_add_f32 v24, v24, v32
  v_add_f32 v25, v25, v33
  v_add_f32 v26, v26, v34
  v_add_f32 v27, v27, v35
  v_add_f32 v20, v20, v24
  v_add_f32 v21, v21, v25
  v_add_f32 v22, v22, v26
  v_add_f32 v23, v23, v27
  v_add_f32 v20, v20, v22
  v_add_f32 v21, v21, v23
  v_add_f32 v20, v20, v21
  v_mov_b32 v2, v20
  s_lshl_b32 s31, s30, 5
  v_and_b32 v4, 31, v0
  v_add_u32 v4, s31, v4
  v_mul_u32_u24 v5, 3641, v4
  v_lshrrev_b32 v5, 19, v5
  v_mul_u32_u24 v5, 1472, v5
  v_lshl_add_u32 v4, v4, 2, v5
  v_bfe_u32 v5, v0, 5, 1
  v_mul_u32_u24 v5, 576, v5
  v_add_u32 v4, v4, v5
  buffer_store_dword v2, v4, s[20:23], 0 offen
  s_waitcnt vmcnt(0)
  s_barrier
  s_add_u32 s30, s30, 1
  s_cmp_lt_u32 s30, s33
  s_cbranch_scc1 k2_uvl
k1_end:
k2_end:
  s_endpgm
  .p2align 8
  .globl k3_kernel
  .type k3_kernel,@function
k3_kernel:
  s_cmp_ge_u32 s2, 512
  s_cbranch_scc1 k3_end
  s_load_dwordx2 s[6:7], s[0:1], 48
  s_load_dwordx2 s[10:11], s[0:1], 112
  v_lshrrev_b32 v1, 6, v0
  s_nop 0
  v_readfirstlane_b32 s3, v1
  s_and_b32 s32, s2, 7
  s_bfe_u32 s33, s2, 0x50003
  s_and_b32 s30, s33, 7
  s_lshr_b32 s31, s33, 3
  s_and_b32 s33, s32, 1
  s_lshl_b32 s33, s33, 3
  s_add_u32 s30, s30, s33
  s_lshr_b32 s32, s32, 1
  s_lshl_b32 s32, s32, 2
  s_add_u32 s31, s31, s32
  s_cmp_lt_u32 s2, 256
  s_cselect_b32 s42, 16, 0
  s_cbranch_scc0 k3_lo
  s_setprio 3
k3_lo:
  s_add_u32 s43, s42, s31
  s_lshl_b32 s34, s30, 2
  s_add_u32 s34, s34, s3
  s_mul_i32 s35, s43, 288
  s_sub_u32 s36, 5308416, s35
  s_mul_i32 s37, s34, 36864
  s_lshl_b32 s38, s34, 8
  s_lshl_b32 s39, s43, 11
  s_mul_i32 s40, s43, 589824
  s_mul_i32 s41, s34, 9216
  s_add_u32 s40, s40, s41
  s_waitcnt lgkmcnt(0)
  s_add_u32 s12, s6, 0
  s_addc_u32 s13, s7, 0
  s_add_u32 s12, s12, s35
  s_addc_u32 s13, s13, 0
  s_mov_b32 s14, s36
  s_mov_b32 s15, 0x20000
  s_add_u32 s16, s10, 29900800
  s_addc_u32 s17, s11, 0
  s_add_u32 s16, s16, s37
  s_addc_u32 s17, s17, 0
  s_mov_b32 s18, 36864
  s_mov_b32 s19, 0x20000
  s_add_u32 s20, s10, 32260096
  s_addc_u32 s21, s11, 0
  s_add_u32 s20, s20, s38
  s_addc_u32 s21, s21, 0
  s_mov_b32 s22, 98304
  s_mov_b32 s23, 0x20000
  s_add_u32 s24, s10, 32358400
  s_addc_u32 s25, s11, 0
  s_add_u32 s24, s24, s39
  s_addc_u32 s25, s25, 0
  s_mov_b32 s26, 1152
  s_mov_b32 s27, 0x20000
  s_add_u32 s52, s10, 32423936
  s_addc_u32 s53, s11, 0
  s_add_u32 s52, s52, s40
  s_addc_u32 s53, s53, 0
  s_mov_b32 s54, 9216
  s_mov_b32 s55, 0x20000
  s_add_u32 s56, s10, 51298304
  s_addc_u32 s57, s11, 0
  s_add_u32 s56, s56, s38
  s_addc_u32 s57, s57, 0
  s_mov_b32 s58, 262144
  s_mov_b32 s59, 0x20000
  s_mov_b32 s44, 0
  s_mov_b32 s45, 0
  v_and_b32 v0, 63, v0
  v_lshlrev_b32 v1, 4, v0
  s_mul_i32 s46, s3, 4608
  s_lshr_b32 s48, s46, 4
  s_add_u32 s48, s48, 0
  v_add_u32 v14, s48, v0
  v_mul_u32_u24 v15, 3641, v14
  v_lshrrev_b32 v15, 16, v15
  v_mul_u32_u24 v2, 18, v15
  v_sub_u32 v14, v14, v2
  v_mul_u32_u24 v2, 9216, v15
  v_lshl_add_u32 v2, v14, 4, v2
  s_lshr_b32 s48, s46, 4
  s_add_u32 s48, s48, 64
  v_add_u32 v14, s48, v0
  v_mul_u32_u24 v15, 3641, v14
  v_lshrrev_b32 v15, 16, v15
  v_mul_u32_u24 v3, 18, v15
  v_sub_u32 v14, v14, v3
  v_mul_u32_u24 v3, 9216, v15
  v_lshl_add_u32 v3, v14, 4, v3
  s_lshr_b32 s48, s46, 4
  s_add_u32 s48, s48, 128
  v_add_u32 v14, s48, v0
  v_mul_u32_u24 v15, 3641, v14
  v_lshrrev_b32 v15, 16, v15
  v_mul_u32_u24 v4, 18, v15
  v_sub_u32 v14, v14, v4
  v_mul_u32_u24 v4, 9216, v15
  v_lshl_add_u32 v4, v14, 4, v4
  s_lshr_b32 s48, s46, 4
  s_add_u32 s48, s48, 192
  v_add_u32 v14, s48, v0
  v_mul_u32_u24 v15, 3641, v14
  v_lshrrev_b32 v15, 16, v15
  v_mul_u32_u24 v5, 18, v15
  v_sub_u32 v14, v14, v5
  v_mul_u32_u24 v5, 9216, v15
  v_lshl_add_u32 v5, v14, 4, v5
  s_lshr_b32 s48, s46, 4
  s_add_u32 s48, s48, 256
  v_add_u32 v14, s48, v0
  v_mul_u32_u24 v15, 3641, v14
  v_lshrrev_b32 v15, 16, v15
  v_mul_u32_u24 v6, 18, v15
  v_sub_u32 v14, v14, v6
  v_mul_u32_u24 v6, 9216, v15
  v_lshl_add_u32 v6, v14, 4, v6
  v_and_b32 v7, 15, v0
  v_lshlrev_b32 v7, 3, v7
  s_and_b32 s48, s2, 255
  s_lshl_b32 s48, s48, 7
  s_add_u32 s60, s10, 52477952
  s_addc_u32 s61, s11, 0
  s_add_u32 s60, s60, s48
  s_addc_u32 s61, s61, 0
  s_mov_b32 s62, 4
  s_mov_b32 s63, 0x20000
  s_cmp_lt_u32 s2, 256
  s_cbranch_scc1 k3_w2
  s_cmp_lg_u32 s3, 0
  s_cbranch_scc1 k3_w1
k3_w0:
  buffer_load_dword v13, v1, s[60:63], 0 offen sc1
  s_waitcnt vmcnt(0)
  v_cmp_ne_u32 vcc, 0, v13
  s_nop 1
  s_cbranch_vccz k3_w1
  s_sleep 3
  s_branch k3_w0
k3_w1:
  s_barrier
  s_mov_b32 s62, 0
k3_w2:
  s_cmp_lg_u32 s3, 0
  s_cselect_b32 s62, 0, s62
  v_mov_b32 v13, 0
  s_add_u32 m0, s46, 0
  s_nop 0
  buffer_load_dwordx4 v2, s[12:15], s44 offen lds
  s_add_u32 m0, s46, 1024
  s_nop 0
  buffer_load_dwordx4 v3, s[12:15], s44 offen lds
  s_add_u32 m0, s46, 2048
  s_nop 0
  buffer_load_dwordx4 v4, s[12:15], s44 offen lds
  s_add_u32 m0, s46, 3072
  s_nop 0
  buffer_load_dwordx4 v5, s[12:15], s44 offen lds
  s_add_u32 m0, s46, 4096
  s_nop 0
  s_mov_b32 exec_hi, 0
  buffer_load_dwordx4 v6, s[12:15], s44 offen lds
  s_mov_b32 exec_hi, -1
  s_add_u32 s44, s44, 589824
  buffer_load_dwordx4 v[188:191], v1, s[16:19], s45 offen offset:0
  buffer_load_dwordx4 v[192:195], v1, s[16:19], s45 offen offset:1024
  buffer_load_dwordx4 v[196:199], v1, s[16:19], s45 offen offset:2048
  buffer_load_dwordx4 v[200:203], v1, s[16:19], s45 offen offset:3072
  s_add_u32 s45, s45, 4096
  s_add_u32 m0, s46, 18432
  s_nop 0
  buffer_load_dwordx4 v2, s[12:15], s44 offen lds
  s_add_u32 m0, s46, 19456
  s_nop 0
  buffer_load_dwordx4 v3, s[12:15], s44 offen lds
  s_add_u32 m0, s46, 20480
  s_nop 0
  buffer_load_dwordx4 v4, s[12:15], s44 offen lds
  s_add_u32 m0, s46, 21504
  s_nop 0
  buffer_load_dwordx4 v5, s[12:15], s44 offen lds
  s_add_u32 m0, s46, 22528
  s_nop 0
  s_mov_b32 exec_hi, 0
  buffer_load_dwordx4 v6, s[12:15], s44 offen lds
  s_mov_b32 exec_hi, -1
  s_add_u32 s44, s44, 589824
  buffer_load_dwordx4 v[204:207], v1, s[16:19], s45 offen offset:0
  buffer_load_dwordx4 v[208:211], v1, s[16:19], s45 offen offset:1024
  buffer_load_dwordx4 v[212:215], v1, s[16:19], s45 offen offset:2048
  buffer_load_dwordx4 v[216:219], v1, s[16:19], s45 offen offset:3072
  s_add_u32 s45, s45, 4096
  v_lshrrev_b32 v14, 2, v0
  v_mul_u32_u24 v8, 288, v14
  v_and_b32 v14, 3, v0
  v_lshl_add_u32 v8, v14, 3, v8
  v_add_u32 v9, 55296, v8
  v_mov_b32 v20, 0
  v_mov_b32 v21, 0
  v_mov_b32 v22, 0
  v_mov_b32 v23, 0
  v_mov_b32 v24, 0
  v_mov_b32 v25, 0
  v_mov_b32 v26, 0
  v_mov_b32 v27, 0
  v_mov_b32 v28, 0
  v_mov_b32 v29, 0
  v_mov_b32 v30, 0
  v_mov_b32 v31, 0
  v_mov_b32 v32, 0
  v_mov_b32 v33, 0
  v_mov_b32 v34, 0
  v_mov_b32 v35, 0
  v_mov_b32 v36, 0
  v_mov_b32 v37, 0
  v_mov_b32 v38, 0
  v_mov_b32 v39, 0
  v_mov_b32 v40, 0
  v_mov_b32 v41, 0
  v_mov_b32 v42, 0
  v_mov_b32 v43, 0
  v_mov_b32 v44, 0
  v_mov_b32 v45, 0
  v_mov_b32 v46, 0
  v_mov_b32 v47, 0
  v_mov_b32 v48, 0
  v_mov_b32 v49, 0
  v_mov_b32 v50, 0
  v_mov_b32 v51, 0
  v_mov_b32 v52, 0
  v_mov_b32 v53, 0
  v_mov_b32 v54, 0
  v_mov_b32 v55, 0
  v_mov_b32 v56, 0
  v_mov_b32 v57, 0
  v_mov_b32 v58, 0
  v_mov_b32 v59, 0
  v_mov_b32 v60, 0
  v_mov_b32 v61, 0
  v_mov_b32 v62, 0
  v_mov_b32 v63, 0
  v_mov_b32 v64, 0
  v_mov_b32 v65, 0
  v_mov_b32 v66, 0
  v_mov_b32 v67, 0
  v_mov_b32 v68, 0
  v_mov_b32 v69, 0
  v_mov_b32 v70, 0
  v_mov_b32 v71, 0
  v_mov_b32 v72, 0
  v_mov_b32 v73, 0
  v_mov_b32 v74, 0
  v_mov_b32 v75, 0
  v_mov_b32 v76, 0
  v_mov_b32 v77, 0
  v_mov_b32 v78, 0
  v_mov_b32 v79, 0
  v_mov_b32 v80, 0
  v_mov_b32 v81, 0
  v_mov_b32 v82, 0
  v_mov_b32 v83, 0
  v_mov_b32 v84, 0
  v_mov_b32 v85, 0
  v_mov_b32 v86, 0
  v_mov_b32 v87, 0
  v_mov_b32 v88, 0
  v_mov_b32 v89, 0
  v_mov_b32 v90, 0
  v_mov_b32 v91, 0
  s_waitcnt vmcnt(9)
  s_barrier
  ds_read_b64_tr_b16 v[92:93], v8 offset:0
  ds_read_b64_tr_b16 v[94:95], v8 offset:4608
  ds_read_b64_tr_b16 v[96:97], v8 offset:32
  ds_read_b64_tr_b16 v[98:99], v8 offset:4640
  ds_read_b64_tr_b16 v[100:101], v8 offset:64
  ds_read_b64_tr_b16 v[102:103], v8 offset:4672
  ds_read_b64_tr_b16 v[104:105], v8 offset:96
  ds_read_b64_tr_b16 v[106:107], v8 offset:4704
  ds_read_b64_tr_b16 v[108:109], v8 offset:128
  ds_read_b64_tr_b16 v[110:111], v8 offset:4736
  ds_read_b64_tr_b16 v[112:113], v8 offset:160
  ds_read_b64_tr_b16 v[114:115], v8 offset:4768
  ds_read_b64_tr_b16 v[116:117], v8 offset:192
  ds_read_b64_tr_b16 v[118:119], v8 offset:4800
  ds_read_b64_tr_b16 v[120:121], v8 offset:224
  ds_read_b64_tr_b16 v[122:123], v8 offset:4832
  ds_read_b64_tr_b16 v[124:125], v8 offset:256
  ds_read_b64_tr_b16 v[126:127], v8 offset:4864
  s_add_u32 m0, s46, 36864
  s_nop 0
  buffer_load_dwordx4 v2, s[12:15], s44 offen lds
  s_add_u32 m0, s46, 37888
  s_nop 0
  buffer_load_dwordx4 v3, s[12:15], s44 offen lds
  s_add_u32 m0, s46, 38912
  s_nop 0
  buffer_load_dwordx4 v4, s[12:15], s44 offen lds
  s_add_u32 m0, s46, 39936
  s_nop 0
  buffer_load_dwordx4 v5, s[12:15], s44 offen lds
  s_add_u32 m0, s46, 40960
  s_nop 0
  s_mov_b32 exec_hi, 0
  buffer_load_dwordx4 v6, s[12:15], s44 offen lds
  s_mov_b32 exec_hi, -1
  s_add_u32 s44, s44, 589824
  s_waitcnt lgkmcnt(8)
  v_mfma_f32_16x16x32_bf16 v[20:23], v[92:95], v[188:191], v[20:23]
  ds_read_b64_tr_b16 v[128:129], v8 offset:9216
  ds_read_b64_tr_b16 v[130:131], v8 offset:13824
  buffer_load_dwordx4 v[220:223], v1, s[16:19], s45 offen offset:0
  v_mfma_f32_16x16x32_bf16 v[56:59], v[92:95], v[192:195], v[56:59]
  ds_read_b64_tr_b16 v[132:133], v8 offset:9248
  v_mfma_f32_16x16x32_bf16 v[24:27], v[96:99], v[188:191], v[24:27]
  ds_read_b64_tr_b16 v[134:135], v8 offset:13856
  v_mfma_f32_16x16x32_bf16 v[60:63], v[96:99], v[192:195], v[60:63]
  ds_read_b64_tr_b16 v[136:137], v8 offset:9280
  v_mfma_f32_16x16x32_bf16 v[28:31], v[100:103], v[188:191], v[28:31]
  ds_read_b64_tr_b16 v[138:139], v8 offset:13888
  buffer_load_dwordx4 v[224:227], v1, s[16:19], s45 offen offset:1024
  v_mfma_f32_16x16x32_bf16 v[64:67], v[100:103], v[192:195], v[64:67]
  ds_read_b64_tr_b16 v[140:141], v8 offset:9312
  v_mfma_f32_16x16x32_bf16 v[32:35], v[104:107], v[188:191], v[32:35]
  ds_read_b64_tr_b16 v[142:143], v8 offset:13920
  v_mfma_f32_16x16x32_bf16 v[68:71], v[104:107], v[192:195], v[68:71]
  ds_read_b64_tr_b16 v[144:145], v8 offset:9344
  v_mfma_f32_16x16x32_bf16 v[36:39], v[108:111], v[188:191], v[36:39]
  ds_read_b64_tr_b16 v[146:147], v8 offset:13952
  ds_read_b64_tr_b16 v[148:149], v8 offset:9376
  buffer_load_dwordx4 v[228:231], v1, s[16:19], s45 offen offset:2048
  v_mfma_f32_16x16x32_bf16 v[72:75], v[108:111], v[192:195], v[72:75]
  ds_read_b64_tr_b16 v[150:151], v8 offset:13984
  s_waitcnt lgkmcnt(12)
  v_mfma_f32_16x16x32_bf16 v[40:43], v[112:115], v[188:191], v[40:43]
  ds_read_b64_tr_b16 v[152:153], v8 offset:9408
  v_mfma_f32_16x16x32_bf16 v[76:79], v[112:115], v[192:195], v[76:79]
  ds_read_b64_tr_b16 v[154:155], v8 offset:14016
  v_mfma_f32_16x16x32_bf16 v[44:47], v[116:119], v[188:191], v[44:47]
  ds_read_b64_tr_b16 v[156:157], v8 offset:9440
  buffer_load_dwordx4 v[232:235], v1, s[16:19], s45 offen offset:3072
  s_add_u32 s45, s45, 4096
  v_mfma_f32_16x16x32_bf16 v[80:83], v[116:119], v[192:195], v[80:83]
  ds_read_b64_tr_b16 v[158:159], v8 offset:14048
  v_mfma_f32_16x16x32_bf16 v[48:51], v[120:123], v[188:191], v[48:51]
  ds_read_b64_tr_b16 v[160:161], v8 offset:9472
  v_mfma_f32_16x16x32_bf16 v[84:87], v[120:123], v[192:195], v[84:87]
  ds_read_b64_tr_b16 v[162:163], v8 offset:14080
  v_mfma_f32_16x16x32_bf16 v[52:55], v[124:127], v[188:191], v[52:55]
  v_mfma_f32_16x16x32_bf16 v[88:91], v[124:127], v[192:195], v[88:91]
  s_waitcnt vmcnt(9)
  s_barrier
  s_waitcnt lgkmcnt(8)
  s_add_u32 m0, s46, 55296
  v_mfma_f32_16x16x32_bf16 v[20:23], v[128:131], v[196:199], v[20:23]
  ds_read_b64_tr_b16 v[92:93], v8 offset:18432
  ds_read_b64_tr_b16 v[94:95], v8 offset:23040
  buffer_load_dwordx4 v2, s[12:15], s44 offen lds
  v_mfma_f32_16x16x32_bf16 v[56:59], v[128:131], v[200:203], v[56:59]
  ds_read_b64_tr_b16 v[96:97], v8 offset:18464
  v_mfma_f32_16x16x32_bf16 v[24:27], v[132:135], v[196:199], v[24:27]
  ds_read_b64_tr_b16 v[98:99], v8 offset:23072
  s_add_u32 m0, s46, 56320
  v_mfma_f32_16x16x32_bf16 v[60:63], v[132:135], v[200:203], v[60:63]
  ds_read_b64_tr_b16 v[100:101], v8 offset:18496
  buffer_load_dwordx4 v3, s[12:15], s44 offen lds
  v_mfma_f32_16x16x32_bf16 v[28:31], v[136:139], v[196:199], v[28:31]
  ds_read_b64_tr_b16 v[102:103], v8 offset:23104
  v_mfma_f32_16x16x32_bf16 v[64:67], v[136:139], v[200:203], v[64:67]
  ds_read_b64_tr_b16 v[104:105], v8 offset:18528
  s_add_u32 m0, s46, 57344
  v_mfma_f32_16x16x32_bf16 v[32:35], v[140:143], v[196:199], v[32:35]
  ds_read_b64_tr_b16 v[106:107], v8 offset:23136
  buffer_load_dwordx4 v4, s[12:15], s44 offen lds
  v_mfma_f32_16x16x32_bf16 v[68:71], v[140:143], v[200:203], v[68:71]
  ds_read_b64_tr_b16 v[108:109], v8 offset:18560
  v_mfma_f32_16x16x32_bf16 v[36:39], v[144:147], v[196:199], v[36:39]
  ds_read_b64_tr_b16 v[110:111], v8 offset:23168
  ds_read_b64_tr_b16 v[112:113], v8 offset:18592
  s_add_u32 m0, s46, 58368
  v_mfma_f32_16x16x32_bf16 v[72:75], v[144:147], v[200:203], v[72:75]
  ds_read_b64_tr_b16 v[114:115], v8 offset:23200
  buffer_load_dwordx4 v5, s[12:15], s44 offen lds
  s_waitcnt lgkmcnt(12)
  v_mfma_f32_16x16x32_bf16 v[40:43], v[148:151], v[196:199], v[40:43]
  ds_read_b64_tr_b16 v[116:117], v8 offset:18624
  v_mfma_f32_16x16x32_bf16 v[76:79], v[148:151], v[200:203], v[76:79]
  ds_read_b64_tr_b16 v[118:119], v8 offset:23232
  s_add_u32 m0, s46, 59392
  v_mfma_f32_16x16x32_bf16 v[44:47], v[152:155], v[196:199], v[44:47]
  ds_read_b64_tr_b16 v[120:121], v8 offset:18656
  s_mov_b32 exec_hi, 0
  buffer_load_dwordx4 v6, s[12:15], s44 offen lds
  s_mov_b32 exec_hi, -1
  s_add_u32 s44, s44, 589824
  v_mfma_f32_16x16x32_bf16 v[80:83], v[152:155], v[200:203], v[80:83]
  ds_read_b64_tr_b16 v[122:123], v8 offset:23264
  v_mfma_f32_16x16x32_bf16 v[48:51], v[156:159], v[196:199], v[48:51]
  ds_read_b64_tr_b16 v[124:125], v8 offset:18688
  v_mfma_f32_16x16x32_bf16 v[84:87], v[156:159], v[200:203], v[84:87]
  ds_read_b64_tr_b16 v[126:127], v8 offset:23296
  v_mfma_f32_16x16x32_bf16 v[52:55], v[160:163], v[196:199], v[52:55]
  v_mfma_f32_16x16x32_bf16 v[88:91], v[160:163], v[200:203], v[88:91]
  s_waitcnt lgkmcnt(8)
  v_mfma_f32_16x16x32_bf16 v[20:23], v[92:95], v[204:207], v[20:23]
  ds_read_b64_tr_b16 v[128:129], v8 offset:27648
  ds_read_b64_tr_b16 v[130:131], v8 offset:32256
  buffer_load_dwordx4 v[236:239], v1, s[16:19], s45 offen offset:0
  v_mfma_f32_16x16x32_bf16 v[56:59], v[92:95], v[208:211], v[56:59]
  ds_read_b64_tr_b16 v[132:133], v8 offset:27680
  v_mfma_f32_16x16x32_bf16 v[24:27], v[96:99], v[204:207], v[24:27]
  ds_read_b64_tr_b16 v[134:135], v8 offset:32288
  v_mfma_f32_16x16x32_bf16 v[60:63], v[96:99], v[208:211], v[60:63]
  ds_read_b64_tr_b16 v[136:137], v8 offset:27712
  v_mfma_f32_16x16x32_bf16 v[28:31], v[100:103], v[204:207], v[28:31]
  ds_read_b64_tr_b16 v[138:139], v8 offset:32320
  buffer_load_dwordx4 v[240:243], v1, s[16:19], s45 offen offset:1024
  v_mfma_f32_16x16x32_bf16 v[64:67], v[100:103], v[208:211], v[64:67]
  ds_read_b64_tr_b16 v[140:141], v8 offset:27744
  v_mfma_f32_16x16x32_bf16 v[32:35], v[104:107], v[204:207], v[32:35]
  ds_read_b64_tr_b16 v[142:143], v8 offset:32352
  v_mfma_f32_16x16x32_bf16 v[68:71], v[104:107], v[208:211], v[68:71]
  ds_read_b64_tr_b16 v[144:145], v8 offset:27776
  v_mfma_f32_16x16x32_bf16 v[36:39], v[108:111], v[204:207], v[36:39]
  ds_read_b64_tr_b16 v[146:147], v8 offset:32384
  ds_read_b64_tr_b16 v[148:149], v8 offset:27808
  buffer_load_dwordx4 v[244:247], v1, s[16:19], s45 offen offset:2048
  v_mfma_f32_16x16x32_bf16 v[72:75], v[108:111], v[208:211], v[72:75]
  ds_read_b64_tr_b16 v[150:151], v8 offset:32416
  s_waitcnt lgkmcnt(12)
  v_mfma_f32_16x16x32_bf16 v[40:43], v[112:115], v[204:207], v[40:43]
  ds_read_b64_tr_b16 v[152:153], v8 offset:27840
  v_mfma_f32_16x16x32_bf16 v[76:79], v[112:115], v[208:211], v[76:79]
  ds_read_b64_tr_b16 v[154:155], v8 offset:32448
  v_mfma_f32_16x16x32_bf16 v[44:47], v[116:119], v[204:207], v[44:47]
  ds_read_b64_tr_b16 v[156:157], v8 offset:27872
  buffer_load_dwordx4 v[248:251], v1, s[16:19], s45 offen offset:3072
  s_add_u32 s45, s45, 4096
  v_mfma_f32_16x16x32_bf16 v[80:83], v[116:119], v[208:211], v[80:83]
  ds_read_b64_tr_b16 v[158:159], v8 offset:32480
  v_mfma_f32_16x16x32_bf16 v[48:51], v[120:123], v[204:207], v[48:51]
  ds_read_b64_tr_b16 v[160:161], v8 offset:27904
  v_mfma_f32_16x16x32_bf16 v[84:87], v[120:123], v[208:211], v[84:87]
  ds_read_b64_tr_b16 v[162:163], v8 offset:32512
  v_mfma_f32_16x16x32_bf16 v[52:55], v[124:127], v[204:207], v[52:55]
  v_mfma_f32_16x16x32_bf16 v[88:91], v[124:127], v[208:211], v[88:91]
  s_waitcnt vmcnt(9)
  s_barrier
  s_waitcnt lgkmcnt(8)
  s_add_u32 m0, s46, 0
  v_mfma_f32_16x16x32_bf16 v[20:23], v[128:131], v[212:215], v[20:23]
  ds_read_b64_tr_b16 v[92:93], v8 offset:36864
  ds_read_b64_tr_b16 v[94:95], v8 offset:41472
  buffer_load_dwordx4 v2, s[12:15], s44 offen lds
  v_mfma_f32_16x16x32_bf16 v[56:59], v[128:131], v[216:219], v[56:59]
  ds_read_b64_tr_b16 v[96:97], v8 offset:36896
  v_mfma_f32_16x16x32_bf16 v[24:27], v[132:135], v[212:215], v[24:27]
  ds_read_b64_tr_b16 v[98:99], v8 offset:41504
  s_add_u32 m0, s46, 1024
  v_mfma_f32_16x16x32_bf16 v[60:63], v[132:135], v[216:219], v[60:63]
  ds_read_b64_tr_b16 v[100:101], v8 offset:36928
  buffer_load_dwordx4 v3, s[12:15], s44 offen lds
  v_mfma_f32_16x16x32_bf16 v[28:31], v[136:139], v[212:215], v[28:31]
  ds_read_b64_tr_b16 v[102:103], v8 offset:41536
  v_mfma_f32_16x16x32_bf16 v[64:67], v[136:139], v[216:219], v[64:67]
  ds_read_b64_tr_b16 v[104:105], v8 offset:36960
  s_add_u32 m0, s46, 2048
  v_mfma_f32_16x16x32_bf16 v[32:35], v[140:143], v[212:215], v[32:35]
  ds_read_b64_tr_b16 v[106:107], v8 offset:41568
  buffer_load_dwordx4 v4, s[12:15], s44 offen lds
  v_mfma_f32_16x16x32_bf16 v[68:71], v[140:143], v[216:219], v[68:71]
  ds_read_b64_tr_b16 v[108:109], v8 offset:36992
  v_mfma_f32_16x16x32_bf16 v[36:39], v[144:147], v[212:215], v[36:39]
  ds_read_b64_tr_b16 v[110:111], v8 offset:41600
  ds_read_b64_tr_b16 v[112:113], v8 offset:37024
  s_add_u32 m0, s46, 3072
  v_mfma_f32_16x16x32_bf16 v[72:75], v[144:147], v[216:219], v[72:75]
  ds_read_b64_tr_b16 v[114:115], v8 offset:41632
  buffer_load_dwordx4 v5, s[12:15], s44 offen lds
  s_waitcnt lgkmcnt(12)
  v_mfma_f32_16x16x32_bf16 v[40:43], v[148:151], v[212:215], v[40:43]
  ds_read_b64_tr_b16 v[116:117], v8 offset:37056
  v_mfma_f32_16x16x32_bf16 v[76:79], v[148:151], v[216:219], v[76:79]
  ds_read_b64_tr_b16 v[118:119], v8 offset:41664
  s_add_u32 m0, s46, 4096
  v_mfma_f32_16x16x32_bf16 v[44:47], v[152:155], v[212:215], v[44:47]
  ds_read_b64_tr_b16 v[120:121], v8 offset:37088
  s_mov_b32 exec_hi, 0
  buffer_load_dwordx4 v6, s[12:15], s44 offen lds
  s_mov_b32 exec_hi, -1
  s_add_u32 s44, s44, 589824
  v_mfma_f32_16x16x32_bf16 v[80:83], v[152:155], v[216:219], v[80:83]
  ds_read_b64_tr_b16 v[122:123], v8 offset:41696
  v_mfma_f32_16x16x32_bf16 v[48:51], v[156:159], v[212:215], v[48:51]
  ds_read_b64_tr_b16 v[124:125], v8 offset:37120
  v_mfma_f32_16x16x32_bf16 v[84:87], v[156:159], v[216:219], v[84:87]
  ds_read_b64_tr_b16 v[126:127], v8 offset:41728
  v_mfma_f32_16x16x32_bf16 v[52:55], v[160:163], v[212:215], v[52:55]
  v_mfma_f32_16x16x32_bf16 v[88:91], v[160:163], v[216:219], v[88:91]
  s_waitcnt lgkmcnt(8)
  v_mfma_f32_16x16x32_bf16 v[20:23], v[92:95], v[220:223], v[20:23]
  ds_read_b64_tr_b16 v[128:129], v8 offset:46080
  ds_read_b64_tr_b16 v[130:131], v8 offset:50688
  buffer_load_dwordx4 v[188:191], v1, s[16:19], s45 offen offset:0
  v_mfma_f32_16x16x32_bf16 v[56:59], v[92:95], v[224:227], v[56:59]
  ds_read_b64_tr_b16 v[132:133], v8 offset:46112
  v_mfma_f32_16x16x32_bf16 v[24:27], v[96:99], v[220:223], v[24:27]
  ds_read_b64_tr_b16 v[134:135], v8 offset:50720
  v_mfma_f32_16x16x32_bf16 v[60:63], v[96:99], v[224:227], v[60:63]
  ds_read_b64_tr_b16 v[136:137], v8 offset:46144
  v_mfma_f32_16x16x32_bf16 v[28:31], v[100:103], v[220:223], v[28:31]
  ds_read_b64_tr_b16 v[138:139], v8 offset:50752
  buffer_load_dwordx4 v[192:195], v1, s[16:19], s45 offen offset:1024
  v_mfma_f32_16x16x32_bf16 v[64:67], v[100:103], v[224:227], v[64:67]
  ds_read_b64_tr_b16 v[140:141], v8 offset:46176
  v_mfma_f32_16x16x32_bf16 v[32:35], v[104:107], v[220:223], v[32:35]
  ds_read_b64_tr_b16 v[142:143], v8 offset:50784
  v_mfma_f32_16x16x32_bf16 v[68:71], v[104:107], v[224:227], v[68:71]
  ds_read_b64_tr_b16 v[144:145], v8 offset:46208
  v_mfma_f32_16x16x32_bf16 v[36:39], v[108:111], v[220:223], v[36:39]
  ds_read_b64_tr_b16 v[146:147], v8 offset:50816
  ds_read_b64_tr_b16 v[148:149], v8 offset:46240
  buffer_load_dwordx4 v[196:199], v1, s[16:19], s45 offen offset:2048
  v_mfma_f32_16x16x32_bf16 v[72:75], v[108:111], v[224:227], v[72:75]
  ds_read_b64_tr_b16 v[150:151], v8 offset:50848
  s_waitcnt lgkmcnt(12)
  v_mfma_f32_16x16x32_bf16 v[40:43], v[112:115], v[220:223], v[40:43]
  ds_read_b64_tr_b16 v[152:153], v8 offset:46272
  v_mfma_f32_16x16x32_bf16 v[76:79], v[112:115], v[224:227], v[76:79]
  ds_read_b64_tr_b16 v[154:155], v8 offset:50880
  v_mfma_f32_16x16x32_bf16 v[44:47], v[116:119], v[220:223], v[44:47]
  ds_read_b64_tr_b16 v[156:157], v8 offset:46304
  buffer_load_dwordx4 v[200:203], v1, s[16:19], s45 offen offset:3072
  s_add_u32 s45, s45, 4096
  v_mfma_f32_16x16x32_bf16 v[80:83], v[116:119], v[224:227], v[80:83]
  ds_read_b64_tr_b16 v[158:159], v8 offset:50912
  v_mfma_f32_16x16x32_bf16 v[48:51], v[120:123], v[220:223], v[48:51]
  ds_read_b64_tr_b16 v[160:161], v8 offset:46336
  v_mfma_f32_16x16x32_bf16 v[84:87], v[120:123], v[224:227], v[84:87]
  ds_read_b64_tr_b16 v[162:163], v8 offset:50944
  v_mfma_f32_16x16x32_bf16 v[52:55], v[124:127], v[220:223], v[52:55]
  v_mfma_f32_16x16x32_bf16 v[88:91], v[124:127], v[224:227], v[88:91]
  s_waitcnt vmcnt(9)
  s_barrier
  s_waitcnt lgkmcnt(8)
  s_add_u32 m0, s46, 18432
  v_mfma_f32_16x16x32_bf16 v[20:23], v[128:131], v[228:231], v[20:23]
  ds_read_b64_tr_b16 v[92:93], v9 offset:0
  ds_read_b64_tr_b16 v[94:95], v9 offset:4608
  buffer_load_dwordx4 v2, s[12:15], s44 offen lds
  v_mfma_f32_16x16x32_bf16 v[56:59], v[128:131], v[232:235], v[56:59]
  ds_read_b64_tr_b16 v[96:97], v9 offset:32
  v_mfma_f32_16x16x32_bf16 v[24:27], v[132:135], v[228:231], v[24:27]
  ds_read_b64_tr_b16 v[98:99], v9 offset:4640
  s_add_u32 m0, s46, 19456
  v_mfma_f32_16x16x32_bf16 v[60:63], v[132:135], v[232:235], v[60:63]
  ds_read_b64_tr_b16 v[100:101], v9 offset:64
  buffer_load_dwordx4 v3, s[12:15], s44 offen lds
  v_mfma_f32_16x16x32_bf16 v[28:31], v[136:139], v[228:231], v[28:31]
  ds_read_b64_tr_b16 v[102:103], v9 offset:4672
  v_mfma_f32_16x16x32_bf16 v[64:67], v[136:139], v[232:235], v[64:67]
  ds_read_b64_tr_b16 v[104:105], v9 offset:96
  s_add_u32 m0, s46, 20480
  v_mfma_f32_16x16x32_bf16 v[32:35], v[140:143], v[228:231], v[32:35]
  ds_read_b64_tr_b16 v[106:107], v9 offset:4704
  buffer_load_dwordx4 v4, s[12:15], s44 offen lds
  v_mfma_f32_16x16x32_bf16 v[68:71], v[140:143], v[232:235], v[68:71]
  ds_read_b64_tr_b16 v[108:109], v9 offset:128
  v_mfma_f32_16x16x32_bf16 v[36:39], v[144:147], v[228:231], v[36:39]
  ds_read_b64_tr_b16 v[110:111], v9 offset:4736
  ds_read_b64_tr_b16 v[112:113], v9 offset:160
  s_add_u32 m0, s46, 21504
  v_mfma_f32_16x16x32_bf16 v[72:75], v[144:147], v[232:235], v[72:75]
  ds_read_b64_tr_b16 v[114:115], v9 offset:4768
  buffer_load_dwordx4 v5, s[12:15], s44 offen lds
  s_waitcnt lgkmcnt(12)
  v_mfma_f32_16x16x32_bf16 v[40:43], v[148:151], v[228:231], v[40:43]
  ds_read_b64_tr_b16 v[116:117], v9 offset:192
  v_mfma_f32_16x16x32_bf16 v[76:79], v[148:151], v[232:235], v[76:79]
  ds_read_b64_tr_b16 v[118:119], v9 offset:4800
  s_add_u32 m0, s46, 22528
  v_mfma_f32_16x16x32_bf16 v[44:47], v[152:155], v[228:231], v[44:47]
  ds_read_b64_tr_b16 v[120:121], v9 offset:224
  s_mov_b32 exec_hi, 0
  buffer_load_dwordx4 v6, s[12:15], s44 offen lds
  s_mov_b32 exec_hi, -1
  s_add_u32 s44, s44, 589824
  v_mfma_f32_16x16x32_bf16 v[80:83], v[152:155], v[232:235], v[80:83]
  ds_read_b64_tr_b16 v[122:123], v9 offset:4832
  v_mfma_f32_16x16x32_bf16 v[48:51], v[156:159], v[228:231], v[48:51]
  ds_read_b64_tr_b16 v[124:125], v9 offset:256
  v_mfma_f32_16x16x32_bf16 v[84:87], v[156:159], v[232:235], v[84:87]
  ds_read_b64_tr_b16 v[126:127], v9 offset:4864
  v_mfma_f32_16x16x32_bf16 v[52:55], v[160:163], v[228:231], v[52:55]
  v_mfma_f32_16x16x32_bf16 v[88:91], v[160:163], v[232:235], v[88:91]
  s_waitcnt lgkmcnt(8)
  v_mfma_f32_16x16x32_bf16 v[20:23], v[92:95], v[236:239], v[20:23]
  ds_read_b64_tr_b16 v[128:129], v9 offset:9216
  ds_read_b64_tr_b16 v[130:131], v9 offset:13824
  buffer_load_dwordx4 v[204:207], v1, s[16:19], s45 offen offset:0
  v_mfma_f32_16x16x32_bf16 v[56:59], v[92:95], v[240:243], v[56:59]
  ds_read_b64_tr_b16 v[132:133], v9 offset:9248
  v_mfma_f32_16x16x32_bf16 v[24:27], v[96:99], v[236:239], v[24:27]
  ds_read_b64_tr_b16 v[134:135], v9 offset:13856
  v_mfma_f32_16x16x32_bf16 v[60:63], v[96:99], v[240:243], v[60:63]
  ds_read_b64_tr_b16 v[136:137], v9 offset:9280
  v_mfma_f32_16x16x32_bf16 v[28:31], v[100:103], v[236:239], v[28:31]
  ds_read_b64_tr_b16 v[138:139], v9 offset:13888
  buffer_load_dwordx4 v[208:211], v1, s[16:19], s45 offen offset:1024
  v_mfma_f32_16x16x32_bf16 v[64:67], v[100:103], v[240:243], v[64:67]
  ds_read_b64_tr_b16 v[140:141], v9 offset:9312
  v_mfma_f32_16x16x32_bf16 v[32:35], v[104:107], v[236:239], v[32:35]
  ds_read_b64_tr_b16 v[142:143], v9 offset:13920
  v_mfma_f32_16x16x32_bf16 v[68:71], v[104:107], v[240:243], v[68:71]
  ds_read_b64_tr_b16 v[144:145], v9 offset:9344
  v_mfma_f32_16x16x32_bf16 v[36:39], v[108:111], v[236:239], v[36:39]
  ds_read_b64_tr_b16 v[146:147], v9 offset:13952
  ds_read_b64_tr_b16 v[148:149], v9 offset:9376
  buffer_load_dwordx4 v[212:215], v1, s[16:19], s45 offen offset:2048
  v_mfma_f32_16x16x32_bf16 v[72:75], v[108:111], v[240:243], v[72:75]
  ds_read_b64_tr_b16 v[150:151], v9 offset:13984
  s_waitcnt lgkmcnt(12)
  v_mfma_f32_16x16x32_bf16 v[40:43], v[112:115], v[236:239], v[40:43]
  ds_read_b64_tr_b16 v[152:153], v9 offset:9408
  v_mfma_f32_16x16x32_bf16 v[76:79], v[112:115], v[240:243], v[76:79]
  ds_read_b64_tr_b16 v[154:155], v9 offset:14016
  v_mfma_f32_16x16x32_bf16 v[44:47], v[116:119], v[236:239], v[44:47]
  ds_read_b64_tr_b16 v[156:157], v9 offset:9440
  buffer_load_dwordx4 v[216:219], v1, s[16:19], s45 offen offset:3072
  s_add_u32 s45, s45, 4096
  v_mfma_f32_16x16x32_bf16 v[80:83], v[116:119], v[240:243], v[80:83]
  ds_read_b64_tr_b16 v[158:159], v9 offset:14048
  v_mfma_f32_16x16x32_bf16 v[48:51], v[120:123], v[236:239], v[48:51]
  ds_read_b64_tr_b16 v[160:161], v9 offset:9472
  v_mfma_f32_16x16x32_bf16 v[84:87], v[120:123], v[240:243], v[84:87]
  ds_read_b64_tr_b16 v[162:163], v9 offset:14080
  v_mfma_f32_16x16x32_bf16 v[52:55], v[124:127], v[236:239], v[52:55]
  v_mfma_f32_16x16x32_bf16 v[88:91], v[124:127], v[240:243], v[88:91]
  s_waitcnt vmcnt(9)
  s_barrier
  s_waitcnt lgkmcnt(8)
  s_add_u32 m0, s46, 36864
  v_mfma_f32_16x16x32_bf16 v[20:23], v[128:131], v[244:247], v[20:23]
  ds_read_b64_tr_b16 v[92:93], v8 offset:0
  ds_read_b64_tr_b16 v[94:95], v8 offset:4608
  buffer_load_dwordx4 v2, s[12:15], s44 offen lds
  v_mfma_f32_16x16x32_bf16 v[56:59], v[128:131], v[248:251], v[56:59]
  ds_read_b64_tr_b16 v[96:97], v8 offset:32
  v_mfma_f32_16x16x32_bf16 v[24:27], v[132:135], v[244:247], v[24:27]
  ds_read_b64_tr_b16 v[98:99], v8 offset:4640
  s_add_u32 m0, s46, 37888
  v_mfma_f32_16x16x32_bf16 v[60:63], v[132:135], v[248:251], v[60:63]
  ds_read_b64_tr_b16 v[100:101], v8 offset:64
  buffer_load_dwordx4 v3, s[12:15], s44 offen lds
  v_mfma_f32_16x16x32_bf16 v[28:31], v[136:139], v[244:247], v[28:31]
  ds_read_b64_tr_b16 v[102:103], v8 offset:4672
  v_mfma_f32_16x16x32_bf16 v[64:67], v[136:139], v[248:251], v[64:67]
  ds_read_b64_tr_b16 v[104:105], v8 offset:96
  s_add_u32 m0, s46, 38912
  v_mfma_f32_16x16x32_bf16 v[32:35], v[140:143], v[244:247], v[32:35]
  ds_read_b64_tr_b16 v[106:107], v8 offset:4704
  buffer_load_dwordx4 v4, s[12:15], s44 offen lds
  v_mfma_f32_16x16x32_bf16 v[68:71], v[140:143], v[248:251], v[68:71]
  ds_read_b64_tr_b16 v[108:109], v8 offset:128
  v_mfma_f32_16x16x32_bf16 v[36:39], v[144:147], v[244:247], v[36:39]
  ds_read_b64_tr_b16 v[110:111], v8 offset:4736
  ds_read_b64_tr_b16 v[112:113], v8 offset:160
  s_add_u32 m0, s46, 39936
  v_mfma_f32_16x16x32_bf16 v[72:75], v[144:147], v[248:251], v[72:75]
  ds_read_b64_tr_b16 v[114:115], v8 offset:4768
  buffer_load_dwordx4 v5, s[12:15], s44 offen lds
  s_waitcnt lgkmcnt(12)
  v_mfma_f32_16x16x32_bf16 v[40:43], v[148:151], v[244:247], v[40:43]
  ds_read_b64_tr_b16 v[116:117], v8 offset:192
  v_mfma_f32_16x16x32_bf16 v[76:79], v[148:151], v[248:251], v[76:79]
  ds_read_b64_tr_b16 v[118:119], v8 offset:4800
  s_add_u32 m0, s46, 40960
  v_mfma_f32_16x16x32_bf16 v[44:47], v[152:155], v[244:247], v[44:47]
  ds_read_b64_tr_b16 v[120:121], v8 offset:224
  s_mov_b32 exec_hi, 0
  buffer_load_dwordx4 v6, s[12:15], s44 offen lds
  s_mov_b32 exec_hi, -1
  s_add_u32 s44, s44, 589824
  v_mfma_f32_16x16x32_bf16 v[80:83], v[152:155], v[248:251], v[80:83]
  ds_read_b64_tr_b16 v[122:123], v8 offset:4832
  v_mfma_f32_16x16x32_bf16 v[48:51], v[156:159], v[244:247], v[48:51]
  ds_read_b64_tr_b16 v[124:125], v8 offset:256
  v_mfma_f32_16x16x32_bf16 v[84:87], v[156:159], v[248:251], v[84:87]
  ds_read_b64_tr_b16 v[126:127], v8 offset:4864
  v_mfma_f32_16x16x32_bf16 v[52:55], v[160:163], v[244:247], v[52:55]
  v_mfma_f32_16x16x32_bf16 v[88:91], v[160:163], v[248:251], v[88:91]
  s_waitcnt lgkmcnt(8)
  v_mfma_f32_16x16x32_bf16 v[20:23], v[92:95], v[188:191], v[20:23]
  ds_read_b64_tr_b16 v[128:129], v8 offset:9216
  ds_read_b64_tr_b16 v[130:131], v8 offset:13824
  buffer_load_dwordx4 v[220:223], v1, s[16:19], s45 offen offset:0
  v_mfma_f32_16x16x32_bf16 v[56:59], v[92:95], v[192:195], v[56:59]
  ds_read_b64_tr_b16 v[132:133], v8 offset:9248
  v_mfma_f32_16x16x32_bf16 v[24:27], v[96:99], v[188:191], v[24:27]
  ds_read_b64_tr_b16 v[134:135], v8 offset:13856
  v_mfma_f32_16x16x32_bf16 v[60:63], v[96:99], v[192:195], v[60:63]
  ds_read_b64_tr_b16 v[136:137], v8 offset:9280
  buffer_load_dwordx4 v[224:227], v1, s[16:19], s45 offen offset:1024
  v_mfma_f32_16x16x32_bf16 v[28:31], v[100:103], v[188:191], v[28:31]
  ds_read_b64_tr_b16 v[138:139], v8 offset:13888
  v_mfma_f32_16x16x32_bf16 v[64:67], v[100:103], v[192:195], v[64:67]
  ds_read_b64_tr_b16 v[140:141], v8 offset:9312
  v_mfma_f32_16x16x32_bf16 v[32:35], v[104:107], v[188:191], v[32:35]
  ds_read_b64_tr_b16 v[142:143], v8 offset:13920
  buffer_load_dwordx4 v[228:231], v1, s[16:19], s45 offen offset:2048
  v_mfma_f32_16x16x32_bf16 v[68:71], v[104:107], v[192:195], v[68:71]
  ds_read_b64_tr_b16 v[144:145], v8 offset:9344
  v_mfma_f32_16x16x32_bf16 v[36:39], v[108:111], v[188:191], v[36:39]
  ds_read_b64_tr_b16 v[146:147], v8 offset:13952
  ds_read_b64_tr_b16 v[148:149], v8 offset:9376
  v_mfma_f32_16x16x32_bf16 v[72:75], v[108:111], v[192:195], v[72:75]
  ds_read_b64_tr_b16 v[150:151], v8 offset:13984
  buffer_load_dwordx4 v[232:235], v1, s[16:19], s45 offen offset:3072
  s_add_u32 s45, s45, 4096
  s_waitcnt lgkmcnt(12)
  v_mfma_f32_16x16x32_bf16 v[40:43], v[112:115], v[188:191], v[40:43]
  ds_read_b64_tr_b16 v[152:153], v8 offset:9408
  v_mfma_f32_16x16x32_bf16 v[76:79], v[112:115], v[192:195], v[76:79]
  ds_read_b64_tr_b16 v[154:155], v8 offset:14016
  v_mfma_f32_16x16x32_bf16 v[44:47], v[116:119], v[188:191], v[44:47]
  ds_read_b64_tr_b16 v[156:157], v8 offset:9440
  buffer_store_dword v13, v1, s[60:63], 0 offen sc1
  v_mfma_f32_16x16x32_bf16 v[80:83], v[116:119], v[192:195], v[80:83]
  ds_read_b64_tr_b16 v[158:159], v8 offset:14048
  v_mfma_f32_16x16x32_bf16 v[48:51], v[120:123], v[188:191], v[48:51]
  ds_read_b64_tr_b16 v[160:161], v8 offset:9472
  v_mfma_f32_16x16x32_bf16 v[84:87], v[120:123], v[192:195], v[84:87]
  ds_read_b64_tr_b16 v[162:163], v8 offset:14080
  v_mfma_f32_16x16x32_bf16 v[52:55], v[124:127], v[188:191], v[52:55]
  v_mfma_f32_16x16x32_bf16 v[88:91], v[124:127], v[192:195], v[88:91]
  s_waitcnt vmcnt(10)
  s_barrier
  s_waitcnt lgkmcnt(8)
  s_add_u32 m0, s46, 55296
  v_mfma_f32_16x16x32_bf16 v[20:23], v[128:131], v[196:199], v[20:23]
  ds_read_b64_tr_b16 v[92:93], v8 offset:18432
  ds_read_b64_tr_b16 v[94:95], v8 offset:23040
  buffer_load_dwordx4 v2, s[12:15], s44 offen lds
  v_mfma_f32_16x16x32_bf16 v[56:59], v[128:131], v[200:203], v[56:59]
  ds_read_b64_tr_b16 v[96:97], v8 offset:18464
  v_mfma_f32_16x16x32_bf16 v[24:27], v[132:135], v[196:199], v[24:27]
  ds_read_b64_tr_b16 v[98:99], v8 offset:23072
  s_add_u32 m0, s46, 56320
  v_mfma_f32_16x16x32_bf16 v[60:63], v[132:135], v[200:203], v[60:63]
  ds_read_b64_tr_b16 v[100:101], v8 offset:18496
  buffer_load_dwordx4 v3, s[12:15], s44 offen lds
  v_mfma_f32_16x16x32_bf16 v[28:31], v[136:139], v[196:199], v[28:31]
  ds_read_b64_tr_b16 v[102:103], v8 offset:23104
  v_mfma_f32_16x16x32_bf16 v[64:67], v[136:139], v[200:203], v[64:67]
  ds_read_b64_tr_b16 v[104:105], v8 offset:18528
  s_add_u32 m0, s46, 57344
  v_mfma_f32_16x16x32_bf16 v[32:35], v[140:143], v[196:199], v[32:35]
  ds_read_b64_tr_b16 v[106:107], v8 offset:23136
  buffer_load_dwordx4 v4, s[12:15], s44 offen lds
  v_mfma_f32_16x16x32_bf16 v[68:71], v[140:143], v[200:203], v[68:71]
  ds_read_b64_tr_b16 v[108:109], v8 offset:18560
  v_mfma_f32_16x16x32_bf16 v[36:39], v[144:147], v[196:199], v[36:39]
  ds_read_b64_tr_b16 v[110:111], v8 offset:23168
  ds_read_b64_tr_b16 v[112:113], v8 offset:18592
  s_add_u32 m0, s46, 58368
  v_mfma_f32_16x16x32_bf16 v[72:75], v[144:147], v[200:203], v[72:75]
  ds_read_b64_tr_b16 v[114:115], v8 offset:23200
  buffer_load_dwordx4 v5, s[12:15], s44 offen lds
  s_waitcnt lgkmcnt(12)
  v_mfma_f32_16x16x32_bf16 v[40:43], v[148:151], v[196:199], v[40:43]
  ds_read_b64_tr_b16 v[116:117], v8 offset:18624
  v_mfma_f32_16x16x32_bf16 v[76:79], v[148:151], v[200:203], v[76:79]
  ds_read_b64_tr_b16 v[118:119], v8 offset:23232
  s_add_u32 m0, s46, 59392
  v_mfma_f32_16x16x32_bf16 v[44:47], v[152:155], v[196:199], v[44:47]
  ds_read_b64_tr_b16 v[120:121], v8 offset:18656
  s_mov_b32 exec_hi, 0
  buffer_load_dwordx4 v6, s[12:15], s44 offen lds
  s_mov_b32 exec_hi, -1
  s_add_u32 s44, s44, 589824
  v_mfma_f32_16x16x32_bf16 v[80:83], v[152:155], v[200:203], v[80:83]
  ds_read_b64_tr_b16 v[122:123], v8 offset:23264
  v_mfma_f32_16x16x32_bf16 v[48:51], v[156:159], v[196:199], v[48:51]
  ds_read_b64_tr_b16 v[124:125], v8 offset:18688
  v_mfma_f32_16x16x32_bf16 v[84:87], v[156:159], v[200:203], v[84:87]
  ds_read_b64_tr_b16 v[126:127], v8 offset:23296
  v_mfma_f32_16x16x32_bf16 v[52:55], v[160:163], v[196:199], v[52:55]
  v_mfma_f32_16x16x32_bf16 v[88:91], v[160:163], v[200:203], v[88:91]
  s_waitcnt lgkmcnt(8)
  v_mfma_f32_16x16x32_bf16 v[20:23], v[92:95], v[204:207], v[20:23]
  ds_read_b64_tr_b16 v[128:129], v8 offset:27648
  ds_read_b64_tr_b16 v[130:131], v8 offset:32256
  buffer_load_dwordx4 v[236:239], v1, s[16:19], s45 offen offset:0
  v_mfma_f32_16x16x32_bf16 v[56:59], v[92:95], v[208:211], v[56:59]
  ds_read_b64_tr_b16 v[132:133], v8 offset:27680
  v_mfma_f32_16x16x32_bf16 v[24:27], v[96:99], v[204:207], v[24:27]
  ds_read_b64_tr_b16 v[134:135], v8 offset:32288
  v_mfma_f32_16x16x32_bf16 v[60:63], v[96:99], v[208:211], v[60:63]
  ds_read_b64_tr_b16 v[136:137], v8 offset:27712
  v_mfma_f32_16x16x32_bf16 v[28:31], v[100:103], v[204:207], v[28:31]
  ds_read_b64_tr_b16 v[138:139], v8 offset:32320
  buffer_load_dwordx4 v[240:243], v1, s[16:19], s45 offen offset:1024
  v_mfma_f32_16x16x32_bf16 v[64:67], v[100:103], v[208:211], v[64:67]
  ds_read_b64_tr_b16 v[140:141], v8 offset:27744
  v_mfma_f32_16x16x32_bf16 v[32:35], v[104:107], v[204:207], v[32:35]
  ds_read_b64_tr_b16 v[142:143], v8 offset:32352
  v_mfma_f32_16x16x32_bf16 v[68:71], v[104:107], v[208:211], v[68:71]
  ds_read_b64_tr_b16 v[144:145], v8 offset:27776
  v_mfma_f32_16x16x32_bf16 v[36:39], v[108:111], v[204:207], v[36:39]
  ds_read_b64_tr_b16 v[146:147], v8 offset:32384
  ds_read_b64_tr_b16 v[148:149], v8 offset:27808
  buffer_load_dwordx4 v[244:247], v1, s[16:19], s45 offen offset:2048
  v_mfma_f32_16x16x32_bf16 v[72:75], v[108:111], v[208:211], v[72:75]
  ds_read_b64_tr_b16 v[150:151], v8 offset:32416
  s_waitcnt lgkmcnt(12)
  v_mfma_f32_16x16x32_bf16 v[40:43], v[112:115], v[204:207], v[40:43]
  ds_read_b64_tr_b16 v[152:153], v8 offset:27840
  v_mfma_f32_16x16x32_bf16 v[76:79], v[112:115], v[208:211], v[76:79]
  ds_read_b64_tr_b16 v[154:155], v8 offset:32448
  v_mfma_f32_16x16x32_bf16 v[44:47], v[116:119], v[204:207], v[44:47]
  ds_read_b64_tr_b16 v[156:157], v8 offset:27872
  buffer_load_dwordx4 v[248:251], v1, s[16:19], s45 offen offset:3072
  s_add_u32 s45, s45, 4096
  v_mfma_f32_16x16x32_bf16 v[80:83], v[116:119], v[208:211], v[80:83]
  ds_read_b64_tr_b16 v[158:159], v8 offset:32480
  v_mfma_f32_16x16x32_bf16 v[48:51], v[120:123], v[204:207], v[48:51]
  ds_read_b64_tr_b16 v[160:161], v8 offset:27904
  v_mfma_f32_16x16x32_bf16 v[84:87], v[120:123], v[208:211], v[84:87]
  ds_read_b64_tr_b16 v[162:163], v8 offset:32512
  v_mfma_f32_16x16x32_bf16 v[52:55], v[124:127], v[204:207], v[52:55]
  v_mfma_f32_16x16x32_bf16 v[88:91], v[124:127], v[208:211], v[88:91]
  s_waitcnt vmcnt(9)
  s_barrier
  s_waitcnt lgkmcnt(8)
  s_add_u32 m0, s46, 0
  v_mfma_f32_16x16x32_bf16 v[20:23], v[128:131], v[212:215], v[20:23]
  ds_read_b64_tr_b16 v[92:93], v8 offset:36864
  ds_read_b64_tr_b16 v[94:95], v8 offset:41472
  buffer_load_dwordx4 v2, s[12:15], s44 offen lds
  v_mfma_f32_16x16x32_bf16 v[56:59], v[128:131], v[216:219], v[56:59]
  ds_read_b64_tr_b16 v[96:97], v8 offset:36896
  v_mfma_f32_16x16x32_bf16 v[24:27], v[132:135], v[212:215], v[24:27]
  ds_read_b64_tr_b16 v[98:99], v8 offset:41504
  s_add_u32 m0, s46, 1024
  v_mfma_f32_16x16x32_bf16 v[60:63], v[132:135], v[216:219], v[60:63]
  ds_read_b64_tr_b16 v[100:101], v8 offset:36928
  buffer_load_dwordx4 v3, s[12:15], s44 offen lds
  v_mfma_f32_16x16x32_bf16 v[28:31], v[136:139], v[212:215], v[28:31]
  ds_read_b64_tr_b16 v[102:103], v8 offset:41536
  v_mfma_f32_16x16x32_bf16 v[64:67], v[136:139], v[216:219], v[64:67]
  ds_read_b64_tr_b16 v[104:105], v8 offset:36960
  s_add_u32 m0, s46, 2048
  v_mfma_f32_16x16x32_bf16 v[32:35], v[140:143], v[212:215], v[32:35]
  ds_read_b64_tr_b16 v[106:107], v8 offset:41568
  buffer_load_dwordx4 v4, s[12:15], s44 offen lds
  v_mfma_f32_16x16x32_bf16 v[68:71], v[140:143], v[216:219], v[68:71]
  ds_read_b64_tr_b16 v[108:109], v8 offset:36992
  v_mfma_f32_16x16x32_bf16 v[36:39], v[144:147], v[212:215], v[36:39]
  ds_read_b64_tr_b16 v[110:111], v8 offset:41600
  ds_read_b64_tr_b16 v[112:113], v8 offset:37024
  s_add_u32 m0, s46, 3072
  v_mfma_f32_16x16x32_bf16 v[72:75], v[144:147], v[216:219], v[72:75]
  ds_read_b64_tr_b16 v[114:115], v8 offset:41632
  buffer_load_dwordx4 v5, s[12:15], s44 offen lds
  s_waitcnt lgkmcnt(12)
  v_mfma_f32_16x16x32_bf16 v[40:43], v[148:151], v[212:215], v[40:43]
  ds_read_b64_tr_b16 v[116:117], v8 offset:37056
  v_mfma_f32_16x16x32_bf16 v[76:79], v[148:151], v[216:219], v[76:79]
  ds_read_b64_tr_b16 v[118:119], v8 offset:41664
  s_add_u32 m0, s46, 4096
  v_mfma_f32_16x16x32_bf16 v[44:47], v[152:155], v[212:215], v[44:47]
  ds_read_b64_tr_b16 v[120:121], v8 offset:37088
  s_mov_b32 exec_hi, 0
  buffer_load_dwordx4 v6, s[12:15], s44 offen lds
  s_mov_b32 exec_hi, -1
  s_add_u32 s44, s44, 589824
  v_mfma_f32_16x16x32_bf16 v[80:83], v[152:155], v[216:219], v[80:83]
  ds_read_b64_tr_b16 v[122:123], v8 offset:41696
  v_mfma_f32_16x16x32_bf16 v[48:51], v[156:159], v[212:215], v[48:51]
  ds_read_b64_tr_b16 v[124:125], v8 offset:37120
  v_mfma_f32_16x16x32_bf16 v[84:87], v[156:159], v[216:219], v[84:87]
  ds_read_b64_tr_b16 v[126:127], v8 offset:41728
  v_mfma_f32_16x16x32_bf16 v[52:55], v[160:163], v[212:215], v[52:55]
  v_mfma_f32_16x16x32_bf16 v[88:91], v[160:163], v[216:219], v[88:91]
  s_waitcnt lgkmcnt(8)
  v_mfma_f32_16x16x32_bf16 v[20:23], v[92:95], v[220:223], v[20:23]
  ds_read_b64_tr_b16 v[128:129], v8 offset:46080
  ds_read_b64_tr_b16 v[130:131], v8 offset:50688
  buffer_load_dwordx4 v[188:191], v1, s[16:19], s45 offen offset:0
  v_mfma_f32_16x16x32_bf16 v[56:59], v[92:95], v[224:227], v[56:59]
  ds_read_b64_tr_b16 v[132:133], v8 offset:46112
  buffer_load_dwordx4 v[192:195], v1, s[16:19], s45 offen offset:1024
  v_mfma_f32_16x16x32_bf16 v[24:27], v[96:99], v[220:223], v[24:27]
  ds_read_b64_tr_b16 v[134:135], v8 offset:50720
  buffer_load_dwordx4 v[196:199], v1, s[16:19], s45 offen offset:2048
  v_mfma_f32_16x16x32_bf16 v[60:63], v[96:99], v[224:227], v[60:63]
  ds_read_b64_tr_b16 v[136:137], v8 offset:46144
  buffer_load_dwordx4 v[200:203], v1, s[16:19], s45 offen offset:3072
  s_add_u32 s45, s45, 4096
  v_mfma_f32_16x16x32_bf16 v[28:31], v[100:103], v[220:223], v[28:31]
  ds_read_b64_tr_b16 v[138:139], v8 offset:50752
  s_getpc_b64 s[96:97]
pc_7384_v252:
  v_lshlrev_b32 v14, 7, v0
  s_lshl_b32 s98, s3, 13
  v_add_u32 v14, s98, v14
  v_add_u32 v14, k4_body-pc_7384_v252, v14
  v_min_u32 v14, k5_end-pc_7384_v252, v14
  v_mov_b32 v15, 0
  v_lshl_add_u64 v[14:15], v[14:15], 0, s[96:97]
  global_load_dword v252, v[14:15], off
  v_mfma_f32_16x16x32_bf16 v[64:67], v[100:103], v[224:227], v[64:67]
  ds_read_b64_tr_b16 v[140:141], v8 offset:46176
  s_mov_b32 s48, 0
  buffer_load_dwordx2 v[164:165], v7, s[20:23], s48 offen offset:0
  v_mfma_f32_16x16x32_bf16 v[32:35], v[104:107], v[220:223], v[32:35]
  ds_read_b64_tr_b16 v[142:143], v8 offset:50784
  s_mov_b32 s48, 16384
  buffer_load_dwordx2 v[166:167], v7, s[20:23], s48 offen offset:0
  v_mfma_f32_16x16x32_bf16 v[68:71], v[104:107], v[224:227], v[68:71]
  ds_read_b64_tr_b16 v[144:145], v8 offset:46208
  s_mov_b32 s48, 32768
  buffer_load_dwordx2 v[168:169], v7, s[20:23], s48 offen offset:0
  v_mfma_f32_16x16x32_bf16 v[36:39], v[108:111], v[220:223], v[36:39]
  ds_read_b64_tr_b16 v[146:147], v8 offset:50816
  ds_read_b64_tr_b16 v[148:149], v8 offset:46240
  s_mov_b32 s48, 49152
  buffer_load_dwordx2 v[170:171], v7, s[20:23], s48 offen offset:0
  v_mfma_f32_16x16x32_bf16 v[72:75], v[108:111], v[224:227], v[72:75]
  ds_read_b64_tr_b16 v[150:151], v8 offset:50848
  s_mov_b32 s48, 65536
  buffer_load_dwordx2 v[172:173], v7, s[20:23], s48 offen offset:0
  s_waitcnt lgkmcnt(12)
  v_mfma_f32_16x16x32_bf16 v[40:43], v[112:115], v[220:223], v[40:43]
  ds_read_b64_tr_b16 v[152:153], v8 offset:46272
  s_mov_b32 s48, 81920
  buffer_load_dwordx2 v[174:175], v7, s[20:23], s48 offen offset:0
  v_mfma_f32_16x16x32_bf16 v[76:79], v[112:115], v[224:227], v[76:79]
  ds_read_b64_tr_b16 v[154:155], v8 offset:50880
  s_mov_b32 s48, 0
  buffer_load_dwordx2 v[176:177], v7, s[20:23], s48 offen offset:128
  v_mfma_f32_16x16x32_bf16 v[44:47], v[116:119], v[220:223], v[44:47]
  ds_read_b64_tr_b16 v[156:157], v8 offset:46304
  s_mov_b32 s48, 16384
  buffer_load_dwordx2 v[178:179], v7, s[20:23], s48 offen offset:128
  v_mfma_f32_16x16x32_bf16 v[80:83], v[116:119], v[224:227], v[80:83]
  ds_read_b64_tr_b16 v[158:159], v8 offset:50912
  s_mov_b32 s48, 32768
  buffer_load_dwordx2 v[180:181], v7, s[20:23], s48 offen offset:128
  v_mfma_f32_16x16x32_bf16 v[48:51], v[120:123], v[220:223], v[48:51]
  ds_read_b64_tr_b16 v[160:161], v8 offset:46336
  s_mov_b32 s48, 49152
  buffer_load_dwordx2 v[182:183], v7, s[20:23], s48 offen offset:128
  v_mfma_f32_16x16x32_bf16 v[84:87], v[120:123], v[224:227], v[84:87]
  ds_read_b64_tr_b16 v[162:163], v8 offset:50944
  s_mov_b32 s48, 65536
  buffer_load_dwordx2 v[184:185], v7, s[20:23], s48 offen offset:128
  v_mfma_f32_16x16x32_bf16 v[52:55], v[124:127], v[220:223], v[52:55]
  s_mov_b32 s48, 81920
  buffer_load_dwordx2 v[186:187], v7, s[20:23], s48 offen offset:128
  v_mfma_f32_16x16x32_bf16 v[88:91], v[124:127], v[224:227], v[88:91]
  s_mov_b32 m0, 73728
  s_nop 0
  buffer_load_dwordx4 v1, s[24:27], 0 offen offset:0 lds
  s_mov_b32 m0, 73728
  s_nop 0
  buffer_load_dwordx4 v1, s[24:27], 0 offen offset:1024 lds
  s_waitcnt vmcnt(24)
  s_barrier
  s_waitcnt lgkmcnt(8)
  v_mfma_f32_16x16x32_bf16 v[20:23], v[128:131], v[228:231], v[20:23]
  ds_read_b64_tr_b16 v[92:93], v9 offset:0
  ds_read_b64_tr_b16 v[94:95], v9 offset:4608
  v_mfma_f32_16x16x32_bf16 v[56:59], v[128:131], v[232:235], v[56:59]
  ds_read_b64_tr_b16 v[96:97], v9 offset:32
  v_mfma_f32_16x16x32_bf16 v[24:27], v[132:135], v[228:231], v[24:27]
  ds_read_b64_tr_b16 v[98:99], v9 offset:4640
  v_mfma_f32_16x16x32_bf16 v[60:63], v[132:135], v[232:235], v[60:63]
  ds_read_b64_tr_b16 v[100:101], v9 offset:64
  v_mfma_f32_16x16x32_bf16 v[28:31], v[136:139], v[228:231], v[28:31]
  ds_read_b64_tr_b16 v[102:103], v9 offset:4672
  v_mfma_f32_16x16x32_bf16 v[64:67], v[136:139], v[232:235], v[64:67]
  ds_read_b64_tr_b16 v[104:105], v9 offset:96
  v_mfma_f32_16x16x32_bf16 v[32:35], v[140:143], v[228:231], v[32:35]
  ds_read_b64_tr_b16 v[106:107], v9 offset:4704
  v_mfma_f32_16x16x32_bf16 v[68:71], v[140:143], v[232:235], v[68:71]
  ds_read_b64_tr_b16 v[108:109], v9 offset:128
  v_mfma_f32_16x16x32_bf16 v[36:39], v[144:147], v[228:231], v[36:39]
  ds_read_b64_tr_b16 v[110:111], v9 offset:4736
  ds_read_b64_tr_b16 v[112:113], v9 offset:160
  v_mfma_f32_16x16x32_bf16 v[72:75], v[144:147], v[232:235], v[72:75]
  ds_read_b64_tr_b16 v[114:115], v9 offset:4768
  s_waitcnt lgkmcnt(12)
  v_mfma_f32_16x16x32_bf16 v[40:43], v[148:151], v[228:231], v[40:43]
  ds_read_b64_tr_b16 v[116:117], v9 offset:192
  v_mfma_f32_16x16x32_bf16 v[76:79], v[148:151], v[232:235], v[76:79]
  ds_read_b64_tr_b16 v[118:119], v9 offset:4800
  v_mfma_f32_16x16x32_bf16 v[44:47], v[152:155], v[228:231], v[44:47]
  ds_read_b64_tr_b16 v[120:121], v9 offset:224
  v_mfma_f32_16x16x32_bf16 v[80:83], v[152:155], v[232:235], v[80:83]
  ds_read_b64_tr_b16 v[122:123], v9 offset:4832
  v_mfma_f32_16x16x32_bf16 v[48:51], v[156:159], v[228:231], v[48:51]
  ds_read_b64_tr_b16 v[124:125], v9 offset:256
  v_mfma_f32_16x16x32_bf16 v[84:87], v[156:159], v[232:235], v[84:87]
  ds_read_b64_tr_b16 v[126:127], v9 offset:4864
  v_mfma_f32_16x16x32_bf16 v[52:55], v[160:163], v[228:231], v[52:55]
  v_mfma_f32_16x16x32_bf16 v[88:91], v[160:163], v[232:235], v[88:91]
  s_waitcnt lgkmcnt(8)
  v_mfma_f32_16x16x32_bf16 v[20:23], v[92:95], v[236:239], v[20:23]
  ds_read_b64_tr_b16 v[128:129], v9 offset:9216
  ds_read_b64_tr_b16 v[130:131], v9 offset:13824
  v_mfma_f32_16x16x32_bf16 v[56:59], v[92:95], v[240:243], v[56:59]
  ds_read_b64_tr_b16 v[132:133], v9 offset:9248
  v_mfma_f32_16x16x32_bf16 v[24:27], v[96:99], v[236:239], v[24:27]
  ds_read_b64_tr_b16 v[134:135], v9 offset:13856
  v_mfma_f32_16x16x32_bf16 v[60:63], v[96:99], v[240:243], v[60:63]
  ds_read_b64_tr_b16 v[136:137], v9 offset:9280
  v_mfma_f32_16x16x32_bf16 v[28:31], v[100:103], v[236:239], v[28:31]
  ds_read_b64_tr_b16 v[138:139], v9 offset:13888
  v_mfma_f32_16x16x32_bf16 v[64:67], v[100:103], v[240:243], v[64:67]
  ds_read_b64_tr_b16 v[140:141], v9 offset:9312
  v_mfma_f32_16x16x32_bf16 v[32:35], v[104:107], v[236:239], v[32:35]
  ds_read_b64_tr_b16 v[142:143], v9 offset:13920
  v_mfma_f32_16x16x32_bf16 v[68:71], v[104:107], v[240:243], v[68:71]
  ds_read_b64_tr_b16 v[144:145], v9 offset:9344
  v_mfma_f32_16x16x32_bf16 v[36:39], v[108:111], v[236:239], v[36:39]
  ds_read_b64_tr_b16 v[146:147], v9 offset:13952
  ds_read_b64_tr_b16 v[148:149], v9 offset:9376
  v_mfma_f32_16x16x32_bf16 v[72:75], v[108:111], v[240:243], v[72:75]
  ds_read_b64_tr_b16 v[150:151], v9 offset:13984
  s_waitcnt lgkmcnt(12)
  v_mfma_f32_16x16x32_bf16 v[40:43], v[112:115], v[236:239], v[40:43]
  ds_read_b64_tr_b16 v[152:153], v9 offset:9408
  v_mfma_f32_16x16x32_bf16 v[76:79], v[112:115], v[240:243], v[76:79]
  ds_read_b64_tr_b16 v[154:155], v9 offset:14016
  v_mfma_f32_16x16x32_bf16 v[44:47], v[116:119], v[236:239], v[44:47]
  ds_read_b64_tr_b16 v[156:157], v9 offset:9440
  v_mfma_f32_16x16x32_bf16 v[80:83], v[116:119], v[240:243], v[80:83]
  ds_read_b64_tr_b16 v[158:159], v9 offset:14048
  v_mfma_f32_16x16x32_bf16 v[48:51], v[120:123], v[236:239], v[48:51]
  ds_read_b64_tr_b16 v[160:161], v9 offset:9472
  v_mfma_f32_16x16x32_bf16 v[84:87], v[120:123], v[240:243], v[84:87]
  ds_read_b64_tr_b16 v[162:163], v9 offset:14080
  v_mfma_f32_16x16x32_bf16 v[52:55], v[124:127], v[236:239], v[52:55]
  v_mfma_f32_16x16x32_bf16 v[88:91], v[124:127], v[240:243], v[88:91]
  s_waitcnt vmcnt(15)
  s_barrier
  s_waitcnt lgkmcnt(8)
  v_mfma_f32_16x16x32_bf16 v[20:23], v[128:131], v[244:247], v[20:23]
  ds_read_b64_tr_b16 v[92:93], v8 offset:0
  ds_read_b64_tr_b16 v[94:95], v8 offset:4608
  v_mfma_f32_16x16x32_bf16 v[56:59], v[128:131], v[248:251], v[56:59]
  ds_read_b64_tr_b16 v[96:97], v8 offset:32
  v_mfma_f32_16x16x32_bf16 v[24:27], v[132:135], v[244:247], v[24:27]
  ds_read_b64_tr_b16 v[98:99], v8 offset:4640
  v_mfma_f32_16x16x32_bf16 v[60:63], v[132:135], v[248:251], v[60:63]
  ds_read_b64_tr_b16 v[100:101], v8 offset:64
  v_mfma_f32_16x16x32_bf16 v[28:31], v[136:139], v[244:247], v[28:31]
  ds_read_b64_tr_b16 v[102:103], v8 offset:4672
  v_mfma_f32_16x16x32_bf16 v[64:67], v[136:139], v[248:251], v[64:67]
  ds_read_b64_tr_b16 v[104:105], v8 offset:96
  v_mfma_f32_16x16x32_bf16 v[32:35], v[140:143], v[244:247], v[32:35]
  ds_read_b64_tr_b16 v[106:107], v8 offset:4704
  v_mfma_f32_16x16x32_bf16 v[68:71], v[140:143], v[248:251], v[68:71]
  ds_read_b64_tr_b16 v[108:109], v8 offset:128
  v_mfma_f32_16x16x32_bf16 v[36:39], v[144:147], v[244:247], v[36:39]
  ds_read_b64_tr_b16 v[110:111], v8 offset:4736
  ds_read_b64_tr_b16 v[112:113], v8 offset:160
  v_mfma_f32_16x16x32_bf16 v[72:75], v[144:147], v[248:251], v[72:75]
  ds_read_b64_tr_b16 v[114:115], v8 offset:4768
  s_waitcnt lgkmcnt(12)
  v_mfma_f32_16x16x32_bf16 v[40:43], v[148:151], v[244:247], v[40:43]
  ds_read_b64_tr_b16 v[116:117], v8 offset:192
  v_mfma_f32_16x16x32_bf16 v[76:79], v[148:151], v[248:251], v[76:79]
  ds_read_b64_tr_b16 v[118:119], v8 offset:4800
  v_mfma_f32_16x16x32_bf16 v[44:47], v[152:155], v[244:247], v[44:47]
  ds_read_b64_tr_b16 v[120:121], v8 offset:224
  v_mfma_f32_16x16x32_bf16 v[80:83], v[152:155], v[248:251], v[80:83]
  ds_read_b64_tr_b16 v[122:123], v8 offset:4832
  v_mfma_f32_16x16x32_bf16 v[48:51], v[156:159], v[244:247], v[48:51]
  ds_read_b64_tr_b16 v[124:125], v8 offset:256
  v_mfma_f32_16x16x32_bf16 v[84:87], v[156:159], v[248:251], v[84:87]
  ds_read_b64_tr_b16 v[126:127], v8 offset:4864
  v_mfma_f32_16x16x32_bf16 v[52:55], v[160:163], v[244:247], v[52:55]
  v_mfma_f32_16x16x32_bf16 v[88:91], v[160:163], v[248:251], v[88:91]
  s_waitcnt lgkmcnt(8)
  v_mfma_f32_16x16x32_bf16 v[20:23], v[92:95], v[188:191], v[20:23]
  ds_read_b64_tr_b16 v[128:129], v8 offset:9216
  ds_read_b64_tr_b16 v[130:131], v8 offset:13824
  v_mfma_f32_16x16x32_bf16 v[56:59], v[92:95], v[192:195], v[56:59]
  ds_read_b64_tr_b16 v[132:133], v8 offset:9248
  v_mfma_f32_16x16x32_bf16 v[24:27], v[96:99], v[188:191], v[24:27]
  ds_read_b64_tr_b16 v[134:135], v8 offset:13856
  v_mfma_f32_16x16x32_bf16 v[60:63], v[96:99], v[192:195], v[60:63]
  ds_read_b64_tr_b16 v[136:137], v8 offset:9280
  v_mfma_f32_16x16x32_bf16 v[28:31], v[100:103], v[188:191], v[28:31]
  ds_read_b64_tr_b16 v[138:139], v8 offset:13888
  v_mfma_f32_16x16x32_bf16 v[64:67], v[100:103], v[192:195], v[64:67]
  ds_read_b64_tr_b16 v[140:141], v8 offset:9312
  v_mfma_f32_16x16x32_bf16 v[32:35], v[104:107], v[188:191], v[32:35]
  ds_read_b64_tr_b16 v[142:143], v8 offset:13920
  v_mfma_f32_16x16x32_bf16 v[68:71], v[104:107], v[192:195], v[68:71]
  ds_read_b64_tr_b16 v[144:145], v8 offset:9344
  v_mfma_f32_16x16x32_bf16 v[36:39], v[108:111], v[188:191], v[36:39]
  ds_read_b64_tr_b16 v[146:147], v8 offset:13952
  ds_read_b64_tr_b16 v[148:149], v8 offset:9376
  v_mfma_f32_16x16x32_bf16 v[72:75], v[108:111], v[192:195], v[72:75]
  ds_read_b64_tr_b16 v[150:151], v8 offset:13984
  s_waitcnt lgkmcnt(12)
  v_mfma_f32_16x16x32_bf16 v[40:43], v[112:115], v[188:191], v[40:43]
  ds_read_b64_tr_b16 v[152:153], v8 offset:9408
  v_mfma_f32_16x16x32_bf16 v[76:79], v[112:115], v[192:195], v[76:79]
  ds_read_b64_tr_b16 v[154:155], v8 offset:14016
  v_mfma_f32_16x16x32_bf16 v[44:47], v[116:119], v[188:191], v[44:47]
  ds_read_b64_tr_b16 v[156:157], v8 offset:9440
  v_mfma_f32_16x16x32_bf16 v[80:83], v[116:119], v[192:195], v[80:83]
  ds_read_b64_tr_b16 v[158:159], v8 offset:14048
  v_mfma_f32_16x16x32_bf16 v[48:51], v[120:123], v[188:191], v[48:51]
  ds_read_b64_tr_b16 v[160:161], v8 offset:9472
  v_mfma_f32_16x16x32_bf16 v[84:87], v[120:123], v[192:195], v[84:87]
  ds_read_b64_tr_b16 v[162:163], v8 offset:14080
  v_mfma_f32_16x16x32_bf16 v[52:55], v[124:127], v[188:191], v[52:55]
  v_mfma_f32_16x16x32_bf16 v[88:91], v[124:127], v[192:195], v[88:91]
  s_waitcnt lgkmcnt(8)
  v_mfma_f32_16x16x32_bf16 v[20:23], v[128:131], v[196:199], v[20:23]
  v_mfma_f32_16x16x32_bf16 v[56:59], v[128:131], v[200:203], v[56:59]
  v_mfma_f32_16x16x32_bf16 v[24:27], v[132:135], v[196:199], v[24:27]
  v_mfma_f32_16x16x32_bf16 v[60:63], v[132:135], v[200:203], v[60:63]
  v_mfma_f32_16x16x32_bf16 v[28:31], v[136:139], v[196:199], v[28:31]
  v_mfma_f32_16x16x32_bf16 v[64:67], v[136:139], v[200:203], v[64:67]
  v_mfma_f32_16x16x32_bf16 v[32:35], v[140:143], v[196:199], v[32:35]
  v_mfma_f32_16x16x32_bf16 v[68:71], v[140:143], v[200:203], v[68:71]
  v_mfma_f32_16x16x32_bf16 v[36:39], v[144:147], v[196:199], v[36:39]
  v_mfma_f32_16x16x32_bf16 v[72:75], v[144:147], v[200:203], v[72:75]
  s_waitcnt lgkmcnt(0)
  v_mfma_f32_16x16x32_bf16 v[40:43], v[148:151], v[196:199], v[40:43]
  v_mfma_f32_16x16x32_bf16 v[76:79], v[148:151], v[200:203], v[76:79]
  v_mfma_f32_16x16x32_bf16 v[44:47], v[152:155], v[196:199], v[44:47]
  v_mfma_f32_16x16x32_bf16 v[80:83], v[152:155], v[200:203], v[80:83]
  v_mfma_f32_16x16x32_bf16 v[48:51], v[156:159], v[196:199], v[48:51]
  v_mfma_f32_16x16x32_bf16 v[84:87], v[156:159], v[200:203], v[84:87]
  v_mfma_f32_16x16x32_bf16 v[52:55], v[160:163], v[196:199], v[52:55]
  v_mfma_f32_16x16x32_bf16 v[88:91], v[160:163], v[200:203], v[88:91]
  s_waitcnt vmcnt(0) lgkmcnt(0)
  s_nop 7
  v_lshrrev_b32 v15, 4, v0
  v_lshlrev_b32 v15, 4, v15
  v_add_u32 v15, 73728, v15
  ds_read_b128 v[92:95], v15 offset:0
  ds_read_b128 v[96:99], v15 offset:64
  ds_read_b128 v[100:103], v15 offset:128
  ds_read_b128 v[104:107], v15 offset:192
  ds_read_b128 v[108:111], v15 offset:256
  ds_read_b128 v[112:115], v15 offset:320
  ds_read_b128 v[116:119], v15 offset:384
  ds_read_b128 v[120:123], v15 offset:448
  ds_read_b128 v[124:127], v15 offset:512
  ds_read_b128 v[128:131], v15 offset:576
  ds_read_b128 v[132:135], v15 offset:640
  ds_read_b128 v[136:139], v15 offset:704
  ds_read_b128 v[140:143], v15 offset:768
  ds_read_b128 v[144:147], v15 offset:832
  ds_read_b128 v[148:151], v15 offset:896
  ds_read_b128 v[152:155], v15 offset:960
  ds_read_b128 v[156:159], v15 offset:1024
  ds_read_b128 v[160:163], v15 offset:1088
  v_add_f32 v164, v164, v166
  v_add_f32 v165, v165, v167
  v_add_f32 v164, v164, v168
  v_add_f32 v165, v165, v169
  v_add_f32 v164, v164, v170
  v_add_f32 v165, v165, v171
  v_add_f32 v164, v164, v172
  v_add_f32 v165, v165, v173
  v_add_f32 v164, v164, v174
  v_add_f32 v165, v165, v175
  v_mul_f32 v164, 0xbae38e39, v164
  v_mov_b32 v4, 0x3727c5ac
  v_fmamk_f32 v165, v165, 0x3ae38e39, v4
  v_fma_f32 v165, -v164, v164, v165
  v_max_f32 v165, v165, v4
  v_rsq_f32 v165, v165
  s_nop 0
  v_mul_f32 v164, v164, v165
  v_add_f32 v176, v176, v178
  v_add_f32 v177, v177, v179
  v_add_f32 v176, v176, v180
  v_add_f32 v177, v177, v181
  v_add_f32 v176, v176, v182
  v_add_f32 v177, v177, v183
  v_add_f32 v176, v176, v184
  v_add_f32 v177, v177, v185
  v_add_f32 v176, v176, v186
  v_add_f32 v177, v177, v187
  v_mul_f32 v176, 0xbae38e39, v176
  v_mov_b32 v4, 0x3727c5ac
  v_fmamk_f32 v177, v177, 0x3ae38e39, v4
  v_fma_f32 v177, -v176, v176, v177
  v_max_f32 v177, v177, v4
  v_rsq_f32 v177, v177
  s_nop 0
  v_mul_f32 v176, v176, v177
  s_waitcnt lgkmcnt(0)
  v_mov_b32 v14, 0xc0135761
  v_fma_f32 v166, v164, v92, v128
  v_fma_f32 v167, v164, v93, v129
  v_fma_f32 v168, v164, v94, v130
  v_fma_f32 v169, v164, v95, v131
  v_fma_f32 v20, v20, v165, v166
  v_fma_f32 v21, v21, v165, v167
  v_fma_f32 v22, v22, v165, v168
  v_fma_f32 v23, v23, v165, v169
  v_mul_f32 v166, v20, v20
  v_mul_f32 v167, v21, v21
  v_mul_f32 v168, v22, v22
  v_mul_f32 v169, v23, v23
  v_fmamk_f32 v166, v166, 0xbdd2d3e8, v14
  v_fmamk_f32 v167, v167, 0xbdd2d3e8, v14
  v_fmamk_f32 v168, v168, 0xbdd2d3e8, v14
  v_fmamk_f32 v169, v169, 0xbdd2d3e8, v14
  v_mul_f32 v166, v166, v20
  v_mul_f32 v167, v167, v21
  v_mul_f32 v168, v168, v22
  v_mul_f32 v169, v169, v23
  v_exp_f32 v166, v166
  v_exp_f32 v167, v167
  v_exp_f32 v168, v168
  v_exp_f32 v169, v169
  v_add_f32 v166, 1.0, v166
  v_add_f32 v167, 1.0, v167
  v_add_f32 v168, 1.0, v168
  v_add_f32 v169, 1.0, v169
  v_rcp_f32 v166, v166
  v_rcp_f32 v167, v167
  v_rcp_f32 v168, v168
  v_rcp_f32 v169, v169
  v_mul_f32 v20, v20, v166
  v_mul_f32 v21, v21, v167
  v_mul_f32 v22, v22, v168
  v_mul_f32 v23, v23, v169
  v_fma_f32 v166, v164, v96, v132
  v_fma_f32 v167, v164, v97, v133
  v_fma_f32 v168, v164, v98, v134
  v_fma_f32 v169, v164, v99, v135
  v_fma_f32 v24, v24, v165, v166
  v_fma_f32 v25, v25, v165, v167
  v_fma_f32 v26, v26, v165, v168
  v_fma_f32 v27, v27, v165, v169
  v_mul_f32 v166, v24, v24
  v_mul_f32 v167, v25, v25
  v_mul_f32 v168, v26, v26
  v_mul_f32 v169, v27, v27
  v_fmamk_f32 v166, v166, 0xbdd2d3e8, v14
  v_fmamk_f32 v167, v167, 0xbdd2d3e8, v14
  v_fmamk_f32 v168, v168, 0xbdd2d3e8, v14
  v_fmamk_f32 v169, v169, 0xbdd2d3e8, v14
  v_mul_f32 v166, v166, v24
  v_mul_f32 v167, v167, v25
  v_mul_f32 v168, v168, v26
  v_mul_f32 v169, v169, v27
  v_exp_f32 v166, v166
  v_exp_f32 v167, v167
  v_exp_f32 v168, v168
  v_exp_f32 v169, v169
  v_add_f32 v166, 1.0, v166
  v_add_f32 v167, 1.0, v167
  v_add_f32 v168, 1.0, v168
  v_add_f32 v169, 1.0, v169
  v_rcp_f32 v166, v166
  v_rcp_f32 v167, v167
  v_rcp_f32 v168, v168
  v_rcp_f32 v169, v169
  v_mul_f32 v24, v24, v166
  v_mul_f32 v25, v25, v167
  v_mul_f32 v26, v26, v168
  v_mul_f32 v27, v27, v169
  v_fma_f32 v166, v164, v100, v136
  v_fma_f32 v167, v164, v101, v137
  v_fma_f32 v168, v164, v102, v138
  v_fma_f32 v169, v164, v103, v139
  v_fma_f32 v28, v28, v165, v166
  v_fma_f32 v29, v29, v165, v167
  v_fma_f32 v30, v30, v165, v168
  v_fma_f32 v31, v31, v165, v169
  v_mul_f32 v166, v28, v28
  v_mul_f32 v167, v29, v29
  v_mul_f32 v168, v30, v30
  v_mul_f32 v169, v31, v31
  v_fmamk_f32 v166, v166, 0xbdd2d3e8, v14
  v_fmamk_f32 v167, v167, 0xbdd2d3e8, v14
  v_fmamk_f32 v168, v168, 0xbdd2d3e8, v14
  v_fmamk_f32 v169, v169, 0xbdd2d3e8, v14
  v_mul_f32 v166, v166, v28
  v_mul_f32 v167, v167, v29
  v_mul_f32 v168, v168, v30
  v_mul_f32 v169, v169, v31
  v_exp_f32 v166, v166
  v_exp_f32 v167, v167
  v_exp_f32 v168, v168
  v_exp_f32 v169, v169
  v_add_f32 v166, 1.0, v166
  v_add_f32 v167, 1.0, v167
  v_add_f32 v168, 1.0, v168
  v_add_f32 v169, 1.0, v169
  v_rcp_f32 v166, v166
  v_rcp_f32 v167, v167
  v_rcp_f32 v168, v168
  v_rcp_f32 v169, v169
  v_mul_f32 v28, v28, v166
  v_mul_f32 v29, v29, v167
  v_mul_f32 v30, v30, v168
  v_mul_f32 v31, v31, v169
  v_fma_f32 v166, v164, v104, v140
  v_fma_f32 v167, v164, v105, v141
  v_fma_f32 v168, v164, v106, v142
  v_fma_f32 v169, v164, v107, v143
  v_fma_f32 v32, v32, v165, v166
  v_fma_f32 v33, v33, v165, v167
  v_fma_f32 v34, v34, v165, v168
  v_fma_f32 v35, v35, v165, v169
  v_mul_f32 v166, v32, v32
  v_mul_f32 v167, v33, v33
  v_mul_f32 v168, v34, v34
  v_mul_f32 v169, v35, v35
  v_fmamk_f32 v166, v166, 0xbdd2d3e8, v14
  v_fmamk_f32 v167, v167, 0xbdd2d3e8, v14
  v_fmamk_f32 v168, v168, 0xbdd2d3e8, v14
  v_fmamk_f32 v169, v169, 0xbdd2d3e8, v14
  v_mul_f32 v166, v166, v32
  v_mul_f32 v167, v167, v33
  v_mul_f32 v168, v168, v34
  v_mul_f32 v169, v169, v35
  v_exp_f32 v166, v166
  v_exp_f32 v167, v167
  v_exp_f32 v168, v168
  v_exp_f32 v169, v169
  v_add_f32 v166, 1.0, v166
  v_add_f32 v167, 1.0, v167
  v_add_f32 v168, 1.0, v168
  v_add_f32 v169, 1.0, v169
  v_rcp_f32 v166, v166
  v_rcp_f32 v167, v167
  v_rcp_f32 v168, v168
  v_rcp_f32 v169, v169
  v_mul_f32 v32, v32, v166
  v_mul_f32 v33, v33, v167
  v_mul_f32 v34, v34, v168
  v_mul_f32 v35, v35, v169
  v_fma_f32 v166, v164, v108, v144
  v_fma_f32 v167, v164, v109, v145
  v_fma_f32 v168, v164, v110, v146
  v_fma_f32 v169, v164, v111, v147
  v_fma_f32 v36, v36, v165, v166
  v_fma_f32 v37, v37, v165, v167
  v_fma_f32 v38, v38, v165, v168
  v_fma_f32 v39, v39, v165, v169
  v_mul_f32 v166, v36, v36
  v_mul_f32 v167, v37, v37
  v_mul_f32 v168, v38, v38
  v_mul_f32 v169, v39, v39
  v_fmamk_f32 v166, v166, 0xbdd2d3e8, v14
  v_fmamk_f32 v167, v167, 0xbdd2d3e8, v14
  v_fmamk_f32 v168, v168, 0xbdd2d3e8, v14
  v_fmamk_f32 v169, v169, 0xbdd2d3e8, v14
  v_mul_f32 v166, v166, v36
  v_mul_f32 v167, v167, v37
  v_mul_f32 v168, v168, v38
  v_mul_f32 v169, v169, v39
  v_exp_f32 v166, v166
  v_exp_f32 v167, v167
  v_exp_f32 v168, v168
  v_exp_f32 v169, v169
  v_add_f32 v166, 1.0, v166
  v_add_f32 v167, 1.0, v167
  v_add_f32 v168, 1.0, v168
  v_add_f32 v169, 1.0, v169
  v_rcp_f32 v166, v166
  v_rcp_f32 v167, v167
  v_rcp_f32 v168, v168
  v_rcp_f32 v169, v169
  v_mul_f32 v36, v36, v166
  v_mul_f32 v37, v37, v167
  v_mul_f32 v38, v38, v168
  v_mul_f32 v39, v39, v169
  v_fma_f32 v166, v164, v112, v148
  v_fma_f32 v167, v164, v113, v149
  v_fma_f32 v168, v164, v114, v150
  v_fma_f32 v169, v164, v115, v151
  v_fma_f32 v40, v40, v165, v166
  v_fma_f32 v41, v41, v165, v167
  v_fma_f32 v42, v42, v165, v168
  v_fma_f32 v43, v43, v165, v169
  v_mul_f32 v166, v40, v40
  v_mul_f32 v167, v41, v41
  v_mul_f32 v168, v42, v42
  v_mul_f32 v169, v43, v43
  v_fmamk_f32 v166, v166, 0xbdd2d3e8, v14
  v_fmamk_f32 v167, v167, 0xbdd2d3e8, v14
  v_fmamk_f32 v168, v168, 0xbdd2d3e8, v14
  v_fmamk_f32 v169, v169, 0xbdd2d3e8, v14
  v_mul_f32 v166, v166, v40
  v_mul_f32 v167, v167, v41
  v_mul_f32 v168, v168, v42
  v_mul_f32 v169, v169, v43
  v_exp_f32 v166, v166
  v_exp_f32 v167, v167
  v_exp_f32 v168, v168
  v_exp_f32 v169, v169
  v_add_f32 v166, 1.0, v166
  v_add_f32 v167, 1.0, v167
  v_add_f32 v168, 1.0, v168
  v_add_f32 v169, 1.0, v169
  v_rcp_f32 v166, v166
  v_rcp_f32 v167, v167
  v_rcp_f32 v168, v168
  v_rcp_f32 v169, v169
  v_mul_f32 v40, v40, v166
  v_mul_f32 v41, v41, v167
  v_mul_f32 v42, v42, v168
  v_mul_f32 v43, v43, v169
  v_fma_f32 v166, v164, v116, v152
  v_fma_f32 v167, v164, v117, v153
  v_fma_f32 v168, v164, v118, v154
  v_fma_f32 v169, v164, v119, v155
  v_fma_f32 v44, v44, v165, v166
  v_fma_f32 v45, v45, v165, v167
  v_fma_f32 v46, v46, v165, v168
  v_fma_f32 v47, v47, v165, v169
  v_mul_f32 v166, v44, v44
  v_mul_f32 v167, v45, v45
  v_mul_f32 v168, v46, v46
  v_mul_f32 v169, v47, v47
  v_fmamk_f32 v166, v166, 0xbdd2d3e8, v14
  v_fmamk_f32 v167, v167, 0xbdd2d3e8, v14
  v_fmamk_f32 v168, v168, 0xbdd2d3e8, v14
  v_fmamk_f32 v169, v169, 0xbdd2d3e8, v14
  v_mul_f32 v166, v166, v44
  v_mul_f32 v167, v167, v45
  v_mul_f32 v168, v168, v46
  v_mul_f32 v169, v169, v47
  v_exp_f32 v166, v166
  v_exp_f32 v167, v167
  v_exp_f32 v168, v168
  v_exp_f32 v169, v169
  v_add_f32 v166, 1.0, v166
  v_add_f32 v167, 1.0, v167
  v_add_f32 v168, 1.0, v168
  v_add_f32 v169, 1.0, v169
  v_rcp_f32 v166, v166
  v_rcp_f32 v167, v167
  v_rcp_f32 v168, v168
  v_rcp_f32 v169, v169
  v_mul_f32 v44, v44, v166
  v_mul_f32 v45, v45, v167
  v_mul_f32 v46, v46, v168
  v_mul_f32 v47, v47, v169
  v_fma_f32 v166, v164, v120, v156
  v_fma_f32 v167, v164, v121, v157
  v_fma_f32 v168, v164, v122, v158
  v_fma_f32 v169, v164, v123, v159
  v_fma_f32 v48, v48, v165, v166
  v_fma_f32 v49, v49, v165, v167
  v_fma_f32 v50, v50, v165, v168
  v_fma_f32 v51, v51, v165, v169
  v_mul_f32 v166, v48, v48
  v_mul_f32 v167, v49, v49
  v_mul_f32 v168, v50, v50
  v_mul_f32 v169, v51, v51
  v_fmamk_f32 v166, v166, 0xbdd2d3e8, v14
  v_fmamk_f32 v167, v167, 0xbdd2d3e8, v14
  v_fmamk_f32 v168, v168, 0xbdd2d3e8, v14
  v_fmamk_f32 v169, v169, 0xbdd2d3e8, v14
  v_mul_f32 v166, v166, v48
  v_mul_f32 v167, v167, v49
  v_mul_f32 v168, v168, v50
  v_mul_f32 v169, v169, v51
  v_exp_f32 v166, v166
  v_exp_f32 v167, v167
  v_exp_f32 v168, v168
  v_exp_f32 v169, v169
  v_add_f32 v166, 1.0, v166
  v_add_f32 v167, 1.0, v167
  v_add_f32 v168, 1.0, v168
  v_add_f32 v169, 1.0, v169
  v_rcp_f32 v166, v166
  v_rcp_f32 v167, v167
  v_rcp_f32 v168, v168
  v_rcp_f32 v169, v169
  v_mul_f32 v48, v48, v166
  v_mul_f32 v49, v49, v167
  v_mul_f32 v50, v50, v168
  v_mul_f32 v51, v51, v169
  v_fma_f32 v166, v164, v124, v160
  v_fma_f32 v167, v164, v125, v161
  v_fma_f32 v168, v164, v126, v162
  v_fma_f32 v169, v164, v127, v163
  v_fma_f32 v52, v52, v165, v166
  v_fma_f32 v53, v53, v165, v167
  v_fma_f32 v54, v54, v165, v168
  v_fma_f32 v55, v55, v165, v169
  v_mul_f32 v166, v52, v52
  v_mul_f32 v167, v53, v53
  v_mul_f32 v168, v54, v54
  v_mul_f32 v169, v55, v55
  v_fmamk_f32 v166, v166, 0xbdd2d3e8, v14
  v_fmamk_f32 v167, v167, 0xbdd2d3e8, v14
  v_fmamk_f32 v168, v168, 0xbdd2d3e8, v14
  v_fmamk_f32 v169, v169, 0xbdd2d3e8, v14
  v_mul_f32 v166, v166, v52
  v_mul_f32 v167, v167, v53
  v_mul_f32 v168, v168, v54
  v_mul_f32 v169, v169, v55
  v_exp_f32 v166, v166
  v_exp_f32 v167, v167
  v_exp_f32 v168, v168
  v_exp_f32 v169, v169
  v_add_f32 v166, 1.0, v166
  v_add_f32 v167, 1.0, v167
  v_add_f32 v168, 1.0, v168
  v_add_f32 v169, 1.0, v169
  v_rcp_f32 v166, v166
  v_rcp_f32 v167, v167
  v_rcp_f32 v168, v168
  v_rcp_f32 v169, v169
  v_mul_f32 v52, v52, v166
  v_mul_f32 v53, v53, v167
  v_mul_f32 v54, v54, v168
  v_mul_f32 v55, v55, v169
  v_fma_f32 v166, v176, v92, v128
  v_fma_f32 v167, v176, v93, v129
  v_fma_f32 v168, v176, v94, v130
  v_fma_f32 v169, v176, v95, v131
  v_fma_f32 v56, v56, v177, v166
  v_fma_f32 v57, v57, v177, v167
  v_fma_f32 v58, v58, v177, v168
  v_fma_f32 v59, v59, v177, v169
  v_mul_f32 v166, v56, v56
  v_mul_f32 v167, v57, v57
  v_mul_f32 v168, v58, v58
  v_mul_f32 v169, v59, v59
  v_fmamk_f32 v166, v166, 0xbdd2d3e8, v14
  v_fmamk_f32 v167, v167, 0xbdd2d3e8, v14
  v_fmamk_f32 v168, v168, 0xbdd2d3e8, v14
  v_fmamk_f32 v169, v169, 0xbdd2d3e8, v14
  v_mul_f32 v166, v166, v56
  v_mul_f32 v167, v167, v57
  v_mul_f32 v168, v168, v58
  v_mul_f32 v169, v169, v59
  v_exp_f32 v166, v166
  v_exp_f32 v167, v167
  v_exp_f32 v168, v168
  v_exp_f32 v169, v169
  v_add_f32 v166, 1.0, v166
  v_add_f32 v167, 1.0, v167
  v_add_f32 v168, 1.0, v168
  v_add_f32 v169, 1.0, v169
  v_rcp_f32 v166, v166
  v_rcp_f32 v167, v167
  v_rcp_f32 v168, v168
  v_rcp_f32 v169, v169
  v_mul_f32 v56, v56, v166
  v_mul_f32 v57, v57, v167
  v_mul_f32 v58, v58, v168
  v_mul_f32 v59, v59, v169
  v_fma_f32 v166, v176, v96, v132
  v_fma_f32 v167, v176, v97, v133
  v_fma_f32 v168, v176, v98, v134
  v_fma_f32 v169, v176, v99, v135
  v_fma_f32 v60, v60, v177, v166
  v_fma_f32 v61, v61, v177, v167
  v_fma_f32 v62, v62, v177, v168
  v_fma_f32 v63, v63, v177, v169
  v_mul_f32 v166, v60, v60
  v_mul_f32 v167, v61, v61
  v_mul_f32 v168, v62, v62
  v_mul_f32 v169, v63, v63
  v_fmamk_f32 v166, v166, 0xbdd2d3e8, v14
  v_fmamk_f32 v167, v167, 0xbdd2d3e8, v14
  v_fmamk_f32 v168, v168, 0xbdd2d3e8, v14
  v_fmamk_f32 v169, v169, 0xbdd2d3e8, v14
  v_mul_f32 v166, v166, v60
  v_mul_f32 v167, v167, v61
  v_mul_f32 v168, v168, v62
  v_mul_f32 v169, v169, v63
  v_exp_f32 v166, v166
  v_exp_f32 v167, v167
  v_exp_f32 v168, v168
  v_exp_f32 v169, v169
  v_add_f32 v166, 1.0, v166
  v_add_f32 v167, 1.0, v167
  v_add_f32 v168, 1.0, v168
  v_add_f32 v169, 1.0, v169
  v_rcp_f32 v166, v166
  v_rcp_f32 v167, v167
  v_rcp_f32 v168, v168
  v_rcp_f32 v169, v169
  v_mul_f32 v60, v60, v166
  v_mul_f32 v61, v61, v167
  v_mul_f32 v62, v62, v168
  v_mul_f32 v63, v63, v169
  v_fma_f32 v166, v176, v100, v136
  v_fma_f32 v167, v176, v101, v137
  v_fma_f32 v168, v176, v102, v138
  v_fma_f32 v169, v176, v103, v139
  v_fma_f32 v64, v64, v177, v166
  v_fma_f32 v65, v65, v177, v167
  v_fma_f32 v66, v66, v177, v168
  v_fma_f32 v67, v67, v177, v169
  v_mul_f32 v166, v64, v64
  v_mul_f32 v167, v65, v65
  v_mul_f32 v168, v66, v66
  v_mul_f32 v169, v67, v67
  v_fmamk_f32 v166, v166, 0xbdd2d3e8, v14
  v_fmamk_f32 v167, v167, 0xbdd2d3e8, v14
  v_fmamk_f32 v168, v168, 0xbdd2d3e8, v14
  v_fmamk_f32 v169, v169, 0xbdd2d3e8, v14
  v_mul_f32 v166, v166, v64
  v_mul_f32 v167, v167, v65
  v_mul_f32 v168, v168, v66
  v_mul_f32 v169, v169, v67
  v_exp_f32 v166, v166
  v_exp_f32 v167, v167
  v_exp_f32 v168, v168
  v_exp_f32 v169, v169
  v_add_f32 v166, 1.0, v166
  v_add_f32 v167, 1.0, v167
  v_add_f32 v168, 1.0, v168
  v_add_f32 v169, 1.0, v169
  v_rcp_f32 v166, v166
  v_rcp_f32 v167, v167
  v_rcp_f32 v168, v168
  v_rcp_f32 v169, v169
  v_mul_f32 v64, v64, v166
  v_mul_f32 v65, v65, v167
  v_mul_f32 v66, v66, v168
  v_mul_f32 v67, v67, v169
  v_fma_f32 v166, v176, v104, v140
  v_fma_f32 v167, v176, v105, v141
  v_fma_f32 v168, v176, v106, v142
  v_fma_f32 v169, v176, v107, v143
  v_fma_f32 v68, v68, v177, v166
  v_fma_f32 v69, v69, v177, v167
  v_fma_f32 v70, v70, v177, v168
  v_fma_f32 v71, v71, v177, v169
  v_mul_f32 v166, v68, v68
  v_mul_f32 v167, v69, v69
  v_mul_f32 v168, v70, v70
  v_mul_f32 v169, v71, v71
  v_fmamk_f32 v166, v166, 0xbdd2d3e8, v14
  v_fmamk_f32 v167, v167, 0xbdd2d3e8, v14
  v_fmamk_f32 v168, v168, 0xbdd2d3e8, v14
  v_fmamk_f32 v169, v169, 0xbdd2d3e8, v14
  v_mul_f32 v166, v166, v68
  v_mul_f32 v167, v167, v69
  v_mul_f32 v168, v168, v70
  v_mul_f32 v169, v169, v71
  v_exp_f32 v166, v166
  v_exp_f32 v167, v167
  v_exp_f32 v168, v168
  v_exp_f32 v169, v169
  v_add_f32 v166, 1.0, v166
  v_add_f32 v167, 1.0, v167
  v_add_f32 v168, 1.0, v168
  v_add_f32 v169, 1.0, v169
  v_rcp_f32 v166, v166
  v_rcp_f32 v167, v167
  v_rcp_f32 v168, v168
  v_rcp_f32 v169, v169
  v_mul_f32 v68, v68, v166
  v_mul_f32 v69, v69, v167
  v_mul_f32 v70, v70, v168
  v_mul_f32 v71, v71, v169
  v_fma_f32 v166, v176, v108, v144
  v_fma_f32 v167, v176, v109, v145
  v_fma_f32 v168, v176, v110, v146
  v_fma_f32 v169, v176, v111, v147
  v_fma_f32 v72, v72, v177, v166
  v_fma_f32 v73, v73, v177, v167
  v_fma_f32 v74, v74, v177, v168
  v_fma_f32 v75, v75, v177, v169
  v_mul_f32 v166, v72, v72
  v_mul_f32 v167, v73, v73
  v_mul_f32 v168, v74, v74
  v_mul_f32 v169, v75, v75
  v_fmamk_f32 v166, v166, 0xbdd2d3e8, v14
  v_fmamk_f32 v167, v167, 0xbdd2d3e8, v14
  v_fmamk_f32 v168, v168, 0xbdd2d3e8, v14
  v_fmamk_f32 v169, v169, 0xbdd2d3e8, v14
  v_mul_f32 v166, v166, v72
  v_mul_f32 v167, v167, v73
  v_mul_f32 v168, v168, v74
  v_mul_f32 v169, v169, v75
  v_exp_f32 v166, v166
  v_exp_f32 v167, v167
  v_exp_f32 v168, v168
  v_exp_f32 v169, v169
  v_add_f32 v166, 1.0, v166
  v_add_f32 v167, 1.0, v167
  v_add_f32 v168, 1.0, v168
  v_add_f32 v169, 1.0, v169
  v_rcp_f32 v166, v166
  v_rcp_f32 v167, v167
  v_rcp_f32 v168, v168
  v_rcp_f32 v169, v169
  v_mul_f32 v72, v72, v166
  v_mul_f32 v73, v73, v167
  v_mul_f32 v74, v74, v168
  v_mul_f32 v75, v75, v169
  v_fma_f32 v166, v176, v112, v148
  v_fma_f32 v167, v176, v113, v149
  v_fma_f32 v168, v176, v114, v150
  v_fma_f32 v169, v176, v115, v151
  v_fma_f32 v76, v76, v177, v166
  v_fma_f32 v77, v77, v177, v167
  v_fma_f32 v78, v78, v177, v168
  v_fma_f32 v79, v79, v177, v169
  v_mul_f32 v166, v76, v76
  v_mul_f32 v167, v77, v77
  v_mul_f32 v168, v78, v78
  v_mul_f32 v169, v79, v79
  v_fmamk_f32 v166, v166, 0xbdd2d3e8, v14
  v_fmamk_f32 v167, v167, 0xbdd2d3e8, v14
  v_fmamk_f32 v168, v168, 0xbdd2d3e8, v14
  v_fmamk_f32 v169, v169, 0xbdd2d3e8, v14
  v_mul_f32 v166, v166, v76
  v_mul_f32 v167, v167, v77
  v_mul_f32 v168, v168, v78
  v_mul_f32 v169, v169, v79
  v_exp_f32 v166, v166
  v_exp_f32 v167, v167
  v_exp_f32 v168, v168
  v_exp_f32 v169, v169
  v_add_f32 v166, 1.0, v166
  v_add_f32 v167, 1.0, v167
  v_add_f32 v168, 1.0, v168
  v_add_f32 v169, 1.0, v169
  v_rcp_f32 v166, v166
  v_rcp_f32 v167, v167
  v_rcp_f32 v168, v168
  v_rcp_f32 v169, v169
  v_mul_f32 v76, v76, v166
  v_mul_f32 v77, v77, v167
  v_mul_f32 v78, v78, v168
  v_mul_f32 v79, v79, v169
  v_fma_f32 v166, v176, v116, v152
  v_fma_f32 v167, v176, v117, v153
  v_fma_f32 v168, v176, v118, v154
  v_fma_f32 v169, v176, v119, v155
  v_fma_f32 v80, v80, v177, v166
  v_fma_f32 v81, v81, v177, v167
  v_fma_f32 v82, v82, v177, v168
  v_fma_f32 v83, v83, v177, v169
  v_mul_f32 v166, v80, v80
  v_mul_f32 v167, v81, v81
  v_mul_f32 v168, v82, v82
  v_mul_f32 v169, v83, v83
  v_fmamk_f32 v166, v166, 0xbdd2d3e8, v14
  v_fmamk_f32 v167, v167, 0xbdd2d3e8, v14
  v_fmamk_f32 v168, v168, 0xbdd2d3e8, v14
  v_fmamk_f32 v169, v169, 0xbdd2d3e8, v14
  v_mul_f32 v166, v166, v80
  v_mul_f32 v167, v167, v81
  v_mul_f32 v168, v168, v82
  v_mul_f32 v169, v169, v83
  v_exp_f32 v166, v166
  v_exp_f32 v167, v167
  v_exp_f32 v168, v168
  v_exp_f32 v169, v169
  v_add_f32 v166, 1.0, v166
  v_add_f32 v167, 1.0, v167
  v_add_f32 v168, 1.0, v168
  v_add_f32 v169, 1.0, v169
  v_rcp_f32 v166, v166
  v_rcp_f32 v167, v167
  v_rcp_f32 v168, v168
  v_rcp_f32 v169, v169
  v_mul_f32 v80, v80, v166
  v_mul_f32 v81, v81, v167
  v_mul_f32 v82, v82, v168
  v_mul_f32 v83, v83, v169
  v_fma_f32 v166, v176, v120, v156
  v_fma_f32 v167, v176, v121, v157
  v_fma_f32 v168, v176, v122, v158
  v_fma_f32 v169, v176, v123, v159
  v_fma_f32 v84, v84, v177, v166
  v_fma_f32 v85, v85, v177, v167
  v_fma_f32 v86, v86, v177, v168
  v_fma_f32 v87, v87, v177, v169
  v_mul_f32 v166, v84, v84
  v_mul_f32 v167, v85, v85
  v_mul_f32 v168, v86, v86
  v_mul_f32 v169, v87, v87
  v_fmamk_f32 v166, v166, 0xbdd2d3e8, v14
  v_fmamk_f32 v167, v167, 0xbdd2d3e8, v14
  v_fmamk_f32 v168, v168, 0xbdd2d3e8, v14
  v_fmamk_f32 v169, v169, 0xbdd2d3e8, v14
  v_mul_f32 v166, v166, v84
  v_mul_f32 v167, v167, v85
  v_mul_f32 v168, v168, v86
  v_mul_f32 v169, v169, v87
  v_exp_f32 v166, v166
  v_exp_f32 v167, v167
  v_exp_f32 v168, v168
  v_exp_f32 v169, v169
  v_add_f32 v166, 1.0, v166
  v_add_f32 v167, 1.0, v167
  v_add_f32 v168, 1.0, v168
  v_add_f32 v169, 1.0, v169
  v_rcp_f32 v166, v166
  v_rcp_f32 v167, v167
  v_rcp_f32 v168, v168
  v_rcp_f32 v169, v169
  v_mul_f32 v84, v84, v166
  v_mul_f32 v85, v85, v167
  v_mul_f32 v86, v86, v168
  v_mul_f32 v87, v87, v169
  v_fma_f32 v166, v176, v124, v160
  v_fma_f32 v167, v176, v125, v161
  v_fma_f32 v168, v176, v126, v162
  v_fma_f32 v169, v176, v127, v163
  v_fma_f32 v88, v88, v177, v166
  v_fma_f32 v89, v89, v177, v167
  v_fma_f32 v90, v90, v177, v168
  v_fma_f32 v91, v91, v177, v169
  v_mul_f32 v166, v88, v88
  v_mul_f32 v167, v89, v89
  v_mul_f32 v168, v90, v90
  v_mul_f32 v169, v91, v91
  v_fmamk_f32 v166, v166, 0xbdd2d3e8, v14
  v_fmamk_f32 v167, v167, 0xbdd2d3e8, v14
  v_fmamk_f32 v168, v168, 0xbdd2d3e8, v14
  v_fmamk_f32 v169, v169, 0xbdd2d3e8, v14
  v_mul_f32 v166, v166, v88
  v_mul_f32 v167, v167, v89
  v_mul_f32 v168, v168, v90
  v_mul_f32 v169, v169, v91
  v_exp_f32 v166, v166
  v_exp_f32 v167, v167
  v_exp_f32 v168, v168
  v_exp_f32 v169, v169
  v_add_f32 v166, 1.0, v166
  v_add_f32 v167, 1.0, v167
  v_add_f32 v168, 1.0, v168
  v_add_f32 v169, 1.0, v169
  v_rcp_f32 v166, v166
  v_rcp_f32 v167, v167
  v_rcp_f32 v168, v168
  v_rcp_f32 v169, v169
  v_mul_f32 v88, v88, v166
  v_mul_f32 v89, v89, v167
  v_mul_f32 v90, v90, v168
  v_mul_f32 v91, v91, v169
  s_cmp_lt_u32 s2, 256
  s_cbranch_scc1 k3_z2
  v_mov_b32 v6, v1
  s_branch k3_st
k3_z2:
  v_mov_b32 v164, 0
  v_mov_b32 v165, 0
  v_add_f32 v164, v164, v20
  v_fmac_f32 v165, v20, v20
  v_add_f32 v164, v164, v21
  v_fmac_f32 v165, v21, v21
  v_add_f32 v164, v164, v22
  v_fmac_f32 v165, v22, v22
  v_add_f32 v164, v164, v23
  v_fmac_f32 v165, v23, v23
  v_add_f32 v164, v164, v24
  v_fmac_f32 v165, v24, v24
  v_add_f32 v164, v164, v25
  v_fmac_f32 v165, v25, v25
  v_add_f32 v164, v164, v26
  v_fmac_f32 v165, v26, v26
  v_add_f32 v164, v164, v27
  v_fmac_f32 v165, v27, v27
  v_add_f32 v164, v164, v28
  v_fmac_f32 v165, v28, v28
  v_add_f32 v164, v164, v29
  v_fmac_f32 v165, v29, v29
  v_add_f32 v164, v164, v30
  v_fmac_f32 v165, v30, v30
  v_add_f32 v164, v164, v31
  v_fmac_f32 v165, v31, v31
  v_add_f32 v164, v164, v32
  v_fmac_f32 v165, v32, v32
  v_add_f32 v164, v164, v33
  v_fmac_f32 v165, v33, v33
  v_add_f32 v164, v164, v34
  v_fmac_f32 v165, v34, v34
  v_add_f32 v164, v164, v35
  v_fmac_f32 v165, v35, v35
  v_add_f32 v164, v164, v36
  v_fmac_f32 v165, v36, v36
  v_add_f32 v164, v164, v37
  v_fmac_f32 v165, v37, v37
  v_add_f32 v164, v164, v38
  v_fmac_f32 v165, v38, v38
  v_add_f32 v164, v164, v39
  v_fmac_f32 v165, v39, v39
  v_add_f32 v164, v164, v40
  v_fmac_f32 v165, v40, v40
  v_add_f32 v164, v164, v41
  v_fmac_f32 v165, v41, v41
  v_add_f32 v164, v164, v42
  v_fmac_f32 v165, v42, v42
  v_add_f32 v164, v164, v43
  v_fmac_f32 v165, v43, v43
  v_add_f32 v164, v164, v44
  v_fmac_f32 v165, v44, v44
  v_add_f32 v164, v164, v45
  v_fmac_f32 v165, v45, v45
  v_add_f32 v164, v164, v46
  v_fmac_f32 v165, v46, v46
  v_add_f32 v164, v164, v47
  v_fmac_f32 v165, v47, v47
  v_add_f32 v164, v164, v48
  v_fmac_f32 v165, v48, v48
  v_add_f32 v164, v164, v49
  v_fmac_f32 v165, v49, v49
  v_add_f32 v164, v164, v50
  v_fmac_f32 v165, v50, v50
  v_add_f32 v164, v164, v51
  v_fmac_f32 v165, v51, v51
  v_add_f32 v164, v164, v52
  v_fmac_f32 v165, v52, v52
  v_add_f32 v164, v164, v53
  v_fmac_f32 v165, v53, v53
  v_add_f32 v164, v164, v54
  v_fmac_f32 v165, v54, v54
  v_add_f32 v164, v164, v55
  v_fmac_f32 v165, v55, v55
  v_mov_b32 v166, 0
  v_mov_b32 v167, 0
  v_add_f32 v166, v166, v56
  v_fmac_f32 v167, v56, v56
  v_add_f32 v166, v166, v57
  v_fmac_f32 v167, v57, v57
  v_add_f32 v166, v166, v58
  v_fmac_f32 v167, v58, v58
  v_add_f32 v166, v166, v59
  v_fmac_f32 v167, v59, v59
  v_add_f32 v166, v166, v60
  v_fmac_f32 v167, v60, v60
  v_add_f32 v166, v166, v61
  v_fmac_f32 v167, v61, v61
  v_add_f32 v166, v166, v62
  v_fmac_f32 v167, v62, v62
  v_add_f32 v166, v166, v63
  v_fmac_f32 v167, v63, v63
  v_add_f32 v166, v166, v64
  v_fmac_f32 v167, v64, v64
  v_add_f32 v166, v166, v65
  v_fmac_f32 v167, v65, v65
  v_add_f32 v166, v166, v66
  v_fmac_f32 v167, v66, v66
  v_add_f32 v166, v166, v67
  v_fmac_f32 v167, v67, v67
  v_add_f32 v166, v166, v68
  v_fmac_f32 v167, v68, v68
  v_add_f32 v166, v166, v69
  v_fmac_f32 v167, v69, v69
  v_add_f32 v166, v166, v70
  v_fmac_f32 v167, v70, v70
  v_add_f32 v166, v166, v71
  v_fmac_f32 v167, v71, v71
  v_add_f32 v166, v166, v72
  v_fmac_f32 v167, v72, v72
  v_add_f32 v166, v166, v73
  v_fmac_f32 v167, v73, v73
  v_add_f32 v166, v166, v74
  v_fmac_f32 v167, v74, v74
  v_add_f32 v166, v166, v75
  v_fmac_f32 v167, v75, v75
  v_add_f32 v166, v166, v76
  v_fmac_f32 v167, v76, v76
  v_add_f32 v166, v166, v77
  v_fmac_f32 v167, v77, v77
  v_add_f32 v166, v166, v78
  v_fmac_f32 v167, v78, v78
  v_add_f32 v166, v166, v79
  v_fmac_f32 v167, v79, v79
  v_add_f32 v166, v166, v80
  v_fmac_f32 v167, v80, v80
  v_add_f32 v166, v166, v81
  v_fmac_f32 v167, v81, v81
  v_add_f32 v166, v166, v82
  v_fmac_f32 v167, v82, v82
  v_add_f32 v166, v166, v83
  v_fmac_f32 v167, v83, v83
  v_add_f32 v166, v166, v84
  v_fmac_f32 v167, v84, v84
  v_add_f32 v166, v166, v85
  v_fmac_f32 v167, v85, v85
  v_add_f32 v166, v166, v86
  v_fmac_f32 v167, v86, v86
  v_add_f32 v166, v166, v87
  v_fmac_f32 v167, v87, v87
  v_add_f32 v166, v166, v88
  v_fmac_f32 v167, v88, v88
  v_add_f32 v166, v166, v89
  v_fmac_f32 v167, v89, v89
  v_add_f32 v166, v166, v90
  v_fmac_f32 v167, v90, v90
  v_add_f32 v166, v166, v91
  v_fmac_f32 v167, v91, v91
  v_mov_b32 v168, v164
  v_mov_b32 v169, v165
  v_mov_b32 v170, v166
  v_mov_b32 v171, v167
  s_nop 1
  v_permlane16_swap_b32 v164, v168
  v_permlane16_swap_b32 v165, v169
  v_permlane16_swap_b32 v166, v170
  v_permlane16_swap_b32 v167, v171
  s_nop 1
  v_add_f32 v164, v164, v168
  v_add_f32 v165, v165, v169
  v_add_f32 v166, v166, v170
  v_add_f32 v167, v167, v171
  v_mov_b32 v168, v164
  v_mov_b32 v169, v165
  v_mov_b32 v170, v166
  v_mov_b32 v171, v167
  s_nop 1
  v_permlane32_swap_b32 v164, v168
  v_permlane32_swap_b32 v165, v169
  v_permlane32_swap_b32 v166, v170
  v_permlane32_swap_b32 v167, v171
  s_nop 1
  v_add_f32 v164, v164, v168
  v_add_f32 v165, v165, v169
  v_add_f32 v166, v166, v170
  v_add_f32 v167, v167, v171
  v_min_u32 v165, -2, v165
  v_min_u32 v167, -2, v167
  s_lshl_b32 s48, s31, 14
  buffer_store_dwordx2 v[164:165], v7, s[56:59], s48 offen offset:0 sc1
  buffer_store_dwordx2 v[166:167], v7, s[56:59], s48 offen offset:128 sc1
  v_lshrrev_b32 v15, 4, v0
  v_lshl_add_u32 v15, v15, 16, v7
  v_bfe_u32 v4, v0, 2, 2
  v_lshlrev_b32 v6, 8, v4
  v_lshrrev_b32 v4, 4, v0
  v_lshl_add_u32 v6, v4, 6, v6
  v_and_b32 v4, 3, v0
  v_lshl_add_u32 v6, v4, 4, v6
  s_setprio 0
  s_waitcnt vmcnt(0)
k3_poll:
  s_mov_b32 s48, 0
  buffer_load_dwordx2 v[164:165], v15, s[56:59], s48 offen offset:0 sc1
  s_mov_b32 s48, 16384
  buffer_load_dwordx2 v[166:167], v15, s[56:59], s48 offen offset:0 sc1
  s_mov_b32 s48, 32768
  buffer_load_dwordx2 v[168:169], v15, s[56:59], s48 offen offset:0 sc1
  s_mov_b32 s48, 49152
  buffer_load_dwordx2 v[170:171], v15, s[56:59], s48 offen offset:0 sc1
  s_mov_b32 s48, 0
  buffer_load_dwordx2 v[172:173], v15, s[56:59], s48 offen offset:128 sc1
  s_mov_b32 s48, 16384
  buffer_load_dwordx2 v[174:175], v15, s[56:59], s48 offen offset:128 sc1
  s_mov_b32 s48, 32768
  buffer_load_dwordx2 v[176:177], v15, s[56:59], s48 offen offset:128 sc1
  s_mov_b32 s48, 49152
  buffer_load_dwordx2 v[178:179], v15, s[56:59], s48 offen offset:128 sc1
  s_waitcnt vmcnt(0)
  v_max3_u32 v4, v165, v167, v169
  v_max3_u32 v4, v4, v171, v173
  v_max3_u32 v4, v4, v175, v177
  v_max_u32 v4, v4, v179
  v_cmp_eq_u32 vcc, -1, v4
  s_nop 4
  s_cbranch_vccz k3_pk
  s_sleep 2
  s_branch k3_poll
k3_pk:
  s_setprio 3
  v_add_f32 v164, v164, v166
  v_add_f32 v165, v165, v167
  v_add_f32 v164, v164, v168
  v_add_f32 v165, v165, v169
  v_add_f32 v164, v164, v170
  v_add_f32 v165, v165, v171
  v_add_f32 v172, v172, v174
  v_add_f32 v173, v173, v175
  v_add_f32 v172, v172, v176
  v_add_f32 v173, v173, v177
  v_add_f32 v172, v172, v178
  v_add_f32 v173, v173, v179
  v_mov_b32 v168, v164
  v_mov_b32 v169, v165
  v_mov_b32 v170, v172
  v_mov_b32 v171, v173
  s_nop 1
  v_permlane16_swap_b32 v164, v168
  v_permlane16_swap_b32 v165, v169
  v_permlane16_swap_b32 v172, v170
  v_permlane16_swap_b32 v173, v171
  s_nop 1
  v_add_f32 v164, v164, v168
  v_add_f32 v165, v165, v169
  v_add_f32 v172, v172, v170
  v_add_f32 v173, v173, v171
  v_mov_b32 v168, v164
  v_mov_b32 v169, v165
  v_mov_b32 v170, v172
  v_mov_b32 v171, v173
  s_nop 1
  v_permlane32_swap_b32 v164, v168
  v_permlane32_swap_b32 v165, v169
  v_permlane32_swap_b32 v172, v170
  v_permlane32_swap_b32 v173, v171
  s_nop 1
  v_add_f32 v164, v164, v168
  v_add_f32 v165, v165, v169
  v_add_f32 v172, v172, v170
  v_add_f32 v173, v173, v171
  v_mul_f32 v164, 0xb9e38e39, v164
  v_mov_b32 v4, 0x3727c5ac
  v_fmamk_f32 v165, v165, 0x39e38e39, v4
  v_fma_f32 v165, -v164, v164, v165
  v_max_f32 v165, v165, v4
  v_rsq_f32 v165, v165
  s_nop 0
  v_mul_f32 v164, v164, v165
  v_fma_f32 v20, v20, v165, v164
  v_fma_f32 v21, v21, v165, v164
  v_fma_f32 v22, v22, v165, v164
  v_fma_f32 v23, v23, v165, v164
  v_fma_f32 v24, v24, v165, v164
  v_fma_f32 v25, v25, v165, v164
  v_fma_f32 v26, v26, v165, v164
  v_fma_f32 v27, v27, v165, v164
  v_fma_f32 v28, v28, v165, v164
  v_fma_f32 v29, v29, v165, v164
  v_fma_f32 v30, v30, v165, v164
  v_fma_f32 v31, v31, v165, v164
  v_fma_f32 v32, v32, v165, v164
  v_fma_f32 v33, v33, v165, v164
  v_fma_f32 v34, v34, v165, v164
  v_fma_f32 v35, v35, v165, v164
  v_fma_f32 v36, v36, v165, v164
  v_fma_f32 v37, v37, v165, v164
  v_fma_f32 v38, v38, v165, v164
  v_fma_f32 v39, v39, v165, v164
  v_fma_f32 v40, v40, v165, v164
  v_fma_f32 v41, v41, v165, v164
  v_fma_f32 v42, v42, v165, v164
  v_fma_f32 v43, v43, v165, v164
  v_fma_f32 v44, v44, v165, v164
  v_fma_f32 v45, v45, v165, v164
  v_fma_f32 v46, v46, v165, v164
  v_fma_f32 v47, v47, v165, v164
  v_fma_f32 v48, v48, v165, v164
  v_fma_f32 v49, v49, v165, v164
  v_fma_f32 v50, v50, v165, v164
  v_fma_f32 v51, v51, v165, v164
  v_fma_f32 v52, v52, v165, v164
  v_fma_f32 v53, v53, v165, v164
  v_fma_f32 v54, v54, v165, v164
  v_fma_f32 v55, v55, v165, v164
  v_mul_f32 v172, 0xb9e38e39, v172
  v_mov_b32 v4, 0x3727c5ac
  v_fmamk_f32 v173, v173, 0x39e38e39, v4
  v_fma_f32 v173, -v172, v172, v173
  v_max_f32 v173, v173, v4
  v_rsq_f32 v173, v173
  s_nop 0
  v_mul_f32 v172, v172, v173
  v_fma_f32 v56, v56, v173, v172
  v_fma_f32 v57, v57, v173, v172
  v_fma_f32 v58, v58, v173, v172
  v_fma_f32 v59, v59, v173, v172
  v_fma_f32 v60, v60, v173, v172
  v_fma_f32 v61, v61, v173, v172
  v_fma_f32 v62, v62, v173, v172
  v_fma_f32 v63, v63, v173, v172
  v_fma_f32 v64, v64, v173, v172
  v_fma_f32 v65, v65, v173, v172
  v_fma_f32 v66, v66, v173, v172
  v_fma_f32 v67, v67, v173, v172
  v_fma_f32 v68, v68, v173, v172
  v_fma_f32 v69, v69, v173, v172
  v_fma_f32 v70, v70, v173, v172
  v_fma_f32 v71, v71, v173, v172
  v_fma_f32 v72, v72, v173, v172
  v_fma_f32 v73, v73, v173, v172
  v_fma_f32 v74, v74, v173, v172
  v_fma_f32 v75, v75, v173, v172
  v_fma_f32 v76, v76, v173, v172
  v_fma_f32 v77, v77, v173, v172
  v_fma_f32 v78, v78, v173, v172
  v_fma_f32 v79, v79, v173, v172
  v_fma_f32 v80, v80, v173, v172
  v_fma_f32 v81, v81, v173, v172
  v_fma_f32 v82, v82, v173, v172
  v_fma_f32 v83, v83, v173, v172
  v_fma_f32 v84, v84, v173, v172
  v_fma_f32 v85, v85, v173, v172
  v_fma_f32 v86, v86, v173, v172
  v_fma_f32 v87, v87, v173, v172
  v_fma_f32 v88, v88, v173, v172
  v_fma_f32 v89, v89, v173, v172
  v_fma_f32 v90, v90, v173, v172
  v_fma_f32 v91, v91, v173, v172
k3_st:
  v_cvt_pk_bf16_f32 v92, v20, v21
  v_cvt_pk_bf16_f32 v93, v22, v23
  v_cvt_pk_bf16_f32 v94, v56, v57
  v_cvt_pk_bf16_f32 v95, v58, v59
  s_mov_b32 s48, 0
  buffer_store_dwordx4 v[92:95], v6, s[52:55], s48 offen sc1
  v_cvt_pk_bf16_f32 v96, v24, v25
  v_cvt_pk_bf16_f32 v97, v26, v27
  v_cvt_pk_bf16_f32 v98, v60, v61
  v_cvt_pk_bf16_f32 v99, v62, v63
  s_mov_b32 s48, 1024
  buffer_store_dwordx4 v[96:99], v6, s[52:55], s48 offen sc1
  v_cvt_pk_bf16_f32 v100, v28, v29
  v_cvt_pk_bf16_f32 v101, v30, v31
  v_cvt_pk_bf16_f32 v102, v64, v65
  v_cvt_pk_bf16_f32 v103, v66, v67
  s_mov_b32 s48, 2048
  buffer_store_dwordx4 v[100:103], v6, s[52:55], s48 offen sc1
  v_cvt_pk_bf16_f32 v104, v32, v33
  v_cvt_pk_bf16_f32 v105, v34, v35
  v_cvt_pk_bf16_f32 v106, v68, v69
  v_cvt_pk_bf16_f32 v107, v70, v71
  s_mov_b32 s48, 3072
  buffer_store_dwordx4 v[104:107], v6, s[52:55], s48 offen sc1
  v_cvt_pk_bf16_f32 v108, v36, v37
  v_cvt_pk_bf16_f32 v109, v38, v39
  v_cvt_pk_bf16_f32 v110, v72, v73
  v_cvt_pk_bf16_f32 v111, v74, v75
  s_mov_b32 s48, 4096
  buffer_store_dwordx4 v[108:111], v6, s[52:55], s48 offen sc1
  v_cvt_pk_bf16_f32 v112, v40, v41
  v_cvt_pk_bf16_f32 v113, v42, v43
  v_cvt_pk_bf16_f32 v114, v76, v77
  v_cvt_pk_bf16_f32 v115, v78, v79
  s_mov_b32 s48, 5120
  buffer_store_dwordx4 v[112:115], v6, s[52:55], s48 offen sc1
  v_cvt_pk_bf16_f32 v116, v44, v45
  v_cvt_pk_bf16_f32 v117, v46, v47
  v_cvt_pk_bf16_f32 v118, v80, v81
  v_cvt_pk_bf16_f32 v119, v82, v83
  s_mov_b32 s48, 6144
  buffer_store_dwordx4 v[116:119], v6, s[52:55], s48 offen sc1
  v_cvt_pk_bf16_f32 v120, v48, v49
  v_cvt_pk_bf16_f32 v121, v50, v51
  v_cvt_pk_bf16_f32 v122, v84, v85
  v_cvt_pk_bf16_f32 v123, v86, v87
  s_mov_b32 s48, 7168
  buffer_store_dwordx4 v[120:123], v6, s[52:55], s48 offen sc1
  v_cvt_pk_bf16_f32 v124, v52, v53
  v_cvt_pk_bf16_f32 v125, v54, v55
  v_cvt_pk_bf16_f32 v126, v88, v89
  v_cvt_pk_bf16_f32 v127, v90, v91
  s_mov_b32 s48, 8192
  buffer_store_dwordx4 v[124:127], v6, s[52:55], s48 offen sc1
  s_lshl_b32 s48, s43, 6
  s_add_u32 s48, s48, s34
  s_lshl_b32 s48, s48, 7
  s_add_u32 s56, s10, 52215808
  s_addc_u32 s57, s11, 0
  s_add_u32 s56, s56, s48
  s_addc_u32 s57, s57, 0
  s_mov_b32 s58, 4
  s_mov_b32 s59, 0x20000
  v_mov_b32 v13, 0
  s_waitcnt vmcnt(0)
  buffer_store_dword v13, v1, s[56:59], 0 offen sc1
k4_body:
  s_cmp_ge_u32 s2, 256
  s_cbranch_scc1 k4_end
  s_setprio 0
  s_load_dwordx2 s[4:5], s[0:1], 64
  s_and_b32 s32, s2, 7
  s_bfe_u32 s33, s2, 0x50003
  s_and_b32 s30, s33, 7
  s_lshr_b32 s31, s33, 3
  s_and_b32 s33, s32, 1
  s_lshl_b32 s33, s33, 3
  s_add_u32 s30, s30, s33
  s_lshr_b32 s32, s32, 1
  s_lshl_b32 s32, s32, 2
  s_add_u32 s31, s31, s32
  s_lshl_b32 s34, s30, 2
  s_add_u32 s34, s34, s3
  s_mul_i32 s35, s31, 589824
  s_lshl_b32 s37, s34, 17
  s_mul_i32 s38, s34, 9216
  s_add_u32 s38, s38, s35
  s_lshl_b32 s39, s34, 6
  s_mul_i32 s40, s34, 147456
  s_mul_i32 s41, s31, 9
  s_lshr_b32 s41, s41, 1
  s_lshl_b32 s41, s41, 11
  s_add_u32 s40, s40, s41
  s_waitcnt lgkmcnt(0)
  s_add_u32 s12, s10, 41861120
  s_addc_u32 s13, s11, 0
  s_add_u32 s12, s12, s35
  s_addc_u32 s13, s13, 0
  s_mov_b32 s14, 589824
  s_mov_b32 s15, 0x20000
  s_add_u32 s16, s10, 2375680
  s_addc_u32 s17, s11, 0
  s_add_u32 s16, s16, s37
  s_addc_u32 s17, s17, 0
  s_mov_b32 s18, 131072
  s_mov_b32 s19, 0x20000
  s_add_u32 s20, s10, 32423936
  s_addc_u32 s21, s11, 0
  s_add_u32 s20, s20, s38
  s_addc_u32 s21, s21, 0
  s_mov_b32 s22, 9216
  s_mov_b32 s23, 0x20000
  s_add_u32 s24, s4, 0
  s_addc_u32 s25, s5, 0
  s_add_u32 s24, s24, s39
  s_addc_u32 s25, s25, 0
  s_mov_b32 s26, 64
  s_mov_b32 s27, 0x20000
  s_add_u32 s52, s10, 59817984
  s_addc_u32 s53, s11, 0
  s_add_u32 s52, s52, s40
  s_addc_u32 s53, s53, 0
  s_mov_b32 s54, 10240
  s_mov_b32 s55, 0x20000
  s_lshl_b32 s41, s34, 4
  s_add_u32 s41, s41, s31
  s_lshl_b32 s41, s41, 7
  s_add_u32 s60, s10, 51658752
  s_addc_u32 s61, s11, 0
  s_add_u32 s60, s60, s41
  s_addc_u32 s61, s61, 0
  s_mov_b32 s62, 4
  s_mov_b32 s63, 0x20000
  s_mov_b32 s44, 0
  s_mov_b32 s45, 0
  v_and_b32 v0, 63, v0
  v_lshlrev_b32 v1, 4, v0
  s_mul_i32 s46, s3, 4608
  s_add_u32 s48, s46, 0
  v_add_u32 v2, s48, v1
  s_add_u32 s48, s46, 1024
  v_add_u32 v3, s48, v1
  s_add_u32 s48, s46, 2048
  v_add_u32 v4, s48, v1
  s_add_u32 s48, s46, 3072
  v_add_u32 v5, s48, v1
  s_add_u32 s48, s46, 4096
  v_add_u32 v6, s48, v1
  v_and_b32 v18, 15, v0
  v_lshlrev_b32 v18, 1, v18
  buffer_load_dwordx4 v[180:183], v1, s[16:19], s45 offen offset:0
  buffer_load_dwordx4 v[184:187], v1, s[16:19], s45 offen offset:1024
  buffer_load_dwordx4 v[188:191], v1, s[16:19], s45 offen offset:2048
  buffer_load_dwordx4 v[192:195], v1, s[16:19], s45 offen offset:3072
  s_add_u32 s45, s45, 4096
  buffer_load_dwordx4 v[196:199], v1, s[16:19], s45 offen offset:0
  buffer_load_dwordx4 v[200:203], v1, s[16:19], s45 offen offset:1024
  buffer_load_dwordx4 v[204:207], v1, s[16:19], s45 offen offset:2048
  buffer_load_dwordx4 v[208:211], v1, s[16:19], s45 offen offset:3072
  s_add_u32 s45, s45, 4096
  s_lshl_b32 s48, s31, 13
  v_lshlrev_b32 v12, 7, v0
  s_add_u32 s40, s10, 52346880
  s_addc_u32 s41, s11, 0
  s_add_u32 s40, s40, s48
  s_addc_u32 s41, s41, 0
  s_mov_b32 s42, 8192
  s_mov_b32 s43, 0x20000
  s_lshl_b32 s49, s34, 7
  s_add_u32 s48, s48, s49
  s_add_u32 s56, s10, 52215808
  s_addc_u32 s57, s11, 0
  s_add_u32 s56, s56, s48
  s_addc_u32 s57, s57, 0
  s_mov_b32 s58, 4
  s_mov_b32 s59, 0x20000
  s_cmp_lg_u32 s3, 0
  s_cbranch_scc1 k4p_b
k4p_a:
  buffer_load_dword v13, v12, s[40:43], 0 offen sc1
  s_waitcnt vmcnt(0)
k4p_c:
  v_cmp_ne_u32 vcc, 0, v13
  s_nop 1
  s_cbranch_vccz k4p_b
  s_sleep 3
  s_branch k4p_a
k4p_b:
  s_barrier
  s_add_u32 m0, s46, 0
  s_nop 0
  buffer_load_dwordx4 v2, s[12:15], s44 offen sc1 lds
  s_add_u32 m0, s46, 1024
  s_nop 0
  buffer_load_dwordx4 v3, s[12:15], s44 offen sc1 lds
  s_add_u32 m0, s46, 2048
  s_nop 0
  buffer_load_dwordx4 v4, s[12:15], s44 offen sc1 lds
  s_add_u32 m0, s46, 3072
  s_nop 0
  buffer_load_dwordx4 v5, s[12:15], s44 offen sc1 lds
  s_add_u32 m0, s46, 4096
  s_nop 0
  s_mov_b32 exec_hi, 0
  buffer_load_dwordx4 v6, s[12:15], s44 offen sc1 lds
  s_mov_b32 exec_hi, -1
  s_add_u32 s44, s44, 18432
  s_add_u32 m0, s46, 18432
  s_nop 0
  buffer_load_dwordx4 v2, s[12:15], s44 offen sc1 lds
  s_add_u32 m0, s46, 19456
  s_nop 0
  buffer_load_dwordx4 v3, s[12:15], s44 offen sc1 lds
  s_add_u32 m0, s46, 20480
  s_nop 0
  buffer_load_dwordx4 v4, s[12:15], s44 offen sc1 lds
  s_add_u32 m0, s46, 21504
  s_nop 0
  buffer_load_dwordx4 v5, s[12:15], s44 offen sc1 lds
  s_add_u32 m0, s46, 22528
  s_nop 0
  s_mov_b32 exec_hi, 0
  buffer_load_dwordx4 v6, s[12:15], s44 offen sc1 lds
  s_mov_b32 exec_hi, -1
  s_add_u32 s44, s44, 18432
  v_lshrrev_b32 v14, 5, v0
  v_lshlrev_b32 v8, 9, v14
  v_and_b32 v14, 3, v0
  v_lshl_add_u32 v8, v14, 6, v8
  v_bfe_u32 v14, v0, 2, 2
  v_lshl_add_u32 v8, v14, 4, v8
  v_bfe_u32 v14, v0, 4, 1
  v_lshl_add_u32 v8, v14, 3, v8
  v_add_u32 v9, 55296, v8
  v_mov_b32 v20, 0
  v_mov_b32 v21, 0
  v_mov_b32 v22, 0
  v_mov_b32 v23, 0
  v_mov_b32 v24, 0
  v_mov_b32 v25, 0
  v_mov_b32 v26, 0
  v_mov_b32 v27, 0
  v_mov_b32 v28, 0
  v_mov_b32 v29, 0
  v_mov_b32 v30, 0
  v_mov_b32 v31, 0
  v_mov_b32 v32, 0
  v_mov_b32 v33, 0
  v_mov_b32 v34, 0
  v_mov_b32 v35, 0
  v_mov_b32 v36, 0
  v_mov_b32 v37, 0
  v_mov_b32 v38, 0
  v_mov_b32 v39, 0
  v_mov_b32 v40, 0
  v_mov_b32 v41, 0
  v_mov_b32 v42, 0
  v_mov_b32 v43, 0
  v_mov_b32 v44, 0
  v_mov_b32 v45, 0
  v_mov_b32 v46, 0
  v_mov_b32 v47, 0
  v_mov_b32 v48, 0
  v_mov_b32 v49, 0
  v_mov_b32 v50, 0
  v_mov_b32 v51, 0
  v_mov_b32 v52, 0
  v_mov_b32 v53, 0
  v_mov_b32 v54, 0
  v_mov_b32 v55, 0
  v_mov_b32 v56, 0
  v_mov_b32 v57, 0
  v_mov_b32 v58, 0
  v_mov_b32 v59, 0
  v_mov_b32 v60, 0
  v_mov_b32 v61, 0
  v_mov_b32 v62, 0
  v_mov_b32 v63, 0
  v_mov_b32 v64, 0
  v_mov_b32 v65, 0
  v_mov_b32 v66, 0
  v_mov_b32 v67, 0
  v_mov_b32 v68, 0
  v_mov_b32 v69, 0
  v_mov_b32 v70, 0
  v_mov_b32 v71, 0
  v_mov_b32 v72, 0
  v_mov_b32 v73, 0
  v_mov_b32 v74, 0
  v_mov_b32 v75, 0
  v_mov_b32 v76, 0
  v_mov_b32 v77, 0
  v_mov_b32 v78, 0
  v_mov_b32 v79, 0
  v_mov_b32 v80, 0
  v_mov_b32 v81, 0
  v_mov_b32 v82, 0
  v_mov_b32 v83, 0
  v_mov_b32 v84, 0
  v_mov_b32 v85, 0
  v_mov_b32 v86, 0
  v_mov_b32 v87, 0
  v_mov_b32 v88, 0
  v_mov_b32 v89, 0
  v_mov_b32 v90, 0
  v_mov_b32 v91, 0
  s_waitcnt vmcnt(5)
  s_barrier
  ds_read_b64_tr_b16 v[92:93], v8 offset:0
  ds_read_b64_tr_b16 v[94:95], v8 offset:256
  ds_read_b64_tr_b16 v[96:97], v8 offset:1024
  ds_read_b64_tr_b16 v[98:99], v8 offset:1280
  ds_read_b64_tr_b16 v[100:101], v8 offset:2048
  ds_read_b64_tr_b16 v[102:103], v8 offset:2304
  ds_read_b64_tr_b16 v[104:105], v8 offset:3072
  ds_read_b64_tr_b16 v[106:107], v8 offset:3328
  ds_read_b64_tr_b16 v[108:109], v8 offset:4096
  ds_read_b64_tr_b16 v[110:111], v8 offset:4352
  ds_read_b64_tr_b16 v[112:113], v8 offset:5120
  ds_read_b64_tr_b16 v[114:115], v8 offset:5376
  ds_read_b64_tr_b16 v[116:117], v8 offset:6144
  ds_read_b64_tr_b16 v[118:119], v8 offset:6400
  ds_read_b64_tr_b16 v[120:121], v8 offset:7168
  ds_read_b64_tr_b16 v[122:123], v8 offset:7424
  ds_read_b64_tr_b16 v[124:125], v8 offset:8192
  ds_read_b64_tr_b16 v[126:127], v8 offset:8448
  s_add_u32 m0, s46, 36864
  s_nop 0
  buffer_load_dwordx4 v2, s[12:15], s44 offen sc1 lds
  s_add_u32 m0, s46, 37888
  s_nop 0
  buffer_load_dwordx4 v3, s[12:15], s44 offen sc1 lds
  s_add_u32 m0, s46, 38912
  s_nop 0
  buffer_load_dwordx4 v4, s[12:15], s44 offen sc1 lds
  s_add_u32 m0, s46, 39936
  s_nop 0
  buffer_load_dwordx4 v5, s[12:15], s44 offen sc1 lds
  s_add_u32 m0, s46, 40960
  s_nop 0
  s_mov_b32 exec_hi, 0
  buffer_load_dwordx4 v6, s[12:15], s44 offen sc1 lds
  s_mov_b32 exec_hi, -1
  s_add_u32 s44, s44, 18432
  s_mov_b32 s47, 7
k4_loop:
  s_waitcnt lgkmcnt(8)
  v_mfma_f32_16x16x32_bf16 v[20:23], v[92:95], v[180:183], v[20:23]
  ds_read_b64_tr_b16 v[128:129], v8 offset:9216
  ds_read_b64_tr_b16 v[130:131], v8 offset:9472
  buffer_load_dwordx4 v[212:215], v1, s[16:19], s45 offen offset:0
  v_mfma_f32_16x16x32_bf16 v[56:59], v[92:95], v[184:187], v[56:59]
  ds_read_b64_tr_b16 v[132:133], v8 offset:10240
  v_mfma_f32_16x16x32_bf16 v[24:27], v[96:99], v[180:183], v[24:27]
  ds_read_b64_tr_b16 v[134:135], v8 offset:10496
  v_mfma_f32_16x16x32_bf16 v[60:63], v[96:99], v[184:187], v[60:63]
  ds_read_b64_tr_b16 v[136:137], v8 offset:11264
  v_mfma_f32_16x16x32_bf16 v[28:31], v[100:103], v[180:183], v[28:31]
  ds_read_b64_tr_b16 v[138:139], v8 offset:11520
  buffer_load_dwordx4 v[216:219], v1, s[16:19], s45 offen offset:1024
  v_mfma_f32_16x16x32_bf16 v[64:67], v[100:103], v[184:187], v[64:67]
  ds_read_b64_tr_b16 v[92:93], v8 offset:12288
  v_mfma_f32_16x16x32_bf16 v[32:35], v[104:107], v[180:183], v[32:35]
  ds_read_b64_tr_b16 v[94:95], v8 offset:12544
  v_mfma_f32_16x16x32_bf16 v[68:71], v[104:107], v[184:187], v[68:71]
  ds_read_b64_tr_b16 v[96:97], v8 offset:13312
  v_mfma_f32_16x16x32_bf16 v[36:39], v[108:111], v[180:183], v[36:39]
  ds_read_b64_tr_b16 v[98:99], v8 offset:13568
  ds_read_b64_tr_b16 v[100:101], v8 offset:14336
  buffer_load_dwordx4 v[220:223], v1, s[16:19], s45 offen offset:2048
  v_mfma_f32_16x16x32_bf16 v[72:75], v[108:111], v[184:187], v[72:75]
  ds_read_b64_tr_b16 v[102:103], v8 offset:14592
  s_waitcnt lgkmcnt(12)
  v_mfma_f32_16x16x32_bf16 v[40:43], v[112:115], v[180:183], v[40:43]
  ds_read_b64_tr_b16 v[104:105], v8 offset:15360
  v_mfma_f32_16x16x32_bf16 v[76:79], v[112:115], v[184:187], v[76:79]
  ds_read_b64_tr_b16 v[106:107], v8 offset:15616
  v_mfma_f32_16x16x32_bf16 v[44:47], v[116:119], v[180:183], v[44:47]
  ds_read_b64_tr_b16 v[108:109], v8 offset:16384
  buffer_load_dwordx4 v[224:227], v1, s[16:19], s45 offen offset:3072
  s_add_u32 s45, s45, 4096
  v_mfma_f32_16x16x32_bf16 v[80:83], v[116:119], v[184:187], v[80:83]
  ds_read_b64_tr_b16 v[110:111], v8 offset:16640
  v_mfma_f32_16x16x32_bf16 v[48:51], v[120:123], v[180:183], v[48:51]
  ds_read_b64_tr_b16 v[112:113], v8 offset:17408
  v_mfma_f32_16x16x32_bf16 v[84:87], v[120:123], v[184:187], v[84:87]
  ds_read_b64_tr_b16 v[114:115], v8 offset:17664
  v_mfma_f32_16x16x32_bf16 v[52:55], v[124:127], v[180:183], v[52:55]
  v_mfma_f32_16x16x32_bf16 v[88:91], v[124:127], v[184:187], v[88:91]
  s_waitcnt vmcnt(9)
  s_barrier
  s_waitcnt lgkmcnt(8)
  s_add_u32 m0, s46, 55296
  v_mfma_f32_16x16x32_bf16 v[20:23], v[128:131], v[188:191], v[20:23]
  ds_read_b64_tr_b16 v[116:117], v8 offset:18432
  ds_read_b64_tr_b16 v[118:119], v8 offset:18688
  buffer_load_dwordx4 v2, s[12:15], s44 offen sc1 lds
  v_mfma_f32_16x16x32_bf16 v[56:59], v[128:131], v[192:195], v[56:59]
  ds_read_b64_tr_b16 v[120:121], v8 offset:19456
  v_mfma_f32_16x16x32_bf16 v[24:27], v[132:135], v[188:191], v[24:27]
  ds_read_b64_tr_b16 v[122:123], v8 offset:19712
  s_add_u32 m0, s46, 56320
  v_mfma_f32_16x16x32_bf16 v[60:63], v[132:135], v[192:195], v[60:63]
  ds_read_b64_tr_b16 v[124:125], v8 offset:20480
  buffer_load_dwordx4 v3, s[12:15], s44 offen sc1 lds
  v_mfma_f32_16x16x32_bf16 v[28:31], v[136:139], v[188:191], v[28:31]
  ds_read_b64_tr_b16 v[126:127], v8 offset:20736
  v_mfma_f32_16x16x32_bf16 v[64:67], v[136:139], v[192:195], v[64:67]
  ds_read_b64_tr_b16 v[128:129], v8 offset:21504
  s_add_u32 m0, s46, 57344
  v_mfma_f32_16x16x32_bf16 v[32:35], v[92:95], v[188:191], v[32:35]
  ds_read_b64_tr_b16 v[130:131], v8 offset:21760
  buffer_load_dwordx4 v4, s[12:15], s44 offen sc1 lds
  v_mfma_f32_16x16x32_bf16 v[68:71], v[92:95], v[192:195], v[68:71]
  ds_read_b64_tr_b16 v[132:133], v8 offset:22528
  v_mfma_f32_16x16x32_bf16 v[36:39], v[96:99], v[188:191], v[36:39]
  ds_read_b64_tr_b16 v[134:135], v8 offset:22784
  ds_read_b64_tr_b16 v[136:137], v8 offset:23552
  s_add_u32 m0, s46, 58368
  v_mfma_f32_16x16x32_bf16 v[72:75], v[96:99], v[192:195], v[72:75]
  ds_read_b64_tr_b16 v[138:139], v8 offset:23808
  buffer_load_dwordx4 v5, s[12:15], s44 offen sc1 lds
  s_waitcnt lgkmcnt(12)
  v_mfma_f32_16x16x32_bf16 v[40:43], v[100:103], v[188:191], v[40:43]
  ds_read_b64_tr_b16 v[92:93], v8 offset:24576
  v_mfma_f32_16x16x32_bf16 v[76:79], v[100:103], v[192:195], v[76:79]
  ds_read_b64_tr_b16 v[94:95], v8 offset:24832
  s_add_u32 m0, s46, 59392
  v_mfma_f32_16x16x32_bf16 v[44:47], v[104:107], v[188:191], v[44:47]
  ds_read_b64_tr_b16 v[96:97], v8 offset:25600
  s_mov_b32 exec_hi, 0
  buffer_load_dwordx4 v6, s[12:15], s44 offen sc1 lds
  s_mov_b32 exec_hi, -1
  s_add_u32 s44, s44, 18432
  v_mfma_f32_16x16x32_bf16 v[80:83], v[104:107], v[192:195], v[80:83]
  ds_read_b64_tr_b16 v[98:99], v8 offset:25856
  v_mfma_f32_16x16x32_bf16 v[48:51], v[108:111], v[188:191], v[48:51]
  ds_read_b64_tr_b16 v[100:101], v8 offset:26624
  v_mfma_f32_16x16x32_bf16 v[84:87], v[108:111], v[192:195], v[84:87]
  ds_read_b64_tr_b16 v[102:103], v8 offset:26880
  v_mfma_f32_16x16x32_bf16 v[52:55], v[112:115], v[188:191], v[52:55]
  v_mfma_f32_16x16x32_bf16 v[88:91], v[112:115], v[192:195], v[88:91]
  s_waitcnt lgkmcnt(8)
  v_mfma_f32_16x16x32_bf16 v[20:23], v[116:119], v[196:199], v[20:23]
  ds_read_b64_tr_b16 v[104:105], v8 offset:27648
  ds_read_b64_tr_b16 v[106:107], v8 offset:27904
  buffer_load_dwordx4 v[228:231], v1, s[16:19], s45 offen offset:0
  v_mfma_f32_16x16x32_bf16 v[56:59], v[116:119], v[200:203], v[56:59]
  ds_read_b64_tr_b16 v[108:109], v8 offset:28672
  v_mfma_f32_16x16x32_bf16 v[24:27], v[120:123], v[196:199], v[24:27]
  ds_read_b64_tr_b16 v[110:111], v8 offset:28928
  v_mfma_f32_16x16x32_bf16 v[60:63], v[120:123], v[200:203], v[60:63]
  ds_read_b64_tr_b16 v[112:113], v8 offset:29696
  v_mfma_f32_16x16x32_bf16 v[28:31], v[124:127], v[196:199], v[28:31]
  ds_read_b64_tr_b16 v[114:115], v8 offset:29952
  buffer_load_dwordx4 v[232:235], v1, s[16:19], s45 offen offset:1024
  v_mfma_f32_16x16x32_bf16 v[64:67], v[124:127], v[200:203], v[64:67]
  ds_read_b64_tr_b16 v[116:117], v8 offset:30720
  v_mfma_f32_16x16x32_bf16 v[32:35], v[128:131], v[196:199], v[32:35]
  ds_read_b64_tr_b16 v[118:119], v8 offset:30976
  v_mfma_f32_16x16x32_bf16 v[68:71], v[128:131], v[200:203], v[68:71]
  ds_read_b64_tr_b16 v[120:121], v8 offset:31744
  v_mfma_f32_16x16x32_bf16 v[36:39], v[132:135], v[196:199], v[36:39]
  ds_read_b64_tr_b16 v[122:123], v8 offset:32000
  ds_read_b64_tr_b16 v[124:125], v8 offset:32768
  buffer_load_dwordx4 v[236:239], v1, s[16:19], s45 offen offset:2048
  v_mfma_f32_16x16x32_bf16 v[72:75], v[132:135], v[200:203], v[72:75]
  ds_read_b64_tr_b16 v[126:127], v8 offset:33024
  s_waitcnt lgkmcnt(12)
  v_mfma_f32_16x16x32_bf16 v[40:43], v[136:139], v[196:199], v[40:43]
  ds_read_b64_tr_b16 v[128:129], v8 offset:33792
  v_mfma_f32_16x16x32_bf16 v[76:79], v[136:139], v[200:203], v[76:79]
  ds_read_b64_tr_b16 v[130:131], v8 offset:34048
  v_mfma_f32_16x16x32_bf16 v[44:47], v[92:95], v[196:199], v[44:47]
  ds_read_b64_tr_b16 v[132:133], v8 offset:34816
  buffer_load_dwordx4 v[240:243], v1, s[16:19], s45 offen offset:3072
  s_add_u32 s45, s45, 4096
  v_mfma_f32_16x16x32_bf16 v[80:83], v[92:95], v[200:203], v[80:83]
  ds_read_b64_tr_b16 v[134:135], v8 offset:35072
  v_mfma_f32_16x16x32_bf16 v[48:51], v[96:99], v[196:199], v[48:51]
  ds_read_b64_tr_b16 v[136:137], v8 offset:35840
  v_mfma_f32_16x16x32_bf16 v[84:87], v[96:99], v[200:203], v[84:87]
  ds_read_b64_tr_b16 v[138:139], v8 offset:36096
  v_mfma_f32_16x16x32_bf16 v[52:55], v[100:103], v[196:199], v[52:55]
  v_mfma_f32_16x16x32_bf16 v[88:91], v[100:103], v[200:203], v[88:91]
  s_waitcnt vmcnt(9)
  s_barrier
  s_waitcnt lgkmcnt(8)
  s_add_u32 m0, s46, 0
  v_mfma_f32_16x16x32_bf16 v[20:23], v[104:107], v[204:207], v[20:23]
  ds_read_b64_tr_b16 v[92:93], v8 offset:36864
  ds_read_b64_tr_b16 v[94:95], v8 offset:37120
  buffer_load_dwordx4 v2, s[12:15], s44 offen sc1 lds
  v_mfma_f32_16x16x32_bf16 v[56:59], v[104:107], v[208:211], v[56:59]
  ds_read_b64_tr_b16 v[96:97], v8 offset:37888
  v_mfma_f32_16x16x32_bf16 v[24:27], v[108:111], v[204:207], v[24:27]
  ds_read_b64_tr_b16 v[98:99], v8 offset:38144
  s_add_u32 m0, s46, 1024
  v_mfma_f32_16x16x32_bf16 v[60:63], v[108:111], v[208:211], v[60:63]
  ds_read_b64_tr_b16 v[100:101], v8 offset:38912
  buffer_load_dwordx4 v3, s[12:15], s44 offen sc1 lds
  v_mfma_f32_16x16x32_bf16 v[28:31], v[112:115], v[204:207], v[28:31]
  ds_read_b64_tr_b16 v[102:103], v8 offset:39168
  v_mfma_f32_16x16x32_bf16 v[64:67], v[112:115], v[208:211], v[64:67]
  ds_read_b64_tr_b16 v[104:105], v8 offset:39936
  s_add_u32 m0, s46, 2048
  v_mfma_f32_16x16x32_bf16 v[32:35], v[116:119], v[204:207], v[32:35]
  ds_read_b64_tr_b16 v[106:107], v8 offset:40192
  buffer_load_dwordx4 v4, s[12:15], s44 offen sc1 lds
  v_mfma_f32_16x16x32_bf16 v[68:71], v[116:119], v[208:211], v[68:71]
  ds_read_b64_tr_b16 v[108:109], v8 offset:40960
  v_mfma_f32_16x16x32_bf16 v[36:39], v[120:123], v[204:207], v[36:39]
  ds_read_b64_tr_b16 v[110:111], v8 offset:41216
  ds_read_b64_tr_b16 v[112:113], v8 offset:41984
  s_add_u32 m0, s46, 3072
  v_mfma_f32_16x16x32_bf16 v[72:75], v[120:123], v[208:211], v[72:75]
  ds_read_b64_tr_b16 v[114:115], v8 offset:42240
  buffer_load_dwordx4 v5, s[12:15], s44 offen sc1 lds
  s_waitcnt lgkmcnt(12)
  v_mfma_f32_16x16x32_bf16 v[40:43], v[124:127], v[204:207], v[40:43]
  ds_read_b64_tr_b16 v[116:117], v8 offset:43008
  v_mfma_f32_16x16x32_bf16 v[76:79], v[124:127], v[208:211], v[76:79]
  ds_read_b64_tr_b16 v[118:119], v8 offset:43264
  s_add_u32 m0, s46, 4096
  v_mfma_f32_16x16x32_bf16 v[44:47], v[128:131], v[204:207], v[44:47]
  ds_read_b64_tr_b16 v[120:121], v8 offset:44032
  s_mov_b32 exec_hi, 0
  buffer_load_dwordx4 v6, s[12:15], s44 offen sc1 lds
  s_mov_b32 exec_hi, -1
  s_add_u32 s44, s44, 18432
  v_mfma_f32_16x16x32_bf16 v[80:83], v[128:131], v[208:211], v[80:83]
  ds_read_b64_tr_b16 v[122:123], v8 offset:44288
  v_mfma_f32_16x16x32_bf16 v[48:51], v[132:135], v[204:207], v[48:51]
  ds_read_b64_tr_b16 v[124:125], v8 offset:45056
  v_mfma_f32_16x16x32_bf16 v[84:87], v[132:135], v[208:211], v[84:87]
  ds_read_b64_tr_b16 v[126:127], v8 offset:45312
  v_mfma_f32_16x16x32_bf16 v[52:55], v[136:139], v[204:207], v[52:55]
  v_mfma_f32_16x16x32_bf16 v[88:91], v[136:139], v[208:211], v[88:91]
  s_waitcnt lgkmcnt(8)
  v_mfma_f32_16x16x32_bf16 v[20:23], v[92:95], v[212:215], v[20:23]
  ds_read_b64_tr_b16 v[128:129], v8 offset:46080
  ds_read_b64_tr_b16 v[130:131], v8 offset:46336
  buffer_load_dwordx4 v[180:183], v1, s[16:19], s45 offen offset:0
  v_mfma_f32_16x16x32_bf16 v[56:59], v[92:95], v[216:219], v[56:59]
  ds_read_b64_tr_b16 v[132:133], v8 offset:47104
  v_mfma_f32_16x16x32_bf16 v[24:27], v[96:99], v[212:215], v[24:27]
  ds_read_b64_tr_b16 v[134:135], v8 offset:47360
  v_mfma_f32_16x16x32_bf16 v[60:63], v[96:99], v[216:219], v[60:63]
  ds_read_b64_tr_b16 v[136:137], v8 offset:48128
  v_mfma_f32_16x16x32_bf16 v[28:31], v[100:103], v[212:215], v[28:31]
  ds_read_b64_tr_b16 v[138:139], v8 offset:48384
  buffer_load_dwordx4 v[184:187], v1, s[16:19], s45 offen offset:1024
  v_mfma_f32_16x16x32_bf16 v[64:67], v[100:103], v[216:219], v[64:67]
  ds_read_b64_tr_b16 v[92:93], v8 offset:49152
  v_mfma_f32_16x16x32_bf16 v[32:35], v[104:107], v[212:215], v[32:35]
  ds_read_b64_tr_b16 v[94:95], v8 offset:49408
  v_mfma_f32_16x16x32_bf16 v[68:71], v[104:107], v[216:219], v[68:71]
  ds_read_b64_tr_b16 v[96:97], v8 offset:50176
  v_mfma_f32_16x16x32_bf16 v[36:39], v[108:111], v[212:215], v[36:39]
  ds_read_b64_tr_b16 v[98:99], v8 offset:50432
  ds_read_b64_tr_b16 v[100:101], v8 offset:51200
  buffer_load_dwordx4 v[188:191], v1, s[16:19], s45 offen offset:2048
  v_mfma_f32_16x16x32_bf16 v[72:75], v[108:111], v[216:219], v[72:75]
  ds_read_b64_tr_b16 v[102:103], v8 offset:51456
  s_waitcnt lgkmcnt(12)
  v_mfma_f32_16x16x32_bf16 v[40:43], v[112:115], v[212:215], v[40:43]
  ds_read_b64_tr_b16 v[104:105], v8 offset:52224
  v_mfma_f32_16x16x32_bf16 v[76:79], v[112:115], v[216:219], v[76:79]
  ds_read_b64_tr_b16 v[106:107], v8 offset:52480
  v_mfma_f32_16x16x32_bf16 v[44:47], v[116:119], v[212:215], v[44:47]
  ds_read_b64_tr_b16 v[108:109], v8 offset:53248
  buffer_load_dwordx4 v[192:195], v1, s[16:19], s45 offen offset:3072
  s_add_u32 s45, s45, 4096
  v_mfma_f32_16x16x32_bf16 v[80:83], v[116:119], v[216:219], v[80:83]
  ds_read_b64_tr_b16 v[110:111], v8 offset:53504
  v_mfma_f32_16x16x32_bf16 v[48:51], v[120:123], v[212:215], v[48:51]
  ds_read_b64_tr_b16 v[112:113], v8 offset:54272
  v_mfma_f32_16x16x32_bf16 v[84:87], v[120:123], v[216:219], v[84:87]
  ds_read_b64_tr_b16 v[114:115], v8 offset:54528
  v_mfma_f32_16x16x32_bf16 v[52:55], v[124:127], v[212:215], v[52:55]
  v_mfma_f32_16x16x32_bf16 v[88:91], v[124:127], v[216:219], v[88:91]
  s_waitcnt vmcnt(9)
  s_barrier
  s_waitcnt lgkmcnt(8)
  s_add_u32 m0, s46, 18432
  v_mfma_f32_16x16x32_bf16 v[20:23], v[128:131], v[220:223], v[20:23]
  ds_read_b64_tr_b16 v[116:117], v9 offset:0
  ds_read_b64_tr_b16 v[118:119], v9 offset:256
  buffer_load_dwordx4 v2, s[12:15], s44 offen sc1 lds
  v_mfma_f32_16x16x32_bf16 v[56:59], v[128:131], v[224:227], v[56:59]
  ds_read_b64_tr_b16 v[120:121], v9 offset:1024
  v_mfma_f32_16x16x32_bf16 v[24:27], v[132:135], v[220:223], v[24:27]
  ds_read_b64_tr_b16 v[122:123], v9 offset:1280
  s_add_u32 m0, s46, 19456
  v_mfma_f32_16x16x32_bf16 v[60:63], v[132:135], v[224:227], v[60:63]
  ds_read_b64_tr_b16 v[124:125], v9 offset:2048
  buffer_load_dwordx4 v3, s[12:15], s44 offen sc1 lds
  v_mfma_f32_16x16x32_bf16 v[28:31], v[136:139], v[220:223], v[28:31]
  ds_read_b64_tr_b16 v[126:127], v9 offset:2304
  v_mfma_f32_16x16x32_bf16 v[64:67], v[136:139], v[224:227], v[64:67]
  ds_read_b64_tr_b16 v[128:129], v9 offset:3072
  s_add_u32 m0, s46, 20480
  v_mfma_f32_16x16x32_bf16 v[32:35], v[92:95], v[220:223], v[32:35]
  ds_read_b64_tr_b16 v[130:131], v9 offset:3328
  buffer_load_dwordx4 v4, s[12:15], s44 offen sc1 lds
  v_mfma_f32_16x16x32_bf16 v[68:71], v[92:95], v[224:227], v[68:71]
  ds_read_b64_tr_b16 v[132:133], v9 offset:4096
  v_mfma_f32_16x16x32_bf16 v[36:39], v[96:99], v[220:223], v[36:39]
  ds_read_b64_tr_b16 v[134:135], v9 offset:4352
  ds_read_b64_tr_b16 v[136:137], v9 offset:5120
  s_add_u32 m0, s46, 21504
  v_mfma_f32_16x16x32_bf16 v[72:75], v[96:99], v[224:227], v[72:75]
  ds_read_b64_tr_b16 v[138:139], v9 offset:5376
  buffer_load_dwordx4 v5, s[12:15], s44 offen sc1 lds
  s_waitcnt lgkmcnt(12)
  v_mfma_f32_16x16x32_bf16 v[40:43], v[100:103], v[220:223], v[40:43]
  ds_read_b64_tr_b16 v[92:93], v9 offset:6144
  v_mfma_f32_16x16x32_bf16 v[76:79], v[100:103], v[224:227], v[76:79]
  ds_read_b64_tr_b16 v[94:95], v9 offset:6400
  s_add_u32 m0, s46, 22528
  v_mfma_f32_16x16x32_bf16 v[44:47], v[104:107], v[220:223], v[44:47]
  ds_read_b64_tr_b16 v[96:97], v9 offset:7168
  s_mov_b32 exec_hi, 0
  buffer_load_dwordx4 v6, s[12:15], s44 offen sc1 lds
  s_mov_b32 exec_hi, -1
  s_add_u32 s44, s44, 18432
  v_mfma_f32_16x16x32_bf16 v[80:83], v[104:107], v[224:227], v[80:83]
  ds_read_b64_tr_b16 v[98:99], v9 offset:7424
  v_mfma_f32_16x16x32_bf16 v[48:51], v[108:111], v[220:223], v[48:51]
  ds_read_b64_tr_b16 v[100:101], v9 offset:8192
  v_mfma_f32_16x16x32_bf16 v[84:87], v[108:111], v[224:227], v[84:87]
  ds_read_b64_tr_b16 v[102:103], v9 offset:8448
  v_mfma_f32_16x16x32_bf16 v[52:55], v[112:115], v[220:223], v[52:55]
  v_mfma_f32_16x16x32_bf16 v[88:91], v[112:115], v[224:227], v[88:91]
  s_waitcnt lgkmcnt(8)
  v_mfma_f32_16x16x32_bf16 v[20:23], v[116:119], v[228:231], v[20:23]
  ds_read_b64_tr_b16 v[104:105], v9 offset:9216
  ds_read_b64_tr_b16 v[106:107], v9 offset:9472
  buffer_load_dwordx4 v[196:199], v1, s[16:19], s45 offen offset:0
  v_mfma_f32_16x16x32_bf16 v[56:59], v[116:119], v[232:235], v[56:59]
  ds_read_b64_tr_b16 v[108:109], v9 offset:10240
  v_mfma_f32_16x16x32_bf16 v[24:27], v[120:123], v[228:231], v[24:27]
  ds_read_b64_tr_b16 v[110:111], v9 offset:10496
  v_mfma_f32_16x16x32_bf16 v[60:63], v[120:123], v[232:235], v[60:63]
  ds_read_b64_tr_b16 v[112:113], v9 offset:11264
  v_mfma_f32_16x16x32_bf16 v[28:31], v[124:127], v[228:231], v[28:31]
  ds_read_b64_tr_b16 v[114:115], v9 offset:11520
  buffer_load_dwordx4 v[200:203], v1, s[16:19], s45 offen offset:1024
  v_mfma_f32_16x16x32_bf16 v[64:67], v[124:127], v[232:235], v[64:67]
  ds_read_b64_tr_b16 v[116:117], v9 offset:12288
  v_mfma_f32_16x16x32_bf16 v[32:35], v[128:131], v[228:231], v[32:35]
  ds_read_b64_tr_b16 v[118:119], v9 offset:12544
  v_mfma_f32_16x16x32_bf16 v[68:71], v[128:131], v[232:235], v[68:71]
  ds_read_b64_tr_b16 v[120:121], v9 offset:13312
  v_mfma_f32_16x16x32_bf16 v[36:39], v[132:135], v[228:231], v[36:39]
  ds_read_b64_tr_b16 v[122:123], v9 offset:13568
  ds_read_b64_tr_b16 v[124:125], v9 offset:14336
  buffer_load_dwordx4 v[204:207], v1, s[16:19], s45 offen offset:2048
  v_mfma_f32_16x16x32_bf16 v[72:75], v[132:135], v[232:235], v[72:75]
  ds_read_b64_tr_b16 v[126:127], v9 offset:14592
  s_waitcnt lgkmcnt(12)
  v_mfma_f32_16x16x32_bf16 v[40:43], v[136:139], v[228:231], v[40:43]
  ds_read_b64_tr_b16 v[128:129], v9 offset:15360
  v_mfma_f32_16x16x32_bf16 v[76:79], v[136:139], v[232:235], v[76:79]
  ds_read_b64_tr_b16 v[130:131], v9 offset:15616
  v_mfma_f32_16x16x32_bf16 v[44:47], v[92:95], v[228:231], v[44:47]
  ds_read_b64_tr_b16 v[132:133], v9 offset:16384
  buffer_load_dwordx4 v[208:211], v1, s[16:19], s45 offen offset:3072
  s_add_u32 s45, s45, 4096
  v_mfma_f32_16x16x32_bf16 v[80:83], v[92:95], v[232:235], v[80:83]
  ds_read_b64_tr_b16 v[134:135], v9 offset:16640
  v_mfma_f32_16x16x32_bf16 v[48:51], v[96:99], v[228:231], v[48:51]
  ds_read_b64_tr_b16 v[136:137], v9 offset:17408
  v_mfma_f32_16x16x32_bf16 v[84:87], v[96:99], v[232:235], v[84:87]
  ds_read_b64_tr_b16 v[138:139], v9 offset:17664
  v_mfma_f32_16x16x32_bf16 v[52:55], v[100:103], v[228:231], v[52:55]
  v_mfma_f32_16x16x32_bf16 v[88:91], v[100:103], v[232:235], v[88:91]
  s_waitcnt vmcnt(9)
  s_barrier
  s_waitcnt lgkmcnt(8)
  s_add_u32 m0, s46, 36864
  v_mfma_f32_16x16x32_bf16 v[20:23], v[104:107], v[236:239], v[20:23]
  ds_read_b64_tr_b16 v[92:93], v8 offset:0
  ds_read_b64_tr_b16 v[94:95], v8 offset:256
  buffer_load_dwordx4 v2, s[12:15], s44 offen sc1 lds
  v_mfma_f32_16x16x32_bf16 v[56:59], v[104:107], v[240:243], v[56:59]
  ds_read_b64_tr_b16 v[96:97], v8 offset:1024
  v_mfma_f32_16x16x32_bf16 v[24:27], v[108:111], v[236:239], v[24:27]
  ds_read_b64_tr_b16 v[98:99], v8 offset:1280
  s_add_u32 m0, s46, 37888
  v_mfma_f32_16x16x32_bf16 v[60:63], v[108:111], v[240:243], v[60:63]
  ds_read_b64_tr_b16 v[100:101], v8 offset:2048
  buffer_load_dwordx4 v3, s[12:15], s44 offen sc1 lds
  v_mfma_f32_16x16x32_bf16 v[28:31], v[112:115], v[236:239], v[28:31]
  ds_read_b64_tr_b16 v[102:103], v8 offset:2304
  v_mfma_f32_16x16x32_bf16 v[64:67], v[112:115], v[240:243], v[64:67]
  ds_read_b64_tr_b16 v[104:105], v8 offset:3072
  s_add_u32 m0, s46, 38912
  v_mfma_f32_16x16x32_bf16 v[32:35], v[116:119], v[236:239], v[32:35]
  ds_read_b64_tr_b16 v[106:107], v8 offset:3328
  buffer_load_dwordx4 v4, s[12:15], s44 offen sc1 lds
  v_mfma_f32_16x16x32_bf16 v[68:71], v[116:119], v[240:243], v[68:71]
  ds_read_b64_tr_b16 v[108:109], v8 offset:4096
  v_mfma_f32_16x16x32_bf16 v[36:39], v[120:123], v[236:239], v[36:39]
  ds_read_b64_tr_b16 v[110:111], v8 offset:4352
  ds_read_b64_tr_b16 v[112:113], v8 offset:5120
  s_add_u32 m0, s46, 39936
  v_mfma_f32_16x16x32_bf16 v[72:75], v[120:123], v[240:243], v[72:75]
  ds_read_b64_tr_b16 v[114:115], v8 offset:5376
  buffer_load_dwordx4 v5, s[12:15], s44 offen sc1 lds
  s_waitcnt lgkmcnt(12)
  v_mfma_f32_16x16x32_bf16 v[40:43], v[124:127], v[236:239], v[40:43]
  ds_read_b64_tr_b16 v[116:117], v8 offset:6144
  v_mfma_f32_16x16x32_bf16 v[76:79], v[124:127], v[240:243], v[76:79]
  ds_read_b64_tr_b16 v[118:119], v8 offset:6400
  s_add_u32 m0, s46, 40960
  v_mfma_f32_16x16x32_bf16 v[44:47], v[128:131], v[236:239], v[44:47]
  ds_read_b64_tr_b16 v[120:121], v8 offset:7168
  s_mov_b32 exec_hi, 0
  buffer_load_dwordx4 v6, s[12:15], s44 offen sc1 lds
  s_mov_b32 exec_hi, -1
  s_add_u32 s44, s44, 18432
  v_mfma_f32_16x16x32_bf16 v[80:83], v[128:131], v[240:243], v[80:83]
  ds_read_b64_tr_b16 v[122:123], v8 offset:7424
  v_mfma_f32_16x16x32_bf16 v[48:51], v[132:135], v[236:239], v[48:51]
  ds_read_b64_tr_b16 v[124:125], v8 offset:8192
  v_mfma_f32_16x16x32_bf16 v[84:87], v[132:135], v[240:243], v[84:87]
  ds_read_b64_tr_b16 v[126:127], v8 offset:8448
  v_mfma_f32_16x16x32_bf16 v[52:55], v[136:139], v[236:239], v[52:55]
  v_mfma_f32_16x16x32_bf16 v[88:91], v[136:139], v[240:243], v[88:91]
  s_sub_u32 s47, s47, 1
  s_cmp_lg_u32 s47, 0
  s_cbranch_scc1 k4_loop
  s_waitcnt lgkmcnt(8)
  v_mfma_f32_16x16x32_bf16 v[20:23], v[92:95], v[180:183], v[20:23]
  ds_read_b64_tr_b16 v[128:129], v8 offset:9216
  ds_read_b64_tr_b16 v[130:131], v8 offset:9472
  buffer_load_dwordx4 v[212:215], v1, s[16:19], s45 offen offset:0
  v_mfma_f32_16x16x32_bf16 v[56:59], v[92:95], v[184:187], v[56:59]
  ds_read_b64_tr_b16 v[132:133], v8 offset:10240
  v_mfma_f32_16x16x32_bf16 v[24:27], v[96:99], v[180:183], v[24:27]
  ds_read_b64_tr_b16 v[134:135], v8 offset:10496
  v_mfma_f32_16x16x32_bf16 v[60:63], v[96:99], v[184:187], v[60:63]
  ds_read_b64_tr_b16 v[136:137], v8 offset:11264
  buffer_load_dwordx4 v[216:219], v1, s[16:19], s45 offen offset:1024
  v_mfma_f32_16x16x32_bf16 v[28:31], v[100:103], v[180:183], v[28:31]
  ds_read_b64_tr_b16 v[138:139], v8 offset:11520
  v_mfma_f32_16x16x32_bf16 v[64:67], v[100:103], v[184:187], v[64:67]
  ds_read_b64_tr_b16 v[92:93], v8 offset:12288
  v_mfma_f32_16x16x32_bf16 v[32:35], v[104:107], v[180:183], v[32:35]
  ds_read_b64_tr_b16 v[94:95], v8 offset:12544
  buffer_load_dwordx4 v[220:223], v1, s[16:19], s45 offen offset:2048
  v_mfma_f32_16x16x32_bf16 v[68:71], v[104:107], v[184:187], v[68:71]
  ds_read_b64_tr_b16 v[96:97], v8 offset:13312
  v_mfma_f32_16x16x32_bf16 v[36:39], v[108:111], v[180:183], v[36:39]
  ds_read_b64_tr_b16 v[98:99], v8 offset:13568
  ds_read_b64_tr_b16 v[100:101], v8 offset:14336
  v_mfma_f32_16x16x32_bf16 v[72:75], v[108:111], v[184:187], v[72:75]
  ds_read_b64_tr_b16 v[102:103], v8 offset:14592
  buffer_load_dwordx4 v[224:227], v1, s[16:19], s45 offen offset:3072
  s_add_u32 s45, s45, 4096
  s_waitcnt lgkmcnt(12)
  v_mfma_f32_16x16x32_bf16 v[40:43], v[112:115], v[180:183], v[40:43]
  ds_read_b64_tr_b16 v[104:105], v8 offset:15360
  v_mfma_f32_16x16x32_bf16 v[76:79], v[112:115], v[184:187], v[76:79]
  ds_read_b64_tr_b16 v[106:107], v8 offset:15616
  v_mfma_f32_16x16x32_bf16 v[44:47], v[116:119], v[180:183], v[44:47]
  ds_read_b64_tr_b16 v[108:109], v8 offset:16384
  buffer_load_dword v13, v12, s[56:59], 0 offen sc1
  v_mfma_f32_16x16x32_bf16 v[80:83], v[116:119], v[184:187], v[80:83]
  ds_read_b64_tr_b16 v[110:111], v8 offset:16640
  v_mfma_f32_16x16x32_bf16 v[48:51], v[120:123], v[180:183], v[48:51]
  ds_read_b64_tr_b16 v[112:113], v8 offset:17408
  v_mfma_f32_16x16x32_bf16 v[84:87], v[120:123], v[184:187], v[84:87]
  ds_read_b64_tr_b16 v[114:115], v8 offset:17664
  v_mfma_f32_16x16x32_bf16 v[52:55], v[124:127], v[180:183], v[52:55]
  v_mfma_f32_16x16x32_bf16 v[88:91], v[124:127], v[184:187], v[88:91]
  s_waitcnt vmcnt(10)
  s_barrier
  s_waitcnt lgkmcnt(8)
  s_add_u32 m0, s46, 55296
  v_mfma_f32_16x16x32_bf16 v[20:23], v[128:131], v[188:191], v[20:23]
  ds_read_b64_tr_b16 v[116:117], v8 offset:18432
  ds_read_b64_tr_b16 v[118:119], v8 offset:18688
  buffer_load_dwordx4 v2, s[12:15], s44 offen sc1 lds
  v_mfma_f32_16x16x32_bf16 v[56:59], v[128:131], v[192:195], v[56:59]
  ds_read_b64_tr_b16 v[120:121], v8 offset:19456
  v_mfma_f32_16x16x32_bf16 v[24:27], v[132:135], v[188:191], v[24:27]
  ds_read_b64_tr_b16 v[122:123], v8 offset:19712
  s_add_u32 m0, s46, 56320
  v_mfma_f32_16x16x32_bf16 v[60:63], v[132:135], v[192:195], v[60:63]
  ds_read_b64_tr_b16 v[124:125], v8 offset:20480
  buffer_load_dwordx4 v3, s[12:15], s44 offen sc1 lds
  v_mfma_f32_16x16x32_bf16 v[28:31], v[136:139], v[188:191], v[28:31]
  ds_read_b64_tr_b16 v[126:127], v8 offset:20736
  v_mfma_f32_16x16x32_bf16 v[64:67], v[136:139], v[192:195], v[64:67]
  ds_read_b64_tr_b16 v[128:129], v8 offset:21504
  s_add_u32 m0, s46, 57344
  v_mfma_f32_16x16x32_bf16 v[32:35], v[92:95], v[188:191], v[32:35]
  ds_read_b64_tr_b16 v[130:131], v8 offset:21760
  buffer_load_dwordx4 v4, s[12:15], s44 offen sc1 lds
  v_mfma_f32_16x16x32_bf16 v[68:71], v[92:95], v[192:195], v[68:71]
  ds_read_b64_tr_b16 v[132:133], v8 offset:22528
  v_mfma_f32_16x16x32_bf16 v[36:39], v[96:99], v[188:191], v[36:39]
  ds_read_b64_tr_b16 v[134:135], v8 offset:22784
  ds_read_b64_tr_b16 v[136:137], v8 offset:23552
  s_add_u32 m0, s46, 58368
  v_mfma_f32_16x16x32_bf16 v[72:75], v[96:99], v[192:195], v[72:75]
  ds_read_b64_tr_b16 v[138:139], v8 offset:23808
  buffer_load_dwordx4 v5, s[12:15], s44 offen sc1 lds
  s_waitcnt lgkmcnt(12)
  v_mfma_f32_16x16x32_bf16 v[40:43], v[100:103], v[188:191], v[40:43]
  ds_read_b64_tr_b16 v[92:93], v8 offset:24576
  v_mfma_f32_16x16x32_bf16 v[76:79], v[100:103], v[192:195], v[76:79]
  ds_read_b64_tr_b16 v[94:95], v8 offset:24832
  s_add_u32 m0, s46, 59392
  v_mfma_f32_16x16x32_bf16 v[44:47], v[104:107], v[188:191], v[44:47]
  ds_read_b64_tr_b16 v[96:97], v8 offset:25600
  s_mov_b32 exec_hi, 0
  buffer_load_dwordx4 v6, s[12:15], s44 offen sc1 lds
  s_mov_b32 exec_hi, -1
  s_add_u32 s44, s44, 18432
  v_mfma_f32_16x16x32_bf16 v[80:83], v[104:107], v[192:195], v[80:83]
  ds_read_b64_tr_b16 v[98:99], v8 offset:25856
  v_mfma_f32_16x16x32_bf16 v[48:51], v[108:111], v[188:191], v[48:51]
  ds_read_b64_tr_b16 v[100:101], v8 offset:26624
  v_mfma_f32_16x16x32_bf16 v[84:87], v[108:111], v[192:195], v[84:87]
  ds_read_b64_tr_b16 v[102:103], v8 offset:26880
  v_mfma_f32_16x16x32_bf16 v[52:55], v[112:115], v[188:191], v[52:55]
  v_mfma_f32_16x16x32_bf16 v[88:91], v[112:115], v[192:195], v[88:91]
  s_waitcnt lgkmcnt(8)
  v_mfma_f32_16x16x32_bf16 v[20:23], v[116:119], v[196:199], v[20:23]
  ds_read_b64_tr_b16 v[104:105], v8 offset:27648
  ds_read_b64_tr_b16 v[106:107], v8 offset:27904
  buffer_load_dwordx4 v[228:231], v1, s[16:19], s45 offen offset:0
  v_mfma_f32_16x16x32_bf16 v[56:59], v[116:119], v[200:203], v[56:59]
  ds_read_b64_tr_b16 v[108:109], v8 offset:28672
  v_mfma_f32_16x16x32_bf16 v[24:27], v[120:123], v[196:199], v[24:27]
  ds_read_b64_tr_b16 v[110:111], v8 offset:28928
  v_mfma_f32_16x16x32_bf16 v[60:63], v[120:123], v[200:203], v[60:63]
  ds_read_b64_tr_b16 v[112:113], v8 offset:29696
  v_mfma_f32_16x16x32_bf16 v[28:31], v[124:127], v[196:199], v[28:31]
  ds_read_b64_tr_b16 v[114:115], v8 offset:29952
  buffer_load_dwordx4 v[232:235], v1, s[16:19], s45 offen offset:1024
  v_mfma_f32_16x16x32_bf16 v[64:67], v[124:127], v[200:203], v[64:67]
  ds_read_b64_tr_b16 v[116:117], v8 offset:30720
  v_mfma_f32_16x16x32_bf16 v[32:35], v[128:131], v[196:199], v[32:35]
  ds_read_b64_tr_b16 v[118:119], v8 offset:30976
  v_mfma_f32_16x16x32_bf16 v[68:71], v[128:131], v[200:203], v[68:71]
  ds_read_b64_tr_b16 v[120:121], v8 offset:31744
  v_mfma_f32_16x16x32_bf16 v[36:39], v[132:135], v[196:199], v[36:39]
  ds_read_b64_tr_b16 v[122:123], v8 offset:32000
  ds_read_b64_tr_b16 v[124:125], v8 offset:32768
  buffer_load_dwordx4 v[236:239], v1, s[16:19], s45 offen offset:2048
  v_mfma_f32_16x16x32_bf16 v[72:75], v[132:135], v[200:203], v[72:75]
  ds_read_b64_tr_b16 v[126:127], v8 offset:33024
  s_waitcnt lgkmcnt(12)
  v_mfma_f32_16x16x32_bf16 v[40:43], v[136:139], v[196:199], v[40:43]
  ds_read_b64_tr_b16 v[128:129], v8 offset:33792
  v_mfma_f32_16x16x32_bf16 v[76:79], v[136:139], v[200:203], v[76:79]
  ds_read_b64_tr_b16 v[130:131], v8 offset:34048
  v_mfma_f32_16x16x32_bf16 v[44:47], v[92:95], v[196:199], v[44:47]
  ds_read_b64_tr_b16 v[132:133], v8 offset:34816
  buffer_load_dwordx4 v[240:243], v1, s[16:19], s45 offen offset:3072
  s_add_u32 s45, s45, 4096
  v_mfma_f32_16x16x32_bf16 v[80:83], v[92:95], v[200:203], v[80:83]
  ds_read_b64_tr_b16 v[134:135], v8 offset:35072
  v_mfma_f32_16x16x32_bf16 v[48:51], v[96:99], v[196:199], v[48:51]
  ds_read_b64_tr_b16 v[136:137], v8 offset:35840
  v_mfma_f32_16x16x32_bf16 v[84:87], v[96:99], v[200:203], v[84:87]
  ds_read_b64_tr_b16 v[138:139], v8 offset:36096
  v_mfma_f32_16x16x32_bf16 v[52:55], v[100:103], v[196:199], v[52:55]
  v_mfma_f32_16x16x32_bf16 v[88:91], v[100:103], v[200:203], v[88:91]
  s_waitcnt vmcnt(9)
  s_barrier
  s_waitcnt lgkmcnt(8)
  v_mfma_f32_16x16x32_bf16 v[20:23], v[104:107], v[204:207], v[20:23]
  ds_read_b64_tr_b16 v[92:93], v8 offset:36864
  ds_read_b64_tr_b16 v[94:95], v8 offset:37120
  v_mfma_f32_16x16x32_bf16 v[56:59], v[104:107], v[208:211], v[56:59]
  ds_read_b64_tr_b16 v[96:97], v8 offset:37888
  v_mfma_f32_16x16x32_bf16 v[24:27], v[108:111], v[204:207], v[24:27]
  ds_read_b64_tr_b16 v[98:99], v8 offset:38144
  v_mfma_f32_16x16x32_bf16 v[60:63], v[108:111], v[208:211], v[60:63]
  ds_read_b64_tr_b16 v[100:101], v8 offset:38912
  v_mfma_f32_16x16x32_bf16 v[28:31], v[112:115], v[204:207], v[28:31]
  ds_read_b64_tr_b16 v[102:103], v8 offset:39168
  v_mfma_f32_16x16x32_bf16 v[64:67], v[112:115], v[208:211], v[64:67]
  ds_read_b64_tr_b16 v[104:105], v8 offset:39936
  v_mfma_f32_16x16x32_bf16 v[32:35], v[116:119], v[204:207], v[32:35]
  ds_read_b64_tr_b16 v[106:107], v8 offset:40192
  v_mfma_f32_16x16x32_bf16 v[68:71], v[116:119], v[208:211], v[68:71]
  ds_read_b64_tr_b16 v[108:109], v8 offset:40960
  v_mfma_f32_16x16x32_bf16 v[36:39], v[120:123], v[204:207], v[36:39]
  ds_read_b64_tr_b16 v[110:111], v8 offset:41216
  ds_read_b64_tr_b16 v[112:113], v8 offset:41984
  v_mfma_f32_16x16x32_bf16 v[72:75], v[120:123], v[208:211], v[72:75]
  ds_read_b64_tr_b16 v[114:115], v8 offset:42240
  s_waitcnt lgkmcnt(12)
  v_mfma_f32_16x16x32_bf16 v[40:43], v[124:127], v[204:207], v[40:43]
  ds_read_b64_tr_b16 v[116:117], v8 offset:43008
  v_mfma_f32_16x16x32_bf16 v[76:79], v[124:127], v[208:211], v[76:79]
  ds_read_b64_tr_b16 v[118:119], v8 offset:43264
  v_mfma_f32_16x16x32_bf16 v[44:47], v[128:131], v[204:207], v[44:47]
  ds_read_b64_tr_b16 v[120:121], v8 offset:44032
  v_mfma_f32_16x16x32_bf16 v[80:83], v[128:131], v[208:211], v[80:83]
  ds_read_b64_tr_b16 v[122:123], v8 offset:44288
  v_mfma_f32_16x16x32_bf16 v[48:51], v[132:135], v[204:207], v[48:51]
  ds_read_b64_tr_b16 v[124:125], v8 offset:45056
  v_mfma_f32_16x16x32_bf16 v[84:87], v[132:135], v[208:211], v[84:87]
  ds_read_b64_tr_b16 v[126:127], v8 offset:45312
  v_mfma_f32_16x16x32_bf16 v[52:55], v[136:139], v[204:207], v[52:55]
  v_mfma_f32_16x16x32_bf16 v[88:91], v[136:139], v[208:211], v[88:91]
  s_waitcnt lgkmcnt(8)
  v_mfma_f32_16x16x32_bf16 v[20:23], v[92:95], v[212:215], v[20:23]
  ds_read_b64_tr_b16 v[128:129], v8 offset:46080
  ds_read_b64_tr_b16 v[130:131], v8 offset:46336
  s_getpc_b64 s[96:97]
pc_9627_v252:
  v_lshlrev_b32 v14, 7, v0
  s_lshl_b32 s98, s3, 13
  v_add_u32 v14, s98, v14
  v_add_u32 v14, k5_body-pc_9627_v252, v14
  v_min_u32 v14, k5_end-pc_9627_v252, v14
  v_mov_b32 v15, 0
  v_lshl_add_u64 v[14:15], v[14:15], 0, s[96:97]
  global_load_dword v252, v[14:15], off
  v_mfma_f32_16x16x32_bf16 v[56:59], v[92:95], v[216:219], v[56:59]
  ds_read_b64_tr_b16 v[132:133], v8 offset:47104
  s_branch k4q_c
k4q_a:
  buffer_load_dword v13, v12, s[56:59], 0 offen sc1
  s_waitcnt vmcnt(0)
k4q_c:
  v_cmp_ne_u32 vcc, 0, v13
  s_nop 1
  s_cbranch_vccz k4q_b
  s_sleep 1
  s_branch k4q_a
k4q_b:
  v_mfma_f32_16x16x32_bf16 v[24:27], v[96:99], v[212:215], v[24:27]
  ds_read_b64_tr_b16 v[134:135], v8 offset:47360
  buffer_load_ushort v176, v18, s[24:27], 0 offen offset:0
  v_mfma_f32_16x16x32_bf16 v[60:63], v[96:99], v[216:219], v[60:63]
  ds_read_b64_tr_b16 v[136:137], v8 offset:48128
  buffer_load_ushort v177, v18, s[24:27], 0 offen offset:32
  v_mfma_f32_16x16x32_bf16 v[28:31], v[100:103], v[212:215], v[28:31]
  ds_read_b64_tr_b16 v[138:139], v8 offset:48384
  s_mov_b32 s48, 0
  buffer_load_dwordx4 v[140:143], v1, s[20:23], s48 offen sc1
  v_mfma_f32_16x16x32_bf16 v[64:67], v[100:103], v[216:219], v[64:67]
  ds_read_b64_tr_b16 v[92:93], v8 offset:49152
  s_mov_b32 s48, 1024
  buffer_load_dwordx4 v[144:147], v1, s[20:23], s48 offen sc1
  v_mfma_f32_16x16x32_bf16 v[32:35], v[104:107], v[212:215], v[32:35]
  ds_read_b64_tr_b16 v[94:95], v8 offset:49408
  s_mov_b32 s48, 2048
  buffer_load_dwordx4 v[148:151], v1, s[20:23], s48 offen sc1
  v_mfma_f32_16x16x32_bf16 v[68:71], v[104:107], v[216:219], v[68:71]
  ds_read_b64_tr_b16 v[96:97], v8 offset:50176
  s_mov_b32 s48, 3072
  buffer_load_dwordx4 v[152:155], v1, s[20:23], s48 offen sc1
  v_mfma_f32_16x16x32_bf16 v[36:39], v[108:111], v[212:215], v[36:39]
  ds_read_b64_tr_b16 v[98:99], v8 offset:50432
  ds_read_b64_tr_b16 v[100:101], v8 offset:51200
  s_mov_b32 s48, 4096
  buffer_load_dwordx4 v[156:159], v1, s[20:23], s48 offen sc1
  v_mfma_f32_16x16x32_bf16 v[72:75], v[108:111], v[216:219], v[72:75]
  ds_read_b64_tr_b16 v[102:103], v8 offset:51456
  s_mov_b32 s48, 5120
  buffer_load_dwordx4 v[160:163], v1, s[20:23], s48 offen sc1
  s_waitcnt lgkmcnt(12)
  v_mfma_f32_16x16x32_bf16 v[40:43], v[112:115], v[212:215], v[40:43]
  ds_read_b64_tr_b16 v[104:105], v8 offset:52224
  s_mov_b32 s48, 6144
  buffer_load_dwordx4 v[164:167], v1, s[20:23], s48 offen sc1
  v_mfma_f32_16x16x32_bf16 v[76:79], v[112:115], v[216:219], v[76:79]
  ds_read_b64_tr_b16 v[106:107], v8 offset:52480
  s_mov_b32 s48, 7168
  buffer_load_dwordx4 v[168:171], v1, s[20:23], s48 offen sc1
  v_mfma_f32_16x16x32_bf16 v[44:47], v[116:119], v[212:215], v[44:47]
  ds_read_b64_tr_b16 v[108:109], v8 offset:53248
  s_mov_b32 s48, 8192
  buffer_load_dwordx4 v[172:175], v1, s[20:23], s48 offen sc1
  v_mfma_f32_16x16x32_bf16 v[80:83], v[116:119], v[216:219], v[80:83]
  ds_read_b64_tr_b16 v[110:111], v8 offset:53504
  v_mfma_f32_16x16x32_bf16 v[48:51], v[120:123], v[212:215], v[48:51]
  ds_read_b64_tr_b16 v[112:113], v8 offset:54272
  v_mfma_f32_16x16x32_bf16 v[84:87], v[120:123], v[216:219], v[84:87]
  ds_read_b64_tr_b16 v[114:115], v8 offset:54528
  v_mfma_f32_16x16x32_bf16 v[52:55], v[124:127], v[212:215], v[52:55]
  v_mfma_f32_16x16x32_bf16 v[88:91], v[124:127], v[216:219], v[88:91]
  s_waitcnt vmcnt(12)
  s_barrier
  s_waitcnt lgkmcnt(8)
  v_mfma_f32_16x16x32_bf16 v[20:23], v[128:131], v[220:223], v[20:23]
  ds_read_b64_tr_b16 v[116:117], v9 offset:0
  ds_read_b64_tr_b16 v[118:119], v9 offset:256
  v_mfma_f32_16x16x32_bf16 v[56:59], v[128:131], v[224:227], v[56:59]
  ds_read_b64_tr_b16 v[120:121], v9 offset:1024
  v_mfma_f32_16x16x32_bf16 v[24:27], v[132:135], v[220:223], v[24:27]
  ds_read_b64_tr_b16 v[122:123], v9 offset:1280
  v_mfma_f32_16x16x32_bf16 v[60:63], v[132:135], v[224:227], v[60:63]
  ds_read_b64_tr_b16 v[124:125], v9 offset:2048
  v_mfma_f32_16x16x32_bf16 v[28:31], v[136:139], v[220:223], v[28:31]
  ds_read_b64_tr_b16 v[126:127], v9 offset:2304
  v_mfma_f32_16x16x32_bf16 v[64:67], v[136:139], v[224:227], v[64:67]
  ds_read_b64_tr_b16 v[128:129], v9 offset:3072
  v_mfma_f32_16x16x32_bf16 v[32:35], v[92:95], v[220:223], v[32:35]
  ds_read_b64_tr_b16 v[130:131], v9 offset:3328
  v_mfma_f32_16x16x32_bf16 v[68:71], v[92:95], v[224:227], v[68:71]
  ds_read_b64_tr_b16 v[132:133], v9 offset:4096
  v_mfma_f32_16x16x32_bf16 v[36:39], v[96:99], v[220:223], v[36:39]
  ds_read_b64_tr_b16 v[134:135], v9 offset:4352
  ds_read_b64_tr_b16 v[136:137], v9 offset:5120
  v_mfma_f32_16x16x32_bf16 v[72:75], v[96:99], v[224:227], v[72:75]
  ds_read_b64_tr_b16 v[138:139], v9 offset:5376
  s_waitcnt lgkmcnt(12)
  v_mfma_f32_16x16x32_bf16 v[40:43], v[100:103], v[220:223], v[40:43]
  ds_read_b64_tr_b16 v[92:93], v9 offset:6144
  v_mfma_f32_16x16x32_bf16 v[76:79], v[100:103], v[224:227], v[76:79]
  ds_read_b64_tr_b16 v[94:95], v9 offset:6400
  v_mfma_f32_16x16x32_bf16 v[44:47], v[104:107], v[220:223], v[44:47]
  ds_read_b64_tr_b16 v[96:97], v9 offset:7168
  v_mfma_f32_16x16x32_bf16 v[80:83], v[104:107], v[224:227], v[80:83]
  ds_read_b64_tr_b16 v[98:99], v9 offset:7424
  v_mfma_f32_16x16x32_bf16 v[48:51], v[108:111], v[220:223], v[48:51]
  ds_read_b64_tr_b16 v[100:101], v9 offset:8192
  v_mfma_f32_16x16x32_bf16 v[84:87], v[108:111], v[224:227], v[84:87]
  ds_read_b64_tr_b16 v[102:103], v9 offset:8448
  v_mfma_f32_16x16x32_bf16 v[52:55], v[112:115], v[220:223], v[52:55]
  v_mfma_f32_16x16x32_bf16 v[88:91], v[112:115], v[224:227], v[88:91]
  s_waitcnt lgkmcnt(8)
  v_mfma_f32_16x16x32_bf16 v[20:23], v[116:119], v[228:231], v[20:23]
  ds_read_b64_tr_b16 v[104:105], v9 offset:9216
  ds_read_b64_tr_b16 v[106:107], v9 offset:9472
  v_mfma_f32_16x16x32_bf16 v[56:59], v[116:119], v[232:235], v[56:59]
  ds_read_b64_tr_b16 v[108:109], v9 offset:10240
  v_mfma_f32_16x16x32_bf16 v[24:27], v[120:123], v[228:231], v[24:27]
  ds_read_b64_tr_b16 v[110:111], v9 offset:10496
  v_mfma_f32_16x16x32_bf16 v[60:63], v[120:123], v[232:235], v[60:63]
  ds_read_b64_tr_b16 v[112:113], v9 offset:11264
  v_mfma_f32_16x16x32_bf16 v[28:31], v[124:127], v[228:231], v[28:31]
  ds_read_b64_tr_b16 v[114:115], v9 offset:11520
  v_mfma_f32_16x16x32_bf16 v[64:67], v[124:127], v[232:235], v[64:67]
  ds_read_b64_tr_b16 v[116:117], v9 offset:12288
  v_mfma_f32_16x16x32_bf16 v[32:35], v[128:131], v[228:231], v[32:35]
  ds_read_b64_tr_b16 v[118:119], v9 offset:12544
  v_mfma_f32_16x16x32_bf16 v[68:71], v[128:131], v[232:235], v[68:71]
  ds_read_b64_tr_b16 v[120:121], v9 offset:13312
  v_mfma_f32_16x16x32_bf16 v[36:39], v[132:135], v[228:231], v[36:39]
  ds_read_b64_tr_b16 v[122:123], v9 offset:13568
  ds_read_b64_tr_b16 v[124:125], v9 offset:14336
  v_mfma_f32_16x16x32_bf16 v[72:75], v[132:135], v[232:235], v[72:75]
  ds_read_b64_tr_b16 v[126:127], v9 offset:14592
  s_waitcnt lgkmcnt(12)
  v_mfma_f32_16x16x32_bf16 v[40:43], v[136:139], v[228:231], v[40:43]
  ds_read_b64_tr_b16 v[128:129], v9 offset:15360
  v_mfma_f32_16x16x32_bf16 v[76:79], v[136:139], v[232:235], v[76:79]
  ds_read_b64_tr_b16 v[130:131], v9 offset:15616
  v_mfma_f32_16x16x32_bf16 v[44:47], v[92:95], v[228:231], v[44:47]
  ds_read_b64_tr_b16 v[132:133], v9 offset:16384
  v_mfma_f32_16x16x32_bf16 v[80:83], v[92:95], v[232:235], v[80:83]
  ds_read_b64_tr_b16 v[134:135], v9 offset:16640
  v_mfma_f32_16x16x32_bf16 v[48:51], v[96:99], v[228:231], v[48:51]
  ds_read_b64_tr_b16 v[136:137], v9 offset:17408
  v_mfma_f32_16x16x32_bf16 v[84:87], v[96:99], v[232:235], v[84:87]
  ds_read_b64_tr_b16 v[138:139], v9 offset:17664
  v_mfma_f32_16x16x32_bf16 v[52:55], v[100:103], v[228:231], v[52:55]
  v_mfma_f32_16x16x32_bf16 v[88:91], v[100:103], v[232:235], v[88:91]
  s_waitcnt lgkmcnt(8)
  v_mfma_f32_16x16x32_bf16 v[20:23], v[104:107], v[236:239], v[20:23]
  v_mfma_f32_16x16x32_bf16 v[56:59], v[104:107], v[240:243], v[56:59]
  v_mfma_f32_16x16x32_bf16 v[24:27], v[108:111], v[236:239], v[24:27]
  v_mfma_f32_16x16x32_bf16 v[60:63], v[108:111], v[240:243], v[60:63]
  v_mfma_f32_16x16x32_bf16 v[28:31], v[112:115], v[236:239], v[28:31]
  v_mfma_f32_16x16x32_bf16 v[64:67], v[112:115], v[240:243], v[64:67]
  v_mfma_f32_16x16x32_bf16 v[32:35], v[116:119], v[236:239], v[32:35]
  v_mfma_f32_16x16x32_bf16 v[68:71], v[116:119], v[240:243], v[68:71]
  v_mfma_f32_16x16x32_bf16 v[36:39], v[120:123], v[236:239], v[36:39]
  v_mfma_f32_16x16x32_bf16 v[72:75], v[120:123], v[240:243], v[72:75]
  s_waitcnt lgkmcnt(0)
  v_mfma_f32_16x16x32_bf16 v[40:43], v[124:127], v[236:239], v[40:43]
  v_mfma_f32_16x16x32_bf16 v[76:79], v[124:127], v[240:243], v[76:79]
  v_mfma_f32_16x16x32_bf16 v[44:47], v[128:131], v[236:239], v[44:47]
  v_mfma_f32_16x16x32_bf16 v[80:83], v[128:131], v[240:243], v[80:83]
  v_mfma_f32_16x16x32_bf16 v[48:51], v[132:135], v[236:239], v[48:51]
  v_mfma_f32_16x16x32_bf16 v[84:87], v[132:135], v[240:243], v[84:87]
  v_mfma_f32_16x16x32_bf16 v[52:55], v[136:139], v[236:239], v[52:55]
  v_mfma_f32_16x16x32_bf16 v[88:91], v[136:139], v[240:243], v[88:91]
  s_waitcnt vmcnt(0) lgkmcnt(0)
  s_nop 7
  v_lshlrev_b32 v176, 16, v176
  v_lshlrev_b32 v177, 16, v177
  v_lshlrev_b32 v2, 3, v18
  v_bfe_u32 v3, v0, 4, 1
  v_lshl_add_u32 v2, v3, 10, v2
  v_lshrrev_b32 v3, 5, v0
  v_lshl_add_u32 v2, v3, 8, v2
  s_bitcmp1_b32 s31, 0
  s_cselect_b32 s42, 512, 0
  s_cselect_b32 s43, 2048, 0
  s_max_u32 s43, s43, 512
  v_lshlrev_b32 v4, 16, v140
  v_and_b32 v5, 0xffff0000, v140
  v_add_f32 v6, v20, v176
  v_add_f32 v7, v21, v176
  v_mul_f32 v4, v4, v6
  v_mul_f32 v5, v5, v7
  v_cvt_pk_bf16_f32 v92, v4, v5
  v_lshlrev_b32 v4, 16, v141
  v_and_b32 v5, 0xffff0000, v141
  v_add_f32 v6, v22, v176
  v_add_f32 v7, v23, v176
  v_mul_f32 v4, v4, v6
  v_mul_f32 v5, v5, v7
  v_cvt_pk_bf16_f32 v93, v4, v5
  v_lshlrev_b32 v4, 16, v142
  v_and_b32 v5, 0xffff0000, v142
  v_add_f32 v6, v56, v177
  v_add_f32 v7, v57, v177
  v_mul_f32 v4, v4, v6
  v_mul_f32 v5, v5, v7
  v_cvt_pk_bf16_f32 v94, v4, v5
  v_lshlrev_b32 v4, 16, v143
  v_and_b32 v5, 0xffff0000, v143
  v_add_f32 v6, v58, v177
  v_add_f32 v7, v59, v177
  v_mul_f32 v4, v4, v6
  v_mul_f32 v5, v5, v7
  v_cvt_pk_bf16_f32 v95, v4, v5
  s_add_u32 s48, s42, 0
  s_nop 0
  v_permlane16_swap_b32 v92, v94
  v_permlane16_swap_b32 v93, v95
  s_nop 1
  buffer_store_dwordx4 v[92:95], v2, s[52:55], s48 offen sc1
  v_lshlrev_b32 v4, 16, v144
  v_and_b32 v5, 0xffff0000, v144
  v_add_f32 v6, v24, v176
  v_add_f32 v7, v25, v176
  v_mul_f32 v4, v4, v6
  v_mul_f32 v5, v5, v7
  v_cvt_pk_bf16_f32 v96, v4, v5
  v_lshlrev_b32 v4, 16, v145
  v_and_b32 v5, 0xffff0000, v145
  v_add_f32 v6, v26, v176
  v_add_f32 v7, v27, v176
  v_mul_f32 v4, v4, v6
  v_mul_f32 v5, v5, v7
  v_cvt_pk_bf16_f32 v97, v4, v5
  v_lshlrev_b32 v4, 16, v146
  v_and_b32 v5, 0xffff0000, v146
  v_add_f32 v6, v60, v177
  v_add_f32 v7, v61, v177
  v_mul_f32 v4, v4, v6
  v_mul_f32 v5, v5, v7
  v_cvt_pk_bf16_f32 v98, v4, v5
  v_lshlrev_b32 v4, 16, v147
  v_and_b32 v5, 0xffff0000, v147
  v_add_f32 v6, v62, v177
  v_add_f32 v7, v63, v177
  v_mul_f32 v4, v4, v6
  v_mul_f32 v5, v5, v7
  v_cvt_pk_bf16_f32 v99, v4, v5
  s_add_u32 s48, s43, 0
  s_nop 0
  v_permlane16_swap_b32 v96, v98
  v_permlane16_swap_b32 v97, v99
  s_nop 1
  buffer_store_dwordx4 v[96:99], v2, s[52:55], s48 offen sc1
  v_lshlrev_b32 v4, 16, v148
  v_and_b32 v5, 0xffff0000, v148
  v_add_f32 v6, v28, v176
  v_add_f32 v7, v29, v176
  v_mul_f32 v4, v4, v6
  v_mul_f32 v5, v5, v7
  v_cvt_pk_bf16_f32 v100, v4, v5
  v_lshlrev_b32 v4, 16, v149
  v_and_b32 v5, 0xffff0000, v149
  v_add_f32 v6, v30, v176
  v_add_f32 v7, v31, v176
  v_mul_f32 v4, v4, v6
  v_mul_f32 v5, v5, v7
  v_cvt_pk_bf16_f32 v101, v4, v5
  v_lshlrev_b32 v4, 16, v150
  v_and_b32 v5, 0xffff0000, v150
  v_add_f32 v6, v64, v177
  v_add_f32 v7, v65, v177
  v_mul_f32 v4, v4, v6
  v_mul_f32 v5, v5, v7
  v_cvt_pk_bf16_f32 v102, v4, v5
  v_lshlrev_b32 v4, 16, v151
  v_and_b32 v5, 0xffff0000, v151
  v_add_f32 v6, v66, v177
  v_add_f32 v7, v67, v177
  v_mul_f32 v4, v4, v6
  v_mul_f32 v5, v5, v7
  v_cvt_pk_bf16_f32 v103, v4, v5
  s_add_u32 s48, s42, 2048
  s_nop 0
  v_permlane16_swap_b32 v100, v102
  v_permlane16_swap_b32 v101, v103
  s_nop 1
  buffer_store_dwordx4 v[100:103], v2, s[52:55], s48 offen sc1
  v_lshlrev_b32 v4, 16, v152
  v_and_b32 v5, 0xffff0000, v152
  v_add_f32 v6, v32, v176
  v_add_f32 v7, v33, v176
  v_mul_f32 v4, v4, v6
  v_mul_f32 v5, v5, v7
  v_cvt_pk_bf16_f32 v104, v4, v5
  v_lshlrev_b32 v4, 16, v153
  v_and_b32 v5, 0xffff0000, v153
  v_add_f32 v6, v34, v176
  v_add_f32 v7, v35, v176
  v_mul_f32 v4, v4, v6
  v_mul_f32 v5, v5, v7
  v_cvt_pk_bf16_f32 v105, v4, v5
  v_lshlrev_b32 v4, 16, v154
  v_and_b32 v5, 0xffff0000, v154
  v_add_f32 v6, v68, v177
  v_add_f32 v7, v69, v177
  v_mul_f32 v4, v4, v6
  v_mul_f32 v5, v5, v7
  v_cvt_pk_bf16_f32 v106, v4, v5
  v_lshlrev_b32 v4, 16, v155
  v_and_b32 v5, 0xffff0000, v155
  v_add_f32 v6, v70, v177
  v_add_f32 v7, v71, v177
  v_mul_f32 v4, v4, v6
  v_mul_f32 v5, v5, v7
  v_cvt_pk_bf16_f32 v107, v4, v5
  s_add_u32 s48, s43, 2048
  s_nop 0
  v_permlane16_swap_b32 v104, v106
  v_permlane16_swap_b32 v105, v107
  s_nop 1
  buffer_store_dwordx4 v[104:107], v2, s[52:55], s48 offen sc1
  v_lshlrev_b32 v4, 16, v156
  v_and_b32 v5, 0xffff0000, v156
  v_add_f32 v6, v36, v176
  v_add_f32 v7, v37, v176
  v_mul_f32 v4, v4, v6
  v_mul_f32 v5, v5, v7
  v_cvt_pk_bf16_f32 v108, v4, v5
  v_lshlrev_b32 v4, 16, v157
  v_and_b32 v5, 0xffff0000, v157
  v_add_f32 v6, v38, v176
  v_add_f32 v7, v39, v176
  v_mul_f32 v4, v4, v6
  v_mul_f32 v5, v5, v7
  v_cvt_pk_bf16_f32 v109, v4, v5
  v_lshlrev_b32 v4, 16, v158
  v_and_b32 v5, 0xffff0000, v158
  v_add_f32 v6, v72, v177
  v_add_f32 v7, v73, v177
  v_mul_f32 v4, v4, v6
  v_mul_f32 v5, v5, v7
  v_cvt_pk_bf16_f32 v110, v4, v5
  v_lshlrev_b32 v4, 16, v159
  v_and_b32 v5, 0xffff0000, v159
  v_add_f32 v6, v74, v177
  v_add_f32 v7, v75, v177
  v_mul_f32 v4, v4, v6
  v_mul_f32 v5, v5, v7
  v_cvt_pk_bf16_f32 v111, v4, v5
  s_add_u32 s48, s42, 4096
  s_nop 0
  v_permlane16_swap_b32 v108, v110
  v_permlane16_swap_b32 v109, v111
  s_nop 1
  buffer_store_dwordx4 v[108:111], v2, s[52:55], s48 offen sc1
  v_lshlrev_b32 v4, 16, v160
  v_and_b32 v5, 0xffff0000, v160
  v_add_f32 v6, v40, v176
  v_add_f32 v7, v41, v176
  v_mul_f32 v4, v4, v6
  v_mul_f32 v5, v5, v7
  v_cvt_pk_bf16_f32 v112, v4, v5
  v_lshlrev_b32 v4, 16, v161
  v_and_b32 v5, 0xffff0000, v161
  v_add_f32 v6, v42, v176
  v_add_f32 v7, v43, v176
  v_mul_f32 v4, v4, v6
  v_mul_f32 v5, v5, v7
  v_cvt_pk_bf16_f32 v113, v4, v5
  v_lshlrev_b32 v4, 16, v162
  v_and_b32 v5, 0xffff0000, v162
  v_add_f32 v6, v76, v177
  v_add_f32 v7, v77, v177
  v_mul_f32 v4, v4, v6
  v_mul_f32 v5, v5, v7
  v_cvt_pk_bf16_f32 v114, v4, v5
  v_lshlrev_b32 v4, 16, v163
  v_and_b32 v5, 0xffff0000, v163
  v_add_f32 v6, v78, v177
  v_add_f32 v7, v79, v177
  v_mul_f32 v4, v4, v6
  v_mul_f32 v5, v5, v7
  v_cvt_pk_bf16_f32 v115, v4, v5
  s_add_u32 s48, s43, 4096
  s_nop 0
  v_permlane16_swap_b32 v112, v114
  v_permlane16_swap_b32 v113, v115
  s_nop 1
  buffer_store_dwordx4 v[112:115], v2, s[52:55], s48 offen sc1
  v_lshlrev_b32 v4, 16, v164
  v_and_b32 v5, 0xffff0000, v164
  v_add_f32 v6, v44, v176
  v_add_f32 v7, v45, v176
  v_mul_f32 v4, v4, v6
  v_mul_f32 v5, v5, v7
  v_cvt_pk_bf16_f32 v116, v4, v5
  v_lshlrev_b32 v4, 16, v165
  v_and_b32 v5, 0xffff0000, v165
  v_add_f32 v6, v46, v176
  v_add_f32 v7, v47, v176
  v_mul_f32 v4, v4, v6
  v_mul_f32 v5, v5, v7
  v_cvt_pk_bf16_f32 v117, v4, v5
  v_lshlrev_b32 v4, 16, v166
  v_and_b32 v5, 0xffff0000, v166
  v_add_f32 v6, v80, v177
  v_add_f32 v7, v81, v177
  v_mul_f32 v4, v4, v6
  v_mul_f32 v5, v5, v7
  v_cvt_pk_bf16_f32 v118, v4, v5
  v_lshlrev_b32 v4, 16, v167
  v_and_b32 v5, 0xffff0000, v167
  v_add_f32 v6, v82, v177
  v_add_f32 v7, v83, v177
  v_mul_f32 v4, v4, v6
  v_mul_f32 v5, v5, v7
  v_cvt_pk_bf16_f32 v119, v4, v5
  s_add_u32 s48, s42, 6144
  s_nop 0
  v_permlane16_swap_b32 v116, v118
  v_permlane16_swap_b32 v117, v119
  s_nop 1
  buffer_store_dwordx4 v[116:119], v2, s[52:55], s48 offen sc1
  v_lshlrev_b32 v4, 16, v168
  v_and_b32 v5, 0xffff0000, v168
  v_add_f32 v6, v48, v176
  v_add_f32 v7, v49, v176
  v_mul_f32 v4, v4, v6
  v_mul_f32 v5, v5, v7
  v_cvt_pk_bf16_f32 v120, v4, v5
  v_lshlrev_b32 v4, 16, v169
  v_and_b32 v5, 0xffff0000, v169
  v_add_f32 v6, v50, v176
  v_add_f32 v7, v51, v176
  v_mul_f32 v4, v4, v6
  v_mul_f32 v5, v5, v7
  v_cvt_pk_bf16_f32 v121, v4, v5
  v_lshlrev_b32 v4, 16, v170
  v_and_b32 v5, 0xffff0000, v170
  v_add_f32 v6, v84, v177
  v_add_f32 v7, v85, v177
  v_mul_f32 v4, v4, v6
  v_mul_f32 v5, v5, v7
  v_cvt_pk_bf16_f32 v122, v4, v5
  v_lshlrev_b32 v4, 16, v171
  v_and_b32 v5, 0xffff0000, v171
  v_add_f32 v6, v86, v177
  v_add_f32 v7, v87, v177
  v_mul_f32 v4, v4, v6
  v_mul_f32 v5, v5, v7
  v_cvt_pk_bf16_f32 v123, v4, v5
  s_add_u32 s48, s43, 6144
  s_nop 0
  v_permlane16_swap_b32 v120, v122
  v_permlane16_swap_b32 v121, v123
  s_nop 1
  buffer_store_dwordx4 v[120:123], v2, s[52:55], s48 offen sc1
  v_lshlrev_b32 v4, 16, v172
  v_and_b32 v5, 0xffff0000, v172
  v_add_f32 v6, v52, v176
  v_add_f32 v7, v53, v176
  v_mul_f32 v4, v4, v6
  v_mul_f32 v5, v5, v7
  v_cvt_pk_bf16_f32 v124, v4, v5
  v_lshlrev_b32 v4, 16, v173
  v_and_b32 v5, 0xffff0000, v173
  v_add_f32 v6, v54, v176
  v_add_f32 v7, v55, v176
  v_mul_f32 v4, v4, v6
  v_mul_f32 v5, v5, v7
  v_cvt_pk_bf16_f32 v125, v4, v5
  v_lshlrev_b32 v4, 16, v174
  v_and_b32 v5, 0xffff0000, v174
  v_add_f32 v6, v88, v177
  v_add_f32 v7, v89, v177
  v_mul_f32 v4, v4, v6
  v_mul_f32 v5, v5, v7
  v_cvt_pk_bf16_f32 v126, v4, v5
  v_lshlrev_b32 v4, 16, v175
  v_and_b32 v5, 0xffff0000, v175
  v_add_f32 v6, v90, v177
  v_add_f32 v7, v91, v177
  v_mul_f32 v4, v4, v6
  v_mul_f32 v5, v5, v7
  v_cvt_pk_bf16_f32 v127, v4, v5
  s_add_u32 s48, s42, 8192
  s_nop 0
  v_permlane16_swap_b32 v124, v126
  v_permlane16_swap_b32 v125, v127
  s_nop 1
  buffer_store_dwordx4 v[124:127], v2, s[52:55], s48 offen sc1
k5_body:
  v_lshlrev_b32 v12, 7, v0
  v_mov_b32 v13, 0
  s_mov_b64 s[64:65], s[60:61]
  s_mov_b64 s[66:67], s[62:63]
  s_cmp_lt_u32 s2, 192
  s_cbranch_scc1 k5_go
  s_waitcnt vmcnt(0)
  buffer_store_dword v13, v12, s[64:67], 0 offen sc1
  s_endpgm
k5_go:
  s_load_dwordx2 s[4:5], s[0:1], 96
  s_load_dwordx2 s[6:7], s[0:1], 72
  s_barrier
  s_bfe_u32 s52, s2, 0x20001
  s_and_b32 s50, s52, 1
  s_lshr_b32 s51, s52, 1
  s_and_b32 s30, s2, 1
  s_lshl_b32 s30, s30, 3
  s_bfe_u32 s31, s2, 0x30003
  s_add_u32 s30, s30, s31
  s_lshr_b32 s53, s2, 6
  s_lshl_b32 s33, s30, 2
  s_add_u32 s33, s33, s3
  s_lshl_b32 s34, s33, 1
  s_add_u32 s34, s34, s50
  s_lshl_b32 s31, s53, 1
  s_add_u32 s31, s31, s51
  s_mul_i32 s35, s53, 384
  s_mul_i32 s36, s52, 663552
  s_add_u32 s35, s35, s36
  s_sub_u32 s36, 2654208, s35
  s_mul_i32 s37, s33, 147456
  s_mul_i32 s38, s52, 36864
  s_add_u32 s37, s37, s38
  s_mul_i32 s38, s34, 18432
  s_mul_i32 s39, s31, 192
  s_add_u32 s38, s38, s39
  s_lshl_b32 s39, s39, 1
  s_mul_i32 s40, s33, 3
  s_add_u32 s40, s40, s53
  s_mul_i32 s41, s40, 36864
  s_lshl_b32 s40, s40, 9
  s_waitcnt lgkmcnt(0)
  s_add_u32 s12, s6, 0
  s_addc_u32 s13, s7, 0
  s_add_u32 s12, s12, s35
  s_addc_u32 s13, s13, 0
  s_mov_b32 s14, s36
  s_mov_b32 s15, 0x20000
  s_add_u32 s16, s10, 59817984
  s_addc_u32 s17, s11, 0
  s_add_u32 s16, s16, s37
  s_addc_u32 s17, s17, 0
  s_mov_b32 s18, 36864
  s_mov_b32 s19, 0x20000
  s_add_u32 s20, s4, 0
  s_addc_u32 s21, s5, 0
  s_add_u32 s20, s20, s38
  s_addc_u32 s21, s21, 0
  s_mov_b32 s22, 17472
  s_mov_b32 s23, 0x20000
  s_add_u32 s24, s10, 0
  s_addc_u32 s25, s11, 0
  s_add_u32 s24, s24, s39
  s_addc_u32 s25, s25, 0
  s_mov_b32 s26, 13824
  s_mov_b32 s27, 0x20000
  s_add_u32 s56, s10, 52740096
  s_addc_u32 s57, s11, 0
  s_add_u32 s56, s56, s41
  s_addc_u32 s57, s57, 0
  s_mov_b32 s58, 36864
  s_mov_b32 s59, 0x20000
  s_add_u32 s60, s10, 52084736
  s_addc_u32 s61, s11, 0
  s_add_u32 s60, s60, s40
  s_addc_u32 s61, s61, 0
  s_mov_b32 s62, 512
  s_mov_b32 s63, 0x20000
  s_mov_b32 s44, 0
  s_mov_b32 s45, 0
  v_and_b32 v0, 63, v0
  v_lshlrev_b32 v1, 4, v0
  s_mul_i32 s46, s3, 6144
  s_lshl_b32 s48, s50, 10
  v_add_u32 v16, s48, v1
  v_xor_b32 v17, 0x400, v16
  s_mul_i32 s49, s51, 12
  s_lshr_b32 s48, s46, 4
  s_add_u32 s48, s48, 0
  v_add_u32 v14, s48, v0
  v_mul_u32_u24 v15, 2731, v14
  v_lshrrev_b32 v15, 16, v15
  v_mul_u32_u24 v2, 24, v15
  v_sub_u32 v14, v14, v2
  v_and_b32 v2, 6, v15
  v_xor_b32 v14, v14, v2
  v_add_u32 v14, s49, v14
  v_subrev_u32 v2, 24, v14
  v_min_u32 v14, v14, v2
  v_bfe_u32 v2, v15, 4, 1
  v_bfe_u32 v18, v15, 2, 2
  v_and_b32 v15, 0x63, v15
  v_lshl_add_u32 v15, v2, 2, v15
  v_lshl_add_u32 v15, v18, 3, v15
  v_mul_u32_u24 v2, 1152, v15
  v_lshl_add_u32 v2, v14, 4, v2
  s_lshr_b32 s48, s46, 4
  s_add_u32 s48, s48, 64
  v_add_u32 v14, s48, v0
  v_mul_u32_u24 v15, 2731, v14
  v_lshrrev_b32 v15, 16, v15
  v_mul_u32_u24 v3, 24, v15
  v_sub_u32 v14, v14, v3
  v_and_b32 v3, 6, v15
  v_xor_b32 v14, v14, v3
  v_add_u32 v14, s49, v14
  v_subrev_u32 v3, 24, v14
  v_min_u32 v14, v14, v3
  v_bfe_u32 v3, v15, 4, 1
  v_bfe_u32 v18, v15, 2, 2
  v_and_b32 v15, 0x63, v15
  v_lshl_add_u32 v15, v3, 2, v15
  v_lshl_add_u32 v15, v18, 3, v15
  v_mul_u32_u24 v3, 1152, v15
  v_lshl_add_u32 v3, v14, 4, v3
  s_lshr_b32 s48, s46, 4
  s_add_u32 s48, s48, 128
  v_add_u32 v14, s48, v0
  v_mul_u32_u24 v15, 2731, v14
  v_lshrrev_b32 v15, 16, v15
  v_mul_u32_u24 v4, 24, v15
  v_sub_u32 v14, v14, v4
  v_and_b32 v4, 6, v15
  v_xor_b32 v14, v14, v4
  v_add_u32 v14, s49, v14
  v_subrev_u32 v4, 24, v14
  v_min_u32 v14, v14, v4
  v_bfe_u32 v4, v15, 4, 1
  v_bfe_u32 v18, v15, 2, 2
  v_and_b32 v15, 0x63, v15
  v_lshl_add_u32 v15, v4, 2, v15
  v_lshl_add_u32 v15, v18, 3, v15
  v_mul_u32_u24 v4, 1152, v15
  v_lshl_add_u32 v4, v14, 4, v4
  s_lshr_b32 s48, s46, 4
  s_add_u32 s48, s48, 192
  v_add_u32 v14, s48, v0
  v_mul_u32_u24 v15, 2731, v14
  v_lshrrev_b32 v15, 16, v15
  v_mul_u32_u24 v5, 24, v15
  v_sub_u32 v14, v14, v5
  v_and_b32 v5, 6, v15
  v_xor_b32 v14, v14, v5
  v_add_u32 v14, s49, v14
  v_subrev_u32 v5, 24, v14
  v_min_u32 v14, v14, v5
  v_bfe_u32 v5, v15, 4, 1
  v_bfe_u32 v18, v15, 2, 2
  v_and_b32 v15, 0x63, v15
  v_lshl_add_u32 v15, v5, 2, v15
  v_lshl_add_u32 v15, v18, 3, v15
  v_mul_u32_u24 v5, 1152, v15
  v_lshl_add_u32 v5, v14, 4, v5
  s_lshr_b32 s48, s46, 4
  s_add_u32 s48, s48, 256
  v_add_u32 v14, s48, v0
  v_mul_u32_u24 v15, 2731, v14
  v_lshrrev_b32 v15, 16, v15
  v_mul_u32_u24 v6, 24, v15
  v_sub_u32 v14, v14, v6
  v_and_b32 v6, 6, v15
  v_xor_b32 v14, v14, v6
  v_add_u32 v14, s49, v14
  v_subrev_u32 v6, 24, v14
  v_min_u32 v14, v14, v6
  v_bfe_u32 v6, v15, 4, 1
  v_bfe_u32 v18, v15, 2, 2
  v_and_b32 v15, 0x63, v15
  v_lshl_add_u32 v15, v6, 2, v15
  v_lshl_add_u32 v15, v18, 3, v15
  v_mul_u32_u24 v6, 1152, v15
  v_lshl_add_u32 v6, v14, 4, v6
  s_lshr_b32 s48, s46, 4
  s_add_u32 s48, s48, 320
  v_add_u32 v14, s48, v0
  v_mul_u32_u24 v15, 2731, v14
  v_lshrrev_b32 v15, 16, v15
  v_mul_u32_u24 v7, 24, v15
  v_sub_u32 v14, v14, v7
  v_and_b32 v7, 6, v15
  v_xor_b32 v14, v14, v7
  v_add_u32 v14, s49, v14
  v_subrev_u32 v7, 24, v14
  v_min_u32 v14, v14, v7
  v_bfe_u32 v7, v15, 4, 1
  v_bfe_u32 v18, v15, 2, 2
  v_and_b32 v15, 0x63, v15
  v_lshl_add_u32 v15, v7, 2, v15
  v_lshl_add_u32 v15, v18, 3, v15
  v_mul_u32_u24 v7, 1152, v15
  v_lshl_add_u32 v7, v14, 4, v7
  v_and_b32 v18, 15, v0
  v_mul_u32_u24 v18, 1152, v18
  v_lshrrev_b32 v19, 4, v0
  v_lshl_add_u32 v18, v19, 3, v18
  v_lshlrev_b32 v19, 4, v19
  s_waitcnt vmcnt(0)
  buffer_store_dword v13, v12, s[64:67], 0 offen sc1
  s_add_u32 m0, s46, 0
  s_nop 0
  buffer_load_dwordx4 v2, s[12:15], s44 offen lds
  s_add_u32 m0, s46, 1024
  s_nop 0
  buffer_load_dwordx4 v3, s[12:15], s44 offen lds
  s_add_u32 m0, s46, 2048
  s_nop 0
  buffer_load_dwordx4 v4, s[12:15], s44 offen lds
  s_add_u32 m0, s46, 3072
  s_nop 0
  buffer_load_dwordx4 v5, s[12:15], s44 offen lds
  s_add_u32 m0, s46, 4096
  s_nop 0
  buffer_load_dwordx4 v6, s[12:15], s44 offen lds
  s_add_u32 m0, s46, 5120
  s_nop 0
  buffer_load_dwordx4 v7, s[12:15], s44 offen lds
  s_add_u32 s44, s44, 73728
  s_add_u32 m0, s46, 24576
  s_nop 0
  buffer_load_dwordx4 v2, s[12:15], s44 offen lds
  s_add_u32 m0, s46, 25600
  s_nop 0
  buffer_load_dwordx4 v3, s[12:15], s44 offen lds
  s_add_u32 m0, s46, 26624
  s_nop 0
  buffer_load_dwordx4 v4, s[12:15], s44 offen lds
  s_add_u32 m0, s46, 27648
  s_nop 0
  buffer_load_dwordx4 v5, s[12:15], s44 offen lds
  s_add_u32 m0, s46, 28672
  s_nop 0
  buffer_load_dwordx4 v6, s[12:15], s44 offen lds
  s_add_u32 m0, s46, 29696
  s_nop 0
  buffer_load_dwordx4 v7, s[12:15], s44 offen lds
  s_add_u32 s44, s44, 73728
  s_lshl_b32 s48, s33, 2
  s_add_u32 s48, s48, s52
  s_lshl_b32 s48, s48, 9
  s_add_u32 s40, s10, 51658752
  s_addc_u32 s41, s11, 0
  s_add_u32 s40, s40, s48
  s_addc_u32 s41, s41, 0
  s_mov_b32 s42, 512
  s_mov_b32 s43, 0x20000
k5_poll:
  buffer_load_dword v13, v12, s[40:43], 0 offen sc1
  s_waitcnt vmcnt(0)
  v_cmp_ne_u32 vcc, 0, v13
  s_nop 1
  s_cbranch_vccz k5_rdy
  s_sleep 1
  s_branch k5_poll
k5_rdy:
  buffer_load_dwordx4 v[188:191], v16, s[16:19], s45 offen offset:0 sc1
  buffer_load_dwordx4 v[192:195], v17, s[16:19], s45 offen offset:0 sc1
  buffer_load_dwordx4 v[196:199], v16, s[16:19], s45 offen offset:2048 sc1
  buffer_load_dwordx4 v[200:203], v17, s[16:19], s45 offen offset:2048 sc1
  s_add_u32 s45, s45, 4096
  buffer_load_dwordx4 v[204:207], v16, s[16:19], s45 offen offset:0 sc1
  buffer_load_dwordx4 v[208:211], v17, s[16:19], s45 offen offset:0 sc1
  buffer_load_dwordx4 v[212:215], v16, s[16:19], s45 offen offset:2048 sc1
  buffer_load_dwordx4 v[216:219], v17, s[16:19], s45 offen offset:2048 sc1
  s_add_u32 s45, s45, 4096
  v_lshrrev_b32 v14, 2, v0
  v_mul_u32_u24 v8, 384, v14
  v_and_b32 v14, 3, v0
  v_lshl_add_u32 v8, v14, 3, v8
  v_bfe_u32 v14, v0, 3, 2
  v_xor_b32 v14, 0, v14
  v_lshl_add_u32 v244, v14, 5, v8
  v_add_u32 v248, 49152, v244
  v_bfe_u32 v14, v0, 3, 2
  v_xor_b32 v14, 1, v14
  v_lshl_add_u32 v245, v14, 5, v8
  v_add_u32 v249, 49152, v245
  v_bfe_u32 v14, v0, 3, 2
  v_xor_b32 v14, 2, v14
  v_lshl_add_u32 v246, v14, 5, v8
  v_add_u32 v250, 49152, v246
  v_bfe_u32 v14, v0, 3, 2
  v_xor_b32 v14, 3, v14
  v_lshl_add_u32 v247, v14, 5, v8
  v_add_u32 v251, 49152, v247
  v_mov_b32 v20, 0
  v_mov_b32 v21, 0
  v_mov_b32 v22, 0
  v_mov_b32 v23, 0
  v_mov_b32 v24, 0
  v_mov_b32 v25, 0
  v_mov_b32 v26, 0
  v_mov_b32 v27, 0
  v_mov_b32 v28, 0
  v_mov_b32 v29, 0
  v_mov_b32 v30, 0
  v_mov_b32 v31, 0
  v_mov_b32 v32, 0
  v_mov_b32 v33, 0
  v_mov_b32 v34, 0
  v_mov_b32 v35, 0
  v_mov_b32 v36, 0
  v_mov_b32 v37, 0
  v_mov_b32 v38, 0
  v_mov_b32 v39, 0
  v_mov_b32 v40, 0
  v_mov_b32 v41, 0
  v_mov_b32 v42, 0
  v_mov_b32 v43, 0
  v_mov_b32 v44, 0
  v_mov_b32 v45, 0
  v_mov_b32 v46, 0
  v_mov_b32 v47, 0
  v_mov_b32 v48, 0
  v_mov_b32 v49, 0
  v_mov_b32 v50, 0
  v_mov_b32 v51, 0
  v_mov_b32 v52, 0
  v_mov_b32 v53, 0
  v_mov_b32 v54, 0
  v_mov_b32 v55, 0
  v_mov_b32 v56, 0
  v_mov_b32 v57, 0
  v_mov_b32 v58, 0
  v_mov_b32 v59, 0
  v_mov_b32 v60, 0
  v_mov_b32 v61, 0
  v_mov_b32 v62, 0
  v_mov_b32 v63, 0
  v_mov_b32 v64, 0
  v_mov_b32 v65, 0
  v_mov_b32 v66, 0
  v_mov_b32 v67, 0
  v_mov_b32 v68, 0
  v_mov_b32 v69, 0
  v_mov_b32 v70, 0
  v_mov_b32 v71, 0
  v_mov_b32 v72, 0
  v_mov_b32 v73, 0
  v_mov_b32 v74, 0
  v_mov_b32 v75, 0
  v_mov_b32 v76, 0
  v_mov_b32 v77, 0
  v_mov_b32 v78, 0
  v_mov_b32 v79, 0
  v_mov_b32 v80, 0
  v_mov_b32 v81, 0
  v_mov_b32 v82, 0
  v_mov_b32 v83, 0
  v_mov_b32 v84, 0
  v_mov_b32 v85, 0
  v_mov_b32 v86, 0
  v_mov_b32 v87, 0
  v_mov_b32 v88, 0
  v_mov_b32 v89, 0
  v_mov_b32 v90, 0
  v_mov_b32 v91, 0
  v_mov_b32 v92, 0
  v_mov_b32 v93, 0
  v_mov_b32 v94, 0
  v_mov_b32 v95, 0
  v_mov_b32 v96, 0
  v_mov_b32 v97, 0
  v_mov_b32 v98, 0
  v_mov_b32 v99, 0
  v_mov_b32 v100, 0
  v_mov_b32 v101, 0
  v_mov_b32 v102, 0
  v_mov_b32 v103, 0
  v_mov_b32 v104, 0
  v_mov_b32 v105, 0
  v_mov_b32 v106, 0
  v_mov_b32 v107, 0
  v_mov_b32 v108, 0
  v_mov_b32 v109, 0
  v_mov_b32 v110, 0
  v_mov_b32 v111, 0
  v_mov_b32 v112, 0
  v_mov_b32 v113, 0
  v_mov_b32 v114, 0
  v_mov_b32 v115, 0
  s_waitcnt vmcnt(4)
  s_barrier
  ds_read_b64_tr_b16 v[116:117], v244 offset:0
  ds_read_b64_tr_b16 v[118:119], v244 offset:6144
  ds_read_b64_tr_b16 v[120:121], v245 offset:0
  ds_read_b64_tr_b16 v[122:123], v245 offset:6144
  ds_read_b64_tr_b16 v[124:125], v246 offset:0
  ds_read_b64_tr_b16 v[126:127], v246 offset:6144
  ds_read_b64_tr_b16 v[128:129], v247 offset:0
  ds_read_b64_tr_b16 v[130:131], v247 offset:6144
  ds_read_b64_tr_b16 v[132:133], v244 offset:128
  ds_read_b64_tr_b16 v[134:135], v244 offset:6272
  ds_read_b64_tr_b16 v[136:137], v245 offset:128
  ds_read_b64_tr_b16 v[138:139], v245 offset:6272
  ds_read_b64_tr_b16 v[140:141], v246 offset:128
  ds_read_b64_tr_b16 v[142:143], v246 offset:6272
  ds_read_b64_tr_b16 v[144:145], v247 offset:128
  ds_read_b64_tr_b16 v[146:147], v247 offset:6272
  ds_read_b64_tr_b16 v[148:149], v244 offset:256
  ds_read_b64_tr_b16 v[150:151], v244 offset:6400
  ds_read_b64_tr_b16 v[152:153], v245 offset:256
  ds_read_b64_tr_b16 v[154:155], v245 offset:6400
  ds_read_b64_tr_b16 v[156:157], v246 offset:256
  ds_read_b64_tr_b16 v[158:159], v246 offset:6400
  ds_read_b64_tr_b16 v[160:161], v247 offset:256
  ds_read_b64_tr_b16 v[162:163], v247 offset:6400
  s_add_u32 m0, s46, 49152
  s_nop 0
  buffer_load_dwordx4 v2, s[12:15], s44 offen lds
  s_add_u32 m0, s46, 50176
  s_nop 0
  buffer_load_dwordx4 v3, s[12:15], s44 offen lds
  s_add_u32 m0, s46, 51200
  s_nop 0
  buffer_load_dwordx4 v4, s[12:15], s44 offen lds
  s_add_u32 m0, s46, 52224
  s_nop 0
  buffer_load_dwordx4 v5, s[12:15], s44 offen lds
  s_add_u32 m0, s46, 53248
  s_nop 0
  buffer_load_dwordx4 v6, s[12:15], s44 offen lds
  s_waitcnt lgkmcnt(12)
  s_add_u32 m0, s46, 54272
  v_mfma_f32_16x16x32_bf16 v[20:23], v[116:119], v[188:191], v[20:23]
  ds_read_b64_tr_b16 v[164:165], v244 offset:12288
  ds_read_b64_tr_b16 v[166:167], v244 offset:18432
  buffer_load_dwordx4 v7, s[12:15], s44 offen lds
  s_add_u32 s44, s44, 73728
  v_mfma_f32_16x16x32_bf16 v[68:71], v[116:119], v[192:195], v[68:71]
  ds_read_b64_tr_b16 v[168:169], v245 offset:12288
  v_mfma_f32_16x16x32_bf16 v[24:27], v[120:123], v[188:191], v[24:27]
  ds_read_b64_tr_b16 v[170:171], v245 offset:18432
  v_mfma_f32_16x16x32_bf16 v[72:75], v[120:123], v[192:195], v[72:75]
  ds_read_b64_tr_b16 v[172:173], v246 offset:12288
  v_mfma_f32_16x16x32_bf16 v[28:31], v[124:127], v[188:191], v[28:31]
  ds_read_b64_tr_b16 v[174:175], v246 offset:18432
  buffer_load_dwordx4 v[220:223], v16, s[16:19], s45 offen offset:0 sc1
  v_mfma_f32_16x16x32_bf16 v[76:79], v[124:127], v[192:195], v[76:79]
  ds_read_b64_tr_b16 v[176:177], v247 offset:12288
  v_mfma_f32_16x16x32_bf16 v[32:35], v[128:131], v[188:191], v[32:35]
  ds_read_b64_tr_b16 v[178:179], v247 offset:18432
  v_mfma_f32_16x16x32_bf16 v[80:83], v[128:131], v[192:195], v[80:83]
  ds_read_b64_tr_b16 v[180:181], v244 offset:12416
  v_mfma_f32_16x16x32_bf16 v[36:39], v[132:135], v[188:191], v[36:39]
  ds_read_b64_tr_b16 v[182:183], v244 offset:18560
  buffer_load_dwordx4 v[224:227], v17, s[16:19], s45 offen offset:0 sc1
  v_mfma_f32_16x16x32_bf16 v[84:87], v[132:135], v[192:195], v[84:87]
  ds_read_b64_tr_b16 v[184:185], v245 offset:12416
  v_mfma_f32_16x16x32_bf16 v[40:43], v[136:139], v[188:191], v[40:43]
  ds_read_b64_tr_b16 v[186:187], v245 offset:18560
  v_mfma_f32_16x16x32_bf16 v[88:91], v[136:139], v[192:195], v[88:91]
  ds_read_b64_tr_b16 v[116:117], v246 offset:12416
  ds_read_b64_tr_b16 v[118:119], v246 offset:18560
  s_waitcnt lgkmcnt(14)
  v_mfma_f32_16x16x32_bf16 v[44:47], v[140:143], v[188:191], v[44:47]
  ds_read_b64_tr_b16 v[120:121], v247 offset:12416
  buffer_load_dwordx4 v[228:231], v16, s[16:19], s45 offen offset:2048 sc1
  v_mfma_f32_16x16x32_bf16 v[92:95], v[140:143], v[192:195], v[92:95]
  ds_read_b64_tr_b16 v[122:123], v247 offset:18560
  v_mfma_f32_16x16x32_bf16 v[48:51], v[144:147], v[188:191], v[48:51]
  ds_read_b64_tr_b16 v[124:125], v244 offset:12544
  v_mfma_f32_16x16x32_bf16 v[96:99], v[144:147], v[192:195], v[96:99]
  ds_read_b64_tr_b16 v[126:127], v244 offset:18688
  v_mfma_f32_16x16x32_bf16 v[52:55], v[148:151], v[188:191], v[52:55]
  ds_read_b64_tr_b16 v[128:129], v245 offset:12544
  buffer_load_dwordx4 v[232:235], v17, s[16:19], s45 offen offset:2048 sc1
  s_add_u32 s45, s45, 4096
  v_mfma_f32_16x16x32_bf16 v[100:103], v[148:151], v[192:195], v[100:103]
  ds_read_b64_tr_b16 v[130:131], v245 offset:18688
  v_mfma_f32_16x16x32_bf16 v[56:59], v[152:155], v[188:191], v[56:59]
  ds_read_b64_tr_b16 v[132:133], v246 offset:12544
  v_mfma_f32_16x16x32_bf16 v[104:107], v[152:155], v[192:195], v[104:107]
  ds_read_b64_tr_b16 v[134:135], v246 offset:18688
  v_mfma_f32_16x16x32_bf16 v[60:63], v[156:159], v[188:191], v[60:63]
  ds_read_b64_tr_b16 v[136:137], v247 offset:12544
  v_mfma_f32_16x16x32_bf16 v[108:111], v[156:159], v[192:195], v[108:111]
  ds_read_b64_tr_b16 v[138:139], v247 offset:18688
  v_mfma_f32_16x16x32_bf16 v[64:67], v[160:163], v[188:191], v[64:67]
  v_mfma_f32_16x16x32_bf16 v[112:115], v[160:163], v[192:195], v[112:115]
  s_waitcnt vmcnt(10)
  s_waitcnt lgkmcnt(0)
  s_barrier
  s_waitcnt lgkmcnt(12)
  s_add_u32 m0, s46, 0
  v_mfma_f32_16x16x32_bf16 v[20:23], v[164:167], v[196:199], v[20:23]
  ds_read_b64_tr_b16 v[140:141], v244 offset:24576
  ds_read_b64_tr_b16 v[142:143], v244 offset:30720
  buffer_load_dwordx4 v2, s[12:15], s44 offen lds
  v_mfma_f32_16x16x32_bf16 v[68:71], v[164:167], v[200:203], v[68:71]
  ds_read_b64_tr_b16 v[144:145], v245 offset:24576
  v_mfma_f32_16x16x32_bf16 v[24:27], v[168:171], v[196:199], v[24:27]
  ds_read_b64_tr_b16 v[146:147], v245 offset:30720
  v_mfma_f32_16x16x32_bf16 v[72:75], v[168:171], v[200:203], v[72:75]
  ds_read_b64_tr_b16 v[148:149], v246 offset:24576
  s_add_u32 m0, s46, 1024
  v_mfma_f32_16x16x32_bf16 v[28:31], v[172:175], v[196:199], v[28:31]
  ds_read_b64_tr_b16 v[150:151], v246 offset:30720
  buffer_load_dwordx4 v3, s[12:15], s44 offen lds
  v_mfma_f32_16x16x32_bf16 v[76:79], v[172:175], v[200:203], v[76:79]
  ds_read_b64_tr_b16 v[152:153], v247 offset:24576
  v_mfma_f32_16x16x32_bf16 v[32:35], v[176:179], v[196:199], v[32:35]
  ds_read_b64_tr_b16 v[154:155], v247 offset:30720
  v_mfma_f32_16x16x32_bf16 v[80:83], v[176:179], v[200:203], v[80:83]
  ds_read_b64_tr_b16 v[156:157], v244 offset:24704
  s_add_u32 m0, s46, 2048
  v_mfma_f32_16x16x32_bf16 v[36:39], v[180:183], v[196:199], v[36:39]
  ds_read_b64_tr_b16 v[158:159], v244 offset:30848
  buffer_load_dwordx4 v4, s[12:15], s44 offen lds
  v_mfma_f32_16x16x32_bf16 v[84:87], v[180:183], v[200:203], v[84:87]
  ds_read_b64_tr_b16 v[160:161], v245 offset:24704
  v_mfma_f32_16x16x32_bf16 v[40:43], v[184:187], v[196:199], v[40:43]
  ds_read_b64_tr_b16 v[162:163], v245 offset:30848
  v_mfma_f32_16x16x32_bf16 v[88:91], v[184:187], v[200:203], v[88:91]
  ds_read_b64_tr_b16 v[164:165], v246 offset:24704
  ds_read_b64_tr_b16 v[166:167], v246 offset:30848
  s_waitcnt lgkmcnt(14)
  s_add_u32 m0, s46, 3072
  v_mfma_f32_16x16x32_bf16 v[44:47], v[116:119], v[196:199], v[44:47]
  ds_read_b64_tr_b16 v[168:169], v247 offset:24704
  buffer_load_dwordx4 v5, s[12:15], s44 offen lds
  v_mfma_f32_16x16x32_bf16 v[92:95], v[116:119], v[200:203], v[92:95]
  ds_read_b64_tr_b16 v[170:171], v247 offset:30848
  v_mfma_f32_16x16x32_bf16 v[48:51], v[120:123], v[196:199], v[48:51]
  ds_read_b64_tr_b16 v[172:173], v244 offset:24832
  v_mfma_f32_16x16x32_bf16 v[96:99], v[120:123], v[200:203], v[96:99]
  ds_read_b64_tr_b16 v[174:175], v244 offset:30976
  s_add_u32 m0, s46, 4096
  v_mfma_f32_16x16x32_bf16 v[52:55], v[124:127], v[196:199], v[52:55]
  ds_read_b64_tr_b16 v[176:177], v245 offset:24832
  buffer_load_dwordx4 v6, s[12:15], s44 offen lds
  v_mfma_f32_16x16x32_bf16 v[100:103], v[124:127], v[200:203], v[100:103]
  ds_read_b64_tr_b16 v[178:179], v245 offset:30976
  v_mfma_f32_16x16x32_bf16 v[56:59], v[128:131], v[196:199], v[56:59]
  ds_read_b64_tr_b16 v[180:181], v246 offset:24832
  v_mfma_f32_16x16x32_bf16 v[104:107], v[128:131], v[200:203], v[104:107]
  ds_read_b64_tr_b16 v[182:183], v246 offset:30976
  v_mfma_f32_16x16x32_bf16 v[60:63], v[132:135], v[196:199], v[60:63]
  ds_read_b64_tr_b16 v[184:185], v247 offset:24832
  v_mfma_f32_16x16x32_bf16 v[108:111], v[132:135], v[200:203], v[108:111]
  ds_read_b64_tr_b16 v[186:187], v247 offset:30976
  v_mfma_f32_16x16x32_bf16 v[64:67], v[136:139], v[196:199], v[64:67]
  v_mfma_f32_16x16x32_bf16 v[112:115], v[136:139], v[200:203], v[112:115]
  s_waitcnt lgkmcnt(12)
  s_add_u32 m0, s46, 5120
  v_mfma_f32_16x16x32_bf16 v[20:23], v[140:143], v[204:207], v[20:23]
  ds_read_b64_tr_b16 v[116:117], v244 offset:36864
  ds_read_b64_tr_b16 v[118:119], v244 offset:43008
  buffer_load_dwordx4 v7, s[12:15], s44 offen lds
  s_add_u32 s44, s44, 73728
  v_mfma_f32_16x16x32_bf16 v[68:71], v[140:143], v[208:211], v[68:71]
  ds_read_b64_tr_b16 v[120:121], v245 offset:36864
  v_mfma_f32_16x16x32_bf16 v[24:27], v[144:147], v[204:207], v[24:27]
  ds_read_b64_tr_b16 v[122:123], v245 offset:43008
  v_mfma_f32_16x16x32_bf16 v[72:75], v[144:147], v[208:211], v[72:75]
  ds_read_b64_tr_b16 v[124:125], v246 offset:36864
  v_mfma_f32_16x16x32_bf16 v[28:31], v[148:151], v[204:207], v[28:31]
  ds_read_b64_tr_b16 v[126:127], v246 offset:43008
  buffer_load_dwordx4 v[188:191], v16, s[16:19], s45 offen offset:0 sc1
  v_mfma_f32_16x16x32_bf16 v[76:79], v[148:151], v[208:211], v[76:79]
  ds_read_b64_tr_b16 v[128:129], v247 offset:36864
  v_mfma_f32_16x16x32_bf16 v[32:35], v[152:155], v[204:207], v[32:35]
  ds_read_b64_tr_b16 v[130:131], v247 offset:43008
  v_mfma_f32_16x16x32_bf16 v[80:83], v[152:155], v[208:211], v[80:83]
  ds_read_b64_tr_b16 v[132:133], v244 offset:36992
  v_mfma_f32_16x16x32_bf16 v[36:39], v[156:159], v[204:207], v[36:39]
  ds_read_b64_tr_b16 v[134:135], v244 offset:43136
  buffer_load_dwordx4 v[192:195], v17, s[16:19], s45 offen offset:0 sc1
  v_mfma_f32_16x16x32_bf16 v[84:87], v[156:159], v[208:211], v[84:87]
  ds_read_b64_tr_b16 v[136:137], v245 offset:36992
  v_mfma_f32_16x16x32_bf16 v[40:43], v[160:163], v[204:207], v[40:43]
  ds_read_b64_tr_b16 v[138:139], v245 offset:43136
  v_mfma_f32_16x16x32_bf16 v[88:91], v[160:163], v[208:211], v[88:91]
  ds_read_b64_tr_b16 v[140:141], v246 offset:36992
  ds_read_b64_tr_b16 v[142:143], v246 offset:43136
  s_waitcnt lgkmcnt(14)
  v_mfma_f32_16x16x32_bf16 v[44:47], v[164:167], v[204:207], v[44:47]
  ds_read_b64_tr_b16 v[144:145], v247 offset:36992
  buffer_load_dwordx4 v[196:199], v16, s[16:19], s45 offen offset:2048 sc1
  v_mfma_f32_16x16x32_bf16 v[92:95], v[164:167], v[208:211], v[92:95]
  ds_read_b64_tr_b16 v[146:147], v247 offset:43136
  v_mfma_f32_16x16x32_bf16 v[48:51], v[168:171], v[204:207], v[48:51]
  ds_read_b64_tr_b16 v[148:149], v244 offset:37120
  v_mfma_f32_16x16x32_bf16 v[96:99], v[168:171], v[208:211], v[96:99]
  ds_read_b64_tr_b16 v[150:151], v244 offset:43264
  v_mfma_f32_16x16x32_bf16 v[52:55], v[172:175], v[204:207], v[52:55]
  ds_read_b64_tr_b16 v[152:153], v245 offset:37120
  buffer_load_dwordx4 v[200:203], v17, s[16:19], s45 offen offset:2048 sc1
  s_add_u32 s45, s45, 4096
  v_mfma_f32_16x16x32_bf16 v[100:103], v[172:175], v[208:211], v[100:103]
  ds_read_b64_tr_b16 v[154:155], v245 offset:43264
  v_mfma_f32_16x16x32_bf16 v[56:59], v[176:179], v[204:207], v[56:59]
  ds_read_b64_tr_b16 v[156:157], v246 offset:37120
  v_mfma_f32_16x16x32_bf16 v[104:107], v[176:179], v[208:211], v[104:107]
  ds_read_b64_tr_b16 v[158:159], v246 offset:43264
  v_mfma_f32_16x16x32_bf16 v[60:63], v[180:183], v[204:207], v[60:63]
  ds_read_b64_tr_b16 v[160:161], v247 offset:37120
  v_mfma_f32_16x16x32_bf16 v[108:111], v[180:183], v[208:211], v[108:111]
  ds_read_b64_tr_b16 v[162:163], v247 offset:43264
  v_mfma_f32_16x16x32_bf16 v[64:67], v[184:187], v[204:207], v[64:67]
  v_mfma_f32_16x16x32_bf16 v[112:115], v[184:187], v[208:211], v[112:115]
  s_waitcnt vmcnt(10)
  s_waitcnt lgkmcnt(0)
  s_barrier
  s_waitcnt lgkmcnt(12)
  s_add_u32 m0, s46, 24576
  v_mfma_f32_16x16x32_bf16 v[20:23], v[116:119], v[212:215], v[20:23]
  ds_read_b64_tr_b16 v[164:165], v248 offset:0
  ds_read_b64_tr_b16 v[166:167], v248 offset:6144
  buffer_load_dwordx4 v2, s[12:15], s44 offen lds
  v_mfma_f32_16x16x32_bf16 v[68:71], v[116:119], v[216:219], v[68:71]
  ds_read_b64_tr_b16 v[168:169], v249 offset:0
  v_mfma_f32_16x16x32_bf16 v[24:27], v[120:123], v[212:215], v[24:27]
  ds_read_b64_tr_b16 v[170:171], v249 offset:6144
  v_mfma_f32_16x16x32_bf16 v[72:75], v[120:123], v[216:219], v[72:75]
  ds_read_b64_tr_b16 v[172:173], v250 offset:0
  s_add_u32 m0, s46, 25600
  v_mfma_f32_16x16x32_bf16 v[28:31], v[124:127], v[212:215], v[28:31]
  ds_read_b64_tr_b16 v[174:175], v250 offset:6144
  buffer_load_dwordx4 v3, s[12:15], s44 offen lds
  v_mfma_f32_16x16x32_bf16 v[76:79], v[124:127], v[216:219], v[76:79]
  ds_read_b64_tr_b16 v[176:177], v251 offset:0
  v_mfma_f32_16x16x32_bf16 v[32:35], v[128:131], v[212:215], v[32:35]
  ds_read_b64_tr_b16 v[178:179], v251 offset:6144
  v_mfma_f32_16x16x32_bf16 v[80:83], v[128:131], v[216:219], v[80:83]
  ds_read_b64_tr_b16 v[180:181], v248 offset:128
  s_add_u32 m0, s46, 26624
  v_mfma_f32_16x16x32_bf16 v[36:39], v[132:135], v[212:215], v[36:39]
  ds_read_b64_tr_b16 v[182:183], v248 offset:6272
  buffer_load_dwordx4 v4, s[12:15], s44 offen lds
  v_mfma_f32_16x16x32_bf16 v[84:87], v[132:135], v[216:219], v[84:87]
  ds_read_b64_tr_b16 v[184:185], v249 offset:128
  v_mfma_f32_16x16x32_bf16 v[40:43], v[136:139], v[212:215], v[40:43]
  ds_read_b64_tr_b16 v[186:187], v249 offset:6272
  v_mfma_f32_16x16x32_bf16 v[88:91], v[136:139], v[216:219], v[88:91]
  ds_read_b64_tr_b16 v[116:117], v250 offset:128
  ds_read_b64_tr_b16 v[118:119], v250 offset:6272
  s_waitcnt lgkmcnt(14)
  s_add_u32 m0, s46, 27648
  v_mfma_f32_16x16x32_bf16 v[44:47], v[140:143], v[212:215], v[44:47]
  ds_read_b64_tr_b16 v[120:121], v251 offset:128
  buffer_load_dwordx4 v5, s[12:15], s44 offen lds
  v_mfma_f32_16x16x32_bf16 v[92:95], v[140:143], v[216:219], v[92:95]
  ds_read_b64_tr_b16 v[122:123], v251 offset:6272
  v_mfma_f32_16x16x32_bf16 v[48:51], v[144:147], v[212:215], v[48:51]
  ds_read_b64_tr_b16 v[124:125], v248 offset:256
  v_mfma_f32_16x16x32_bf16 v[96:99], v[144:147], v[216:219], v[96:99]
  ds_read_b64_tr_b16 v[126:127], v248 offset:6400
  s_add_u32 m0, s46, 28672
  v_mfma_f32_16x16x32_bf16 v[52:55], v[148:151], v[212:215], v[52:55]
  ds_read_b64_tr_b16 v[128:129], v249 offset:256
  buffer_load_dwordx4 v6, s[12:15], s44 offen lds
  v_mfma_f32_16x16x32_bf16 v[100:103], v[148:151], v[216:219], v[100:103]
  ds_read_b64_tr_b16 v[130:131], v249 offset:6400
  v_mfma_f32_16x16x32_bf16 v[56:59], v[152:155], v[212:215], v[56:59]
  ds_read_b64_tr_b16 v[132:133], v250 offset:256
  v_mfma_f32_16x16x32_bf16 v[104:107], v[152:155], v[216:219], v[104:107]
  ds_read_b64_tr_b16 v[134:135], v250 offset:6400
  v_mfma_f32_16x16x32_bf16 v[60:63], v[156:159], v[212:215], v[60:63]
  ds_read_b64_tr_b16 v[136:137], v251 offset:256
  v_mfma_f32_16x16x32_bf16 v[108:111], v[156:159], v[216:219], v[108:111]
  ds_read_b64_tr_b16 v[138:139], v251 offset:6400
  v_mfma_f32_16x16x32_bf16 v[64:67], v[160:163], v[212:215], v[64:67]
  v_mfma_f32_16x16x32_bf16 v[112:115], v[160:163], v[216:219], v[112:115]
  s_waitcnt lgkmcnt(12)
  s_add_u32 m0, s46, 29696
  v_mfma_f32_16x16x32_bf16 v[20:23], v[164:167], v[220:223], v[20:23]
  ds_read_b64_tr_b16 v[140:141], v248 offset:12288
  ds_read_b64_tr_b16 v[142:143], v248 offset:18432
  buffer_load_dwordx4 v7, s[12:15], s44 offen lds
  s_add_u32 s44, s44, 73728
  v_mfma_f32_16x16x32_bf16 v[68:71], v[164:167], v[224:227], v[68:71]
  ds_read_b64_tr_b16 v[144:145], v249 offset:12288
  v_mfma_f32_16x16x32_bf16 v[24:27], v[168:171], v[220:223], v[24:27]
  ds_read_b64_tr_b16 v[146:147], v249 offset:18432
  v_mfma_f32_16x16x32_bf16 v[72:75], v[168:171], v[224:227], v[72:75]
  ds_read_b64_tr_b16 v[148:149], v250 offset:12288
  v_mfma_f32_16x16x32_bf16 v[28:31], v[172:175], v[220:223], v[28:31]
  ds_read_b64_tr_b16 v[150:151], v250 offset:18432
  buffer_load_dwordx4 v[204:207], v16, s[16:19], s45 offen offset:0 sc1
  v_mfma_f32_16x16x32_bf16 v[76:79], v[172:175], v[224:227], v[76:79]
  ds_read_b64_tr_b16 v[152:153], v251 offset:12288
  v_mfma_f32_16x16x32_bf16 v[32:35], v[176:179], v[220:223], v[32:35]
  ds_read_b64_tr_b16 v[154:155], v251 offset:18432
  v_mfma_f32_16x16x32_bf16 v[80:83], v[176:179], v[224:227], v[80:83]
  ds_read_b64_tr_b16 v[156:157], v248 offset:12416
  v_mfma_f32_16x16x32_bf16 v[36:39], v[180:183], v[220:223], v[36:39]
  ds_read_b64_tr_b16 v[158:159], v248 offset:18560
  buffer_load_dwordx4 v[208:211], v17, s[16:19], s45 offen offset:0 sc1
  v_mfma_f32_16x16x32_bf16 v[84:87], v[180:183], v[224:227], v[84:87]
  ds_read_b64_tr_b16 v[160:161], v249 offset:12416
  v_mfma_f32_16x16x32_bf16 v[40:43], v[184:187], v[220:223], v[40:43]
  ds_read_b64_tr_b16 v[162:163], v249 offset:18560
  v_mfma_f32_16x16x32_bf16 v[88:91], v[184:187], v[224:227], v[88:91]
  ds_read_b64_tr_b16 v[164:165], v250 offset:12416
  ds_read_b64_tr_b16 v[166:167], v250 offset:18560
  s_waitcnt lgkmcnt(14)
  v_mfma_f32_16x16x32_bf16 v[44:47], v[116:119], v[220:223], v[44:47]
  ds_read_b64_tr_b16 v[168:169], v251 offset:12416
  buffer_load_dwordx4 v[212:215], v16, s[16:19], s45 offen offset:2048 sc1
  v_mfma_f32_16x16x32_bf16 v[92:95], v[116:119], v[224:227], v[92:95]
  ds_read_b64_tr_b16 v[170:171], v251 offset:18560
  v_mfma_f32_16x16x32_bf16 v[48:51], v[120:123], v[220:223], v[48:51]
  ds_read_b64_tr_b16 v[172:173], v248 offset:12544
  v_mfma_f32_16x16x32_bf16 v[96:99], v[120:123], v[224:227], v[96:99]
  ds_read_b64_tr_b16 v[174:175], v248 offset:18688
  v_mfma_f32_16x16x32_bf16 v[52:55], v[124:127], v[220:223], v[52:55]
  ds_read_b64_tr_b16 v[176:177], v249 offset:12544
  buffer_load_dwordx4 v[216:219], v17, s[16:19], s45 offen offset:2048 sc1
  s_add_u32 s45, s45, 4096
  v_mfma_f32_16x16x32_bf16 v[100:103], v[124:127], v[224:227], v[100:103]
  ds_read_b64_tr_b16 v[178:179], v249 offset:18688
  v_mfma_f32_16x16x32_bf16 v[56:59], v[128:131], v[220:223], v[56:59]
  ds_read_b64_tr_b16 v[180:181], v250 offset:12544
  v_mfma_f32_16x16x32_bf16 v[104:107], v[128:131], v[224:227], v[104:107]
  ds_read_b64_tr_b16 v[182:183], v250 offset:18688
  v_mfma_f32_16x16x32_bf16 v[60:63], v[132:135], v[220:223], v[60:63]
  ds_read_b64_tr_b16 v[184:185], v251 offset:12544
  v_mfma_f32_16x16x32_bf16 v[108:111], v[132:135], v[224:227], v[108:111]
  ds_read_b64_tr_b16 v[186:187], v251 offset:18688
  v_mfma_f32_16x16x32_bf16 v[64:67], v[136:139], v[220:223], v[64:67]
  v_mfma_f32_16x16x32_bf16 v[112:115], v[136:139], v[224:227], v[112:115]
  s_waitcnt vmcnt(10)
  s_waitcnt lgkmcnt(0)
  s_barrier
  s_waitcnt lgkmcnt(12)
  s_add_u32 m0, s46, 49152
  v_mfma_f32_16x16x32_bf16 v[20:23], v[140:143], v[228:231], v[20:23]
  ds_read_b64_tr_b16 v[116:117], v244 offset:0
  ds_read_b64_tr_b16 v[118:119], v244 offset:6144
  buffer_load_dwordx4 v2, s[12:15], s44 offen lds
  v_mfma_f32_16x16x32_bf16 v[68:71], v[140:143], v[232:235], v[68:71]
  ds_read_b64_tr_b16 v[120:121], v245 offset:0
  v_mfma_f32_16x16x32_bf16 v[24:27], v[144:147], v[228:231], v[24:27]
  ds_read_b64_tr_b16 v[122:123], v245 offset:6144
  v_mfma_f32_16x16x32_bf16 v[72:75], v[144:147], v[232:235], v[72:75]
  ds_read_b64_tr_b16 v[124:125], v246 offset:0
  s_add_u32 m0, s46, 50176
  v_mfma_f32_16x16x32_bf16 v[28:31], v[148:151], v[228:231], v[28:31]
  ds_read_b64_tr_b16 v[126:127], v246 offset:6144
  buffer_load_dwordx4 v3, s[12:15], s44 offen lds
  v_mfma_f32_16x16x32_bf16 v[76:79], v[148:151], v[232:235], v[76:79]
  ds_read_b64_tr_b16 v[128:129], v247 offset:0
  v_mfma_f32_16x16x32_bf16 v[32:35], v[152:155], v[228:231], v[32:35]
  ds_read_b64_tr_b16 v[130:131], v247 offset:6144
  v_mfma_f32_16x16x32_bf16 v[80:83], v[152:155], v[232:235], v[80:83]
  ds_read_b64_tr_b16 v[132:133], v244 offset:128
  s_add_u32 m0, s46, 51200
  v_mfma_f32_16x16x32_bf16 v[36:39], v[156:159], v[228:231], v[36:39]
  ds_read_b64_tr_b16 v[134:135], v244 offset:6272
  buffer_load_dwordx4 v4, s[12:15], s44 offen lds
  v_mfma_f32_16x16x32_bf16 v[84:87], v[156:159], v[232:235], v[84:87]
  ds_read_b64_tr_b16 v[136:137], v245 offset:128
  v_mfma_f32_16x16x32_bf16 v[40:43], v[160:163], v[228:231], v[40:43]
  ds_read_b64_tr_b16 v[138:139], v245 offset:6272
  v_mfma_f32_16x16x32_bf16 v[88:91], v[160:163], v[232:235], v[88:91]
  ds_read_b64_tr_b16 v[140:141], v246 offset:128
  ds_read_b64_tr_b16 v[142:143], v246 offset:6272
  s_waitcnt lgkmcnt(14)
  s_add_u32 m0, s46, 52224
  v_mfma_f32_16x16x32_bf16 v[44:47], v[164:167], v[228:231], v[44:47]
  ds_read_b64_tr_b16 v[144:145], v247 offset:128
  buffer_load_dwordx4 v5, s[12:15], s44 offen lds
  v_mfma_f32_16x16x32_bf16 v[92:95], v[164:167], v[232:235], v[92:95]
  ds_read_b64_tr_b16 v[146:147], v247 offset:6272
  v_mfma_f32_16x16x32_bf16 v[48:51], v[168:171], v[228:231], v[48:51]
  ds_read_b64_tr_b16 v[148:149], v244 offset:256
  v_mfma_f32_16x16x32_bf16 v[96:99], v[168:171], v[232:235], v[96:99]
  ds_read_b64_tr_b16 v[150:151], v244 offset:6400
  s_add_u32 m0, s46, 53248
  v_mfma_f32_16x16x32_bf16 v[52:55], v[172:175], v[228:231], v[52:55]
  ds_read_b64_tr_b16 v[152:153], v245 offset:256
  buffer_load_dwordx4 v6, s[12:15], s44 offen lds
  v_mfma_f32_16x16x32_bf16 v[100:103], v[172:175], v[232:235], v[100:103]
  ds_read_b64_tr_b16 v[154:155], v245 offset:6400
  v_mfma_f32_16x16x32_bf16 v[56:59], v[176:179], v[228:231], v[56:59]
  ds_read_b64_tr_b16 v[156:157], v246 offset:256
  v_mfma_f32_16x16x32_bf16 v[104:107], v[176:179], v[232:235], v[104:107]
  ds_read_b64_tr_b16 v[158:159], v246 offset:6400
  v_mfma_f32_16x16x32_bf16 v[60:63], v[180:183], v[228:231], v[60:63]
  ds_read_b64_tr_b16 v[160:161], v247 offset:256
  v_mfma_f32_16x16x32_bf16 v[108:111], v[180:183], v[232:235], v[108:111]
  ds_read_b64_tr_b16 v[162:163], v247 offset:6400
  v_mfma_f32_16x16x32_bf16 v[64:67], v[184:187], v[228:231], v[64:67]
  v_mfma_f32_16x16x32_bf16 v[112:115], v[184:187], v[232:235], v[112:115]
  s_waitcnt lgkmcnt(12)
  s_add_u32 m0, s46, 54272
  v_mfma_f32_16x16x32_bf16 v[20:23], v[116:119], v[188:191], v[20:23]
  ds_read_b64_tr_b16 v[164:165], v244 offset:12288
  ds_read_b64_tr_b16 v[166:167], v244 offset:18432
  buffer_load_dwordx4 v7, s[12:15], s44 offen lds
  s_add_u32 s44, s44, 73728
  v_mfma_f32_16x16x32_bf16 v[68:71], v[116:119], v[192:195], v[68:71]
  ds_read_b64_tr_b16 v[168:169], v245 offset:12288
  v_mfma_f32_16x16x32_bf16 v[24:27], v[120:123], v[188:191], v[24:27]
  ds_read_b64_tr_b16 v[170:171], v245 offset:18432
  v_mfma_f32_16x16x32_bf16 v[72:75], v[120:123], v[192:195], v[72:75]
  ds_read_b64_tr_b16 v[172:173], v246 offset:12288
  v_mfma_f32_16x16x32_bf16 v[28:31], v[124:127], v[188:191], v[28:31]
  ds_read_b64_tr_b16 v[174:175], v246 offset:18432
  buffer_load_dwordx4 v[220:223], v16, s[16:19], s45 offen offset:0 sc1
  v_mfma_f32_16x16x32_bf16 v[76:79], v[124:127], v[192:195], v[76:79]
  ds_read_b64_tr_b16 v[176:177], v247 offset:12288
  v_mfma_f32_16x16x32_bf16 v[32:35], v[128:131], v[188:191], v[32:35]
  ds_read_b64_tr_b16 v[178:179], v247 offset:18432
  v_mfma_f32_16x16x32_bf16 v[80:83], v[128:131], v[192:195], v[80:83]
  ds_read_b64_tr_b16 v[180:181], v244 offset:12416
  v_mfma_f32_16x16x32_bf16 v[36:39], v[132:135], v[188:191], v[36:39]
  ds_read_b64_tr_b16 v[182:183], v244 offset:18560
  buffer_load_dwordx4 v[224:227], v17, s[16:19], s45 offen offset:0 sc1
  v_mfma_f32_16x16x32_bf16 v[84:87], v[132:135], v[192:195], v[84:87]
  ds_read_b64_tr_b16 v[184:185], v245 offset:12416
  v_mfma_f32_16x16x32_bf16 v[40:43], v[136:139], v[188:191], v[40:43]
  ds_read_b64_tr_b16 v[186:187], v245 offset:18560
  v_mfma_f32_16x16x32_bf16 v[88:91], v[136:139], v[192:195], v[88:91]
  ds_read_b64_tr_b16 v[116:117], v246 offset:12416
  ds_read_b64_tr_b16 v[118:119], v246 offset:18560
  s_waitcnt lgkmcnt(14)
  v_mfma_f32_16x16x32_bf16 v[44:47], v[140:143], v[188:191], v[44:47]
  ds_read_b64_tr_b16 v[120:121], v247 offset:12416
  buffer_load_dwordx4 v[228:231], v16, s[16:19], s45 offen offset:2048 sc1
  v_mfma_f32_16x16x32_bf16 v[92:95], v[140:143], v[192:195], v[92:95]
  ds_read_b64_tr_b16 v[122:123], v247 offset:18560
  v_mfma_f32_16x16x32_bf16 v[48:51], v[144:147], v[188:191], v[48:51]
  ds_read_b64_tr_b16 v[124:125], v244 offset:12544
  v_mfma_f32_16x16x32_bf16 v[96:99], v[144:147], v[192:195], v[96:99]
  ds_read_b64_tr_b16 v[126:127], v244 offset:18688
  v_mfma_f32_16x16x32_bf16 v[52:55], v[148:151], v[188:191], v[52:55]
  ds_read_b64_tr_b16 v[128:129], v245 offset:12544
  buffer_load_dwordx4 v[232:235], v17, s[16:19], s45 offen offset:2048 sc1
  s_add_u32 s45, s45, 4096
  v_mfma_f32_16x16x32_bf16 v[100:103], v[148:151], v[192:195], v[100:103]
  ds_read_b64_tr_b16 v[130:131], v245 offset:18688
  v_mfma_f32_16x16x32_bf16 v[56:59], v[152:155], v[188:191], v[56:59]
  ds_read_b64_tr_b16 v[132:133], v246 offset:12544
  v_mfma_f32_16x16x32_bf16 v[104:107], v[152:155], v[192:195], v[104:107]
  ds_read_b64_tr_b16 v[134:135], v246 offset:18688
  v_mfma_f32_16x16x32_bf16 v[60:63], v[156:159], v[188:191], v[60:63]
  ds_read_b64_tr_b16 v[136:137], v247 offset:12544
  v_mfma_f32_16x16x32_bf16 v[108:111], v[156:159], v[192:195], v[108:111]
  ds_read_b64_tr_b16 v[138:139], v247 offset:18688
  v_mfma_f32_16x16x32_bf16 v[64:67], v[160:163], v[188:191], v[64:67]
  v_mfma_f32_16x16x32_bf16 v[112:115], v[160:163], v[192:195], v[112:115]
  s_waitcnt vmcnt(10)
  s_waitcnt lgkmcnt(0)
  s_barrier
  s_waitcnt lgkmcnt(12)
  s_add_u32 m0, s46, 0
  v_mfma_f32_16x16x32_bf16 v[20:23], v[164:167], v[196:199], v[20:23]
  ds_read_b64_tr_b16 v[140:141], v244 offset:24576
  ds_read_b64_tr_b16 v[142:143], v244 offset:30720
  buffer_load_dwordx4 v2, s[12:15], s44 offen lds
  v_mfma_f32_16x16x32_bf16 v[68:71], v[164:167], v[200:203], v[68:71]
  ds_read_b64_tr_b16 v[144:145], v245 offset:24576
  v_mfma_f32_16x16x32_bf16 v[24:27], v[168:171], v[196:199], v[24:27]
  ds_read_b64_tr_b16 v[146:147], v245 offset:30720
  v_mfma_f32_16x16x32_bf16 v[72:75], v[168:171], v[200:203], v[72:75]
  ds_read_b64_tr_b16 v[148:149], v246 offset:24576
  s_add_u32 m0, s46, 1024
  v_mfma_f32_16x16x32_bf16 v[28:31], v[172:175], v[196:199], v[28:31]
  ds_read_b64_tr_b16 v[150:151], v246 offset:30720
  buffer_load_dwordx4 v3, s[12:15], s44 offen lds
  v_mfma_f32_16x16x32_bf16 v[76:79], v[172:175], v[200:203], v[76:79]
  ds_read_b64_tr_b16 v[152:153], v247 offset:24576
  v_mfma_f32_16x16x32_bf16 v[32:35], v[176:179], v[196:199], v[32:35]
  ds_read_b64_tr_b16 v[154:155], v247 offset:30720
  v_mfma_f32_16x16x32_bf16 v[80:83], v[176:179], v[200:203], v[80:83]
  ds_read_b64_tr_b16 v[156:157], v244 offset:24704
  s_add_u32 m0, s46, 2048
  v_mfma_f32_16x16x32_bf16 v[36:39], v[180:183], v[196:199], v[36:39]
  ds_read_b64_tr_b16 v[158:159], v244 offset:30848
  buffer_load_dwordx4 v4, s[12:15], s44 offen lds
  v_mfma_f32_16x16x32_bf16 v[84:87], v[180:183], v[200:203], v[84:87]
  ds_read_b64_tr_b16 v[160:161], v245 offset:24704
  v_mfma_f32_16x16x32_bf16 v[40:43], v[184:187], v[196:199], v[40:43]
  ds_read_b64_tr_b16 v[162:163], v245 offset:30848
  v_mfma_f32_16x16x32_bf16 v[88:91], v[184:187], v[200:203], v[88:91]
  ds_read_b64_tr_b16 v[164:165], v246 offset:24704
  ds_read_b64_tr_b16 v[166:167], v246 offset:30848
  s_waitcnt lgkmcnt(14)
  s_add_u32 m0, s46, 3072
  v_mfma_f32_16x16x32_bf16 v[44:47], v[116:119], v[196:199], v[44:47]
  ds_read_b64_tr_b16 v[168:169], v247 offset:24704
  buffer_load_dwordx4 v5, s[12:15], s44 offen lds
  v_mfma_f32_16x16x32_bf16 v[92:95], v[116:119], v[200:203], v[92:95]
  ds_read_b64_tr_b16 v[170:171], v247 offset:30848
  v_mfma_f32_16x16x32_bf16 v[48:51], v[120:123], v[196:199], v[48:51]
  ds_read_b64_tr_b16 v[172:173], v244 offset:24832
  v_mfma_f32_16x16x32_bf16 v[96:99], v[120:123], v[200:203], v[96:99]
  ds_read_b64_tr_b16 v[174:175], v244 offset:30976
  s_add_u32 m0, s46, 4096
  v_mfma_f32_16x16x32_bf16 v[52:55], v[124:127], v[196:199], v[52:55]
  ds_read_b64_tr_b16 v[176:177], v245 offset:24832
  buffer_load_dwordx4 v6, s[12:15], s44 offen lds
  v_mfma_f32_16x16x32_bf16 v[100:103], v[124:127], v[200:203], v[100:103]
  ds_read_b64_tr_b16 v[178:179], v245 offset:30976
  v_mfma_f32_16x16x32_bf16 v[56:59], v[128:131], v[196:199], v[56:59]
  ds_read_b64_tr_b16 v[180:181], v246 offset:24832
  v_mfma_f32_16x16x32_bf16 v[104:107], v[128:131], v[200:203], v[104:107]
  ds_read_b64_tr_b16 v[182:183], v246 offset:30976
  v_mfma_f32_16x16x32_bf16 v[60:63], v[132:135], v[196:199], v[60:63]
  ds_read_b64_tr_b16 v[184:185], v247 offset:24832
  v_mfma_f32_16x16x32_bf16 v[108:111], v[132:135], v[200:203], v[108:111]
  ds_read_b64_tr_b16 v[186:187], v247 offset:30976
  v_mfma_f32_16x16x32_bf16 v[64:67], v[136:139], v[196:199], v[64:67]
  v_mfma_f32_16x16x32_bf16 v[112:115], v[136:139], v[200:203], v[112:115]
  s_waitcnt lgkmcnt(12)
  s_add_u32 m0, s46, 5120
  v_mfma_f32_16x16x32_bf16 v[20:23], v[140:143], v[204:207], v[20:23]
  ds_read_b64_tr_b16 v[116:117], v244 offset:36864
  ds_read_b64_tr_b16 v[118:119], v244 offset:43008
  buffer_load_dwordx4 v7, s[12:15], s44 offen lds
  s_add_u32 s44, s44, 73728
  v_mfma_f32_16x16x32_bf16 v[68:71], v[140:143], v[208:211], v[68:71]
  ds_read_b64_tr_b16 v[120:121], v245 offset:36864
  v_mfma_f32_16x16x32_bf16 v[24:27], v[144:147], v[204:207], v[24:27]
  ds_read_b64_tr_b16 v[122:123], v245 offset:43008
  v_mfma_f32_16x16x32_bf16 v[72:75], v[144:147], v[208:211], v[72:75]
  ds_read_b64_tr_b16 v[124:125], v246 offset:36864
  v_mfma_f32_16x16x32_bf16 v[28:31], v[148:151], v[204:207], v[28:31]
  ds_read_b64_tr_b16 v[126:127], v246 offset:43008
  buffer_load_dwordx4 v[188:191], v16, s[16:19], s45 offen offset:0 sc1
  v_mfma_f32_16x16x32_bf16 v[76:79], v[148:151], v[208:211], v[76:79]
  ds_read_b64_tr_b16 v[128:129], v247 offset:36864
  v_mfma_f32_16x16x32_bf16 v[32:35], v[152:155], v[204:207], v[32:35]
  ds_read_b64_tr_b16 v[130:131], v247 offset:43008
  v_mfma_f32_16x16x32_bf16 v[80:83], v[152:155], v[208:211], v[80:83]
  ds_read_b64_tr_b16 v[132:133], v244 offset:36992
  v_mfma_f32_16x16x32_bf16 v[36:39], v[156:159], v[204:207], v[36:39]
  ds_read_b64_tr_b16 v[134:135], v244 offset:43136
  buffer_load_dwordx4 v[192:195], v17, s[16:19], s45 offen offset:0 sc1
  v_mfma_f32_16x16x32_bf16 v[84:87], v[156:159], v[208:211], v[84:87]
  ds_read_b64_tr_b16 v[136:137], v245 offset:36992
  v_mfma_f32_16x16x32_bf16 v[40:43], v[160:163], v[204:207], v[40:43]
  ds_read_b64_tr_b16 v[138:139], v245 offset:43136
  v_mfma_f32_16x16x32_bf16 v[88:91], v[160:163], v[208:211], v[88:91]
  ds_read_b64_tr_b16 v[140:141], v246 offset:36992
  ds_read_b64_tr_b16 v[142:143], v246 offset:43136
  s_waitcnt lgkmcnt(14)
  v_mfma_f32_16x16x32_bf16 v[44:47], v[164:167], v[204:207], v[44:47]
  ds_read_b64_tr_b16 v[144:145], v247 offset:36992
  buffer_load_dwordx4 v[196:199], v16, s[16:19], s45 offen offset:2048 sc1
  v_mfma_f32_16x16x32_bf16 v[92:95], v[164:167], v[208:211], v[92:95]
  ds_read_b64_tr_b16 v[146:147], v247 offset:43136
  v_mfma_f32_16x16x32_bf16 v[48:51], v[168:171], v[204:207], v[48:51]
  ds_read_b64_tr_b16 v[148:149], v244 offset:37120
  v_mfma_f32_16x16x32_bf16 v[96:99], v[168:171], v[208:211], v[96:99]
  ds_read_b64_tr_b16 v[150:151], v244 offset:43264
  v_mfma_f32_16x16x32_bf16 v[52:55], v[172:175], v[204:207], v[52:55]
  ds_read_b64_tr_b16 v[152:153], v245 offset:37120
  buffer_load_dwordx4 v[200:203], v17, s[16:19], s45 offen offset:2048 sc1
  s_add_u32 s45, s45, 4096
  v_mfma_f32_16x16x32_bf16 v[100:103], v[172:175], v[208:211], v[100:103]
  ds_read_b64_tr_b16 v[154:155], v245 offset:43264
  v_mfma_f32_16x16x32_bf16 v[56:59], v[176:179], v[204:207], v[56:59]
  ds_read_b64_tr_b16 v[156:157], v246 offset:37120
  v_mfma_f32_16x16x32_bf16 v[104:107], v[176:179], v[208:211], v[104:107]
  ds_read_b64_tr_b16 v[158:159], v246 offset:43264
  v_mfma_f32_16x16x32_bf16 v[60:63], v[180:183], v[204:207], v[60:63]
  ds_read_b64_tr_b16 v[160:161], v247 offset:37120
  v_mfma_f32_16x16x32_bf16 v[108:111], v[180:183], v[208:211], v[108:111]
  ds_read_b64_tr_b16 v[162:163], v247 offset:43264
  v_mfma_f32_16x16x32_bf16 v[64:67], v[184:187], v[204:207], v[64:67]
  v_mfma_f32_16x16x32_bf16 v[112:115], v[184:187], v[208:211], v[112:115]
  s_waitcnt vmcnt(10)
  s_waitcnt lgkmcnt(0)
  s_barrier
  s_waitcnt lgkmcnt(12)
  s_add_u32 m0, s46, 24576
  v_mfma_f32_16x16x32_bf16 v[20:23], v[116:119], v[212:215], v[20:23]
  ds_read_b64_tr_b16 v[164:165], v248 offset:0
  ds_read_b64_tr_b16 v[166:167], v248 offset:6144
  buffer_load_dwordx4 v2, s[12:15], s44 offen lds
  v_mfma_f32_16x16x32_bf16 v[68:71], v[116:119], v[216:219], v[68:71]
  ds_read_b64_tr_b16 v[168:169], v249 offset:0
  v_mfma_f32_16x16x32_bf16 v[24:27], v[120:123], v[212:215], v[24:27]
  ds_read_b64_tr_b16 v[170:171], v249 offset:6144
  v_mfma_f32_16x16x32_bf16 v[72:75], v[120:123], v[216:219], v[72:75]
  ds_read_b64_tr_b16 v[172:173], v250 offset:0
  s_add_u32 m0, s46, 25600
  v_mfma_f32_16x16x32_bf16 v[28:31], v[124:127], v[212:215], v[28:31]
  ds_read_b64_tr_b16 v[174:175], v250 offset:6144
  buffer_load_dwordx4 v3, s[12:15], s44 offen lds
  v_mfma_f32_16x16x32_bf16 v[76:79], v[124:127], v[216:219], v[76:79]
  ds_read_b64_tr_b16 v[176:177], v251 offset:0
  v_mfma_f32_16x16x32_bf16 v[32:35], v[128:131], v[212:215], v[32:35]
  ds_read_b64_tr_b16 v[178:179], v251 offset:6144
  v_mfma_f32_16x16x32_bf16 v[80:83], v[128:131], v[216:219], v[80:83]
  ds_read_b64_tr_b16 v[180:181], v248 offset:128
  s_add_u32 m0, s46, 26624
  v_mfma_f32_16x16x32_bf16 v[36:39], v[132:135], v[212:215], v[36:39]
  ds_read_b64_tr_b16 v[182:183], v248 offset:6272
  buffer_load_dwordx4 v4, s[12:15], s44 offen lds
  v_mfma_f32_16x16x32_bf16 v[84:87], v[132:135], v[216:219], v[84:87]
  ds_read_b64_tr_b16 v[184:185], v249 offset:128
  v_mfma_f32_16x16x32_bf16 v[40:43], v[136:139], v[212:215], v[40:43]
  ds_read_b64_tr_b16 v[186:187], v249 offset:6272
  v_mfma_f32_16x16x32_bf16 v[88:91], v[136:139], v[216:219], v[88:91]
  ds_read_b64_tr_b16 v[116:117], v250 offset:128
  ds_read_b64_tr_b16 v[118:119], v250 offset:6272
  s_waitcnt lgkmcnt(14)
  s_add_u32 m0, s46, 27648
  v_mfma_f32_16x16x32_bf16 v[44:47], v[140:143], v[212:215], v[44:47]
  ds_read_b64_tr_b16 v[120:121], v251 offset:128
  buffer_load_dwordx4 v5, s[12:15], s44 offen lds
  v_mfma_f32_16x16x32_bf16 v[92:95], v[140:143], v[216:219], v[92:95]
  ds_read_b64_tr_b16 v[122:123], v251 offset:6272
  v_mfma_f32_16x16x32_bf16 v[48:51], v[144:147], v[212:215], v[48:51]
  ds_read_b64_tr_b16 v[124:125], v248 offset:256
  v_mfma_f32_16x16x32_bf16 v[96:99], v[144:147], v[216:219], v[96:99]
  ds_read_b64_tr_b16 v[126:127], v248 offset:6400
  s_add_u32 m0, s46, 28672
  v_mfma_f32_16x16x32_bf16 v[52:55], v[148:151], v[212:215], v[52:55]
  ds_read_b64_tr_b16 v[128:129], v249 offset:256
  buffer_load_dwordx4 v6, s[12:15], s44 offen lds
  v_mfma_f32_16x16x32_bf16 v[100:103], v[148:151], v[216:219], v[100:103]
  ds_read_b64_tr_b16 v[130:131], v249 offset:6400
  v_mfma_f32_16x16x32_bf16 v[56:59], v[152:155], v[212:215], v[56:59]
  ds_read_b64_tr_b16 v[132:133], v250 offset:256
  v_mfma_f32_16x16x32_bf16 v[104:107], v[152:155], v[216:219], v[104:107]
  ds_read_b64_tr_b16 v[134:135], v250 offset:6400
  v_mfma_f32_16x16x32_bf16 v[60:63], v[156:159], v[212:215], v[60:63]
  ds_read_b64_tr_b16 v[136:137], v251 offset:256
  v_mfma_f32_16x16x32_bf16 v[108:111], v[156:159], v[216:219], v[108:111]
  ds_read_b64_tr_b16 v[138:139], v251 offset:6400
  v_mfma_f32_16x16x32_bf16 v[64:67], v[160:163], v[212:215], v[64:67]
  v_mfma_f32_16x16x32_bf16 v[112:115], v[160:163], v[216:219], v[112:115]
  s_waitcnt lgkmcnt(12)
  s_add_u32 m0, s46, 29696
  v_mfma_f32_16x16x32_bf16 v[20:23], v[164:167], v[220:223], v[20:23]
  ds_read_b64_tr_b16 v[140:141], v248 offset:12288
  ds_read_b64_tr_b16 v[142:143], v248 offset:18432
  buffer_load_dwordx4 v7, s[12:15], s44 offen lds
  s_add_u32 s44, s44, 73728
  v_mfma_f32_16x16x32_bf16 v[68:71], v[164:167], v[224:227], v[68:71]
  ds_read_b64_tr_b16 v[144:145], v249 offset:12288
  v_mfma_f32_16x16x32_bf16 v[24:27], v[168:171], v[220:223], v[24:27]
  ds_read_b64_tr_b16 v[146:147], v249 offset:18432
  v_mfma_f32_16x16x32_bf16 v[72:75], v[168:171], v[224:227], v[72:75]
  ds_read_b64_tr_b16 v[148:149], v250 offset:12288
  v_mfma_f32_16x16x32_bf16 v[28:31], v[172:175], v[220:223], v[28:31]
  ds_read_b64_tr_b16 v[150:151], v250 offset:18432
  buffer_load_dwordx4 v[204:207], v16, s[16:19], s45 offen offset:0 sc1
  v_mfma_f32_16x16x32_bf16 v[76:79], v[172:175], v[224:227], v[76:79]
  ds_read_b64_tr_b16 v[152:153], v251 offset:12288
  v_mfma_f32_16x16x32_bf16 v[32:35], v[176:179], v[220:223], v[32:35]
  ds_read_b64_tr_b16 v[154:155], v251 offset:18432
  v_mfma_f32_16x16x32_bf16 v[80:83], v[176:179], v[224:227], v[80:83]
  ds_read_b64_tr_b16 v[156:157], v248 offset:12416
  v_mfma_f32_16x16x32_bf16 v[36:39], v[180:183], v[220:223], v[36:39]
  ds_read_b64_tr_b16 v[158:159], v248 offset:18560
  buffer_load_dwordx4 v[208:211], v17, s[16:19], s45 offen offset:0 sc1
  v_mfma_f32_16x16x32_bf16 v[84:87], v[180:183], v[224:227], v[84:87]
  ds_read_b64_tr_b16 v[160:161], v249 offset:12416
  v_mfma_f32_16x16x32_bf16 v[40:43], v[184:187], v[220:223], v[40:43]
  ds_read_b64_tr_b16 v[162:163], v249 offset:18560
  v_mfma_f32_16x16x32_bf16 v[88:91], v[184:187], v[224:227], v[88:91]
  ds_read_b64_tr_b16 v[164:165], v250 offset:12416
  ds_read_b64_tr_b16 v[166:167], v250 offset:18560
  s_waitcnt lgkmcnt(14)
  v_mfma_f32_16x16x32_bf16 v[44:47], v[116:119], v[220:223], v[44:47]
  ds_read_b64_tr_b16 v[168:169], v251 offset:12416
  buffer_load_dwordx4 v[212:215], v16, s[16:19], s45 offen offset:2048 sc1
  v_mfma_f32_16x16x32_bf16 v[92:95], v[116:119], v[224:227], v[92:95]
  ds_read_b64_tr_b16 v[170:171], v251 offset:18560
  v_mfma_f32_16x16x32_bf16 v[48:51], v[120:123], v[220:223], v[48:51]
  ds_read_b64_tr_b16 v[172:173], v248 offset:12544
  v_mfma_f32_16x16x32_bf16 v[96:99], v[120:123], v[224:227], v[96:99]
  ds_read_b64_tr_b16 v[174:175], v248 offset:18688
  v_mfma_f32_16x16x32_bf16 v[52:55], v[124:127], v[220:223], v[52:55]
  ds_read_b64_tr_b16 v[176:177], v249 offset:12544
  buffer_load_dwordx4 v[216:219], v17, s[16:19], s45 offen offset:2048 sc1
  s_add_u32 s45, s45, 4096
  v_mfma_f32_16x16x32_bf16 v[100:103], v[124:127], v[224:227], v[100:103]
  ds_read_b64_tr_b16 v[178:179], v249 offset:18688
  v_mfma_f32_16x16x32_bf16 v[56:59], v[128:131], v[220:223], v[56:59]
  ds_read_b64_tr_b16 v[180:181], v250 offset:12544
  v_mfma_f32_16x16x32_bf16 v[104:107], v[128:131], v[224:227], v[104:107]
  ds_read_b64_tr_b16 v[182:183], v250 offset:18688
  v_mfma_f32_16x16x32_bf16 v[60:63], v[132:135], v[220:223], v[60:63]
  ds_read_b64_tr_b16 v[184:185], v251 offset:12544
  v_mfma_f32_16x16x32_bf16 v[108:111], v[132:135], v[224:227], v[108:111]
  ds_read_b64_tr_b16 v[186:187], v251 offset:18688
  v_mfma_f32_16x16x32_bf16 v[64:67], v[136:139], v[220:223], v[64:67]
  v_mfma_f32_16x16x32_bf16 v[112:115], v[136:139], v[224:227], v[112:115]
  s_waitcnt vmcnt(10)
  s_waitcnt lgkmcnt(0)
  s_barrier
  s_waitcnt lgkmcnt(12)
  s_add_u32 m0, s46, 49152
  v_mfma_f32_16x16x32_bf16 v[20:23], v[140:143], v[228:231], v[20:23]
  ds_read_b64_tr_b16 v[116:117], v244 offset:0
  ds_read_b64_tr_b16 v[118:119], v244 offset:6144
  buffer_load_dwordx4 v2, s[12:15], s44 offen lds
  v_mfma_f32_16x16x32_bf16 v[68:71], v[140:143], v[232:235], v[68:71]
  ds_read_b64_tr_b16 v[120:121], v245 offset:0
  v_mfma_f32_16x16x32_bf16 v[24:27], v[144:147], v[228:231], v[24:27]
  ds_read_b64_tr_b16 v[122:123], v245 offset:6144
  v_mfma_f32_16x16x32_bf16 v[72:75], v[144:147], v[232:235], v[72:75]
  ds_read_b64_tr_b16 v[124:125], v246 offset:0
  s_add_u32 m0, s46, 50176
  v_mfma_f32_16x16x32_bf16 v[28:31], v[148:151], v[228:231], v[28:31]
  ds_read_b64_tr_b16 v[126:127], v246 offset:6144
  buffer_load_dwordx4 v3, s[12:15], s44 offen lds
  v_mfma_f32_16x16x32_bf16 v[76:79], v[148:151], v[232:235], v[76:79]
  ds_read_b64_tr_b16 v[128:129], v247 offset:0
  v_mfma_f32_16x16x32_bf16 v[32:35], v[152:155], v[228:231], v[32:35]
  ds_read_b64_tr_b16 v[130:131], v247 offset:6144
  v_mfma_f32_16x16x32_bf16 v[80:83], v[152:155], v[232:235], v[80:83]
  ds_read_b64_tr_b16 v[132:133], v244 offset:128
  s_add_u32 m0, s46, 51200
  v_mfma_f32_16x16x32_bf16 v[36:39], v[156:159], v[228:231], v[36:39]
  ds_read_b64_tr_b16 v[134:135], v244 offset:6272
  buffer_load_dwordx4 v4, s[12:15], s44 offen lds
  v_mfma_f32_16x16x32_bf16 v[84:87], v[156:159], v[232:235], v[84:87]
  ds_read_b64_tr_b16 v[136:137], v245 offset:128
  v_mfma_f32_16x16x32_bf16 v[40:43], v[160:163], v[228:231], v[40:43]
  ds_read_b64_tr_b16 v[138:139], v245 offset:6272
  v_mfma_f32_16x16x32_bf16 v[88:91], v[160:163], v[232:235], v[88:91]
  ds_read_b64_tr_b16 v[140:141], v246 offset:128
  ds_read_b64_tr_b16 v[142:143], v246 offset:6272
  s_waitcnt lgkmcnt(14)
  s_add_u32 m0, s46, 52224
  v_mfma_f32_16x16x32_bf16 v[44:47], v[164:167], v[228:231], v[44:47]
  ds_read_b64_tr_b16 v[144:145], v247 offset:128
  buffer_load_dwordx4 v5, s[12:15], s44 offen lds
  v_mfma_f32_16x16x32_bf16 v[92:95], v[164:167], v[232:235], v[92:95]
  ds_read_b64_tr_b16 v[146:147], v247 offset:6272
  v_mfma_f32_16x16x32_bf16 v[48:51], v[168:171], v[228:231], v[48:51]
  ds_read_b64_tr_b16 v[148:149], v244 offset:256
  v_mfma_f32_16x16x32_bf16 v[96:99], v[168:171], v[232:235], v[96:99]
  ds_read_b64_tr_b16 v[150:151], v244 offset:6400
  s_add_u32 m0, s46, 53248
  v_mfma_f32_16x16x32_bf16 v[52:55], v[172:175], v[228:231], v[52:55]
  ds_read_b64_tr_b16 v[152:153], v245 offset:256
  buffer_load_dwordx4 v6, s[12:15], s44 offen lds
  v_mfma_f32_16x16x32_bf16 v[100:103], v[172:175], v[232:235], v[100:103]
  ds_read_b64_tr_b16 v[154:155], v245 offset:6400
  v_mfma_f32_16x16x32_bf16 v[56:59], v[176:179], v[228:231], v[56:59]
  ds_read_b64_tr_b16 v[156:157], v246 offset:256
  v_mfma_f32_16x16x32_bf16 v[104:107], v[176:179], v[232:235], v[104:107]
  ds_read_b64_tr_b16 v[158:159], v246 offset:6400
  v_mfma_f32_16x16x32_bf16 v[60:63], v[180:183], v[228:231], v[60:63]
  ds_read_b64_tr_b16 v[160:161], v247 offset:256
  v_mfma_f32_16x16x32_bf16 v[108:111], v[180:183], v[232:235], v[108:111]
  ds_read_b64_tr_b16 v[162:163], v247 offset:6400
  v_mfma_f32_16x16x32_bf16 v[64:67], v[184:187], v[228:231], v[64:67]
  v_mfma_f32_16x16x32_bf16 v[112:115], v[184:187], v[232:235], v[112:115]
  s_waitcnt lgkmcnt(12)
  s_add_u32 m0, s46, 54272
  v_mfma_f32_16x16x32_bf16 v[20:23], v[116:119], v[188:191], v[20:23]
  ds_read_b64_tr_b16 v[164:165], v244 offset:12288
  ds_read_b64_tr_b16 v[166:167], v244 offset:18432
  buffer_load_dwordx4 v7, s[12:15], s44 offen lds
  s_add_u32 s44, s44, 73728
  v_mfma_f32_16x16x32_bf16 v[68:71], v[116:119], v[192:195], v[68:71]
  ds_read_b64_tr_b16 v[168:169], v245 offset:12288
  v_mfma_f32_16x16x32_bf16 v[24:27], v[120:123], v[188:191], v[24:27]
  ds_read_b64_tr_b16 v[170:171], v245 offset:18432
  v_mfma_f32_16x16x32_bf16 v[72:75], v[120:123], v[192:195], v[72:75]
  ds_read_b64_tr_b16 v[172:173], v246 offset:12288
  v_mfma_f32_16x16x32_bf16 v[28:31], v[124:127], v[188:191], v[28:31]
  ds_read_b64_tr_b16 v[174:175], v246 offset:18432
  buffer_load_dwordx4 v[220:223], v16, s[16:19], s45 offen offset:0 sc1
  v_mfma_f32_16x16x32_bf16 v[76:79], v[124:127], v[192:195], v[76:79]
  ds_read_b64_tr_b16 v[176:177], v247 offset:12288
  v_mfma_f32_16x16x32_bf16 v[32:35], v[128:131], v[188:191], v[32:35]
  ds_read_b64_tr_b16 v[178:179], v247 offset:18432
  v_mfma_f32_16x16x32_bf16 v[80:83], v[128:131], v[192:195], v[80:83]
  ds_read_b64_tr_b16 v[180:181], v244 offset:12416
  v_mfma_f32_16x16x32_bf16 v[36:39], v[132:135], v[188:191], v[36:39]
  ds_read_b64_tr_b16 v[182:183], v244 offset:18560
  buffer_load_dwordx4 v[224:227], v17, s[16:19], s45 offen offset:0 sc1
  v_mfma_f32_16x16x32_bf16 v[84:87], v[132:135], v[192:195], v[84:87]
  ds_read_b64_tr_b16 v[184:185], v245 offset:12416
  v_mfma_f32_16x16x32_bf16 v[40:43], v[136:139], v[188:191], v[40:43]
  ds_read_b64_tr_b16 v[186:187], v245 offset:18560
  v_mfma_f32_16x16x32_bf16 v[88:91], v[136:139], v[192:195], v[88:91]
  ds_read_b64_tr_b16 v[116:117], v246 offset:12416
  ds_read_b64_tr_b16 v[118:119], v246 offset:18560
  s_waitcnt lgkmcnt(14)
  v_mfma_f32_16x16x32_bf16 v[44:47], v[140:143], v[188:191], v[44:47]
  ds_read_b64_tr_b16 v[120:121], v247 offset:12416
  buffer_load_dwordx4 v[228:231], v16, s[16:19], s45 offen offset:2048 sc1
  v_mfma_f32_16x16x32_bf16 v[92:95], v[140:143], v[192:195], v[92:95]
  ds_read_b64_tr_b16 v[122:123], v247 offset:18560
  v_mfma_f32_16x16x32_bf16 v[48:51], v[144:147], v[188:191], v[48:51]
  ds_read_b64_tr_b16 v[124:125], v244 offset:12544
  v_mfma_f32_16x16x32_bf16 v[96:99], v[144:147], v[192:195], v[96:99]
  ds_read_b64_tr_b16 v[126:127], v244 offset:18688
  v_mfma_f32_16x16x32_bf16 v[52:55], v[148:151], v[188:191], v[52:55]
  ds_read_b64_tr_b16 v[128:129], v245 offset:12544
  buffer_load_dwordx4 v[232:235], v17, s[16:19], s45 offen offset:2048 sc1
  s_add_u32 s45, s45, 4096
  v_mfma_f32_16x16x32_bf16 v[100:103], v[148:151], v[192:195], v[100:103]
  ds_read_b64_tr_b16 v[130:131], v245 offset:18688
  v_mfma_f32_16x16x32_bf16 v[56:59], v[152:155], v[188:191], v[56:59]
  ds_read_b64_tr_b16 v[132:133], v246 offset:12544
  v_mfma_f32_16x16x32_bf16 v[104:107], v[152:155], v[192:195], v[104:107]
  ds_read_b64_tr_b16 v[134:135], v246 offset:18688
  v_mfma_f32_16x16x32_bf16 v[60:63], v[156:159], v[188:191], v[60:63]
  ds_read_b64_tr_b16 v[136:137], v247 offset:12544
  v_mfma_f32_16x16x32_bf16 v[108:111], v[156:159], v[192:195], v[108:111]
  ds_read_b64_tr_b16 v[138:139], v247 offset:18688
  v_mfma_f32_16x16x32_bf16 v[64:67], v[160:163], v[188:191], v[64:67]
  v_mfma_f32_16x16x32_bf16 v[112:115], v[160:163], v[192:195], v[112:115]
  s_waitcnt vmcnt(10)
  s_waitcnt lgkmcnt(0)
  s_barrier
  s_waitcnt lgkmcnt(12)
  v_mfma_f32_16x16x32_bf16 v[20:23], v[164:167], v[196:199], v[20:23]
  ds_read_b64_tr_b16 v[140:141], v244 offset:24576
  ds_read_b64_tr_b16 v[142:143], v244 offset:30720
  v_mfma_f32_16x16x32_bf16 v[68:71], v[164:167], v[200:203], v[68:71]
  ds_read_b64_tr_b16 v[144:145], v245 offset:24576
  v_mfma_f32_16x16x32_bf16 v[24:27], v[168:171], v[196:199], v[24:27]
  ds_read_b64_tr_b16 v[146:147], v245 offset:30720
  v_mfma_f32_16x16x32_bf16 v[72:75], v[168:171], v[200:203], v[72:75]
  ds_read_b64_tr_b16 v[148:149], v246 offset:24576
  v_mfma_f32_16x16x32_bf16 v[28:31], v[172:175], v[196:199], v[28:31]
  ds_read_b64_tr_b16 v[150:151], v246 offset:30720
  v_mfma_f32_16x16x32_bf16 v[76:79], v[172:175], v[200:203], v[76:79]
  ds_read_b64_tr_b16 v[152:153], v247 offset:24576
  v_mfma_f32_16x16x32_bf16 v[32:35], v[176:179], v[196:199], v[32:35]
  ds_read_b64_tr_b16 v[154:155], v247 offset:30720
  v_mfma_f32_16x16x32_bf16 v[80:83], v[176:179], v[200:203], v[80:83]
  ds_read_b64_tr_b16 v[156:157], v244 offset:24704
  v_mfma_f32_16x16x32_bf16 v[36:39], v[180:183], v[196:199], v[36:39]
  ds_read_b64_tr_b16 v[158:159], v244 offset:30848
  v_mfma_f32_16x16x32_bf16 v[84:87], v[180:183], v[200:203], v[84:87]
  ds_read_b64_tr_b16 v[160:161], v245 offset:24704
  v_mfma_f32_16x16x32_bf16 v[40:43], v[184:187], v[196:199], v[40:43]
  ds_read_b64_tr_b16 v[162:163], v245 offset:30848
  v_mfma_f32_16x16x32_bf16 v[88:91], v[184:187], v[200:203], v[88:91]
  ds_read_b64_tr_b16 v[164:165], v246 offset:24704
  ds_read_b64_tr_b16 v[166:167], v246 offset:30848
  s_waitcnt lgkmcnt(14)
  v_mfma_f32_16x16x32_bf16 v[44:47], v[116:119], v[196:199], v[44:47]
  ds_read_b64_tr_b16 v[168:169], v247 offset:24704
  v_mfma_f32_16x16x32_bf16 v[92:95], v[116:119], v[200:203], v[92:95]
  ds_read_b64_tr_b16 v[170:171], v247 offset:30848
  v_mfma_f32_16x16x32_bf16 v[48:51], v[120:123], v[196:199], v[48:51]
  ds_read_b64_tr_b16 v[172:173], v244 offset:24832
  v_mfma_f32_16x16x32_bf16 v[96:99], v[120:123], v[200:203], v[96:99]
  ds_read_b64_tr_b16 v[174:175], v244 offset:30976
  v_mfma_f32_16x16x32_bf16 v[52:55], v[124:127], v[196:199], v[52:55]
  ds_read_b64_tr_b16 v[176:177], v245 offset:24832
  v_mfma_f32_16x16x32_bf16 v[100:103], v[124:127], v[200:203], v[100:103]
  ds_read_b64_tr_b16 v[178:179], v245 offset:30976
  v_mfma_f32_16x16x32_bf16 v[56:59], v[128:131], v[196:199], v[56:59]
  ds_read_b64_tr_b16 v[180:181], v246 offset:24832
  v_mfma_f32_16x16x32_bf16 v[104:107], v[128:131], v[200:203], v[104:107]
  ds_read_b64_tr_b16 v[182:183], v246 offset:30976
  v_mfma_f32_16x16x32_bf16 v[60:63], v[132:135], v[196:199], v[60:63]
  ds_read_b64_tr_b16 v[184:185], v247 offset:24832
  v_mfma_f32_16x16x32_bf16 v[108:111], v[132:135], v[200:203], v[108:111]
  ds_read_b64_tr_b16 v[186:187], v247 offset:30976
  v_mfma_f32_16x16x32_bf16 v[64:67], v[136:139], v[196:199], v[64:67]
  v_mfma_f32_16x16x32_bf16 v[112:115], v[136:139], v[200:203], v[112:115]
  s_waitcnt lgkmcnt(12)
  v_mfma_f32_16x16x32_bf16 v[20:23], v[140:143], v[204:207], v[20:23]
  ds_read_b64_tr_b16 v[116:117], v244 offset:36864
  ds_read_b64_tr_b16 v[118:119], v244 offset:43008
  v_mfma_f32_16x16x32_bf16 v[68:71], v[140:143], v[208:211], v[68:71]
  ds_read_b64_tr_b16 v[120:121], v245 offset:36864
  v_mfma_f32_16x16x32_bf16 v[24:27], v[144:147], v[204:207], v[24:27]
  ds_read_b64_tr_b16 v[122:123], v245 offset:43008
  v_mfma_f32_16x16x32_bf16 v[72:75], v[144:147], v[208:211], v[72:75]
  ds_read_b64_tr_b16 v[124:125], v246 offset:36864
  v_mfma_f32_16x16x32_bf16 v[28:31], v[148:151], v[204:207], v[28:31]
  ds_read_b64_tr_b16 v[126:127], v246 offset:43008
  v_mfma_f32_16x16x32_bf16 v[76:79], v[148:151], v[208:211], v[76:79]
  ds_read_b64_tr_b16 v[128:129], v247 offset:36864
  v_mfma_f32_16x16x32_bf16 v[32:35], v[152:155], v[204:207], v[32:35]
  ds_read_b64_tr_b16 v[130:131], v247 offset:43008
  v_mfma_f32_16x16x32_bf16 v[80:83], v[152:155], v[208:211], v[80:83]
  ds_read_b64_tr_b16 v[132:133], v244 offset:36992
  v_mfma_f32_16x16x32_bf16 v[36:39], v[156:159], v[204:207], v[36:39]
  ds_read_b64_tr_b16 v[134:135], v244 offset:43136
  v_mfma_f32_16x16x32_bf16 v[84:87], v[156:159], v[208:211], v[84:87]
  ds_read_b64_tr_b16 v[136:137], v245 offset:36992
  v_mfma_f32_16x16x32_bf16 v[40:43], v[160:163], v[204:207], v[40:43]
  ds_read_b64_tr_b16 v[138:139], v245 offset:43136
  v_mfma_f32_16x16x32_bf16 v[88:91], v[160:163], v[208:211], v[88:91]
  ds_read_b64_tr_b16 v[140:141], v246 offset:36992
  ds_read_b64_tr_b16 v[142:143], v246 offset:43136
  s_waitcnt lgkmcnt(14)
  v_mfma_f32_16x16x32_bf16 v[44:47], v[164:167], v[204:207], v[44:47]
  ds_read_b64_tr_b16 v[144:145], v247 offset:36992
  v_mfma_f32_16x16x32_bf16 v[92:95], v[164:167], v[208:211], v[92:95]
  ds_read_b64_tr_b16 v[146:147], v247 offset:43136
  v_mfma_f32_16x16x32_bf16 v[48:51], v[168:171], v[204:207], v[48:51]
  ds_read_b64_tr_b16 v[148:149], v244 offset:37120
  v_mfma_f32_16x16x32_bf16 v[96:99], v[168:171], v[208:211], v[96:99]
  ds_read_b64_tr_b16 v[150:151], v244 offset:43264
  v_mfma_f32_16x16x32_bf16 v[52:55], v[172:175], v[204:207], v[52:55]
  ds_read_b64_tr_b16 v[152:153], v245 offset:37120
  v_mfma_f32_16x16x32_bf16 v[100:103], v[172:175], v[208:211], v[100:103]
  ds_read_b64_tr_b16 v[154:155], v245 offset:43264
  v_mfma_f32_16x16x32_bf16 v[56:59], v[176:179], v[204:207], v[56:59]
  ds_read_b64_tr_b16 v[156:157], v246 offset:37120
  v_mfma_f32_16x16x32_bf16 v[104:107], v[176:179], v[208:211], v[104:107]
  ds_read_b64_tr_b16 v[158:159], v246 offset:43264
  v_mfma_f32_16x16x32_bf16 v[60:63], v[180:183], v[204:207], v[60:63]
  ds_read_b64_tr_b16 v[160:161], v247 offset:37120
  v_mfma_f32_16x16x32_bf16 v[108:111], v[180:183], v[208:211], v[108:111]
  ds_read_b64_tr_b16 v[162:163], v247 offset:43264
  v_mfma_f32_16x16x32_bf16 v[64:67], v[184:187], v[204:207], v[64:67]
  v_mfma_f32_16x16x32_bf16 v[112:115], v[184:187], v[208:211], v[112:115]
  s_waitcnt vmcnt(0)
  s_waitcnt lgkmcnt(0)
  s_barrier
  s_waitcnt lgkmcnt(12)
  v_mfma_f32_16x16x32_bf16 v[20:23], v[116:119], v[212:215], v[20:23]
  ds_read_b64_tr_b16 v[164:165], v248 offset:0
  ds_read_b64_tr_b16 v[166:167], v248 offset:6144
  v_mfma_f32_16x16x32_bf16 v[68:71], v[116:119], v[216:219], v[68:71]
  ds_read_b64_tr_b16 v[168:169], v249 offset:0
  v_mfma_f32_16x16x32_bf16 v[24:27], v[120:123], v[212:215], v[24:27]
  ds_read_b64_tr_b16 v[170:171], v249 offset:6144
  v_mfma_f32_16x16x32_bf16 v[72:75], v[120:123], v[216:219], v[72:75]
  ds_read_b64_tr_b16 v[172:173], v250 offset:0
  v_mfma_f32_16x16x32_bf16 v[28:31], v[124:127], v[212:215], v[28:31]
  ds_read_b64_tr_b16 v[174:175], v250 offset:6144
  v_mfma_f32_16x16x32_bf16 v[76:79], v[124:127], v[216:219], v[76:79]
  ds_read_b64_tr_b16 v[176:177], v251 offset:0
  v_mfma_f32_16x16x32_bf16 v[32:35], v[128:131], v[212:215], v[32:35]
  ds_read_b64_tr_b16 v[178:179], v251 offset:6144
  v_mfma_f32_16x16x32_bf16 v[80:83], v[128:131], v[216:219], v[80:83]
  ds_read_b64_tr_b16 v[180:181], v248 offset:128
  v_mfma_f32_16x16x32_bf16 v[36:39], v[132:135], v[212:215], v[36:39]
  ds_read_b64_tr_b16 v[182:183], v248 offset:6272
  v_mfma_f32_16x16x32_bf16 v[84:87], v[132:135], v[216:219], v[84:87]
  ds_read_b64_tr_b16 v[184:185], v249 offset:128
  v_mfma_f32_16x16x32_bf16 v[40:43], v[136:139], v[212:215], v[40:43]
  ds_read_b64_tr_b16 v[186:187], v249 offset:6272
  v_mfma_f32_16x16x32_bf16 v[88:91], v[136:139], v[216:219], v[88:91]
  ds_read_b64_tr_b16 v[116:117], v250 offset:128
  ds_read_b64_tr_b16 v[118:119], v250 offset:6272
  s_waitcnt lgkmcnt(14)
  v_mfma_f32_16x16x32_bf16 v[44:47], v[140:143], v[212:215], v[44:47]
  ds_read_b64_tr_b16 v[120:121], v251 offset:128
  v_mfma_f32_16x16x32_bf16 v[92:95], v[140:143], v[216:219], v[92:95]
  ds_read_b64_tr_b16 v[122:123], v251 offset:6272
  v_mfma_f32_16x16x32_bf16 v[48:51], v[144:147], v[212:215], v[48:51]
  ds_read_b64_tr_b16 v[124:125], v248 offset:256
  v_mfma_f32_16x16x32_bf16 v[96:99], v[144:147], v[216:219], v[96:99]
  ds_read_b64_tr_b16 v[126:127], v248 offset:6400
  v_mfma_f32_16x16x32_bf16 v[52:55], v[148:151], v[212:215], v[52:55]
  ds_read_b64_tr_b16 v[128:129], v249 offset:256
  v_mfma_f32_16x16x32_bf16 v[100:103], v[148:151], v[216:219], v[100:103]
  ds_read_b64_tr_b16 v[130:131], v249 offset:6400
  v_mfma_f32_16x16x32_bf16 v[56:59], v[152:155], v[212:215], v[56:59]
  ds_read_b64_tr_b16 v[132:133], v250 offset:256
  v_mfma_f32_16x16x32_bf16 v[104:107], v[152:155], v[216:219], v[104:107]
  ds_read_b64_tr_b16 v[134:135], v250 offset:6400
  v_mfma_f32_16x16x32_bf16 v[60:63], v[156:159], v[212:215], v[60:63]
  ds_read_b64_tr_b16 v[136:137], v251 offset:256
  v_mfma_f32_16x16x32_bf16 v[108:111], v[156:159], v[216:219], v[108:111]
  ds_read_b64_tr_b16 v[138:139], v251 offset:6400
  v_mfma_f32_16x16x32_bf16 v[64:67], v[160:163], v[212:215], v[64:67]
  v_mfma_f32_16x16x32_bf16 v[112:115], v[160:163], v[216:219], v[112:115]
  s_waitcnt lgkmcnt(12)
  v_mfma_f32_16x16x32_bf16 v[20:23], v[164:167], v[220:223], v[20:23]
  ds_read_b64_tr_b16 v[140:141], v248 offset:12288
  ds_read_b64_tr_b16 v[142:143], v248 offset:18432
  v_mfma_f32_16x16x32_bf16 v[68:71], v[164:167], v[224:227], v[68:71]
  ds_read_b64_tr_b16 v[144:145], v249 offset:12288
  v_mfma_f32_16x16x32_bf16 v[24:27], v[168:171], v[220:223], v[24:27]
  ds_read_b64_tr_b16 v[146:147], v249 offset:18432
  v_mfma_f32_16x16x32_bf16 v[72:75], v[168:171], v[224:227], v[72:75]
  ds_read_b64_tr_b16 v[148:149], v250 offset:12288
  v_mfma_f32_16x16x32_bf16 v[28:31], v[172:175], v[220:223], v[28:31]
  ds_read_b64_tr_b16 v[150:151], v250 offset:18432
  v_mfma_f32_16x16x32_bf16 v[76:79], v[172:175], v[224:227], v[76:79]
  ds_read_b64_tr_b16 v[152:153], v251 offset:12288
  v_mfma_f32_16x16x32_bf16 v[32:35], v[176:179], v[220:223], v[32:35]
  ds_read_b64_tr_b16 v[154:155], v251 offset:18432
  v_mfma_f32_16x16x32_bf16 v[80:83], v[176:179], v[224:227], v[80:83]
  ds_read_b64_tr_b16 v[156:157], v248 offset:12416
  v_mfma_f32_16x16x32_bf16 v[36:39], v[180:183], v[220:223], v[36:39]
  ds_read_b64_tr_b16 v[158:159], v248 offset:18560
  v_mfma_f32_16x16x32_bf16 v[84:87], v[180:183], v[224:227], v[84:87]
  ds_read_b64_tr_b16 v[160:161], v249 offset:12416
  v_mfma_f32_16x16x32_bf16 v[40:43], v[184:187], v[220:223], v[40:43]
  ds_read_b64_tr_b16 v[162:163], v249 offset:18560
  v_mfma_f32_16x16x32_bf16 v[88:91], v[184:187], v[224:227], v[88:91]
  ds_read_b64_tr_b16 v[164:165], v250 offset:12416
  ds_read_b64_tr_b16 v[166:167], v250 offset:18560
  s_waitcnt lgkmcnt(14)
  v_mfma_f32_16x16x32_bf16 v[44:47], v[116:119], v[220:223], v[44:47]
  ds_read_b64_tr_b16 v[168:169], v251 offset:12416
  v_mfma_f32_16x16x32_bf16 v[92:95], v[116:119], v[224:227], v[92:95]
  ds_read_b64_tr_b16 v[170:171], v251 offset:18560
  v_mfma_f32_16x16x32_bf16 v[48:51], v[120:123], v[220:223], v[48:51]
  ds_read_b64_tr_b16 v[172:173], v248 offset:12544
  v_mfma_f32_16x16x32_bf16 v[96:99], v[120:123], v[224:227], v[96:99]
  ds_read_b64_tr_b16 v[174:175], v248 offset:18688
  v_mfma_f32_16x16x32_bf16 v[52:55], v[124:127], v[220:223], v[52:55]
  ds_read_b64_tr_b16 v[176:177], v249 offset:12544
  v_mfma_f32_16x16x32_bf16 v[100:103], v[124:127], v[224:227], v[100:103]
  ds_read_b64_tr_b16 v[178:179], v249 offset:18688
  v_mfma_f32_16x16x32_bf16 v[56:59], v[128:131], v[220:223], v[56:59]
  ds_read_b64_tr_b16 v[180:181], v250 offset:12544
  v_mfma_f32_16x16x32_bf16 v[104:107], v[128:131], v[224:227], v[104:107]
  ds_read_b64_tr_b16 v[182:183], v250 offset:18688
  v_mfma_f32_16x16x32_bf16 v[60:63], v[132:135], v[220:223], v[60:63]
  ds_read_b64_tr_b16 v[184:185], v251 offset:12544
  v_mfma_f32_16x16x32_bf16 v[108:111], v[132:135], v[224:227], v[108:111]
  ds_read_b64_tr_b16 v[186:187], v251 offset:18688
  v_mfma_f32_16x16x32_bf16 v[64:67], v[136:139], v[220:223], v[64:67]
  v_mfma_f32_16x16x32_bf16 v[112:115], v[136:139], v[224:227], v[112:115]
  s_waitcnt lgkmcnt(12)
  v_mfma_f32_16x16x32_bf16 v[20:23], v[140:143], v[228:231], v[20:23]
  v_mfma_f32_16x16x32_bf16 v[68:71], v[140:143], v[232:235], v[68:71]
  v_mfma_f32_16x16x32_bf16 v[24:27], v[144:147], v[228:231], v[24:27]
  v_mfma_f32_16x16x32_bf16 v[72:75], v[144:147], v[232:235], v[72:75]
  v_mfma_f32_16x16x32_bf16 v[28:31], v[148:151], v[228:231], v[28:31]
  v_mfma_f32_16x16x32_bf16 v[76:79], v[148:151], v[232:235], v[76:79]
  v_mfma_f32_16x16x32_bf16 v[32:35], v[152:155], v[228:231], v[32:35]
  v_mfma_f32_16x16x32_bf16 v[80:83], v[152:155], v[232:235], v[80:83]
  v_mfma_f32_16x16x32_bf16 v[36:39], v[156:159], v[228:231], v[36:39]
  v_mfma_f32_16x16x32_bf16 v[84:87], v[156:159], v[232:235], v[84:87]
  v_mfma_f32_16x16x32_bf16 v[40:43], v[160:163], v[228:231], v[40:43]
  v_mfma_f32_16x16x32_bf16 v[88:91], v[160:163], v[232:235], v[88:91]
  s_waitcnt lgkmcnt(0)
  v_mfma_f32_16x16x32_bf16 v[44:47], v[164:167], v[228:231], v[44:47]
  v_mfma_f32_16x16x32_bf16 v[92:95], v[164:167], v[232:235], v[92:95]
  v_mfma_f32_16x16x32_bf16 v[48:51], v[168:171], v[228:231], v[48:51]
  v_mfma_f32_16x16x32_bf16 v[96:99], v[168:171], v[232:235], v[96:99]
  v_mfma_f32_16x16x32_bf16 v[52:55], v[172:175], v[228:231], v[52:55]
  v_mfma_f32_16x16x32_bf16 v[100:103], v[172:175], v[232:235], v[100:103]
  v_mfma_f32_16x16x32_bf16 v[56:59], v[176:179], v[228:231], v[56:59]
  v_mfma_f32_16x16x32_bf16 v[104:107], v[176:179], v[232:235], v[104:107]
  v_mfma_f32_16x16x32_bf16 v[60:63], v[180:183], v[228:231], v[60:63]
  v_mfma_f32_16x16x32_bf16 v[108:111], v[180:183], v[232:235], v[108:111]
  v_mfma_f32_16x16x32_bf16 v[64:67], v[184:187], v[228:231], v[64:67]
  v_mfma_f32_16x16x32_bf16 v[112:115], v[184:187], v[232:235], v[112:115]
  s_mul_i32 s48, s34, 6
  s_add_u32 s48, s48, s31
  s_mul_i32 s48, s48, 3072
  s_nop 3
  s_add_u32 s40, s10, 27541504
  s_addc_u32 s41, s11, 0
  s_add_u32 s40, s40, s48
  s_addc_u32 s41, s41, 0
  s_mov_b32 s42, 3072
  s_mov_b32 s43, 0x20000
  v_cvt_pk_bf16_f32 v44, v44, v45
  v_cvt_pk_bf16_f32 v45, v46, v47
  v_cvt_pk_bf16_f32 v46, v48, v49
  v_cvt_pk_bf16_f32 v47, v50, v51
  v_cvt_pk_bf16_f32 v48, v52, v53
  v_cvt_pk_bf16_f32 v49, v54, v55
  v_cvt_pk_bf16_f32 v50, v56, v57
  v_cvt_pk_bf16_f32 v51, v58, v59
  v_cvt_pk_bf16_f32 v52, v60, v61
  v_cvt_pk_bf16_f32 v53, v62, v63
  v_cvt_pk_bf16_f32 v54, v64, v65
  v_cvt_pk_bf16_f32 v55, v66, v67
  s_xor_b32 s48, s52, 2
  s_mul_i32 s48, s48, 9216
  s_add_u32 s48, s48, 3072
  buffer_store_dwordx4 v[44:47], v1, s[56:59], s48 offen offset:0 sc1
  buffer_store_dwordx4 v[48:51], v1, s[56:59], s48 offen offset:1024 sc1
  buffer_store_dwordx4 v[52:55], v1, s[56:59], s48 offen offset:2048 sc1
  v_cvt_pk_bf16_f32 v68, v68, v69
  v_cvt_pk_bf16_f32 v69, v70, v71
  v_cvt_pk_bf16_f32 v70, v72, v73
  v_cvt_pk_bf16_f32 v71, v74, v75
  v_cvt_pk_bf16_f32 v72, v76, v77
  v_cvt_pk_bf16_f32 v73, v78, v79
  v_cvt_pk_bf16_f32 v74, v80, v81
  v_cvt_pk_bf16_f32 v75, v82, v83
  v_cvt_pk_bf16_f32 v76, v84, v85
  v_cvt_pk_bf16_f32 v77, v86, v87
  v_cvt_pk_bf16_f32 v78, v88, v89
  v_cvt_pk_bf16_f32 v79, v90, v91
  s_xor_b32 s48, s52, 1
  s_mul_i32 s48, s48, 9216
  s_add_u32 s48, s48, 0
  buffer_store_dwordx4 v[68:71], v1, s[56:59], s48 offen offset:0 sc1
  buffer_store_dwordx4 v[72:75], v1, s[56:59], s48 offen offset:1024 sc1
  buffer_store_dwordx4 v[76:79], v1, s[56:59], s48 offen offset:2048 sc1
  v_cvt_pk_bf16_f32 v92, v92, v93
  v_cvt_pk_bf16_f32 v93, v94, v95
  v_cvt_pk_bf16_f32 v94, v96, v97
  v_cvt_pk_bf16_f32 v95, v98, v99
  v_cvt_pk_bf16_f32 v96, v100, v101
  v_cvt_pk_bf16_f32 v97, v102, v103
  v_cvt_pk_bf16_f32 v98, v104, v105
  v_cvt_pk_bf16_f32 v99, v106, v107
  v_cvt_pk_bf16_f32 v100, v108, v109
  v_cvt_pk_bf16_f32 v101, v110, v111
  v_cvt_pk_bf16_f32 v102, v112, v113
  v_cvt_pk_bf16_f32 v103, v114, v115
  s_xor_b32 s48, s52, 3
  s_mul_i32 s48, s48, 9216
  s_add_u32 s48, s48, 6144
  buffer_store_dwordx4 v[92:95], v1, s[56:59], s48 offen offset:0 sc1
  buffer_store_dwordx4 v[96:99], v1, s[56:59], s48 offen offset:1024 sc1
  buffer_store_dwordx4 v[100:103], v1, s[56:59], s48 offen offset:2048 sc1
  v_lshlrev_b32 v2, 7, v0
  v_lshlrev_b32 v3, 9, v0
  s_lshl_b32 s48, s52, 7
  v_add_u32 v3, s48, v3
  v_mov_b32 v4, 0
  s_mul_i32 s49, s52, 9216
  s_waitcnt vmcnt(0)
  buffer_store_dword v4, v3, s[60:63], 0 offen sc1
  buffer_load_dwordx4 v[140:143], v1, s[40:43], 0 offen offset:0
  buffer_load_dwordx4 v[144:147], v1, s[40:43], 0 offen offset:1024
  buffer_load_dwordx4 v[148:151], v1, s[40:43], 0 offen offset:2048
  s_mov_b32 s48, 11520
  buffer_load_dwordx4 v[152:155], v19, s[24:27], s48 offen offset:0 sc1
  s_mov_b32 s48, 11520
  buffer_load_dwordx4 v[156:159], v19, s[24:27], s48 offen offset:64 sc1
  s_mov_b32 s48, 11520
  buffer_load_dwordx4 v[160:163], v19, s[24:27], s48 offen offset:128 sc1
  s_mov_b32 s48, 11520
  buffer_load_dwordx4 v[164:167], v19, s[24:27], s48 offen offset:192 sc1
  s_mov_b32 s48, 11520
  buffer_load_dwordx4 v[168:171], v19, s[24:27], s48 offen offset:256 sc1
  s_mov_b32 s48, 11520
  buffer_load_dwordx4 v[172:175], v19, s[24:27], s48 offen offset:320 sc1
k5_xp:
  buffer_load_dword v4, v2, s[60:63], 0 offen sc1
  s_waitcnt vmcnt(0)
  v_cmp_ne_u32 vcc, 0, v4
  s_nop 1
  s_cbranch_vccz k5_xg
  s_sleep 1
  s_branch k5_xp
k5_xg:
  s_add_u32 s48, s49, 0
  buffer_load_dwordx4 v[80:83], v1, s[56:59], s48 offen offset:0 sc1
  buffer_load_dwordx4 v[84:87], v1, s[56:59], s48 offen offset:1024 sc1
  buffer_load_dwordx4 v[88:91], v1, s[56:59], s48 offen offset:2048 sc1
  s_add_u32 s48, s49, 3072
  buffer_load_dwordx4 v[56:59], v1, s[56:59], s48 offen offset:0 sc1
  buffer_load_dwordx4 v[60:63], v1, s[56:59], s48 offen offset:1024 sc1
  buffer_load_dwordx4 v[64:67], v1, s[56:59], s48 offen offset:2048 sc1
  s_add_u32 s48, s49, 6144
  buffer_load_dwordx4 v[104:107], v1, s[56:59], s48 offen offset:0 sc1
  buffer_load_dwordx4 v[108:111], v1, s[56:59], s48 offen offset:1024 sc1
  buffer_load_dwordx4 v[112:115], v1, s[56:59], s48 offen offset:2048 sc1
  s_waitcnt vmcnt(6)
  v_lshlrev_b32 v4, 16, v80
  v_and_b32 v5, 0xffff0000, v80
  v_add_f32 v20, v20, v4
  v_add_f32 v21, v21, v5
  v_lshlrev_b32 v4, 16, v81
  v_and_b32 v5, 0xffff0000, v81
  v_add_f32 v22, v22, v4
  v_add_f32 v23, v23, v5
  v_lshlrev_b32 v4, 16, v82
  v_and_b32 v5, 0xffff0000, v82
  v_add_f32 v24, v24, v4
  v_add_f32 v25, v25, v5
  v_lshlrev_b32 v4, 16, v83
  v_and_b32 v5, 0xffff0000, v83
  v_add_f32 v26, v26, v4
  v_add_f32 v27, v27, v5
  v_lshlrev_b32 v4, 16, v84
  v_and_b32 v5, 0xffff0000, v84
  v_add_f32 v28, v28, v4
  v_add_f32 v29, v29, v5
  v_lshlrev_b32 v4, 16, v85
  v_and_b32 v5, 0xffff0000, v85
  v_add_f32 v30, v30, v4
  v_add_f32 v31, v31, v5
  v_lshlrev_b32 v4, 16, v86
  v_and_b32 v5, 0xffff0000, v86
  v_add_f32 v32, v32, v4
  v_add_f32 v33, v33, v5
  v_lshlrev_b32 v4, 16, v87
  v_and_b32 v5, 0xffff0000, v87
  v_add_f32 v34, v34, v4
  v_add_f32 v35, v35, v5
  v_lshlrev_b32 v4, 16, v88
  v_and_b32 v5, 0xffff0000, v88
  v_add_f32 v36, v36, v4
  v_add_f32 v37, v37, v5
  v_lshlrev_b32 v4, 16, v89
  v_and_b32 v5, 0xffff0000, v89
  v_add_f32 v38, v38, v4
  v_add_f32 v39, v39, v5
  v_lshlrev_b32 v4, 16, v90
  v_and_b32 v5, 0xffff0000, v90
  v_add_f32 v40, v40, v4
  v_add_f32 v41, v41, v5
  v_lshlrev_b32 v4, 16, v91
  v_and_b32 v5, 0xffff0000, v91
  v_add_f32 v42, v42, v4
  v_add_f32 v43, v43, v5
  s_waitcnt vmcnt(3)
  v_lshlrev_b32 v4, 16, v56
  v_and_b32 v5, 0xffff0000, v56
  v_add_f32 v20, v20, v4
  v_add_f32 v21, v21, v5
  v_lshlrev_b32 v4, 16, v57
  v_and_b32 v5, 0xffff0000, v57
  v_add_f32 v22, v22, v4
  v_add_f32 v23, v23, v5
  v_lshlrev_b32 v4, 16, v58
  v_and_b32 v5, 0xffff0000, v58
  v_add_f32 v24, v24, v4
  v_add_f32 v25, v25, v5
  v_lshlrev_b32 v4, 16, v59
  v_and_b32 v5, 0xffff0000, v59
  v_add_f32 v26, v26, v4
  v_add_f32 v27, v27, v5
  v_lshlrev_b32 v4, 16, v60
  v_and_b32 v5, 0xffff0000, v60
  v_add_f32 v28, v28, v4
  v_add_f32 v29, v29, v5
  v_lshlrev_b32 v4, 16, v61
  v_and_b32 v5, 0xffff0000, v61
  v_add_f32 v30, v30, v4
  v_add_f32 v31, v31, v5
  v_lshlrev_b32 v4, 16, v62
  v_and_b32 v5, 0xffff0000, v62
  v_add_f32 v32, v32, v4
  v_add_f32 v33, v33, v5
  v_lshlrev_b32 v4, 16, v63
  v_and_b32 v5, 0xffff0000, v63
  v_add_f32 v34, v34, v4
  v_add_f32 v35, v35, v5
  v_lshlrev_b32 v4, 16, v64
  v_and_b32 v5, 0xffff0000, v64
  v_add_f32 v36, v36, v4
  v_add_f32 v37, v37, v5
  v_lshlrev_b32 v4, 16, v65
  v_and_b32 v5, 0xffff0000, v65
  v_add_f32 v38, v38, v4
  v_add_f32 v39, v39, v5
  v_lshlrev_b32 v4, 16, v66
  v_and_b32 v5, 0xffff0000, v66
  v_add_f32 v40, v40, v4
  v_add_f32 v41, v41, v5
  v_lshlrev_b32 v4, 16, v67
  v_and_b32 v5, 0xffff0000, v67
  v_add_f32 v42, v42, v4
  v_add_f32 v43, v43, v5
  s_waitcnt vmcnt(0)
  v_lshlrev_b32 v4, 16, v104
  v_and_b32 v5, 0xffff0000, v104
  v_add_f32 v20, v20, v4
  v_add_f32 v21, v21, v5
  v_lshlrev_b32 v4, 16, v105
  v_and_b32 v5, 0xffff0000, v105
  v_add_f32 v22, v22, v4
  v_add_f32 v23, v23, v5
  v_lshlrev_b32 v4, 16, v106
  v_and_b32 v5, 0xffff0000, v106
  v_add_f32 v24, v24, v4
  v_add_f32 v25, v25, v5
  v_lshlrev_b32 v4, 16, v107
  v_and_b32 v5, 0xffff0000, v107
  v_add_f32 v26, v26, v4
  v_add_f32 v27, v27, v5
  v_lshlrev_b32 v4, 16, v108
  v_and_b32 v5, 0xffff0000, v108
  v_add_f32 v28, v28, v4
  v_add_f32 v29, v29, v5
  v_lshlrev_b32 v4, 16, v109
  v_and_b32 v5, 0xffff0000, v109
  v_add_f32 v30, v30, v4
  v_add_f32 v31, v31, v5
  v_lshlrev_b32 v4, 16, v110
  v_and_b32 v5, 0xffff0000, v110
  v_add_f32 v32, v32, v4
  v_add_f32 v33, v33, v5
  v_lshlrev_b32 v4, 16, v111
  v_and_b32 v5, 0xffff0000, v111
  v_add_f32 v34, v34, v4
  v_add_f32 v35, v35, v5
  v_lshlrev_b32 v4, 16, v112
  v_and_b32 v5, 0xffff0000, v112
  v_add_f32 v36, v36, v4
  v_add_f32 v37, v37, v5
  v_lshlrev_b32 v4, 16, v113
  v_and_b32 v5, 0xffff0000, v113
  v_add_f32 v38, v38, v4
  v_add_f32 v39, v39, v5
  v_lshlrev_b32 v4, 16, v114
  v_and_b32 v5, 0xffff0000, v114
  v_add_f32 v40, v40, v4
  v_add_f32 v41, v41, v5
  v_lshlrev_b32 v4, 16, v115
  v_and_b32 v5, 0xffff0000, v115
  v_add_f32 v42, v42, v4
  v_add_f32 v43, v43, v5
  v_lshlrev_b32 v4, 16, v140
  v_and_b32 v5, 0xffff0000, v140
  v_fmac_f32 v4, v20, v152
  v_fmac_f32 v5, v21, v153
  v_cvt_pk_bf16_f32 v116, v4, v5
  v_lshlrev_b32 v4, 16, v141
  v_and_b32 v5, 0xffff0000, v141
  v_fmac_f32 v4, v22, v154
  v_fmac_f32 v5, v23, v155
  v_cvt_pk_bf16_f32 v117, v4, v5
  buffer_store_dwordx2 v[116:117], v18, s[20:23], 0 offen offset:0
  v_lshlrev_b32 v4, 16, v142
  v_and_b32 v5, 0xffff0000, v142
  v_fmac_f32 v4, v24, v156
  v_fmac_f32 v5, v25, v157
  v_cvt_pk_bf16_f32 v118, v4, v5
  v_lshlrev_b32 v4, 16, v143
  v_and_b32 v5, 0xffff0000, v143
  v_fmac_f32 v4, v26, v158
  v_fmac_f32 v5, v27, v159
  v_cvt_pk_bf16_f32 v119, v4, v5
  buffer_store_dwordx2 v[118:119], v18, s[20:23], 0 offen offset:32
  v_lshlrev_b32 v4, 16, v144
  v_and_b32 v5, 0xffff0000, v144
  v_fmac_f32 v4, v28, v160
  v_fmac_f32 v5, v29, v161
  v_cvt_pk_bf16_f32 v120, v4, v5
  v_lshlrev_b32 v4, 16, v145
  v_and_b32 v5, 0xffff0000, v145
  v_fmac_f32 v4, v30, v162
  v_fmac_f32 v5, v31, v163
  v_cvt_pk_bf16_f32 v121, v4, v5
  buffer_store_dwordx2 v[120:121], v18, s[20:23], 0 offen offset:64
  v_lshlrev_b32 v4, 16, v146
  v_and_b32 v5, 0xffff0000, v146
  v_fmac_f32 v4, v32, v164
  v_fmac_f32 v5, v33, v165
  v_cvt_pk_bf16_f32 v122, v4, v5
  v_lshlrev_b32 v4, 16, v147
  v_and_b32 v5, 0xffff0000, v147
  v_fmac_f32 v4, v34, v166
  v_fmac_f32 v5, v35, v167
  v_cvt_pk_bf16_f32 v123, v4, v5
  buffer_store_dwordx2 v[122:123], v18, s[20:23], 0 offen offset:96
  v_lshlrev_b32 v4, 16, v148
  v_and_b32 v5, 0xffff0000, v148
  v_fmac_f32 v4, v36, v168
  v_fmac_f32 v5, v37, v169
  v_cvt_pk_bf16_f32 v124, v4, v5
  v_lshlrev_b32 v4, 16, v149
  v_and_b32 v5, 0xffff0000, v149
  v_fmac_f32 v4, v38, v170
  v_fmac_f32 v5, v39, v171
  v_cvt_pk_bf16_f32 v125, v4, v5
  buffer_store_dwordx2 v[124:125], v18, s[20:23], 0 offen offset:128
  v_lshlrev_b32 v4, 16, v150
  v_and_b32 v5, 0xffff0000, v150
  v_fmac_f32 v4, v40, v172
  v_fmac_f32 v5, v41, v173
  v_cvt_pk_bf16_f32 v126, v4, v5
  v_lshlrev_b32 v4, 16, v151
  v_and_b32 v5, 0xffff0000, v151
  v_fmac_f32 v4, v42, v174
  v_fmac_f32 v5, v43, v175
  v_cvt_pk_bf16_f32 v127, v4, v5
  buffer_store_dwordx2 v[126:127], v18, s[20:23], 0 offen offset:160
k3_end:
k4_end:
k5_end:
  s_endpgm
.section .rodata,"a"
.p2align 6
.amdhsa_kernel k1_kernel
  .amdhsa_next_free_vgpr 256
  .amdhsa_next_free_sgpr 100
  .amdhsa_accum_offset 256
  .amdhsa_group_segment_fixed_size 0
  .amdhsa_kernarg_size 120
  .amdhsa_user_sgpr_count 2
  .amdhsa_user_sgpr_kernarg_segment_ptr 1
  .amdhsa_system_sgpr_workgroup_id_x 1
.end_amdhsa_kernel
.p2align 6
.amdhsa_kernel k3_kernel
  .amdhsa_next_free_vgpr 256
  .amdhsa_next_free_sgpr 100
  .amdhsa_accum_offset 256
  .amdhsa_group_segment_fixed_size 0
  .amdhsa_kernarg_size 120
  .amdhsa_user_sgpr_count 2
  .amdhsa_user_sgpr_kernarg_segment_ptr 1
  .amdhsa_system_sgpr_workgroup_id_x 1
.end_amdhsa_kernel
```
